```python
import torch

def _softmax(x, axis=-1):
    return torch.softmax(x, dim=axis)
def _gelu(x):
    return torch.nn.functional.gelu(x, approximate="tanh")
def _silu(x):
    return torch.nn.functional.silu(x)
def _sigmoid(x):
    return torch.sigmoid(x)
def _layernorm(x, axis=-1, eps=1e-5):
    m = x.mean(dim=axis, keepdim=True)
    v = x.var(dim=axis, keepdim=True, unbiased=False)
    return (x - m) / torch.sqrt(v + eps)
def _scatter_add(tgt, idx, src, axis=0):
    return tgt.clone().index_add_(axis, idx, src)
def _segment_sum(src, seg, n):
    out = torch.zeros((n,) + src.shape[1:], dtype=src.dtype)
    return out.index_add_(0, seg, src)
def _pad(x, pw):
    flat = tuple(v for pair in reversed(pw) for v in pair)
    return torch.nn.functional.pad(x, flat)

kernel_name = 'concat_heads__mha_block_cached__gqa_block_cached__near_ridge'

def setup_inputs():

    _w = (lambda a: (lambda t: t.to(torch.bfloat16) if t.is_floating_point() else t)(torch.as_tensor(a)))
    def _A_setup():
        B, Sq, D = 8, 144, 1024
        H, Sk, Dh = 32, 1024, 128
        return {
            "x": _w((lambda *s: torch.randn(*s, dtype=torch.bfloat16) * 0.8)(B, Sq, D)),
            "k_cache": _w((lambda *s: torch.randn(*s, dtype=torch.bfloat16) * 0.8)(B, H, Sk, Dh)),
            "v_cache": _w((lambda *s: torch.randn(*s, dtype=torch.bfloat16) * 0.05)(B, H, Sk, Dh)),
            "wq": _w((lambda *s: torch.randn(*s, dtype=torch.bfloat16) * 0.8)(D, H * Dh) * (D ** -0.5)),
            "wo": _w((lambda *s: torch.randn(*s, dtype=torch.bfloat16) * 0.05)(H * Dh, D) * ((H * Dh) ** -0.5)),
        }
    _A_in = _A_setup()

    def _B_setup():
        B, Sq, D = 8, 144, 1024
        Hq, Hkv, Sk, Dh = 32, 32, 1024, 128
        assert Hq % Hkv == 0, (Hq, Hkv)
        return {
            "x": _w((lambda *s: torch.randn(*s, dtype=torch.bfloat16) * 0.8)(B, Sq, D)),
            "k_cache": _w((lambda *s: torch.randn(*s, dtype=torch.bfloat16) * 0.8)(B, Hkv, Sk, Dh)),
            "v_cache": _w((lambda *s: torch.randn(*s, dtype=torch.bfloat16) * 0.05)(B, Hkv, Sk, Dh)),
            "wq": _w((lambda *s: torch.randn(*s, dtype=torch.bfloat16) * 0.8)(D, Hq * Dh) * (D ** -0.5)),
            "wo": _w((lambda *s: torch.randn(*s, dtype=torch.bfloat16) * 0.05)(Hq * Dh, D) * ((Hq * Dh) ** -0.5)),
        }
    _B_in = _B_setup()

    return {
        "A_x": _A_in["x"],
        "A_k_cache": _A_in["k_cache"],
        "A_v_cache": _A_in["v_cache"],
        "A_wq": _A_in["wq"],
        "A_wo": _A_in["wo"],
        "B_x": _B_in["x"],
        "B_k_cache": _B_in["k_cache"],
        "B_v_cache": _B_in["v_cache"],
        "B_wq": _B_in["wq"],
        "B_wo": _B_in["wo"],
    }

def reference(A_x, A_k_cache, A_v_cache, A_wq, A_wo, B_x, B_k_cache, B_v_cache, B_wq, B_wo):
    def _A_ref(x, k_cache, v_cache, wq, wo):
        B, Sq, D = x.shape
        H, Dh = 32, 128
        q = (lambda x, *d: x.permute(*d))((x @ wq).reshape(B, Sq, H, Dh), 0, 2, 1, 3)
        scores = torch.einsum("bhqd,bhkd->bhqk", q, k_cache) * (Dh ** -0.5)
        p = _softmax(scores, axis=-1)
        o = torch.einsum("bhqk,bhkd->bhqd", p, v_cache)
        return (lambda x, *d: x.permute(*d))(o, 0, 2, 1, 3).reshape(B, Sq, H * Dh) @ wo

    def _B_ref(x, k_cache, v_cache, wq, wo):
        B, Sq, D = x.shape
        Hq, Dh = 32, 128
        Hkv = k_cache.shape[1]
        rep = Hq // Hkv
        q = (lambda x, *d: x.permute(*d))((x @ wq).reshape(B, Sq, Hq, Dh), 0, 2, 1, 3)
        k = (lambda x, n, axis: torch.repeat_interleave(x, n, dim=axis))(k_cache, rep, axis=1)
        v = (lambda x, n, axis: torch.repeat_interleave(x, n, dim=axis))(v_cache, rep, axis=1)
        scores = torch.einsum("bhqd,bhkd->bhqk", q, k) * (Dh ** -0.5)
        p = _softmax(scores, axis=-1)
        o = torch.einsum("bhqk,bhkd->bhqd", p, v)
        return (lambda x, *d: x.permute(*d))(o, 0, 2, 1, 3).reshape(B, Sq, Hq * Dh) @ wo

    a = _A_ref(A_x, A_k_cache, A_v_cache, A_wq, A_wo)
    b = _B_ref(B_x, B_k_cache, B_v_cache, B_wq, B_wo)
    return torch.concatenate([a, b], axis=-1)
```

```asm
; @launch kernel=fa_kernel grid=(256,1,1) block=(256,1,1) lds=163840
; @launch kernel=oproj_kernel grid=(256,1,1) block=(256,1,1) lds=131072
.amdgcn_target "amdgcn-amd-amdhsa--gfx950"
.text
.p2align 8
.globl fa_kernel
.type fa_kernel,@function
fa_kernel:
  s_cmp_ge_u32 s2, 256
  s_cbranch_scc1 fa_kernel_done
  s_and_b32 s39, s2, 7
  s_lshr_b32 s40, s2, 3
  s_lshr_b32 s27, s39, 2
  s_and_b32 s39, s39, 3
  s_and_b32 s28, s40, 7
  s_lshr_b32 s40, s40, 3
  s_mov_b32 s74, s40
  s_lshl_b32 s39, s39, 3
  s_lshl_b32 s40, s40, 1
  s_add_u32 s29, s39, s40
  s_mul_i32 s39, s27, 40
  s_add_u32 s60, s0, s39
  s_addc_u32 s61, s1, 0
  s_load_dwordx2 s[4:5], s[60:61], 0
  s_load_dwordx2 s[62:63], s[60:61], 8
  s_load_dwordx2 s[64:65], s[60:61], 16
  s_load_dwordx2 s[66:67], s[60:61], 24
  s_load_dwordx2 s[68:69], s[0:1], 96
  s_load_dwordx2 s[76:77], s[60:61], 32
  v_lshrrev_b32 v2, 6, v0
  v_and_b32 v1, 63, v0
  v_readfirstlane_b32 s24, v2
  s_nop 0
  s_and_b32 s25, s24, 1
  s_lshr_b32 s26, s24, 1
  v_lshrrev_b32 v2, 4, v1
  v_and_b32 v3, 15, v1
  v_xor_b32 v4, v3, v2
  v_lshlrev_b32 v5, 2, v2
  v_xor_b32 v5, v3, v5
  v_lshlrev_b32 v4, 4, v4
  v_lshlrev_b32 v5, 4, v5
  v_lshlrev_b32 v2, 8, v2
  v_add_u32 v17, v4, v2
  v_add_u32 v18, v5, v2
  s_cmp_eq_u32 s25, 0
  s_cselect_b32 s39, 64, 16
  s_cselect_b64 vcc, -1, 0
  v_cndmask_b32 v10, v18, v17, vcc
  v_xor_b32 v11, s39, v10
  s_lshl_b32 s40, s39, 1
  v_xor_b32 v12, s40, v10
  s_add_u32 s40, s40, s39
  v_xor_b32 v13, s40, v10
  v_add_u32 v248, 4096, v10
  v_add_u32 v249, 4096, v11
  v_add_u32 v250, 4096, v12
  v_add_u32 v251, 4096, v13
  v_lshrrev_b32 v2, 1, v1
  v_lshlrev_b32 v2, 13, v2
  v_and_b32 v3, 1, v1
  v_lshlrev_b32 v3, 7, v3
  v_add_u32 v14, v2, v3
  v_lshrrev_b32 v2, 4, v1
  v_lshlrev_b32 v2, 11, v2
  v_and_b32 v3, 15, v1
  v_lshlrev_b32 v3, 7, v3
  v_add_u32 v15, v2, v3
  v_and_b32 v3, 15, v1
  v_lshrrev_b32 v2, 4, v1
  v_xor_b32 v4, v2, v3
  v_lshlrev_b32 v4, 4, v4
  v_lshlrev_b32 v5, 8, v3
  s_lshl_b32 s39, s26, 14
  v_add_u32 v5, s39, v5
  v_xor_b32 v6, 0, v4
  v_add_u32 v20, v5, v6
  v_xor_b32 v6, 64, v4
  v_add_u32 v21, v5, v6
  v_xor_b32 v6, 128, v4
  v_add_u32 v22, v5, v6
  v_xor_b32 v6, 192, v4
  v_add_u32 v23, v5, v6
  v_lshrrev_b32 v3, 2, v1
  v_and_b32 v3, 3, v3
  v_and_b32 v4, 3, v1
  v_xor_b32 v4, v4, v2
  v_lshlrev_b32 v4, 4, v4
  v_lshlrev_b32 v5, 6, v3
  v_add_u32 v4, v4, v5
  v_lshlrev_b32 v5, 2, v2
  v_add_u32 v5, v5, v3
  v_lshlrev_b32 v5, 8, v5
  s_lshl_b32 s39, s26, 14
  s_add_u32 s39, s39, 8192
  v_add_u32 v5, s39, v5
  s_lshl_b32 s39, s26, 1
  s_add_u32 s39, s39, 0
  s_and_b32 s39, s39, 3
  s_lshl_b32 s39, s39, 6
  v_xor_b32 v6, s39, v4
  v_add_u32 v24, v5, v6
  s_lshl_b32 s39, s26, 1
  s_add_u32 s39, s39, 1
  s_and_b32 s39, s39, 3
  s_lshl_b32 s39, s39, 6
  v_xor_b32 v6, s39, v4
  v_add_u32 v25, v5, v6
  s_lshl_b32 s39, s26, 1
  s_add_u32 s39, s39, 2
  s_and_b32 s39, s39, 3
  s_lshl_b32 s39, s39, 6
  v_xor_b32 v6, s39, v4
  v_add_u32 v26, v5, v6
  s_lshl_b32 s39, s26, 1
  s_add_u32 s39, s39, 3
  s_and_b32 s39, s39, 3
  s_lshl_b32 s39, s39, 6
  v_xor_b32 v6, s39, v4
  v_add_u32 v27, v5, v6
  v_mov_b32 v52, 0x3f803f80
  v_mov_b32 v53, 0x3f803f80
  v_mov_b32 v54, 0x3f803f80
  v_mov_b32 v55, 0x3f803f80
  v_lshrrev_b32 v2, 3, v1
  v_and_b32 v3, 7, v1
  v_lshrrev_b32 v4, 4, v1
  v_xor_b32 v3, v3, v4
  v_lshlrev_b32 v3, 4, v3
  v_lshlrev_b32 v2, 11, v2
  v_add_u32 v2, v2, v3
  s_mul_i32 s39, s24, 5
  s_add_u32 s39, s39, 0
  s_cmp_gt_u32 s39, 17
  s_cselect_b32 s40, 2, 0
  s_sub_u32 s39, s39, s40
  s_lshl_b32 s96, s39, 10
  s_and_b32 s40, s39, 1
  s_lshl_b32 s40, s40, 6
  v_xor_b32 v3, s40, v2
  s_lshl_b32 s39, s39, 14
  v_add_u32 v106, s39, v3
  s_mul_i32 s39, s24, 5
  s_add_u32 s39, s39, 1
  s_cmp_gt_u32 s39, 17
  s_cselect_b32 s40, 2, 0
  s_sub_u32 s39, s39, s40
  s_lshl_b32 s97, s39, 10
  s_and_b32 s40, s39, 1
  s_lshl_b32 s40, s40, 6
  v_xor_b32 v3, s40, v2
  s_lshl_b32 s39, s39, 14
  v_add_u32 v107, s39, v3
  s_mul_i32 s39, s24, 5
  s_add_u32 s39, s39, 2
  s_cmp_gt_u32 s39, 17
  s_cselect_b32 s40, 2, 0
  s_sub_u32 s39, s39, s40
  s_lshl_b32 s98, s39, 10
  s_and_b32 s40, s39, 1
  s_lshl_b32 s40, s40, 6
  v_xor_b32 v3, s40, v2
  s_lshl_b32 s39, s39, 14
  v_add_u32 v108, s39, v3
  s_mul_i32 s39, s24, 5
  s_add_u32 s39, s39, 3
  s_cmp_gt_u32 s39, 17
  s_cselect_b32 s40, 2, 0
  s_sub_u32 s39, s39, s40
  s_lshl_b32 s99, s39, 10
  s_and_b32 s40, s39, 1
  s_lshl_b32 s40, s40, 6
  v_xor_b32 v3, s40, v2
  s_lshl_b32 s39, s39, 14
  v_add_u32 v109, s39, v3
  s_mul_i32 s39, s24, 5
  s_add_u32 s39, s39, 4
  s_cmp_gt_u32 s39, 17
  s_cselect_b32 s40, 2, 0
  s_sub_u32 s39, s39, s40
  s_lshl_b32 s100, s39, 10
  s_and_b32 s40, s39, 1
  s_lshl_b32 s40, s40, 6
  v_xor_b32 v3, s40, v2
  s_lshl_b32 s39, s39, 14
  v_add_u32 v110, s39, v3
  v_lshrrev_b32 v2, 4, v1
  v_and_b32 v3, 15, v1
  v_lshlrev_b32 v4, 2, v2
  v_xor_b32 v3, v3, v4
  v_xor_b32 v3, s24, v3
  v_lshlrev_b32 v3, 4, v3
  v_lshlrev_b32 v4, 13, v2
  v_add_u32 v3, v3, v4
  s_lshl_b32 s39, s24, 16
  v_add_u32 v98, s39, v3
  v_add_u32 v99, 32768, v98
  v_and_b32 v3, 15, v1
  v_lshrrev_b32 v4, 1, v3
  v_xor_b32 v4, v4, v2
  v_lshlrev_b32 v4, 4, v4
  v_lshlrev_b32 v5, 7, v3
  v_xor_b32 v6, 64, v4
  v_add_u32 v4, v4, v5
  v_add_u32 v6, v6, v5
  s_lshl_b32 s39, s25, 13
  s_add_u32 s39, s39, 98304
  v_add_u32 v100, s39, v4
  v_add_u32 v101, s39, v6
  v_add_u32 v102, 114688, v4
  v_add_u32 v103, 114688, v6
  v_lshrrev_b32 v3, 2, v1
  v_and_b32 v3, 3, v3
  v_and_b32 v4, 3, v1
  v_xor_b32 v4, v4, v2
  v_lshlrev_b32 v4, 4, v4
  v_lshlrev_b32 v5, 6, v3
  v_add_u32 v4, v4, v5
  v_lshlrev_b32 v5, 3, v2
  v_add_u32 v5, v5, v3
  v_lshlrev_b32 v5, 8, v5
  s_xor_b32 s39, s25, 0
  s_lshl_b32 s40, s26, 1
  s_add_u32 s39, s39, s40
  s_lshl_b32 s39, s39, 6
  v_xor_b32 v6, s39, v4
  v_add_u32 v104, v5, v6
  s_xor_b32 s39, s25, 1
  s_lshl_b32 s40, s26, 1
  s_add_u32 s39, s39, s40
  s_lshl_b32 s39, s39, 6
  v_xor_b32 v6, s39, v4
  v_add_u32 v105, v5, v6
  v_accvgpr_write_b32 a240, v98
  v_accvgpr_write_b32 a241, v99
  v_accvgpr_write_b32 a242, v100
  v_accvgpr_write_b32 a243, v101
  v_accvgpr_write_b32 a244, v102
  v_accvgpr_write_b32 a245, v103
  v_accvgpr_write_b32 a246, v104
  v_accvgpr_write_b32 a247, v105
  v_accvgpr_write_b32 a248, v106
  v_accvgpr_write_b32 a249, v107
  v_accvgpr_write_b32 a250, v108
  v_accvgpr_write_b32 a251, v109
  v_accvgpr_write_b32 a252, v110
  s_lshl_b32 s101, s24, 11
  s_waitcnt lgkmcnt(0)
  s_cmp_eq_u32 s25, 0
  s_cselect_b32 s8, s62, s64
  s_cselect_b32 s9, s63, s65
  s_lshl_b32 s39, s28, 5
  s_add_u32 s39, s39, s29
  s_lshr_b32 s40, s39, 14
  s_lshl_b32 s39, s39, 18
  s_and_b32 s39, s39, -1
  s_add_u32 s8, s8, s39
  s_addc_u32 s9, s9, s40
  s_lshl_b32 s39, s26, 13
  s_add_u32 s8, s8, s39
  s_addc_u32 s9, s9, 0
  s_and_b32 s9, s9, 0xffff
  s_sub_u32 s10, 524288, s39
  s_mov_b32 s11, 0x20000
  s_mul_i32 s39, s28, 294912
  s_add_u32 s12, s4, s39
  s_addc_u32 s13, s5, 0
  s_and_b32 s13, s13, 0xffff
  s_mov_b32 s14, 294912
  s_mov_b32 s15, 0x20000
  s_lshl_b32 s39, s29, 8
  s_add_u32 s16, s66, s39
  s_addc_u32 s17, s67, 0
  s_and_b32 s17, s17, 0xffff
  s_sub_u32 s18, 8388608, s39
  s_mov_b32 s19, 0x20000
  s_lshl_b32 s39, s27, 3
  s_add_u32 s39, s39, s28
  s_lshl_b32 s39, s39, 5
  s_add_u32 s39, s39, s29
  s_mul_i32 s39, s39, 36864
  s_add_u32 s20, s68, s39
  s_addc_u32 s21, s69, 0
  s_add_u32 s20, s20, 0
  s_addc_u32 s21, s21, 0
  s_and_b32 s21, s21, 0xffff
  s_mov_b32 s22, 73728
  s_mov_b32 s23, 0x20000
  s_lshl_b32 s42, s24, 13
  s_add_u32 s31, s42, 32768
  s_add_u32 s30, s42, 98304
  s_mov_b32 s41, 0
  s_mov_b32 s32, 32768
  s_mov_b32 s58, 0
  s_mov_b32 s70, 0
  s_mov_b32 s52, 1
  s_lshl_b32 s39, s28, 5
  s_add_u32 s39, s39, s29
  s_lshl_b32 s66, s39, 18
  s_mov_b32 s67, 0
  s_lshr_b32 s39, s29, 3
  s_lshl_b32 s39, s39, 5
  s_lshr_b32 s40, s2, 3
  s_add_u32 s39, s39, s40
  s_lshl_b32 s39, s39, 16
  s_add_u32 s76, s76, s39
  s_addc_u32 s77, s77, 0
  s_and_b32 s77, s77, 0xffff
  s_mov_b32 s78, 65536
  s_mov_b32 s79, 0x20000
  v_lshlrev_b32 v19, 7, v1
  s_mov_b32 s71, 0
  s_xor_b32 s52, s71, 1
  s_mov_b32 s44, 0
  s_mov_b32 s45, 0
  s_mov_b32 s53, s10
  s_mov_b32 s70, 0
fa_kernel_qpL:
  v_mov_b32 v116, 0
  v_mov_b32 v117, 0
  v_mov_b32 v118, 0
  v_mov_b32 v119, 0
  v_accvgpr_read_b32 v98, a240
  v_accvgpr_read_b32 v99, a241
  v_accvgpr_read_b32 v100, a242
  v_accvgpr_read_b32 v101, a243
  v_accvgpr_read_b32 v102, a244
  v_accvgpr_read_b32 v103, a245
  v_accvgpr_read_b32 v104, a246
  v_accvgpr_read_b32 v105, a247
  v_accvgpr_read_b32 v106, a248
  v_accvgpr_read_b32 v107, a249
  v_accvgpr_read_b32 v108, a250
  v_accvgpr_read_b32 v109, a251
  v_accvgpr_read_b32 v110, a252
  v_add_u32 v96, 256, v98
  v_add_u32 v97, 256, v99
  v_add_u32 v112, 65536, v104
  v_add_u32 v113, 65536, v105
  s_mov_b32 s47, 0
  s_mov_b32 s46, 0
  s_waitcnt vmcnt(0)
  s_barrier
  s_add_u32 m0, s96, 98304
  s_nop 0
  buffer_load_dwordx4 v106, s[12:15], s46 offen lds
  s_add_u32 m0, s97, 98304
  s_nop 0
  buffer_load_dwordx4 v107, s[12:15], s46 offen lds
  s_add_u32 m0, s98, 98304
  s_nop 0
  buffer_load_dwordx4 v108, s[12:15], s46 offen lds
  s_add_u32 m0, s99, 98304
  s_nop 0
  buffer_load_dwordx4 v109, s[12:15], s46 offen lds
  s_add_u32 m0, s100, 98304
  s_nop 0
  buffer_load_dwordx4 v110, s[12:15], s46 offen lds
  s_add_u32 s46, s46, 128
  s_add_u32 m0, s101, 0
  s_nop 0
  buffer_load_dwordx4 v98, s[16:19], s47 offen nt lds
  s_add_u32 m0, s101, 1024
  s_nop 0
  buffer_load_dwordx4 v99, s[16:19], s47 offen nt lds
  s_add_u32 m0, s101, 8192
  s_nop 0
  buffer_load_dwordx4 v96, s[16:19], s47 offen nt lds
  s_add_u32 m0, s101, 9216
  s_nop 0
  buffer_load_dwordx4 v97, s[16:19], s47 offen nt lds
  s_add_u32 s47, s47, 262144
  s_add_u32 m0, s101, 16384
  s_nop 0
  buffer_load_dwordx4 v98, s[16:19], s47 offen nt lds
  s_add_u32 m0, s101, 17408
  s_nop 0
  buffer_load_dwordx4 v99, s[16:19], s47 offen nt lds
  s_add_u32 m0, s101, 24576
  s_nop 0
  buffer_load_dwordx4 v96, s[16:19], s47 offen nt lds
  s_add_u32 m0, s101, 25600
  s_nop 0
  buffer_load_dwordx4 v97, s[16:19], s47 offen nt lds
  s_add_u32 s47, s47, 262144
  s_add_u32 m0, s96, 116736
  s_nop 0
  buffer_load_dwordx4 v106, s[12:15], s46 offen lds
  s_add_u32 m0, s97, 116736
  s_nop 0
  buffer_load_dwordx4 v107, s[12:15], s46 offen lds
  s_add_u32 m0, s98, 116736
  s_nop 0
  buffer_load_dwordx4 v108, s[12:15], s46 offen lds
  s_add_u32 m0, s99, 116736
  s_nop 0
  buffer_load_dwordx4 v109, s[12:15], s46 offen lds
  s_add_u32 m0, s100, 116736
  s_nop 0
  buffer_load_dwordx4 v110, s[12:15], s46 offen lds
  s_add_u32 s46, s46, 128
  v_mfma_f32_16x16x32_bf16 a[0:3], v[116:119], v[116:119], 0
  v_mfma_f32_16x16x32_bf16 a[4:7], v[116:119], v[116:119], 0
  v_mfma_f32_16x16x32_bf16 a[8:11], v[116:119], v[116:119], 0
  v_mfma_f32_16x16x32_bf16 a[12:15], v[116:119], v[116:119], 0
  v_mfma_f32_16x16x32_bf16 a[16:19], v[116:119], v[116:119], 0
  v_mfma_f32_16x16x32_bf16 a[20:23], v[116:119], v[116:119], 0
  v_mfma_f32_16x16x32_bf16 a[24:27], v[116:119], v[116:119], 0
  v_mfma_f32_16x16x32_bf16 a[28:31], v[116:119], v[116:119], 0
  v_mfma_f32_16x16x32_bf16 a[32:35], v[116:119], v[116:119], 0
  v_mfma_f32_16x16x32_bf16 a[36:39], v[116:119], v[116:119], 0
  v_mfma_f32_16x16x32_bf16 a[40:43], v[116:119], v[116:119], 0
  v_mfma_f32_16x16x32_bf16 a[44:47], v[116:119], v[116:119], 0
  v_mfma_f32_16x16x32_bf16 a[48:51], v[116:119], v[116:119], 0
  v_mfma_f32_16x16x32_bf16 a[52:55], v[116:119], v[116:119], 0
  v_mfma_f32_16x16x32_bf16 a[56:59], v[116:119], v[116:119], 0
  v_mfma_f32_16x16x32_bf16 a[60:63], v[116:119], v[116:119], 0
  v_mfma_f32_16x16x32_bf16 a[64:67], v[116:119], v[116:119], 0
  v_mfma_f32_16x16x32_bf16 a[68:71], v[116:119], v[116:119], 0
  v_mfma_f32_16x16x32_bf16 a[72:75], v[116:119], v[116:119], 0
  v_mfma_f32_16x16x32_bf16 a[76:79], v[116:119], v[116:119], 0
  v_mfma_f32_16x16x32_bf16 a[80:83], v[116:119], v[116:119], 0
  v_mfma_f32_16x16x32_bf16 a[84:87], v[116:119], v[116:119], 0
  v_mfma_f32_16x16x32_bf16 a[88:91], v[116:119], v[116:119], 0
  v_mfma_f32_16x16x32_bf16 a[92:95], v[116:119], v[116:119], 0
  v_mfma_f32_16x16x32_bf16 a[96:99], v[116:119], v[116:119], 0
  v_mfma_f32_16x16x32_bf16 a[100:103], v[116:119], v[116:119], 0
  v_mfma_f32_16x16x32_bf16 a[104:107], v[116:119], v[116:119], 0
  v_mfma_f32_16x16x32_bf16 a[108:111], v[116:119], v[116:119], 0
  v_mfma_f32_16x16x32_bf16 a[112:115], v[116:119], v[116:119], 0
  v_mfma_f32_16x16x32_bf16 a[116:119], v[116:119], v[116:119], 0
  v_mfma_f32_16x16x32_bf16 a[120:123], v[116:119], v[116:119], 0
  v_mfma_f32_16x16x32_bf16 a[124:127], v[116:119], v[116:119], 0
  v_mfma_f32_16x16x32_bf16 a[128:131], v[116:119], v[116:119], 0
  v_mfma_f32_16x16x32_bf16 a[132:135], v[116:119], v[116:119], 0
  v_mfma_f32_16x16x32_bf16 a[136:139], v[116:119], v[116:119], 0
  v_mfma_f32_16x16x32_bf16 a[140:143], v[116:119], v[116:119], 0
  s_add_u32 m0, s101, 32768
  s_nop 0
  buffer_load_dwordx4 v98, s[16:19], s47 offen nt lds
  s_add_u32 m0, s101, 33792
  s_nop 0
  buffer_load_dwordx4 v99, s[16:19], s47 offen nt lds
  s_add_u32 m0, s101, 40960
  s_nop 0
  buffer_load_dwordx4 v96, s[16:19], s47 offen nt lds
  s_add_u32 m0, s101, 41984
  s_nop 0
  buffer_load_dwordx4 v97, s[16:19], s47 offen nt lds
  s_add_u32 s47, s47, 262144
  s_add_u32 m0, s101, 49152
  s_nop 0
  buffer_load_dwordx4 v98, s[16:19], s47 offen nt lds
  s_add_u32 m0, s101, 50176
  s_nop 0
  buffer_load_dwordx4 v99, s[16:19], s47 offen nt lds
  s_add_u32 m0, s101, 57344
  s_nop 0
  buffer_load_dwordx4 v96, s[16:19], s47 offen nt lds
  s_add_u32 m0, s101, 58368
  s_nop 0
  buffer_load_dwordx4 v97, s[16:19], s47 offen nt lds
  s_add_u32 s47, s47, 262144
  s_add_u32 m0, s96, 135168
  s_nop 0
  buffer_load_dwordx4 v106, s[12:15], s46 offen lds
  s_add_u32 m0, s97, 135168
  s_nop 0
  buffer_load_dwordx4 v107, s[12:15], s46 offen lds
  s_add_u32 m0, s98, 135168
  s_nop 0
  buffer_load_dwordx4 v108, s[12:15], s46 offen lds
  s_add_u32 m0, s99, 135168
  s_nop 0
  buffer_load_dwordx4 v109, s[12:15], s46 offen lds
  s_add_u32 m0, s100, 135168
  s_nop 0
  buffer_load_dwordx4 v110, s[12:15], s46 offen lds
  s_add_u32 s46, s46, 128
  s_add_u32 m0, s101, 65536
  s_nop 0
  buffer_load_dwordx4 v98, s[16:19], s47 offen nt lds
  s_add_u32 m0, s101, 66560
  s_nop 0
  buffer_load_dwordx4 v99, s[16:19], s47 offen nt lds
  s_add_u32 m0, s101, 73728
  s_nop 0
  buffer_load_dwordx4 v96, s[16:19], s47 offen nt lds
  s_add_u32 m0, s101, 74752
  s_nop 0
  buffer_load_dwordx4 v97, s[16:19], s47 offen nt lds
  s_add_u32 s47, s47, 262144
  s_add_u32 m0, s101, 81920
  s_nop 0
  buffer_load_dwordx4 v98, s[16:19], s47 offen nt lds
  s_add_u32 m0, s101, 82944
  s_nop 0
  buffer_load_dwordx4 v99, s[16:19], s47 offen nt lds
  s_add_u32 m0, s101, 90112
  s_nop 0
  buffer_load_dwordx4 v96, s[16:19], s47 offen nt lds
  s_add_u32 m0, s101, 91136
  s_nop 0
  buffer_load_dwordx4 v97, s[16:19], s47 offen nt lds
  s_add_u32 s47, s47, 262144
  s_waitcnt vmcnt(30)
  s_barrier
  ds_read_b64_tr_b16 v[120:121], v104 offset:0
  ds_read_b64_tr_b16 v[122:123], v104 offset:1024
  ds_read_b64_tr_b16 v[124:125], v104 offset:8
  ds_read_b64_tr_b16 v[126:127], v104 offset:1032
  ds_read_b64_tr_b16 v[128:129], v105 offset:0
  ds_read_b64_tr_b16 v[130:131], v105 offset:1024
  ds_read_b64_tr_b16 v[132:133], v105 offset:8
  ds_read_b64_tr_b16 v[134:135], v105 offset:1032
  ds_read_b128 v[152:155], v100 offset:0
  ds_read_b128 v[156:159], v100 offset:2048
  ds_read_b128 v[160:163], v100 offset:4096
  ds_read_b128 v[164:167], v100 offset:6144
  ds_read_b128 v[168:171], v102 offset:0
  ds_read_b64_tr_b16 v[136:137], v104 offset:8192
  ds_read_b64_tr_b16 v[138:139], v104 offset:9216
  s_waitcnt lgkmcnt(14)
  ds_read_b64_tr_b16 v[140:141], v104 offset:8200
  s_waitcnt lgkmcnt(14)
  ds_read_b64_tr_b16 v[142:143], v104 offset:9224
  s_waitcnt lgkmcnt(14)
  ds_read_b64_tr_b16 v[144:145], v105 offset:8192
  s_waitcnt lgkmcnt(14)
  ds_read_b64_tr_b16 v[146:147], v105 offset:9216
  s_waitcnt lgkmcnt(14)
  ds_read_b64_tr_b16 v[148:149], v105 offset:8200
  s_waitcnt lgkmcnt(14)
  ds_read_b64_tr_b16 v[150:151], v105 offset:9224
  s_cmp_ge_u32 s24, 3
  s_cbranch_scc1 fa_kernel_ncpa
  s_getpc_b64 s[60:61]
fa_kernel_cpa:
  s_add_u32 s60, s60, fa_kernel_hot0-fa_kernel_cpa
  s_addc_u32 s61, s61, 0
  s_lshl_b32 s39, s24, 13
  v_add_u32 v2, s39, v19
  s_mov_b32 s39, fa_kernel_done-fa_kernel_hot0
  v_cmp_gt_u32 vcc, s39, v2
  s_nop 0
  s_and_saveexec_b64 s[72:73], vcc
  s_cbranch_execz fa_kernel_rcpa
  global_load_dword v16, v2, s[60:61]
fa_kernel_rcpa:
  s_mov_b64 exec, s[72:73]
fa_kernel_ncpa:
  s_waitcnt lgkmcnt(0)
  s_mov_b32 s33, 4
fa_kernel_qpx:
  s_waitcnt vmcnt(26) lgkmcnt(0)
  s_barrier
  v_mfma_f32_16x16x32_bf16 a[0:3], v[120:123], v[152:155], a[0:3]
  ds_read_b64_tr_b16 v[172:173], v104 offset:16384
  v_mfma_f32_16x16x32_bf16 a[4:7], v[124:127], v[152:155], a[4:7]
  ds_read_b64_tr_b16 v[174:175], v104 offset:17408
  s_add_u32 m0, s101, 0
  v_mfma_f32_16x16x32_bf16 a[8:11], v[128:131], v[152:155], a[8:11]
  buffer_load_dwordx4 v98, s[16:19], s47 offen nt lds
  v_mfma_f32_16x16x32_bf16 a[12:15], v[132:135], v[152:155], a[12:15]
  ds_read_b64_tr_b16 v[176:177], v104 offset:16392
  v_mfma_f32_16x16x32_bf16 a[16:19], v[120:123], v[156:159], a[16:19]
  ds_read_b64_tr_b16 v[178:179], v104 offset:17416
  s_add_u32 m0, s101, 1024
  v_mfma_f32_16x16x32_bf16 a[20:23], v[124:127], v[156:159], a[20:23]
  buffer_load_dwordx4 v99, s[16:19], s47 offen nt lds
  v_mfma_f32_16x16x32_bf16 a[24:27], v[128:131], v[156:159], a[24:27]
  ds_read_b64_tr_b16 v[180:181], v105 offset:16384
  v_mfma_f32_16x16x32_bf16 a[28:31], v[132:135], v[156:159], a[28:31]
  ds_read_b64_tr_b16 v[182:183], v105 offset:17408
  s_add_u32 m0, s101, 8192
  v_mfma_f32_16x16x32_bf16 a[32:35], v[120:123], v[160:163], a[32:35]
  buffer_load_dwordx4 v96, s[16:19], s47 offen nt lds
  v_mfma_f32_16x16x32_bf16 a[36:39], v[124:127], v[160:163], a[36:39]
  ds_read_b64_tr_b16 v[184:185], v105 offset:16392
  v_mfma_f32_16x16x32_bf16 a[40:43], v[128:131], v[160:163], a[40:43]
  ds_read_b64_tr_b16 v[186:187], v105 offset:17416
  s_add_u32 m0, s101, 9216
  v_mfma_f32_16x16x32_bf16 a[44:47], v[132:135], v[160:163], a[44:47]
  buffer_load_dwordx4 v97, s[16:19], s47 offen nt lds
  v_mfma_f32_16x16x32_bf16 a[48:51], v[120:123], v[164:167], a[48:51]
  ds_read_b128 v[204:207], v101 offset:0
  v_mfma_f32_16x16x32_bf16 a[52:55], v[124:127], v[164:167], a[52:55]
  ds_read_b128 v[208:211], v101 offset:2048
  v_mfma_f32_16x16x32_bf16 a[56:59], v[128:131], v[164:167], a[56:59]
  s_add_u32 s47, s47, 262144
  ds_read_b128 v[212:215], v101 offset:4096
  v_mfma_f32_16x16x32_bf16 a[60:63], v[132:135], v[164:167], a[60:63]
  ds_read_b128 v[216:219], v101 offset:6144
  v_mfma_f32_16x16x32_bf16 a[64:67], v[120:123], v[168:171], a[64:67]
  ds_read_b128 v[220:223], v103 offset:0
  v_mfma_f32_16x16x32_bf16 a[68:71], v[124:127], v[168:171], a[68:71]
  ds_read_b64_tr_b16 v[188:189], v104 offset:24576
  v_mfma_f32_16x16x32_bf16 a[72:75], v[136:139], v[152:155], a[72:75]
  ds_read_b64_tr_b16 v[190:191], v104 offset:25600
  v_mfma_f32_16x16x32_bf16 a[76:79], v[140:143], v[152:155], a[76:79]
  s_waitcnt lgkmcnt(14)
  ds_read_b64_tr_b16 v[192:193], v104 offset:24584
  v_mfma_f32_16x16x32_bf16 a[80:83], v[144:147], v[152:155], a[80:83]
  s_waitcnt lgkmcnt(14)
  ds_read_b64_tr_b16 v[194:195], v104 offset:25608
  v_mfma_f32_16x16x32_bf16 a[84:87], v[148:151], v[152:155], a[84:87]
  s_waitcnt lgkmcnt(14)
  ds_read_b64_tr_b16 v[196:197], v105 offset:24576
  v_mfma_f32_16x16x32_bf16 a[88:91], v[136:139], v[156:159], a[88:91]
  s_waitcnt lgkmcnt(14)
  ds_read_b64_tr_b16 v[198:199], v105 offset:25600
  v_mfma_f32_16x16x32_bf16 a[92:95], v[140:143], v[156:159], a[92:95]
  s_waitcnt lgkmcnt(14)
  ds_read_b64_tr_b16 v[200:201], v105 offset:24584
  v_mfma_f32_16x16x32_bf16 a[96:99], v[144:147], v[156:159], a[96:99]
  s_waitcnt lgkmcnt(14)
  ds_read_b64_tr_b16 v[202:203], v105 offset:25608
  v_mfma_f32_16x16x32_bf16 a[100:103], v[148:151], v[156:159], a[100:103]
  v_mfma_f32_16x16x32_bf16 a[104:107], v[136:139], v[160:163], a[104:107]
  v_mfma_f32_16x16x32_bf16 a[108:111], v[140:143], v[160:163], a[108:111]
  v_mfma_f32_16x16x32_bf16 a[112:115], v[144:147], v[160:163], a[112:115]
  v_mfma_f32_16x16x32_bf16 a[116:119], v[148:151], v[160:163], a[116:119]
  v_mfma_f32_16x16x32_bf16 a[120:123], v[136:139], v[164:167], a[120:123]
  v_mfma_f32_16x16x32_bf16 a[124:127], v[140:143], v[164:167], a[124:127]
  v_mfma_f32_16x16x32_bf16 a[128:131], v[144:147], v[164:167], a[128:131]
  v_mfma_f32_16x16x32_bf16 a[132:135], v[148:151], v[164:167], a[132:135]
  v_mfma_f32_16x16x32_bf16 a[136:139], v[136:139], v[168:171], a[136:139]
  v_mfma_f32_16x16x32_bf16 a[140:143], v[140:143], v[168:171], a[140:143]
  s_waitcnt vmcnt(17) lgkmcnt(0)
  s_barrier
  v_mfma_f32_16x16x32_bf16 a[0:3], v[172:175], v[204:207], a[0:3]
  ds_read_b64_tr_b16 v[120:121], v104 offset:32768
  v_mfma_f32_16x16x32_bf16 a[4:7], v[176:179], v[204:207], a[4:7]
  ds_read_b64_tr_b16 v[122:123], v104 offset:33792
  s_add_u32 m0, s101, 16384
  v_mfma_f32_16x16x32_bf16 a[8:11], v[180:183], v[204:207], a[8:11]
  buffer_load_dwordx4 v98, s[16:19], s47 offen nt lds
  v_mfma_f32_16x16x32_bf16 a[12:15], v[184:187], v[204:207], a[12:15]
  ds_read_b64_tr_b16 v[124:125], v104 offset:32776
  v_mfma_f32_16x16x32_bf16 a[16:19], v[172:175], v[208:211], a[16:19]
  ds_read_b64_tr_b16 v[126:127], v104 offset:33800
  s_add_u32 m0, s101, 17408
  v_mfma_f32_16x16x32_bf16 a[20:23], v[176:179], v[208:211], a[20:23]
  buffer_load_dwordx4 v99, s[16:19], s47 offen nt lds
  v_mfma_f32_16x16x32_bf16 a[24:27], v[180:183], v[208:211], a[24:27]
  ds_read_b64_tr_b16 v[128:129], v105 offset:32768
  v_mfma_f32_16x16x32_bf16 a[28:31], v[184:187], v[208:211], a[28:31]
  ds_read_b64_tr_b16 v[130:131], v105 offset:33792
  s_add_u32 m0, s101, 24576
  v_mfma_f32_16x16x32_bf16 a[32:35], v[172:175], v[212:215], a[32:35]
  buffer_load_dwordx4 v96, s[16:19], s47 offen nt lds
  v_mfma_f32_16x16x32_bf16 a[36:39], v[176:179], v[212:215], a[36:39]
  ds_read_b64_tr_b16 v[132:133], v105 offset:32776
  v_mfma_f32_16x16x32_bf16 a[40:43], v[180:183], v[212:215], a[40:43]
  ds_read_b64_tr_b16 v[134:135], v105 offset:33800
  s_add_u32 m0, s101, 25600
  v_mfma_f32_16x16x32_bf16 a[44:47], v[184:187], v[212:215], a[44:47]
  buffer_load_dwordx4 v97, s[16:19], s47 offen nt lds
  v_mfma_f32_16x16x32_bf16 a[48:51], v[172:175], v[216:219], a[48:51]
  ds_read_b128 v[152:155], v100 offset:18432
  v_mfma_f32_16x16x32_bf16 a[52:55], v[176:179], v[216:219], a[52:55]
  ds_read_b128 v[156:159], v100 offset:20480
  v_mfma_f32_16x16x32_bf16 a[56:59], v[180:183], v[216:219], a[56:59]
  s_add_u32 s47, s47, 262144
  ds_read_b128 v[160:163], v100 offset:22528
  v_mfma_f32_16x16x32_bf16 a[60:63], v[184:187], v[216:219], a[60:63]
  ds_read_b128 v[164:167], v100 offset:24576
  s_add_u32 m0, s96, 98304
  v_mfma_f32_16x16x32_bf16 a[64:67], v[172:175], v[220:223], a[64:67]
  buffer_load_dwordx4 v106, s[12:15], s46 offen lds
  v_mfma_f32_16x16x32_bf16 a[68:71], v[176:179], v[220:223], a[68:71]
  ds_read_b128 v[168:171], v102 offset:18432
  v_mfma_f32_16x16x32_bf16 a[72:75], v[188:191], v[204:207], a[72:75]
  ds_read_b64_tr_b16 v[136:137], v104 offset:40960
  s_add_u32 m0, s97, 98304
  v_mfma_f32_16x16x32_bf16 a[76:79], v[192:195], v[204:207], a[76:79]
  buffer_load_dwordx4 v107, s[12:15], s46 offen lds
  v_mfma_f32_16x16x32_bf16 a[80:83], v[196:199], v[204:207], a[80:83]
  ds_read_b64_tr_b16 v[138:139], v104 offset:41984
  v_mfma_f32_16x16x32_bf16 a[84:87], v[200:203], v[204:207], a[84:87]
  s_waitcnt lgkmcnt(14)
  ds_read_b64_tr_b16 v[140:141], v104 offset:40968
  s_add_u32 m0, s98, 98304
  v_mfma_f32_16x16x32_bf16 a[88:91], v[188:191], v[208:211], a[88:91]
  buffer_load_dwordx4 v108, s[12:15], s46 offen lds
  v_mfma_f32_16x16x32_bf16 a[92:95], v[192:195], v[208:211], a[92:95]
  s_waitcnt lgkmcnt(14)
  ds_read_b64_tr_b16 v[142:143], v104 offset:41992
  v_mfma_f32_16x16x32_bf16 a[96:99], v[196:199], v[208:211], a[96:99]
  s_waitcnt lgkmcnt(14)
  ds_read_b64_tr_b16 v[144:145], v105 offset:40960
  s_add_u32 m0, s99, 98304
  v_mfma_f32_16x16x32_bf16 a[100:103], v[200:203], v[208:211], a[100:103]
  buffer_load_dwordx4 v109, s[12:15], s46 offen lds
  v_mfma_f32_16x16x32_bf16 a[104:107], v[188:191], v[212:215], a[104:107]
  s_waitcnt lgkmcnt(14)
  ds_read_b64_tr_b16 v[146:147], v105 offset:41984
  v_mfma_f32_16x16x32_bf16 a[108:111], v[192:195], v[212:215], a[108:111]
  s_waitcnt lgkmcnt(14)
  ds_read_b64_tr_b16 v[148:149], v105 offset:40968
  s_add_u32 m0, s100, 98304
  v_mfma_f32_16x16x32_bf16 a[112:115], v[196:199], v[212:215], a[112:115]
  buffer_load_dwordx4 v110, s[12:15], s46 offen lds
  v_mfma_f32_16x16x32_bf16 a[116:119], v[200:203], v[212:215], a[116:119]
  s_waitcnt lgkmcnt(14)
  ds_read_b64_tr_b16 v[150:151], v105 offset:41992
  v_mfma_f32_16x16x32_bf16 a[120:123], v[188:191], v[216:219], a[120:123]
  s_add_u32 s46, s46, 128
  v_mfma_f32_16x16x32_bf16 a[124:127], v[192:195], v[216:219], a[124:127]
  v_mfma_f32_16x16x32_bf16 a[128:131], v[196:199], v[216:219], a[128:131]
  v_mfma_f32_16x16x32_bf16 a[132:135], v[200:203], v[216:219], a[132:135]
  v_mfma_f32_16x16x32_bf16 a[136:139], v[188:191], v[220:223], a[136:139]
  v_mfma_f32_16x16x32_bf16 a[140:143], v[192:195], v[220:223], a[140:143]
  s_waitcnt vmcnt(26) lgkmcnt(0)
  s_barrier
  v_mfma_f32_16x16x32_bf16 a[0:3], v[120:123], v[152:155], a[0:3]
  ds_read_b64_tr_b16 v[172:173], v104 offset:49152
  v_mfma_f32_16x16x32_bf16 a[4:7], v[124:127], v[152:155], a[4:7]
  ds_read_b64_tr_b16 v[174:175], v104 offset:50176
  s_add_u32 m0, s101, 32768
  v_mfma_f32_16x16x32_bf16 a[8:11], v[128:131], v[152:155], a[8:11]
  buffer_load_dwordx4 v98, s[16:19], s47 offen nt lds
  v_mfma_f32_16x16x32_bf16 a[12:15], v[132:135], v[152:155], a[12:15]
  ds_read_b64_tr_b16 v[176:177], v104 offset:49160
  v_mfma_f32_16x16x32_bf16 a[16:19], v[120:123], v[156:159], a[16:19]
  ds_read_b64_tr_b16 v[178:179], v104 offset:50184
  s_add_u32 m0, s101, 33792
  v_mfma_f32_16x16x32_bf16 a[20:23], v[124:127], v[156:159], a[20:23]
  buffer_load_dwordx4 v99, s[16:19], s47 offen nt lds
  v_mfma_f32_16x16x32_bf16 a[24:27], v[128:131], v[156:159], a[24:27]
  ds_read_b64_tr_b16 v[180:181], v105 offset:49152
  v_mfma_f32_16x16x32_bf16 a[28:31], v[132:135], v[156:159], a[28:31]
  ds_read_b64_tr_b16 v[182:183], v105 offset:50176
  s_add_u32 m0, s101, 40960
  v_mfma_f32_16x16x32_bf16 a[32:35], v[120:123], v[160:163], a[32:35]
  buffer_load_dwordx4 v96, s[16:19], s47 offen nt lds
  v_mfma_f32_16x16x32_bf16 a[36:39], v[124:127], v[160:163], a[36:39]
  ds_read_b64_tr_b16 v[184:185], v105 offset:49160
  v_mfma_f32_16x16x32_bf16 a[40:43], v[128:131], v[160:163], a[40:43]
  ds_read_b64_tr_b16 v[186:187], v105 offset:50184
  s_add_u32 m0, s101, 41984
  v_mfma_f32_16x16x32_bf16 a[44:47], v[132:135], v[160:163], a[44:47]
  buffer_load_dwordx4 v97, s[16:19], s47 offen nt lds
  v_mfma_f32_16x16x32_bf16 a[48:51], v[120:123], v[164:167], a[48:51]
  ds_read_b128 v[204:207], v101 offset:18432
  v_mfma_f32_16x16x32_bf16 a[52:55], v[124:127], v[164:167], a[52:55]
  ds_read_b128 v[208:211], v101 offset:20480
  v_mfma_f32_16x16x32_bf16 a[56:59], v[128:131], v[164:167], a[56:59]
  s_add_u32 s47, s47, 262144
  ds_read_b128 v[212:215], v101 offset:22528
  v_mfma_f32_16x16x32_bf16 a[60:63], v[132:135], v[164:167], a[60:63]
  ds_read_b128 v[216:219], v101 offset:24576
  v_mfma_f32_16x16x32_bf16 a[64:67], v[120:123], v[168:171], a[64:67]
  ds_read_b128 v[220:223], v103 offset:18432
  v_mfma_f32_16x16x32_bf16 a[68:71], v[124:127], v[168:171], a[68:71]
  ds_read_b64_tr_b16 v[188:189], v104 offset:57344
  v_mfma_f32_16x16x32_bf16 a[72:75], v[136:139], v[152:155], a[72:75]
  ds_read_b64_tr_b16 v[190:191], v104 offset:58368
  v_mfma_f32_16x16x32_bf16 a[76:79], v[140:143], v[152:155], a[76:79]
  s_waitcnt lgkmcnt(14)
  ds_read_b64_tr_b16 v[192:193], v104 offset:57352
  v_mfma_f32_16x16x32_bf16 a[80:83], v[144:147], v[152:155], a[80:83]
  s_waitcnt lgkmcnt(14)
  ds_read_b64_tr_b16 v[194:195], v104 offset:58376
  v_mfma_f32_16x16x32_bf16 a[84:87], v[148:151], v[152:155], a[84:87]
  s_waitcnt lgkmcnt(14)
  ds_read_b64_tr_b16 v[196:197], v105 offset:57344
  v_mfma_f32_16x16x32_bf16 a[88:91], v[136:139], v[156:159], a[88:91]
  s_waitcnt lgkmcnt(14)
  ds_read_b64_tr_b16 v[198:199], v105 offset:58368
  v_mfma_f32_16x16x32_bf16 a[92:95], v[140:143], v[156:159], a[92:95]
  s_waitcnt lgkmcnt(14)
  ds_read_b64_tr_b16 v[200:201], v105 offset:57352
  v_mfma_f32_16x16x32_bf16 a[96:99], v[144:147], v[156:159], a[96:99]
  s_waitcnt lgkmcnt(14)
  ds_read_b64_tr_b16 v[202:203], v105 offset:58376
  v_mfma_f32_16x16x32_bf16 a[100:103], v[148:151], v[156:159], a[100:103]
  v_mfma_f32_16x16x32_bf16 a[104:107], v[136:139], v[160:163], a[104:107]
  v_mfma_f32_16x16x32_bf16 a[108:111], v[140:143], v[160:163], a[108:111]
  v_mfma_f32_16x16x32_bf16 a[112:115], v[144:147], v[160:163], a[112:115]
  v_mfma_f32_16x16x32_bf16 a[116:119], v[148:151], v[160:163], a[116:119]
  v_mfma_f32_16x16x32_bf16 a[120:123], v[136:139], v[164:167], a[120:123]
  v_mfma_f32_16x16x32_bf16 a[124:127], v[140:143], v[164:167], a[124:127]
  v_mfma_f32_16x16x32_bf16 a[128:131], v[144:147], v[164:167], a[128:131]
  v_mfma_f32_16x16x32_bf16 a[132:135], v[148:151], v[164:167], a[132:135]
  v_mfma_f32_16x16x32_bf16 a[136:139], v[136:139], v[168:171], a[136:139]
  v_mfma_f32_16x16x32_bf16 a[140:143], v[140:143], v[168:171], a[140:143]
  s_waitcnt vmcnt(17) lgkmcnt(0)
  s_barrier
  v_mfma_f32_16x16x32_bf16 a[0:3], v[172:175], v[204:207], a[0:3]
  ds_read_b64_tr_b16 v[120:121], v112 offset:0
  v_mfma_f32_16x16x32_bf16 a[4:7], v[176:179], v[204:207], a[4:7]
  ds_read_b64_tr_b16 v[122:123], v112 offset:1024
  s_add_u32 m0, s101, 49152
  v_mfma_f32_16x16x32_bf16 a[8:11], v[180:183], v[204:207], a[8:11]
  buffer_load_dwordx4 v98, s[16:19], s47 offen nt lds
  v_mfma_f32_16x16x32_bf16 a[12:15], v[184:187], v[204:207], a[12:15]
  ds_read_b64_tr_b16 v[124:125], v112 offset:8
  v_mfma_f32_16x16x32_bf16 a[16:19], v[172:175], v[208:211], a[16:19]
  ds_read_b64_tr_b16 v[126:127], v112 offset:1032
  s_add_u32 m0, s101, 50176
  v_mfma_f32_16x16x32_bf16 a[20:23], v[176:179], v[208:211], a[20:23]
  buffer_load_dwordx4 v99, s[16:19], s47 offen nt lds
  v_mfma_f32_16x16x32_bf16 a[24:27], v[180:183], v[208:211], a[24:27]
  ds_read_b64_tr_b16 v[128:129], v113 offset:0
  v_mfma_f32_16x16x32_bf16 a[28:31], v[184:187], v[208:211], a[28:31]
  ds_read_b64_tr_b16 v[130:131], v113 offset:1024
  s_add_u32 m0, s101, 57344
  v_mfma_f32_16x16x32_bf16 a[32:35], v[172:175], v[212:215], a[32:35]
  buffer_load_dwordx4 v96, s[16:19], s47 offen nt lds
  v_mfma_f32_16x16x32_bf16 a[36:39], v[176:179], v[212:215], a[36:39]
  ds_read_b64_tr_b16 v[132:133], v113 offset:8
  v_mfma_f32_16x16x32_bf16 a[40:43], v[180:183], v[212:215], a[40:43]
  ds_read_b64_tr_b16 v[134:135], v113 offset:1032
  s_add_u32 m0, s101, 58368
  v_mfma_f32_16x16x32_bf16 a[44:47], v[184:187], v[212:215], a[44:47]
  buffer_load_dwordx4 v97, s[16:19], s47 offen nt lds
  v_mfma_f32_16x16x32_bf16 a[48:51], v[172:175], v[216:219], a[48:51]
  ds_read_b128 v[152:155], v100 offset:36864
  v_mfma_f32_16x16x32_bf16 a[52:55], v[176:179], v[216:219], a[52:55]
  ds_read_b128 v[156:159], v100 offset:38912
  v_mfma_f32_16x16x32_bf16 a[56:59], v[180:183], v[216:219], a[56:59]
  s_add_u32 s47, s47, 262144
  ds_read_b128 v[160:163], v100 offset:40960
  v_mfma_f32_16x16x32_bf16 a[60:63], v[184:187], v[216:219], a[60:63]
  ds_read_b128 v[164:167], v100 offset:43008
  s_add_u32 m0, s96, 116736
  v_mfma_f32_16x16x32_bf16 a[64:67], v[172:175], v[220:223], a[64:67]
  buffer_load_dwordx4 v106, s[12:15], s46 offen lds
  v_mfma_f32_16x16x32_bf16 a[68:71], v[176:179], v[220:223], a[68:71]
  ds_read_b128 v[168:171], v102 offset:36864
  v_mfma_f32_16x16x32_bf16 a[72:75], v[188:191], v[204:207], a[72:75]
  ds_read_b64_tr_b16 v[136:137], v112 offset:8192
  s_add_u32 m0, s97, 116736
  v_mfma_f32_16x16x32_bf16 a[76:79], v[192:195], v[204:207], a[76:79]
  buffer_load_dwordx4 v107, s[12:15], s46 offen lds
  v_mfma_f32_16x16x32_bf16 a[80:83], v[196:199], v[204:207], a[80:83]
  ds_read_b64_tr_b16 v[138:139], v112 offset:9216
  v_mfma_f32_16x16x32_bf16 a[84:87], v[200:203], v[204:207], a[84:87]
  s_waitcnt lgkmcnt(14)
  ds_read_b64_tr_b16 v[140:141], v112 offset:8200
  s_add_u32 m0, s98, 116736
  v_mfma_f32_16x16x32_bf16 a[88:91], v[188:191], v[208:211], a[88:91]
  buffer_load_dwordx4 v108, s[12:15], s46 offen lds
  v_mfma_f32_16x16x32_bf16 a[92:95], v[192:195], v[208:211], a[92:95]
  s_waitcnt lgkmcnt(14)
  ds_read_b64_tr_b16 v[142:143], v112 offset:9224
  v_mfma_f32_16x16x32_bf16 a[96:99], v[196:199], v[208:211], a[96:99]
  s_waitcnt lgkmcnt(14)
  ds_read_b64_tr_b16 v[144:145], v113 offset:8192
  s_add_u32 m0, s99, 116736
  v_mfma_f32_16x16x32_bf16 a[100:103], v[200:203], v[208:211], a[100:103]
  buffer_load_dwordx4 v109, s[12:15], s46 offen lds
  v_mfma_f32_16x16x32_bf16 a[104:107], v[188:191], v[212:215], a[104:107]
  s_waitcnt lgkmcnt(14)
  ds_read_b64_tr_b16 v[146:147], v113 offset:9216
  v_mfma_f32_16x16x32_bf16 a[108:111], v[192:195], v[212:215], a[108:111]
  s_waitcnt lgkmcnt(14)
  ds_read_b64_tr_b16 v[148:149], v113 offset:8200
  s_add_u32 m0, s100, 116736
  v_mfma_f32_16x16x32_bf16 a[112:115], v[196:199], v[212:215], a[112:115]
  buffer_load_dwordx4 v110, s[12:15], s46 offen lds
  v_mfma_f32_16x16x32_bf16 a[116:119], v[200:203], v[212:215], a[116:119]
  s_waitcnt lgkmcnt(14)
  ds_read_b64_tr_b16 v[150:151], v113 offset:9224
  v_mfma_f32_16x16x32_bf16 a[120:123], v[188:191], v[216:219], a[120:123]
  s_add_u32 s46, s46, 128
  v_mfma_f32_16x16x32_bf16 a[124:127], v[192:195], v[216:219], a[124:127]
  v_mfma_f32_16x16x32_bf16 a[128:131], v[196:199], v[216:219], a[128:131]
  v_mfma_f32_16x16x32_bf16 a[132:135], v[200:203], v[216:219], a[132:135]
  v_mfma_f32_16x16x32_bf16 a[136:139], v[188:191], v[220:223], a[136:139]
  v_mfma_f32_16x16x32_bf16 a[140:143], v[192:195], v[220:223], a[140:143]
  s_waitcnt vmcnt(26) lgkmcnt(0)
  s_barrier
  v_mfma_f32_16x16x32_bf16 a[0:3], v[120:123], v[152:155], a[0:3]
  ds_read_b64_tr_b16 v[172:173], v112 offset:16384
  v_mfma_f32_16x16x32_bf16 a[4:7], v[124:127], v[152:155], a[4:7]
  ds_read_b64_tr_b16 v[174:175], v112 offset:17408
  s_add_u32 m0, s101, 65536
  v_mfma_f32_16x16x32_bf16 a[8:11], v[128:131], v[152:155], a[8:11]
  buffer_load_dwordx4 v98, s[16:19], s47 offen nt lds
  v_mfma_f32_16x16x32_bf16 a[12:15], v[132:135], v[152:155], a[12:15]
  ds_read_b64_tr_b16 v[176:177], v112 offset:16392
  v_mfma_f32_16x16x32_bf16 a[16:19], v[120:123], v[156:159], a[16:19]
  ds_read_b64_tr_b16 v[178:179], v112 offset:17416
  s_add_u32 m0, s101, 66560
  v_mfma_f32_16x16x32_bf16 a[20:23], v[124:127], v[156:159], a[20:23]
  buffer_load_dwordx4 v99, s[16:19], s47 offen nt lds
  v_mfma_f32_16x16x32_bf16 a[24:27], v[128:131], v[156:159], a[24:27]
  ds_read_b64_tr_b16 v[180:181], v113 offset:16384
  v_mfma_f32_16x16x32_bf16 a[28:31], v[132:135], v[156:159], a[28:31]
  ds_read_b64_tr_b16 v[182:183], v113 offset:17408
  s_add_u32 m0, s101, 73728
  v_mfma_f32_16x16x32_bf16 a[32:35], v[120:123], v[160:163], a[32:35]
  buffer_load_dwordx4 v96, s[16:19], s47 offen nt lds
  v_mfma_f32_16x16x32_bf16 a[36:39], v[124:127], v[160:163], a[36:39]
  ds_read_b64_tr_b16 v[184:185], v113 offset:16392
  v_mfma_f32_16x16x32_bf16 a[40:43], v[128:131], v[160:163], a[40:43]
  ds_read_b64_tr_b16 v[186:187], v113 offset:17416
  s_add_u32 m0, s101, 74752
  v_mfma_f32_16x16x32_bf16 a[44:47], v[132:135], v[160:163], a[44:47]
  buffer_load_dwordx4 v97, s[16:19], s47 offen nt lds
  v_mfma_f32_16x16x32_bf16 a[48:51], v[120:123], v[164:167], a[48:51]
  ds_read_b128 v[204:207], v101 offset:36864
  v_mfma_f32_16x16x32_bf16 a[52:55], v[124:127], v[164:167], a[52:55]
  ds_read_b128 v[208:211], v101 offset:38912
  v_mfma_f32_16x16x32_bf16 a[56:59], v[128:131], v[164:167], a[56:59]
  s_add_u32 s47, s47, 262144
  ds_read_b128 v[212:215], v101 offset:40960
  v_mfma_f32_16x16x32_bf16 a[60:63], v[132:135], v[164:167], a[60:63]
  ds_read_b128 v[216:219], v101 offset:43008
  v_mfma_f32_16x16x32_bf16 a[64:67], v[120:123], v[168:171], a[64:67]
  ds_read_b128 v[220:223], v103 offset:36864
  v_mfma_f32_16x16x32_bf16 a[68:71], v[124:127], v[168:171], a[68:71]
  ds_read_b64_tr_b16 v[188:189], v112 offset:24576
  v_mfma_f32_16x16x32_bf16 a[72:75], v[136:139], v[152:155], a[72:75]
  ds_read_b64_tr_b16 v[190:191], v112 offset:25600
  v_mfma_f32_16x16x32_bf16 a[76:79], v[140:143], v[152:155], a[76:79]
  s_waitcnt lgkmcnt(14)
  ds_read_b64_tr_b16 v[192:193], v112 offset:24584
  v_mfma_f32_16x16x32_bf16 a[80:83], v[144:147], v[152:155], a[80:83]
  s_waitcnt lgkmcnt(14)
  ds_read_b64_tr_b16 v[194:195], v112 offset:25608
  v_mfma_f32_16x16x32_bf16 a[84:87], v[148:151], v[152:155], a[84:87]
  s_waitcnt lgkmcnt(14)
  ds_read_b64_tr_b16 v[196:197], v113 offset:24576
  v_mfma_f32_16x16x32_bf16 a[88:91], v[136:139], v[156:159], a[88:91]
  s_waitcnt lgkmcnt(14)
  ds_read_b64_tr_b16 v[198:199], v113 offset:25600
  v_mfma_f32_16x16x32_bf16 a[92:95], v[140:143], v[156:159], a[92:95]
  s_waitcnt lgkmcnt(14)
  ds_read_b64_tr_b16 v[200:201], v113 offset:24584
  v_mfma_f32_16x16x32_bf16 a[96:99], v[144:147], v[156:159], a[96:99]
  s_waitcnt lgkmcnt(14)
  ds_read_b64_tr_b16 v[202:203], v113 offset:25608
  v_mfma_f32_16x16x32_bf16 a[100:103], v[148:151], v[156:159], a[100:103]
  v_mfma_f32_16x16x32_bf16 a[104:107], v[136:139], v[160:163], a[104:107]
  v_mfma_f32_16x16x32_bf16 a[108:111], v[140:143], v[160:163], a[108:111]
  v_mfma_f32_16x16x32_bf16 a[112:115], v[144:147], v[160:163], a[112:115]
  v_mfma_f32_16x16x32_bf16 a[116:119], v[148:151], v[160:163], a[116:119]
  v_mfma_f32_16x16x32_bf16 a[120:123], v[136:139], v[164:167], a[120:123]
  v_mfma_f32_16x16x32_bf16 a[124:127], v[140:143], v[164:167], a[124:127]
  v_mfma_f32_16x16x32_bf16 a[128:131], v[144:147], v[164:167], a[128:131]
  v_mfma_f32_16x16x32_bf16 a[132:135], v[148:151], v[164:167], a[132:135]
  v_mfma_f32_16x16x32_bf16 a[136:139], v[136:139], v[168:171], a[136:139]
  v_mfma_f32_16x16x32_bf16 a[140:143], v[140:143], v[168:171], a[140:143]
  s_waitcnt vmcnt(17) lgkmcnt(0)
  s_barrier
  v_mfma_f32_16x16x32_bf16 a[0:3], v[172:175], v[204:207], a[0:3]
  ds_read_b64_tr_b16 v[120:121], v104 offset:0
  v_mfma_f32_16x16x32_bf16 a[4:7], v[176:179], v[204:207], a[4:7]
  ds_read_b64_tr_b16 v[122:123], v104 offset:1024
  s_add_u32 m0, s101, 81920
  v_mfma_f32_16x16x32_bf16 a[8:11], v[180:183], v[204:207], a[8:11]
  buffer_load_dwordx4 v98, s[16:19], s47 offen nt lds
  v_mfma_f32_16x16x32_bf16 a[12:15], v[184:187], v[204:207], a[12:15]
  ds_read_b64_tr_b16 v[124:125], v104 offset:8
  v_mfma_f32_16x16x32_bf16 a[16:19], v[172:175], v[208:211], a[16:19]
  ds_read_b64_tr_b16 v[126:127], v104 offset:1032
  s_add_u32 m0, s101, 82944
  v_mfma_f32_16x16x32_bf16 a[20:23], v[176:179], v[208:211], a[20:23]
  buffer_load_dwordx4 v99, s[16:19], s47 offen nt lds
  v_mfma_f32_16x16x32_bf16 a[24:27], v[180:183], v[208:211], a[24:27]
  ds_read_b64_tr_b16 v[128:129], v105 offset:0
  v_mfma_f32_16x16x32_bf16 a[28:31], v[184:187], v[208:211], a[28:31]
  ds_read_b64_tr_b16 v[130:131], v105 offset:1024
  s_add_u32 m0, s101, 90112
  v_mfma_f32_16x16x32_bf16 a[32:35], v[172:175], v[212:215], a[32:35]
  buffer_load_dwordx4 v96, s[16:19], s47 offen nt lds
  v_mfma_f32_16x16x32_bf16 a[36:39], v[176:179], v[212:215], a[36:39]
  ds_read_b64_tr_b16 v[132:133], v105 offset:8
  v_mfma_f32_16x16x32_bf16 a[40:43], v[180:183], v[212:215], a[40:43]
  ds_read_b64_tr_b16 v[134:135], v105 offset:1032
  s_add_u32 m0, s101, 91136
  v_mfma_f32_16x16x32_bf16 a[44:47], v[184:187], v[212:215], a[44:47]
  buffer_load_dwordx4 v97, s[16:19], s47 offen nt lds
  v_mfma_f32_16x16x32_bf16 a[48:51], v[172:175], v[216:219], a[48:51]
  ds_read_b128 v[152:155], v100 offset:0
  v_mfma_f32_16x16x32_bf16 a[52:55], v[176:179], v[216:219], a[52:55]
  ds_read_b128 v[156:159], v100 offset:2048
  v_mfma_f32_16x16x32_bf16 a[56:59], v[180:183], v[216:219], a[56:59]
  s_add_u32 s47, s47, 262144
  ds_read_b128 v[160:163], v100 offset:4096
  v_mfma_f32_16x16x32_bf16 a[60:63], v[184:187], v[216:219], a[60:63]
  ds_read_b128 v[164:167], v100 offset:6144
  s_add_u32 m0, s96, 135168
  v_mfma_f32_16x16x32_bf16 a[64:67], v[172:175], v[220:223], a[64:67]
  buffer_load_dwordx4 v106, s[12:15], s46 offen lds
  v_mfma_f32_16x16x32_bf16 a[68:71], v[176:179], v[220:223], a[68:71]
  ds_read_b128 v[168:171], v102 offset:0
  v_mfma_f32_16x16x32_bf16 a[72:75], v[188:191], v[204:207], a[72:75]
  ds_read_b64_tr_b16 v[136:137], v104 offset:8192
  s_add_u32 m0, s97, 135168
  v_mfma_f32_16x16x32_bf16 a[76:79], v[192:195], v[204:207], a[76:79]
  buffer_load_dwordx4 v107, s[12:15], s46 offen lds
  v_mfma_f32_16x16x32_bf16 a[80:83], v[196:199], v[204:207], a[80:83]
  ds_read_b64_tr_b16 v[138:139], v104 offset:9216
  v_mfma_f32_16x16x32_bf16 a[84:87], v[200:203], v[204:207], a[84:87]
  s_waitcnt lgkmcnt(14)
  ds_read_b64_tr_b16 v[140:141], v104 offset:8200
  s_add_u32 m0, s98, 135168
  v_mfma_f32_16x16x32_bf16 a[88:91], v[188:191], v[208:211], a[88:91]
  buffer_load_dwordx4 v108, s[12:15], s46 offen lds
  v_mfma_f32_16x16x32_bf16 a[92:95], v[192:195], v[208:211], a[92:95]
  s_waitcnt lgkmcnt(14)
  ds_read_b64_tr_b16 v[142:143], v104 offset:9224
  v_mfma_f32_16x16x32_bf16 a[96:99], v[196:199], v[208:211], a[96:99]
  s_waitcnt lgkmcnt(14)
  ds_read_b64_tr_b16 v[144:145], v105 offset:8192
  s_add_u32 m0, s99, 135168
  v_mfma_f32_16x16x32_bf16 a[100:103], v[200:203], v[208:211], a[100:103]
  buffer_load_dwordx4 v109, s[12:15], s46 offen lds
  v_mfma_f32_16x16x32_bf16 a[104:107], v[188:191], v[212:215], a[104:107]
  s_waitcnt lgkmcnt(14)
  ds_read_b64_tr_b16 v[146:147], v105 offset:9216
  v_mfma_f32_16x16x32_bf16 a[108:111], v[192:195], v[212:215], a[108:111]
  s_waitcnt lgkmcnt(14)
  ds_read_b64_tr_b16 v[148:149], v105 offset:8200
  s_add_u32 m0, s100, 135168
  v_mfma_f32_16x16x32_bf16 a[112:115], v[196:199], v[212:215], a[112:115]
  buffer_load_dwordx4 v110, s[12:15], s46 offen lds
  v_mfma_f32_16x16x32_bf16 a[116:119], v[200:203], v[212:215], a[116:119]
  s_waitcnt lgkmcnt(14)
  ds_read_b64_tr_b16 v[150:151], v105 offset:9224
  v_mfma_f32_16x16x32_bf16 a[120:123], v[188:191], v[216:219], a[120:123]
  s_add_u32 s46, s46, 128
  v_mfma_f32_16x16x32_bf16 a[124:127], v[192:195], v[216:219], a[124:127]
  v_mfma_f32_16x16x32_bf16 a[128:131], v[196:199], v[216:219], a[128:131]
  v_mfma_f32_16x16x32_bf16 a[132:135], v[200:203], v[216:219], a[132:135]
  v_mfma_f32_16x16x32_bf16 a[136:139], v[188:191], v[220:223], a[136:139]
  v_mfma_f32_16x16x32_bf16 a[140:143], v[192:195], v[220:223], a[140:143]
  s_sub_u32 s33, s33, 1
  s_cmp_lg_u32 s33, 0
  s_cbranch_scc1 fa_kernel_qpx
  s_waitcnt vmcnt(26) lgkmcnt(0)
  s_barrier
  v_mfma_f32_16x16x32_bf16 a[0:3], v[120:123], v[152:155], a[0:3]
  ds_read_b64_tr_b16 v[172:173], v104 offset:16384
  v_mfma_f32_16x16x32_bf16 a[4:7], v[124:127], v[152:155], a[4:7]
  ds_read_b64_tr_b16 v[174:175], v104 offset:17408
  s_add_u32 m0, s101, 0
  v_mfma_f32_16x16x32_bf16 a[8:11], v[128:131], v[152:155], a[8:11]
  buffer_load_dwordx4 v98, s[16:19], s47 offen nt lds
  v_mfma_f32_16x16x32_bf16 a[12:15], v[132:135], v[152:155], a[12:15]
  ds_read_b64_tr_b16 v[176:177], v104 offset:16392
  v_mfma_f32_16x16x32_bf16 a[16:19], v[120:123], v[156:159], a[16:19]
  ds_read_b64_tr_b16 v[178:179], v104 offset:17416
  s_add_u32 m0, s101, 1024
  v_mfma_f32_16x16x32_bf16 a[20:23], v[124:127], v[156:159], a[20:23]
  buffer_load_dwordx4 v99, s[16:19], s47 offen nt lds
  v_mfma_f32_16x16x32_bf16 a[24:27], v[128:131], v[156:159], a[24:27]
  ds_read_b64_tr_b16 v[180:181], v105 offset:16384
  v_mfma_f32_16x16x32_bf16 a[28:31], v[132:135], v[156:159], a[28:31]
  ds_read_b64_tr_b16 v[182:183], v105 offset:17408
  s_add_u32 m0, s101, 8192
  v_mfma_f32_16x16x32_bf16 a[32:35], v[120:123], v[160:163], a[32:35]
  buffer_load_dwordx4 v96, s[16:19], s47 offen nt lds
  v_mfma_f32_16x16x32_bf16 a[36:39], v[124:127], v[160:163], a[36:39]
  ds_read_b64_tr_b16 v[184:185], v105 offset:16392
  v_mfma_f32_16x16x32_bf16 a[40:43], v[128:131], v[160:163], a[40:43]
  ds_read_b64_tr_b16 v[186:187], v105 offset:17416
  s_add_u32 m0, s101, 9216
  v_mfma_f32_16x16x32_bf16 a[44:47], v[132:135], v[160:163], a[44:47]
  buffer_load_dwordx4 v97, s[16:19], s47 offen nt lds
  v_mfma_f32_16x16x32_bf16 a[48:51], v[120:123], v[164:167], a[48:51]
  ds_read_b128 v[204:207], v101 offset:0
  v_mfma_f32_16x16x32_bf16 a[52:55], v[124:127], v[164:167], a[52:55]
  ds_read_b128 v[208:211], v101 offset:2048
  v_mfma_f32_16x16x32_bf16 a[56:59], v[128:131], v[164:167], a[56:59]
  s_add_u32 s47, s47, 262144
  ds_read_b128 v[212:215], v101 offset:4096
  v_mfma_f32_16x16x32_bf16 a[60:63], v[132:135], v[164:167], a[60:63]
  ds_read_b128 v[216:219], v101 offset:6144
  v_mfma_f32_16x16x32_bf16 a[64:67], v[120:123], v[168:171], a[64:67]
  ds_read_b128 v[220:223], v103 offset:0
  v_mfma_f32_16x16x32_bf16 a[68:71], v[124:127], v[168:171], a[68:71]
  ds_read_b64_tr_b16 v[188:189], v104 offset:24576
  v_mfma_f32_16x16x32_bf16 a[72:75], v[136:139], v[152:155], a[72:75]
  ds_read_b64_tr_b16 v[190:191], v104 offset:25600
  v_mfma_f32_16x16x32_bf16 a[76:79], v[140:143], v[152:155], a[76:79]
  s_waitcnt lgkmcnt(14)
  ds_read_b64_tr_b16 v[192:193], v104 offset:24584
  v_mfma_f32_16x16x32_bf16 a[80:83], v[144:147], v[152:155], a[80:83]
  s_waitcnt lgkmcnt(14)
  ds_read_b64_tr_b16 v[194:195], v104 offset:25608
  v_mfma_f32_16x16x32_bf16 a[84:87], v[148:151], v[152:155], a[84:87]
  s_waitcnt lgkmcnt(14)
  ds_read_b64_tr_b16 v[196:197], v105 offset:24576
  v_mfma_f32_16x16x32_bf16 a[88:91], v[136:139], v[156:159], a[88:91]
  s_waitcnt lgkmcnt(14)
  ds_read_b64_tr_b16 v[198:199], v105 offset:25600
  v_mfma_f32_16x16x32_bf16 a[92:95], v[140:143], v[156:159], a[92:95]
  s_waitcnt lgkmcnt(14)
  ds_read_b64_tr_b16 v[200:201], v105 offset:24584
  v_mfma_f32_16x16x32_bf16 a[96:99], v[144:147], v[156:159], a[96:99]
  s_waitcnt lgkmcnt(14)
  ds_read_b64_tr_b16 v[202:203], v105 offset:25608
  v_mfma_f32_16x16x32_bf16 a[100:103], v[148:151], v[156:159], a[100:103]
  v_mfma_f32_16x16x32_bf16 a[104:107], v[136:139], v[160:163], a[104:107]
  v_mfma_f32_16x16x32_bf16 a[108:111], v[140:143], v[160:163], a[108:111]
  v_mfma_f32_16x16x32_bf16 a[112:115], v[144:147], v[160:163], a[112:115]
  v_mfma_f32_16x16x32_bf16 a[116:119], v[148:151], v[160:163], a[116:119]
  v_mfma_f32_16x16x32_bf16 a[120:123], v[136:139], v[164:167], a[120:123]
  v_mfma_f32_16x16x32_bf16 a[124:127], v[140:143], v[164:167], a[124:127]
  v_mfma_f32_16x16x32_bf16 a[128:131], v[144:147], v[164:167], a[128:131]
  v_mfma_f32_16x16x32_bf16 a[132:135], v[148:151], v[164:167], a[132:135]
  v_mfma_f32_16x16x32_bf16 a[136:139], v[136:139], v[168:171], a[136:139]
  v_mfma_f32_16x16x32_bf16 a[140:143], v[140:143], v[168:171], a[140:143]
  s_waitcnt vmcnt(17) lgkmcnt(0)
  s_barrier
  v_mfma_f32_16x16x32_bf16 a[0:3], v[172:175], v[204:207], a[0:3]
  ds_read_b64_tr_b16 v[120:121], v104 offset:32768
  v_mfma_f32_16x16x32_bf16 a[4:7], v[176:179], v[204:207], a[4:7]
  ds_read_b64_tr_b16 v[122:123], v104 offset:33792
  s_add_u32 m0, s101, 16384
  v_mfma_f32_16x16x32_bf16 a[8:11], v[180:183], v[204:207], a[8:11]
  buffer_load_dwordx4 v98, s[16:19], s47 offen nt lds
  v_mfma_f32_16x16x32_bf16 a[12:15], v[184:187], v[204:207], a[12:15]
  ds_read_b64_tr_b16 v[124:125], v104 offset:32776
  v_mfma_f32_16x16x32_bf16 a[16:19], v[172:175], v[208:211], a[16:19]
  ds_read_b64_tr_b16 v[126:127], v104 offset:33800
  s_add_u32 m0, s101, 17408
  v_mfma_f32_16x16x32_bf16 a[20:23], v[176:179], v[208:211], a[20:23]
  buffer_load_dwordx4 v99, s[16:19], s47 offen nt lds
  v_mfma_f32_16x16x32_bf16 a[24:27], v[180:183], v[208:211], a[24:27]
  ds_read_b64_tr_b16 v[128:129], v105 offset:32768
  v_mfma_f32_16x16x32_bf16 a[28:31], v[184:187], v[208:211], a[28:31]
  ds_read_b64_tr_b16 v[130:131], v105 offset:33792
  s_add_u32 m0, s101, 24576
  v_mfma_f32_16x16x32_bf16 a[32:35], v[172:175], v[212:215], a[32:35]
  buffer_load_dwordx4 v96, s[16:19], s47 offen nt lds
  v_mfma_f32_16x16x32_bf16 a[36:39], v[176:179], v[212:215], a[36:39]
  ds_read_b64_tr_b16 v[132:133], v105 offset:32776
  v_mfma_f32_16x16x32_bf16 a[40:43], v[180:183], v[212:215], a[40:43]
  ds_read_b64_tr_b16 v[134:135], v105 offset:33800
  s_add_u32 m0, s101, 25600
  v_mfma_f32_16x16x32_bf16 a[44:47], v[184:187], v[212:215], a[44:47]
  buffer_load_dwordx4 v97, s[16:19], s47 offen nt lds
  v_mfma_f32_16x16x32_bf16 a[48:51], v[172:175], v[216:219], a[48:51]
  ds_read_b128 v[152:155], v100 offset:18432
  v_mfma_f32_16x16x32_bf16 a[52:55], v[176:179], v[216:219], a[52:55]
  ds_read_b128 v[156:159], v100 offset:20480
  v_mfma_f32_16x16x32_bf16 a[56:59], v[180:183], v[216:219], a[56:59]
  s_add_u32 s47, s47, 262144
  ds_read_b128 v[160:163], v100 offset:22528
  v_mfma_f32_16x16x32_bf16 a[60:63], v[184:187], v[216:219], a[60:63]
  ds_read_b128 v[164:167], v100 offset:24576
  s_add_u32 m0, s96, 98304
  v_mfma_f32_16x16x32_bf16 a[64:67], v[172:175], v[220:223], a[64:67]
  buffer_load_dwordx4 v106, s[12:15], s46 offen lds
  v_mfma_f32_16x16x32_bf16 a[68:71], v[176:179], v[220:223], a[68:71]
  ds_read_b128 v[168:171], v102 offset:18432
  v_mfma_f32_16x16x32_bf16 a[72:75], v[188:191], v[204:207], a[72:75]
  ds_read_b64_tr_b16 v[136:137], v104 offset:40960
  s_add_u32 m0, s97, 98304
  v_mfma_f32_16x16x32_bf16 a[76:79], v[192:195], v[204:207], a[76:79]
  buffer_load_dwordx4 v107, s[12:15], s46 offen lds
  v_mfma_f32_16x16x32_bf16 a[80:83], v[196:199], v[204:207], a[80:83]
  ds_read_b64_tr_b16 v[138:139], v104 offset:41984
  v_mfma_f32_16x16x32_bf16 a[84:87], v[200:203], v[204:207], a[84:87]
  s_waitcnt lgkmcnt(14)
  ds_read_b64_tr_b16 v[140:141], v104 offset:40968
  s_add_u32 m0, s98, 98304
  v_mfma_f32_16x16x32_bf16 a[88:91], v[188:191], v[208:211], a[88:91]
  buffer_load_dwordx4 v108, s[12:15], s46 offen lds
  v_mfma_f32_16x16x32_bf16 a[92:95], v[192:195], v[208:211], a[92:95]
  s_waitcnt lgkmcnt(14)
  ds_read_b64_tr_b16 v[142:143], v104 offset:41992
  v_mfma_f32_16x16x32_bf16 a[96:99], v[196:199], v[208:211], a[96:99]
  s_waitcnt lgkmcnt(14)
  ds_read_b64_tr_b16 v[144:145], v105 offset:40960
  s_add_u32 m0, s99, 98304
  v_mfma_f32_16x16x32_bf16 a[100:103], v[200:203], v[208:211], a[100:103]
  buffer_load_dwordx4 v109, s[12:15], s46 offen lds
  v_mfma_f32_16x16x32_bf16 a[104:107], v[188:191], v[212:215], a[104:107]
  s_waitcnt lgkmcnt(14)
  ds_read_b64_tr_b16 v[146:147], v105 offset:41984
  v_mfma_f32_16x16x32_bf16 a[108:111], v[192:195], v[212:215], a[108:111]
  s_waitcnt lgkmcnt(14)
  ds_read_b64_tr_b16 v[148:149], v105 offset:40968
  s_add_u32 m0, s100, 98304
  v_mfma_f32_16x16x32_bf16 a[112:115], v[196:199], v[212:215], a[112:115]
  buffer_load_dwordx4 v110, s[12:15], s46 offen lds
  v_mfma_f32_16x16x32_bf16 a[116:119], v[200:203], v[212:215], a[116:119]
  s_waitcnt lgkmcnt(14)
  ds_read_b64_tr_b16 v[150:151], v105 offset:41992
  v_mfma_f32_16x16x32_bf16 a[120:123], v[188:191], v[216:219], a[120:123]
  s_add_u32 s46, s46, 128
  v_mfma_f32_16x16x32_bf16 a[124:127], v[192:195], v[216:219], a[124:127]
  v_mfma_f32_16x16x32_bf16 a[128:131], v[196:199], v[216:219], a[128:131]
  v_mfma_f32_16x16x32_bf16 a[132:135], v[200:203], v[216:219], a[132:135]
  v_mfma_f32_16x16x32_bf16 a[136:139], v[188:191], v[220:223], a[136:139]
  v_mfma_f32_16x16x32_bf16 a[140:143], v[192:195], v[220:223], a[140:143]
  s_waitcnt vmcnt(26) lgkmcnt(0)
  s_barrier
  v_mfma_f32_16x16x32_bf16 a[0:3], v[120:123], v[152:155], a[0:3]
  ds_read_b64_tr_b16 v[172:173], v104 offset:49152
  v_mfma_f32_16x16x32_bf16 a[4:7], v[124:127], v[152:155], a[4:7]
  ds_read_b64_tr_b16 v[174:175], v104 offset:50176
  v_mfma_f32_16x16x32_bf16 a[8:11], v[128:131], v[152:155], a[8:11]
  ds_read_b64_tr_b16 v[176:177], v104 offset:49160
  v_mfma_f32_16x16x32_bf16 a[12:15], v[132:135], v[152:155], a[12:15]
  ds_read_b64_tr_b16 v[178:179], v104 offset:50184
  v_mfma_f32_16x16x32_bf16 a[16:19], v[120:123], v[156:159], a[16:19]
  ds_read_b64_tr_b16 v[180:181], v105 offset:49152
  v_mfma_f32_16x16x32_bf16 a[20:23], v[124:127], v[156:159], a[20:23]
  ds_read_b64_tr_b16 v[182:183], v105 offset:50176
  v_mfma_f32_16x16x32_bf16 a[24:27], v[128:131], v[156:159], a[24:27]
  ds_read_b64_tr_b16 v[184:185], v105 offset:49160
  v_mfma_f32_16x16x32_bf16 a[28:31], v[132:135], v[156:159], a[28:31]
  ds_read_b64_tr_b16 v[186:187], v105 offset:50184
  v_mfma_f32_16x16x32_bf16 a[32:35], v[120:123], v[160:163], a[32:35]
  ds_read_b128 v[204:207], v101 offset:18432
  v_mfma_f32_16x16x32_bf16 a[36:39], v[124:127], v[160:163], a[36:39]
  ds_read_b128 v[208:211], v101 offset:20480
  v_mfma_f32_16x16x32_bf16 a[40:43], v[128:131], v[160:163], a[40:43]
  ds_read_b128 v[212:215], v101 offset:22528
  v_mfma_f32_16x16x32_bf16 a[44:47], v[132:135], v[160:163], a[44:47]
  ds_read_b128 v[216:219], v101 offset:24576
  v_mfma_f32_16x16x32_bf16 a[48:51], v[120:123], v[164:167], a[48:51]
  ds_read_b128 v[220:223], v103 offset:18432
  v_mfma_f32_16x16x32_bf16 a[52:55], v[124:127], v[164:167], a[52:55]
  ds_read_b64_tr_b16 v[188:189], v104 offset:57344
  v_mfma_f32_16x16x32_bf16 a[56:59], v[128:131], v[164:167], a[56:59]
  ds_read_b64_tr_b16 v[190:191], v104 offset:58368
  v_mfma_f32_16x16x32_bf16 a[60:63], v[132:135], v[164:167], a[60:63]
  s_waitcnt lgkmcnt(14)
  ds_read_b64_tr_b16 v[192:193], v104 offset:57352
  v_mfma_f32_16x16x32_bf16 a[64:67], v[120:123], v[168:171], a[64:67]
  s_waitcnt lgkmcnt(14)
  ds_read_b64_tr_b16 v[194:195], v104 offset:58376
  v_mfma_f32_16x16x32_bf16 a[68:71], v[124:127], v[168:171], a[68:71]
  s_waitcnt lgkmcnt(14)
  ds_read_b64_tr_b16 v[196:197], v105 offset:57344
  v_mfma_f32_16x16x32_bf16 a[72:75], v[136:139], v[152:155], a[72:75]
  s_waitcnt lgkmcnt(14)
  ds_read_b64_tr_b16 v[198:199], v105 offset:58368
  v_mfma_f32_16x16x32_bf16 a[76:79], v[140:143], v[152:155], a[76:79]
  s_waitcnt lgkmcnt(14)
  ds_read_b64_tr_b16 v[200:201], v105 offset:57352
  v_mfma_f32_16x16x32_bf16 a[80:83], v[144:147], v[152:155], a[80:83]
  s_waitcnt lgkmcnt(14)
  ds_read_b64_tr_b16 v[202:203], v105 offset:58376
  v_mfma_f32_16x16x32_bf16 a[84:87], v[148:151], v[152:155], a[84:87]
  v_mfma_f32_16x16x32_bf16 a[88:91], v[136:139], v[156:159], a[88:91]
  v_mfma_f32_16x16x32_bf16 a[92:95], v[140:143], v[156:159], a[92:95]
  v_mfma_f32_16x16x32_bf16 a[96:99], v[144:147], v[156:159], a[96:99]
  v_mfma_f32_16x16x32_bf16 a[100:103], v[148:151], v[156:159], a[100:103]
  v_mfma_f32_16x16x32_bf16 a[104:107], v[136:139], v[160:163], a[104:107]
  v_mfma_f32_16x16x32_bf16 a[108:111], v[140:143], v[160:163], a[108:111]
  v_mfma_f32_16x16x32_bf16 a[112:115], v[144:147], v[160:163], a[112:115]
  v_mfma_f32_16x16x32_bf16 a[116:119], v[148:151], v[160:163], a[116:119]
  v_mfma_f32_16x16x32_bf16 a[120:123], v[136:139], v[164:167], a[120:123]
  v_mfma_f32_16x16x32_bf16 a[124:127], v[140:143], v[164:167], a[124:127]
  v_mfma_f32_16x16x32_bf16 a[128:131], v[144:147], v[164:167], a[128:131]
  v_mfma_f32_16x16x32_bf16 a[132:135], v[148:151], v[164:167], a[132:135]
  v_mfma_f32_16x16x32_bf16 a[136:139], v[136:139], v[168:171], a[136:139]
  v_mfma_f32_16x16x32_bf16 a[140:143], v[140:143], v[168:171], a[140:143]
  s_waitcnt vmcnt(13) lgkmcnt(0)
  s_barrier
  v_mfma_f32_16x16x32_bf16 a[0:3], v[172:175], v[204:207], a[0:3]
  ds_read_b64_tr_b16 v[120:121], v112 offset:0
  v_mfma_f32_16x16x32_bf16 a[4:7], v[176:179], v[204:207], a[4:7]
  ds_read_b64_tr_b16 v[122:123], v112 offset:1024
  s_mov_b32 m0, s31
  v_mfma_f32_16x16x32_bf16 a[8:11], v[180:183], v[204:207], a[8:11]
  buffer_load_dwordx4 v10, s[8:11], s41 offen offset:0 nt lds
  v_mfma_f32_16x16x32_bf16 a[12:15], v[184:187], v[204:207], a[12:15]
  ds_read_b64_tr_b16 v[124:125], v112 offset:8
  v_mfma_f32_16x16x32_bf16 a[16:19], v[172:175], v[208:211], a[16:19]
  ds_read_b64_tr_b16 v[126:127], v112 offset:1032
  v_mfma_f32_16x16x32_bf16 a[20:23], v[176:179], v[208:211], a[20:23]
  buffer_load_dwordx4 v11, s[8:11], s41 offen offset:1024 nt lds
  v_mfma_f32_16x16x32_bf16 a[24:27], v[180:183], v[208:211], a[24:27]
  ds_read_b64_tr_b16 v[128:129], v113 offset:0
  v_mfma_f32_16x16x32_bf16 a[28:31], v[184:187], v[208:211], a[28:31]
  ds_read_b64_tr_b16 v[130:131], v113 offset:1024
  v_mfma_f32_16x16x32_bf16 a[32:35], v[172:175], v[212:215], a[32:35]
  buffer_load_dwordx4 v12, s[8:11], s41 offen offset:2048 nt lds
  v_mfma_f32_16x16x32_bf16 a[36:39], v[176:179], v[212:215], a[36:39]
  ds_read_b64_tr_b16 v[132:133], v113 offset:8
  v_mfma_f32_16x16x32_bf16 a[40:43], v[180:183], v[212:215], a[40:43]
  ds_read_b64_tr_b16 v[134:135], v113 offset:1032
  v_mfma_f32_16x16x32_bf16 a[44:47], v[184:187], v[212:215], a[44:47]
  buffer_load_dwordx4 v13, s[8:11], s41 offen offset:3072 nt lds
  v_mfma_f32_16x16x32_bf16 a[48:51], v[172:175], v[216:219], a[48:51]
  ds_read_b128 v[152:155], v100 offset:36864
  v_mfma_f32_16x16x32_bf16 a[52:55], v[176:179], v[216:219], a[52:55]
  ds_read_b128 v[156:159], v100 offset:38912
  s_add_u32 m0, s31, 4096
  v_mfma_f32_16x16x32_bf16 a[56:59], v[180:183], v[216:219], a[56:59]
  buffer_load_dwordx4 v248, s[8:11], s41 offen offset:0 nt lds
  v_mfma_f32_16x16x32_bf16 a[60:63], v[184:187], v[216:219], a[60:63]
  ds_read_b128 v[160:163], v100 offset:40960
  v_mfma_f32_16x16x32_bf16 a[64:67], v[172:175], v[220:223], a[64:67]
  ds_read_b128 v[164:167], v100 offset:43008
  v_mfma_f32_16x16x32_bf16 a[68:71], v[176:179], v[220:223], a[68:71]
  buffer_load_dwordx4 v249, s[8:11], s41 offen offset:1024 nt lds
  v_mfma_f32_16x16x32_bf16 a[72:75], v[188:191], v[204:207], a[72:75]
  ds_read_b128 v[168:171], v102 offset:36864
  v_mfma_f32_16x16x32_bf16 a[76:79], v[192:195], v[204:207], a[76:79]
  ds_read_b64_tr_b16 v[136:137], v112 offset:8192
  v_mfma_f32_16x16x32_bf16 a[80:83], v[196:199], v[204:207], a[80:83]
  buffer_load_dwordx4 v250, s[8:11], s41 offen offset:2048 nt lds
  v_mfma_f32_16x16x32_bf16 a[84:87], v[200:203], v[204:207], a[84:87]
  ds_read_b64_tr_b16 v[138:139], v112 offset:9216
  v_mfma_f32_16x16x32_bf16 a[88:91], v[188:191], v[208:211], a[88:91]
  s_waitcnt lgkmcnt(14)
  ds_read_b64_tr_b16 v[140:141], v112 offset:8200
  v_mfma_f32_16x16x32_bf16 a[92:95], v[192:195], v[208:211], a[92:95]
  buffer_load_dwordx4 v251, s[8:11], s41 offen offset:3072 nt lds
  v_mfma_f32_16x16x32_bf16 a[96:99], v[196:199], v[208:211], a[96:99]
  s_waitcnt lgkmcnt(14)
  ds_read_b64_tr_b16 v[142:143], v112 offset:9224
  v_mfma_f32_16x16x32_bf16 a[100:103], v[200:203], v[208:211], a[100:103]
  s_waitcnt lgkmcnt(14)
  ds_read_b64_tr_b16 v[144:145], v113 offset:8192
  v_mfma_f32_16x16x32_bf16 a[104:107], v[188:191], v[212:215], a[104:107]
  s_add_u32 s41, s41, 16384
  s_add_u32 s31, s31, 32768
  s_cmp_eq_u32 s31, s30
  s_cselect_b32 s31, s42, s31
  s_waitcnt lgkmcnt(14)
  ds_read_b64_tr_b16 v[146:147], v113 offset:9216
  v_mfma_f32_16x16x32_bf16 a[108:111], v[192:195], v[212:215], a[108:111]
  s_waitcnt lgkmcnt(14)
  ds_read_b64_tr_b16 v[148:149], v113 offset:8200
  v_mfma_f32_16x16x32_bf16 a[112:115], v[196:199], v[212:215], a[112:115]
  s_waitcnt lgkmcnt(14)
  ds_read_b64_tr_b16 v[150:151], v113 offset:9224
  v_mfma_f32_16x16x32_bf16 a[116:119], v[200:203], v[212:215], a[116:119]
  v_mfma_f32_16x16x32_bf16 a[120:123], v[188:191], v[216:219], a[120:123]
  v_mfma_f32_16x16x32_bf16 a[124:127], v[192:195], v[216:219], a[124:127]
  v_mfma_f32_16x16x32_bf16 a[128:131], v[196:199], v[216:219], a[128:131]
  v_mfma_f32_16x16x32_bf16 a[132:135], v[200:203], v[216:219], a[132:135]
  v_mfma_f32_16x16x32_bf16 a[136:139], v[188:191], v[220:223], a[136:139]
  v_mfma_f32_16x16x32_bf16 a[140:143], v[192:195], v[220:223], a[140:143]
  s_waitcnt vmcnt(21) lgkmcnt(0)
  s_barrier
  v_mfma_f32_16x16x32_bf16 a[0:3], v[120:123], v[152:155], a[0:3]
  ds_read_b64_tr_b16 v[172:173], v112 offset:16384
  v_mfma_f32_16x16x32_bf16 a[4:7], v[124:127], v[152:155], a[4:7]
  ds_read_b64_tr_b16 v[174:175], v112 offset:17408
  v_mfma_f32_16x16x32_bf16 a[8:11], v[128:131], v[152:155], a[8:11]
  ds_read_b64_tr_b16 v[176:177], v112 offset:16392
  v_mfma_f32_16x16x32_bf16 a[12:15], v[132:135], v[152:155], a[12:15]
  ds_read_b64_tr_b16 v[178:179], v112 offset:17416
  v_mfma_f32_16x16x32_bf16 a[16:19], v[120:123], v[156:159], a[16:19]
  ds_read_b64_tr_b16 v[180:181], v113 offset:16384
  v_mfma_f32_16x16x32_bf16 a[20:23], v[124:127], v[156:159], a[20:23]
  ds_read_b64_tr_b16 v[182:183], v113 offset:17408
  v_mfma_f32_16x16x32_bf16 a[24:27], v[128:131], v[156:159], a[24:27]
  ds_read_b64_tr_b16 v[184:185], v113 offset:16392
  v_mfma_f32_16x16x32_bf16 a[28:31], v[132:135], v[156:159], a[28:31]
  ds_read_b64_tr_b16 v[186:187], v113 offset:17416
  v_mfma_f32_16x16x32_bf16 a[32:35], v[120:123], v[160:163], a[32:35]
  ds_read_b128 v[204:207], v101 offset:36864
  v_mfma_f32_16x16x32_bf16 a[36:39], v[124:127], v[160:163], a[36:39]
  ds_read_b128 v[208:211], v101 offset:38912
  v_mfma_f32_16x16x32_bf16 a[40:43], v[128:131], v[160:163], a[40:43]
  ds_read_b128 v[212:215], v101 offset:40960
  v_mfma_f32_16x16x32_bf16 a[44:47], v[132:135], v[160:163], a[44:47]
  ds_read_b128 v[216:219], v101 offset:43008
  v_mfma_f32_16x16x32_bf16 a[48:51], v[120:123], v[164:167], a[48:51]
  ds_read_b128 v[220:223], v103 offset:36864
  v_mfma_f32_16x16x32_bf16 a[52:55], v[124:127], v[164:167], a[52:55]
  ds_read_b64_tr_b16 v[188:189], v112 offset:24576
  v_mfma_f32_16x16x32_bf16 a[56:59], v[128:131], v[164:167], a[56:59]
  ds_read_b64_tr_b16 v[190:191], v112 offset:25600
  v_mfma_f32_16x16x32_bf16 a[60:63], v[132:135], v[164:167], a[60:63]
  s_waitcnt lgkmcnt(14)
  ds_read_b64_tr_b16 v[192:193], v112 offset:24584
  v_mfma_f32_16x16x32_bf16 a[64:67], v[120:123], v[168:171], a[64:67]
  s_waitcnt lgkmcnt(14)
  ds_read_b64_tr_b16 v[194:195], v112 offset:25608
  v_mfma_f32_16x16x32_bf16 a[68:71], v[124:127], v[168:171], a[68:71]
  s_waitcnt lgkmcnt(14)
  ds_read_b64_tr_b16 v[196:197], v113 offset:24576
  v_mfma_f32_16x16x32_bf16 a[72:75], v[136:139], v[152:155], a[72:75]
  s_waitcnt lgkmcnt(14)
  ds_read_b64_tr_b16 v[198:199], v113 offset:25600
  v_mfma_f32_16x16x32_bf16 a[76:79], v[140:143], v[152:155], a[76:79]
  s_waitcnt lgkmcnt(14)
  ds_read_b64_tr_b16 v[200:201], v113 offset:24584
  v_mfma_f32_16x16x32_bf16 a[80:83], v[144:147], v[152:155], a[80:83]
  s_waitcnt lgkmcnt(14)
  ds_read_b64_tr_b16 v[202:203], v113 offset:25608
  v_mfma_f32_16x16x32_bf16 a[84:87], v[148:151], v[152:155], a[84:87]
  v_mfma_f32_16x16x32_bf16 a[88:91], v[136:139], v[156:159], a[88:91]
  v_mfma_f32_16x16x32_bf16 a[92:95], v[140:143], v[156:159], a[92:95]
  v_mfma_f32_16x16x32_bf16 a[96:99], v[144:147], v[156:159], a[96:99]
  v_mfma_f32_16x16x32_bf16 a[100:103], v[148:151], v[156:159], a[100:103]
  v_mfma_f32_16x16x32_bf16 a[104:107], v[136:139], v[160:163], a[104:107]
  v_mfma_f32_16x16x32_bf16 a[108:111], v[140:143], v[160:163], a[108:111]
  v_mfma_f32_16x16x32_bf16 a[112:115], v[144:147], v[160:163], a[112:115]
  v_mfma_f32_16x16x32_bf16 a[116:119], v[148:151], v[160:163], a[116:119]
  v_mfma_f32_16x16x32_bf16 a[120:123], v[136:139], v[164:167], a[120:123]
  v_mfma_f32_16x16x32_bf16 a[124:127], v[140:143], v[164:167], a[124:127]
  v_mfma_f32_16x16x32_bf16 a[128:131], v[144:147], v[164:167], a[128:131]
  v_mfma_f32_16x16x32_bf16 a[132:135], v[148:151], v[164:167], a[132:135]
  v_mfma_f32_16x16x32_bf16 a[136:139], v[136:139], v[168:171], a[136:139]
  v_mfma_f32_16x16x32_bf16 a[140:143], v[140:143], v[168:171], a[140:143]
  s_waitcnt vmcnt(8) lgkmcnt(0)
  s_barrier
  v_mfma_f32_16x16x32_bf16 a[0:3], v[172:175], v[204:207], a[0:3]
  ds_read_b64_tr_b16 v[120:121], v104 offset:0
  v_mfma_f32_16x16x32_bf16 a[4:7], v[176:179], v[204:207], a[4:7]
  ds_read_b64_tr_b16 v[122:123], v104 offset:1024
  s_mov_b32 m0, s31
  v_mfma_f32_16x16x32_bf16 a[8:11], v[180:183], v[204:207], a[8:11]
  buffer_load_dwordx4 v10, s[8:11], s41 offen offset:0 nt lds
  v_mfma_f32_16x16x32_bf16 a[12:15], v[184:187], v[204:207], a[12:15]
  ds_read_b64_tr_b16 v[124:125], v104 offset:8
  v_mfma_f32_16x16x32_bf16 a[16:19], v[172:175], v[208:211], a[16:19]
  ds_read_b64_tr_b16 v[126:127], v104 offset:1032
  v_mfma_f32_16x16x32_bf16 a[20:23], v[176:179], v[208:211], a[20:23]
  buffer_load_dwordx4 v11, s[8:11], s41 offen offset:1024 nt lds
  v_mfma_f32_16x16x32_bf16 a[24:27], v[180:183], v[208:211], a[24:27]
  ds_read_b64_tr_b16 v[128:129], v105 offset:0
  v_mfma_f32_16x16x32_bf16 a[28:31], v[184:187], v[208:211], a[28:31]
  ds_read_b64_tr_b16 v[130:131], v105 offset:1024
  v_mfma_f32_16x16x32_bf16 a[32:35], v[172:175], v[212:215], a[32:35]
  buffer_load_dwordx4 v12, s[8:11], s41 offen offset:2048 nt lds
  v_mfma_f32_16x16x32_bf16 a[36:39], v[176:179], v[212:215], a[36:39]
  ds_read_b64_tr_b16 v[132:133], v105 offset:8
  v_mfma_f32_16x16x32_bf16 a[40:43], v[180:183], v[212:215], a[40:43]
  ds_read_b64_tr_b16 v[134:135], v105 offset:1032
  v_mfma_f32_16x16x32_bf16 a[44:47], v[184:187], v[212:215], a[44:47]
  buffer_load_dwordx4 v13, s[8:11], s41 offen offset:3072 nt lds
  v_mfma_f32_16x16x32_bf16 a[48:51], v[172:175], v[216:219], a[48:51]
  ds_read_b128 v[152:155], v100 offset:0
  v_mfma_f32_16x16x32_bf16 a[52:55], v[176:179], v[216:219], a[52:55]
  ds_read_b128 v[156:159], v100 offset:2048
  s_add_u32 m0, s31, 4096
  v_mfma_f32_16x16x32_bf16 a[56:59], v[180:183], v[216:219], a[56:59]
  buffer_load_dwordx4 v248, s[8:11], s41 offen offset:0 nt lds
  v_mfma_f32_16x16x32_bf16 a[60:63], v[184:187], v[216:219], a[60:63]
  ds_read_b128 v[160:163], v100 offset:4096
  v_mfma_f32_16x16x32_bf16 a[64:67], v[172:175], v[220:223], a[64:67]
  ds_read_b128 v[164:167], v100 offset:6144
  v_mfma_f32_16x16x32_bf16 a[68:71], v[176:179], v[220:223], a[68:71]
  buffer_load_dwordx4 v249, s[8:11], s41 offen offset:1024 nt lds
  v_mfma_f32_16x16x32_bf16 a[72:75], v[188:191], v[204:207], a[72:75]
  ds_read_b128 v[168:171], v102 offset:0
  v_mfma_f32_16x16x32_bf16 a[76:79], v[192:195], v[204:207], a[76:79]
  ds_read_b64_tr_b16 v[136:137], v104 offset:8192
  v_mfma_f32_16x16x32_bf16 a[80:83], v[196:199], v[204:207], a[80:83]
  buffer_load_dwordx4 v250, s[8:11], s41 offen offset:2048 nt lds
  v_mfma_f32_16x16x32_bf16 a[84:87], v[200:203], v[204:207], a[84:87]
  ds_read_b64_tr_b16 v[138:139], v104 offset:9216
  v_mfma_f32_16x16x32_bf16 a[88:91], v[188:191], v[208:211], a[88:91]
  s_waitcnt lgkmcnt(14)
  ds_read_b64_tr_b16 v[140:141], v104 offset:8200
  v_mfma_f32_16x16x32_bf16 a[92:95], v[192:195], v[208:211], a[92:95]
  buffer_load_dwordx4 v251, s[8:11], s41 offen offset:3072 nt lds
  v_mfma_f32_16x16x32_bf16 a[96:99], v[196:199], v[208:211], a[96:99]
  s_waitcnt lgkmcnt(14)
  ds_read_b64_tr_b16 v[142:143], v104 offset:9224
  v_mfma_f32_16x16x32_bf16 a[100:103], v[200:203], v[208:211], a[100:103]
  s_waitcnt lgkmcnt(14)
  ds_read_b64_tr_b16 v[144:145], v105 offset:8192
  v_mfma_f32_16x16x32_bf16 a[104:107], v[188:191], v[212:215], a[104:107]
  s_add_u32 s41, s41, 16384
  s_add_u32 s31, s31, 32768
  s_cmp_eq_u32 s31, s30
  s_cselect_b32 s31, s42, s31
  s_waitcnt lgkmcnt(14)
  ds_read_b64_tr_b16 v[146:147], v105 offset:9216
  v_mfma_f32_16x16x32_bf16 a[108:111], v[192:195], v[212:215], a[108:111]
  s_waitcnt lgkmcnt(14)
  ds_read_b64_tr_b16 v[148:149], v105 offset:8200
  v_mfma_f32_16x16x32_bf16 a[112:115], v[196:199], v[212:215], a[112:115]
  s_waitcnt lgkmcnt(14)
  ds_read_b64_tr_b16 v[150:151], v105 offset:9224
  v_mfma_f32_16x16x32_bf16 a[116:119], v[200:203], v[212:215], a[116:119]
  v_mfma_f32_16x16x32_bf16 a[120:123], v[188:191], v[216:219], a[120:123]
  v_mfma_f32_16x16x32_bf16 a[124:127], v[192:195], v[216:219], a[124:127]
  v_mfma_f32_16x16x32_bf16 a[128:131], v[196:199], v[216:219], a[128:131]
  v_mfma_f32_16x16x32_bf16 a[132:135], v[200:203], v[216:219], a[132:135]
  v_mfma_f32_16x16x32_bf16 a[136:139], v[188:191], v[220:223], a[136:139]
  v_mfma_f32_16x16x32_bf16 a[140:143], v[192:195], v[220:223], a[140:143]
  s_waitcnt vmcnt(16) lgkmcnt(0)
  s_barrier
  v_mfma_f32_16x16x32_bf16 a[0:3], v[120:123], v[152:155], a[0:3]
  ds_read_b64_tr_b16 v[172:173], v104 offset:16384
  v_mfma_f32_16x16x32_bf16 a[4:7], v[124:127], v[152:155], a[4:7]
  ds_read_b64_tr_b16 v[174:175], v104 offset:17408
  v_mfma_f32_16x16x32_bf16 a[8:11], v[128:131], v[152:155], a[8:11]
  ds_read_b64_tr_b16 v[176:177], v104 offset:16392
  v_mfma_f32_16x16x32_bf16 a[12:15], v[132:135], v[152:155], a[12:15]
  ds_read_b64_tr_b16 v[178:179], v104 offset:17416
  v_mfma_f32_16x16x32_bf16 a[16:19], v[120:123], v[156:159], a[16:19]
  ds_read_b64_tr_b16 v[180:181], v105 offset:16384
  v_mfma_f32_16x16x32_bf16 a[20:23], v[124:127], v[156:159], a[20:23]
  ds_read_b64_tr_b16 v[182:183], v105 offset:17408
  v_mfma_f32_16x16x32_bf16 a[24:27], v[128:131], v[156:159], a[24:27]
  ds_read_b64_tr_b16 v[184:185], v105 offset:16392
  v_mfma_f32_16x16x32_bf16 a[28:31], v[132:135], v[156:159], a[28:31]
  ds_read_b64_tr_b16 v[186:187], v105 offset:17416
  v_mfma_f32_16x16x32_bf16 a[32:35], v[120:123], v[160:163], a[32:35]
  ds_read_b128 v[204:207], v101 offset:0
  v_mfma_f32_16x16x32_bf16 a[36:39], v[124:127], v[160:163], a[36:39]
  ds_read_b128 v[208:211], v101 offset:2048
  v_mfma_f32_16x16x32_bf16 a[40:43], v[128:131], v[160:163], a[40:43]
  ds_read_b128 v[212:215], v101 offset:4096
  v_mfma_f32_16x16x32_bf16 a[44:47], v[132:135], v[160:163], a[44:47]
  ds_read_b128 v[216:219], v101 offset:6144
  v_mfma_f32_16x16x32_bf16 a[48:51], v[120:123], v[164:167], a[48:51]
  ds_read_b128 v[220:223], v103 offset:0
  v_mfma_f32_16x16x32_bf16 a[52:55], v[124:127], v[164:167], a[52:55]
  ds_read_b64_tr_b16 v[188:189], v104 offset:24576
  v_mfma_f32_16x16x32_bf16 a[56:59], v[128:131], v[164:167], a[56:59]
  ds_read_b64_tr_b16 v[190:191], v104 offset:25600
  v_mfma_f32_16x16x32_bf16 a[60:63], v[132:135], v[164:167], a[60:63]
  s_waitcnt lgkmcnt(14)
  ds_read_b64_tr_b16 v[192:193], v104 offset:24584
  v_mfma_f32_16x16x32_bf16 a[64:67], v[120:123], v[168:171], a[64:67]
  s_waitcnt lgkmcnt(14)
  ds_read_b64_tr_b16 v[194:195], v104 offset:25608
  v_mfma_f32_16x16x32_bf16 a[68:71], v[124:127], v[168:171], a[68:71]
  s_waitcnt lgkmcnt(14)
  ds_read_b64_tr_b16 v[196:197], v105 offset:24576
  v_mfma_f32_16x16x32_bf16 a[72:75], v[136:139], v[152:155], a[72:75]
  s_waitcnt lgkmcnt(14)
  ds_read_b64_tr_b16 v[198:199], v105 offset:25600
  v_mfma_f32_16x16x32_bf16 a[76:79], v[140:143], v[152:155], a[76:79]
  s_waitcnt lgkmcnt(14)
  ds_read_b64_tr_b16 v[200:201], v105 offset:24584
  v_mfma_f32_16x16x32_bf16 a[80:83], v[144:147], v[152:155], a[80:83]
  s_waitcnt lgkmcnt(14)
  ds_read_b64_tr_b16 v[202:203], v105 offset:25608
  v_mfma_f32_16x16x32_bf16 a[84:87], v[148:151], v[152:155], a[84:87]
  v_mfma_f32_16x16x32_bf16 a[88:91], v[136:139], v[156:159], a[88:91]
  v_mfma_f32_16x16x32_bf16 a[92:95], v[140:143], v[156:159], a[92:95]
  v_mfma_f32_16x16x32_bf16 a[96:99], v[144:147], v[156:159], a[96:99]
  v_mfma_f32_16x16x32_bf16 a[100:103], v[148:151], v[156:159], a[100:103]
  v_mfma_f32_16x16x32_bf16 a[104:107], v[136:139], v[160:163], a[104:107]
  v_mfma_f32_16x16x32_bf16 a[108:111], v[140:143], v[160:163], a[108:111]
  v_mfma_f32_16x16x32_bf16 a[112:115], v[144:147], v[160:163], a[112:115]
  v_mfma_f32_16x16x32_bf16 a[116:119], v[148:151], v[160:163], a[116:119]
  v_mfma_f32_16x16x32_bf16 a[120:123], v[136:139], v[164:167], a[120:123]
  v_mfma_f32_16x16x32_bf16 a[124:127], v[140:143], v[164:167], a[124:127]
  v_mfma_f32_16x16x32_bf16 a[128:131], v[144:147], v[164:167], a[128:131]
  v_mfma_f32_16x16x32_bf16 a[132:135], v[148:151], v[164:167], a[132:135]
  v_mfma_f32_16x16x32_bf16 a[136:139], v[136:139], v[168:171], a[136:139]
  v_mfma_f32_16x16x32_bf16 a[140:143], v[140:143], v[168:171], a[140:143]
  s_waitcnt vmcnt(63) lgkmcnt(0)
  s_barrier
  v_mfma_f32_16x16x32_bf16 a[0:3], v[172:175], v[204:207], a[0:3]
  s_mov_b32 m0, s31
  s_nop 0
  buffer_load_dwordx4 v10, s[8:11], s41 offen offset:0 nt lds
  v_mfma_f32_16x16x32_bf16 a[4:7], v[176:179], v[204:207], a[4:7]
  buffer_load_dwordx4 v11, s[8:11], s41 offen offset:1024 nt lds
  v_mfma_f32_16x16x32_bf16 a[8:11], v[180:183], v[204:207], a[8:11]
  buffer_load_dwordx4 v12, s[8:11], s41 offen offset:2048 nt lds
  v_mfma_f32_16x16x32_bf16 a[12:15], v[184:187], v[204:207], a[12:15]
  buffer_load_dwordx4 v13, s[8:11], s41 offen offset:3072 nt lds
  v_mfma_f32_16x16x32_bf16 a[16:19], v[172:175], v[208:211], a[16:19]
  s_add_u32 m0, s31, 4096
  s_nop 0
  buffer_load_dwordx4 v248, s[8:11], s41 offen offset:0 nt lds
  v_mfma_f32_16x16x32_bf16 a[20:23], v[176:179], v[208:211], a[20:23]
  buffer_load_dwordx4 v249, s[8:11], s41 offen offset:1024 nt lds
  v_mfma_f32_16x16x32_bf16 a[24:27], v[180:183], v[208:211], a[24:27]
  buffer_load_dwordx4 v250, s[8:11], s41 offen offset:2048 nt lds
  v_mfma_f32_16x16x32_bf16 a[28:31], v[184:187], v[208:211], a[28:31]
  buffer_load_dwordx4 v251, s[8:11], s41 offen offset:3072 nt lds
  v_mfma_f32_16x16x32_bf16 a[32:35], v[172:175], v[212:215], a[32:35]
  s_add_u32 s41, s41, 16384
  s_add_u32 s31, s31, 32768
  s_cmp_eq_u32 s31, s30
  s_cselect_b32 s31, s42, s31
  v_mfma_f32_16x16x32_bf16 a[36:39], v[176:179], v[212:215], a[36:39]
  v_mfma_f32_16x16x32_bf16 a[40:43], v[180:183], v[212:215], a[40:43]
  v_mfma_f32_16x16x32_bf16 a[44:47], v[184:187], v[212:215], a[44:47]
  v_mfma_f32_16x16x32_bf16 a[48:51], v[172:175], v[216:219], a[48:51]
  v_mfma_f32_16x16x32_bf16 a[52:55], v[176:179], v[216:219], a[52:55]
  v_mfma_f32_16x16x32_bf16 a[56:59], v[180:183], v[216:219], a[56:59]
  v_mfma_f32_16x16x32_bf16 a[60:63], v[184:187], v[216:219], a[60:63]
  v_mfma_f32_16x16x32_bf16 a[64:67], v[172:175], v[220:223], a[64:67]
  v_mfma_f32_16x16x32_bf16 a[68:71], v[176:179], v[220:223], a[68:71]
  v_mfma_f32_16x16x32_bf16 a[72:75], v[188:191], v[204:207], a[72:75]
  v_mfma_f32_16x16x32_bf16 a[76:79], v[192:195], v[204:207], a[76:79]
  v_mfma_f32_16x16x32_bf16 a[80:83], v[196:199], v[204:207], a[80:83]
  v_mfma_f32_16x16x32_bf16 a[84:87], v[200:203], v[204:207], a[84:87]
  v_mfma_f32_16x16x32_bf16 a[88:91], v[188:191], v[208:211], a[88:91]
  v_mfma_f32_16x16x32_bf16 a[92:95], v[192:195], v[208:211], a[92:95]
  v_mfma_f32_16x16x32_bf16 a[96:99], v[196:199], v[208:211], a[96:99]
  v_mfma_f32_16x16x32_bf16 a[100:103], v[200:203], v[208:211], a[100:103]
  v_mfma_f32_16x16x32_bf16 a[104:107], v[188:191], v[212:215], a[104:107]
  v_mfma_f32_16x16x32_bf16 a[108:111], v[192:195], v[212:215], a[108:111]
  v_mfma_f32_16x16x32_bf16 a[112:115], v[196:199], v[212:215], a[112:115]
  v_mfma_f32_16x16x32_bf16 a[116:119], v[200:203], v[212:215], a[116:119]
  v_mfma_f32_16x16x32_bf16 a[120:123], v[188:191], v[216:219], a[120:123]
  v_mfma_f32_16x16x32_bf16 a[124:127], v[192:195], v[216:219], a[124:127]
  v_mfma_f32_16x16x32_bf16 a[128:131], v[196:199], v[216:219], a[128:131]
  v_mfma_f32_16x16x32_bf16 a[132:135], v[200:203], v[216:219], a[132:135]
  v_mfma_f32_16x16x32_bf16 a[136:139], v[188:191], v[220:223], a[136:139]
  v_mfma_f32_16x16x32_bf16 a[140:143], v[192:195], v[220:223], a[140:143]
fa_kernel_hot0:
  s_waitcnt lgkmcnt(0)
  s_nop 7
  s_barrier
  s_cmp_lg_u32 s45, 0
  s_cbranch_scc1 fa_kernel_qredo
  v_mov_b32 v8, 0x3e0293ee
  v_lshlrev_b32 v2, 4, v1
  v_add_u32 v2, 98304, v2
  s_lshl_b32 s40, s25, 14
  s_lshl_b32 s43, s26, 11
  s_add_u32 s40, s40, s43
  s_lshl_b32 s43, s25, 10
  s_add_u32 s46, s40, s43
  s_xor_b32 s43, s43, 1024
  s_add_u32 s47, s40, s43
  v_add_u32 v3, s46, v2
  v_add_u32 v4, s47, v2
  s_lshl_b32 s40, s26, 11
  s_lshl_b32 s43, s25, 10
  s_add_u32 s40, s40, s43
  v_add_u32 v5, s40, v2
  v_accvgpr_read_b32 v124, a0
  v_accvgpr_read_b32 v125, a1
  v_accvgpr_read_b32 v126, a2
  v_accvgpr_read_b32 v127, a3
  v_accvgpr_read_b32 v128, a4
  v_accvgpr_read_b32 v129, a5
  v_accvgpr_read_b32 v130, a6
  v_accvgpr_read_b32 v131, a7
  v_mul_f32 v124, v8, v124
  v_mul_f32 v125, v8, v125
  v_mul_f32 v126, v8, v126
  v_mul_f32 v127, v8, v127
  v_mul_f32 v128, v8, v128
  v_mul_f32 v129, v8, v129
  v_mul_f32 v130, v8, v130
  v_mul_f32 v131, v8, v131
  v_cvt_pk_bf16_f32 v120, v124, v125
  v_cvt_pk_bf16_f32 v121, v126, v127
  v_cvt_pk_bf16_f32 v122, v128, v129
  v_cvt_pk_bf16_f32 v123, v130, v131
  ds_write_b128 v3, v[120:123] offset:0
  v_accvgpr_read_b32 v136, a8
  v_accvgpr_read_b32 v137, a9
  v_accvgpr_read_b32 v138, a10
  v_accvgpr_read_b32 v139, a11
  v_accvgpr_read_b32 v140, a12
  v_accvgpr_read_b32 v141, a13
  v_accvgpr_read_b32 v142, a14
  v_accvgpr_read_b32 v143, a15
  v_mul_f32 v136, v8, v136
  v_mul_f32 v137, v8, v137
  v_mul_f32 v138, v8, v138
  v_mul_f32 v139, v8, v139
  v_mul_f32 v140, v8, v140
  v_mul_f32 v141, v8, v141
  v_mul_f32 v142, v8, v142
  v_mul_f32 v143, v8, v143
  v_cvt_pk_bf16_f32 v132, v136, v137
  v_cvt_pk_bf16_f32 v133, v138, v139
  v_cvt_pk_bf16_f32 v134, v140, v141
  v_cvt_pk_bf16_f32 v135, v142, v143
  ds_write_b128 v4, v[132:135] offset:0
  v_accvgpr_read_b32 v148, a16
  v_accvgpr_read_b32 v149, a17
  v_accvgpr_read_b32 v150, a18
  v_accvgpr_read_b32 v151, a19
  v_accvgpr_read_b32 v152, a20
  v_accvgpr_read_b32 v153, a21
  v_accvgpr_read_b32 v154, a22
  v_accvgpr_read_b32 v155, a23
  v_mul_f32 v148, v8, v148
  v_mul_f32 v149, v8, v149
  v_mul_f32 v150, v8, v150
  v_mul_f32 v151, v8, v151
  v_mul_f32 v152, v8, v152
  v_mul_f32 v153, v8, v153
  v_mul_f32 v154, v8, v154
  v_mul_f32 v155, v8, v155
  v_cvt_pk_bf16_f32 v144, v148, v149
  v_cvt_pk_bf16_f32 v145, v150, v151
  v_cvt_pk_bf16_f32 v146, v152, v153
  v_cvt_pk_bf16_f32 v147, v154, v155
  ds_write_b128 v3, v[144:147] offset:4096
  v_accvgpr_read_b32 v160, a24
  v_accvgpr_read_b32 v161, a25
  v_accvgpr_read_b32 v162, a26
  v_accvgpr_read_b32 v163, a27
  v_accvgpr_read_b32 v164, a28
  v_accvgpr_read_b32 v165, a29
  v_accvgpr_read_b32 v166, a30
  v_accvgpr_read_b32 v167, a31
  v_mul_f32 v160, v8, v160
  v_mul_f32 v161, v8, v161
  v_mul_f32 v162, v8, v162
  v_mul_f32 v163, v8, v163
  v_mul_f32 v164, v8, v164
  v_mul_f32 v165, v8, v165
  v_mul_f32 v166, v8, v166
  v_mul_f32 v167, v8, v167
  v_cvt_pk_bf16_f32 v156, v160, v161
  v_cvt_pk_bf16_f32 v157, v162, v163
  v_cvt_pk_bf16_f32 v158, v164, v165
  v_cvt_pk_bf16_f32 v159, v166, v167
  ds_write_b128 v4, v[156:159] offset:4096
  v_accvgpr_read_b32 v172, a32
  v_accvgpr_read_b32 v173, a33
  v_accvgpr_read_b32 v174, a34
  v_accvgpr_read_b32 v175, a35
  v_accvgpr_read_b32 v176, a36
  v_accvgpr_read_b32 v177, a37
  v_accvgpr_read_b32 v178, a38
  v_accvgpr_read_b32 v179, a39
  v_mul_f32 v172, v8, v172
  v_mul_f32 v173, v8, v173
  v_mul_f32 v174, v8, v174
  v_mul_f32 v175, v8, v175
  v_mul_f32 v176, v8, v176
  v_mul_f32 v177, v8, v177
  v_mul_f32 v178, v8, v178
  v_mul_f32 v179, v8, v179
  v_cvt_pk_bf16_f32 v168, v172, v173
  v_cvt_pk_bf16_f32 v169, v174, v175
  v_cvt_pk_bf16_f32 v170, v176, v177
  v_cvt_pk_bf16_f32 v171, v178, v179
  ds_write_b128 v3, v[168:171] offset:8192
  v_accvgpr_read_b32 v184, a40
  v_accvgpr_read_b32 v185, a41
  v_accvgpr_read_b32 v186, a42
  v_accvgpr_read_b32 v187, a43
  v_accvgpr_read_b32 v188, a44
  v_accvgpr_read_b32 v189, a45
  v_accvgpr_read_b32 v190, a46
  v_accvgpr_read_b32 v191, a47
  v_mul_f32 v184, v8, v184
  v_mul_f32 v185, v8, v185
  v_mul_f32 v186, v8, v186
  v_mul_f32 v187, v8, v187
  v_mul_f32 v188, v8, v188
  v_mul_f32 v189, v8, v189
  v_mul_f32 v190, v8, v190
  v_mul_f32 v191, v8, v191
  v_cvt_pk_bf16_f32 v180, v184, v185
  v_cvt_pk_bf16_f32 v181, v186, v187
  v_cvt_pk_bf16_f32 v182, v188, v189
  v_cvt_pk_bf16_f32 v183, v190, v191
  ds_write_b128 v4, v[180:183] offset:8192
  v_accvgpr_read_b32 v196, a48
  v_accvgpr_read_b32 v197, a49
  v_accvgpr_read_b32 v198, a50
  v_accvgpr_read_b32 v199, a51
  v_accvgpr_read_b32 v200, a52
  v_accvgpr_read_b32 v201, a53
  v_accvgpr_read_b32 v202, a54
  v_accvgpr_read_b32 v203, a55
  v_mul_f32 v196, v8, v196
  v_mul_f32 v197, v8, v197
  v_mul_f32 v198, v8, v198
  v_mul_f32 v199, v8, v199
  v_mul_f32 v200, v8, v200
  v_mul_f32 v201, v8, v201
  v_mul_f32 v202, v8, v202
  v_mul_f32 v203, v8, v203
  v_cvt_pk_bf16_f32 v192, v196, v197
  v_cvt_pk_bf16_f32 v193, v198, v199
  v_cvt_pk_bf16_f32 v194, v200, v201
  v_cvt_pk_bf16_f32 v195, v202, v203
  ds_write_b128 v3, v[192:195] offset:12288
  v_accvgpr_read_b32 v208, a56
  v_accvgpr_read_b32 v209, a57
  v_accvgpr_read_b32 v210, a58
  v_accvgpr_read_b32 v211, a59
  v_accvgpr_read_b32 v212, a60
  v_accvgpr_read_b32 v213, a61
  v_accvgpr_read_b32 v214, a62
  v_accvgpr_read_b32 v215, a63
  v_mul_f32 v208, v8, v208
  v_mul_f32 v209, v8, v209
  v_mul_f32 v210, v8, v210
  v_mul_f32 v211, v8, v211
  v_mul_f32 v212, v8, v212
  v_mul_f32 v213, v8, v213
  v_mul_f32 v214, v8, v214
  v_mul_f32 v215, v8, v215
  v_cvt_pk_bf16_f32 v204, v208, v209
  v_cvt_pk_bf16_f32 v205, v210, v211
  v_cvt_pk_bf16_f32 v206, v212, v213
  v_cvt_pk_bf16_f32 v207, v214, v215
  ds_write_b128 v4, v[204:207] offset:12288
  v_accvgpr_read_b32 v220, a64
  v_accvgpr_read_b32 v221, a65
  v_accvgpr_read_b32 v222, a66
  v_accvgpr_read_b32 v223, a67
  v_accvgpr_read_b32 v224, a68
  v_accvgpr_read_b32 v225, a69
  v_accvgpr_read_b32 v226, a70
  v_accvgpr_read_b32 v227, a71
  v_mul_f32 v220, v8, v220
  v_mul_f32 v221, v8, v221
  v_mul_f32 v222, v8, v222
  v_mul_f32 v223, v8, v223
  v_mul_f32 v224, v8, v224
  v_mul_f32 v225, v8, v225
  v_mul_f32 v226, v8, v226
  v_mul_f32 v227, v8, v227
  v_cvt_pk_bf16_f32 v216, v220, v221
  v_cvt_pk_bf16_f32 v217, v222, v223
  v_cvt_pk_bf16_f32 v218, v224, v225
  v_cvt_pk_bf16_f32 v219, v226, v227
  ds_write_b128 v5, v[216:219] offset:32768
  s_waitcnt lgkmcnt(0)
  s_barrier
  v_lshlrev_b32 v2, 4, v1
  v_add_u32 v2, 98304, v2
  s_lshl_b32 s39, s25, 14
  v_add_u32 v3, s39, v2
  ds_read_b128 a[160:163], v3 offset:0
  ds_read_b128 a[164:167], v3 offset:1024
  ds_read_b128 a[168:171], v3 offset:2048
  ds_read_b128 a[172:175], v3 offset:3072
  ds_read_b128 a[176:179], v3 offset:4096
  ds_read_b128 a[180:183], v3 offset:5120
  ds_read_b128 a[184:187], v3 offset:6144
  ds_read_b128 a[188:191], v3 offset:7168
  ds_read_b128 a[192:195], v3 offset:8192
  ds_read_b128 a[196:199], v3 offset:9216
  ds_read_b128 a[200:203], v3 offset:10240
  ds_read_b128 a[204:207], v3 offset:11264
  ds_read_b128 a[208:211], v3 offset:12288
  ds_read_b128 a[212:215], v3 offset:13312
  ds_read_b128 a[216:219], v3 offset:14336
  s_waitcnt lgkmcnt(14)
  ds_read_b128 a[220:223], v3 offset:15360
  s_waitcnt lgkmcnt(14)
  ds_read_b128 a[224:227], v2 offset:32768
  s_waitcnt lgkmcnt(14)
  ds_read_b128 a[228:231], v2 offset:33792
  s_waitcnt lgkmcnt(14)
  ds_read_b128 a[232:235], v2 offset:34816
  s_waitcnt lgkmcnt(14)
  ds_read_b128 a[236:239], v2 offset:35840
  s_waitcnt lgkmcnt(0)
  s_barrier
  v_mov_b32 v8, 0x3e0293ee
  v_lshlrev_b32 v2, 4, v1
  v_add_u32 v2, 98304, v2
  s_lshl_b32 s40, s25, 14
  s_lshl_b32 s43, s26, 11
  s_add_u32 s40, s40, s43
  s_lshl_b32 s43, s25, 10
  s_add_u32 s46, s40, s43
  s_xor_b32 s43, s43, 1024
  s_add_u32 s47, s40, s43
  v_add_u32 v3, s46, v2
  v_add_u32 v4, s47, v2
  s_lshl_b32 s40, s26, 11
  s_lshl_b32 s43, s25, 10
  s_add_u32 s40, s40, s43
  v_add_u32 v5, s40, v2
  v_accvgpr_read_b32 v124, a72
  v_accvgpr_read_b32 v125, a73
  v_accvgpr_read_b32 v126, a74
  v_accvgpr_read_b32 v127, a75
  v_accvgpr_read_b32 v128, a76
  v_accvgpr_read_b32 v129, a77
  v_accvgpr_read_b32 v130, a78
  v_accvgpr_read_b32 v131, a79
  v_mul_f32 v124, v8, v124
  v_mul_f32 v125, v8, v125
  v_mul_f32 v126, v8, v126
  v_mul_f32 v127, v8, v127
  v_mul_f32 v128, v8, v128
  v_mul_f32 v129, v8, v129
  v_mul_f32 v130, v8, v130
  v_mul_f32 v131, v8, v131
  v_cvt_pk_bf16_f32 v120, v124, v125
  v_cvt_pk_bf16_f32 v121, v126, v127
  v_cvt_pk_bf16_f32 v122, v128, v129
  v_cvt_pk_bf16_f32 v123, v130, v131
  ds_write_b128 v3, v[120:123] offset:0
  v_accvgpr_read_b32 v136, a80
  v_accvgpr_read_b32 v137, a81
  v_accvgpr_read_b32 v138, a82
  v_accvgpr_read_b32 v139, a83
  v_accvgpr_read_b32 v140, a84
  v_accvgpr_read_b32 v141, a85
  v_accvgpr_read_b32 v142, a86
  v_accvgpr_read_b32 v143, a87
  v_mul_f32 v136, v8, v136
  v_mul_f32 v137, v8, v137
  v_mul_f32 v138, v8, v138
  v_mul_f32 v139, v8, v139
  v_mul_f32 v140, v8, v140
  v_mul_f32 v141, v8, v141
  v_mul_f32 v142, v8, v142
  v_mul_f32 v143, v8, v143
  v_cvt_pk_bf16_f32 v132, v136, v137
  v_cvt_pk_bf16_f32 v133, v138, v139
  v_cvt_pk_bf16_f32 v134, v140, v141
  v_cvt_pk_bf16_f32 v135, v142, v143
  ds_write_b128 v4, v[132:135] offset:0
  v_accvgpr_read_b32 v148, a88
  v_accvgpr_read_b32 v149, a89
  v_accvgpr_read_b32 v150, a90
  v_accvgpr_read_b32 v151, a91
  v_accvgpr_read_b32 v152, a92
  v_accvgpr_read_b32 v153, a93
  v_accvgpr_read_b32 v154, a94
  v_accvgpr_read_b32 v155, a95
  v_mul_f32 v148, v8, v148
  v_mul_f32 v149, v8, v149
  v_mul_f32 v150, v8, v150
  v_mul_f32 v151, v8, v151
  v_mul_f32 v152, v8, v152
  v_mul_f32 v153, v8, v153
  v_mul_f32 v154, v8, v154
  v_mul_f32 v155, v8, v155
  v_cvt_pk_bf16_f32 v144, v148, v149
  v_cvt_pk_bf16_f32 v145, v150, v151
  v_cvt_pk_bf16_f32 v146, v152, v153
  v_cvt_pk_bf16_f32 v147, v154, v155
  ds_write_b128 v3, v[144:147] offset:4096
  v_accvgpr_read_b32 v160, a96
  v_accvgpr_read_b32 v161, a97
  v_accvgpr_read_b32 v162, a98
  v_accvgpr_read_b32 v163, a99
  v_accvgpr_read_b32 v164, a100
  v_accvgpr_read_b32 v165, a101
  v_accvgpr_read_b32 v166, a102
  v_accvgpr_read_b32 v167, a103
  v_mul_f32 v160, v8, v160
  v_mul_f32 v161, v8, v161
  v_mul_f32 v162, v8, v162
  v_mul_f32 v163, v8, v163
  v_mul_f32 v164, v8, v164
  v_mul_f32 v165, v8, v165
  v_mul_f32 v166, v8, v166
  v_mul_f32 v167, v8, v167
  v_cvt_pk_bf16_f32 v156, v160, v161
  v_cvt_pk_bf16_f32 v157, v162, v163
  v_cvt_pk_bf16_f32 v158, v164, v165
  v_cvt_pk_bf16_f32 v159, v166, v167
  ds_write_b128 v4, v[156:159] offset:4096
  v_accvgpr_read_b32 v172, a104
  v_accvgpr_read_b32 v173, a105
  v_accvgpr_read_b32 v174, a106
  v_accvgpr_read_b32 v175, a107
  v_accvgpr_read_b32 v176, a108
  v_accvgpr_read_b32 v177, a109
  v_accvgpr_read_b32 v178, a110
  v_accvgpr_read_b32 v179, a111
  v_mul_f32 v172, v8, v172
  v_mul_f32 v173, v8, v173
  v_mul_f32 v174, v8, v174
  v_mul_f32 v175, v8, v175
  v_mul_f32 v176, v8, v176
  v_mul_f32 v177, v8, v177
  v_mul_f32 v178, v8, v178
  v_mul_f32 v179, v8, v179
  v_cvt_pk_bf16_f32 v168, v172, v173
  v_cvt_pk_bf16_f32 v169, v174, v175
  v_cvt_pk_bf16_f32 v170, v176, v177
  v_cvt_pk_bf16_f32 v171, v178, v179
  ds_write_b128 v3, v[168:171] offset:8192
  v_accvgpr_read_b32 v184, a112
  v_accvgpr_read_b32 v185, a113
  v_accvgpr_read_b32 v186, a114
  v_accvgpr_read_b32 v187, a115
  v_accvgpr_read_b32 v188, a116
  v_accvgpr_read_b32 v189, a117
  v_accvgpr_read_b32 v190, a118
  v_accvgpr_read_b32 v191, a119
  v_mul_f32 v184, v8, v184
  v_mul_f32 v185, v8, v185
  v_mul_f32 v186, v8, v186
  v_mul_f32 v187, v8, v187
  v_mul_f32 v188, v8, v188
  v_mul_f32 v189, v8, v189
  v_mul_f32 v190, v8, v190
  v_mul_f32 v191, v8, v191
  v_cvt_pk_bf16_f32 v180, v184, v185
  v_cvt_pk_bf16_f32 v181, v186, v187
  v_cvt_pk_bf16_f32 v182, v188, v189
  v_cvt_pk_bf16_f32 v183, v190, v191
  ds_write_b128 v4, v[180:183] offset:8192
  v_accvgpr_read_b32 v196, a120
  v_accvgpr_read_b32 v197, a121
  v_accvgpr_read_b32 v198, a122
  v_accvgpr_read_b32 v199, a123
  v_accvgpr_read_b32 v200, a124
  v_accvgpr_read_b32 v201, a125
  v_accvgpr_read_b32 v202, a126
  v_accvgpr_read_b32 v203, a127
  v_mul_f32 v196, v8, v196
  v_mul_f32 v197, v8, v197
  v_mul_f32 v198, v8, v198
  v_mul_f32 v199, v8, v199
  v_mul_f32 v200, v8, v200
  v_mul_f32 v201, v8, v201
  v_mul_f32 v202, v8, v202
  v_mul_f32 v203, v8, v203
  v_cvt_pk_bf16_f32 v192, v196, v197
  v_cvt_pk_bf16_f32 v193, v198, v199
  v_cvt_pk_bf16_f32 v194, v200, v201
  v_cvt_pk_bf16_f32 v195, v202, v203
  ds_write_b128 v3, v[192:195] offset:12288
  v_accvgpr_read_b32 v208, a128
  v_accvgpr_read_b32 v209, a129
  v_accvgpr_read_b32 v210, a130
  v_accvgpr_read_b32 v211, a131
  v_accvgpr_read_b32 v212, a132
  v_accvgpr_read_b32 v213, a133
  v_accvgpr_read_b32 v214, a134
  v_accvgpr_read_b32 v215, a135
  v_mul_f32 v208, v8, v208
  v_mul_f32 v209, v8, v209
  v_mul_f32 v210, v8, v210
  v_mul_f32 v211, v8, v211
  v_mul_f32 v212, v8, v212
  v_mul_f32 v213, v8, v213
  v_mul_f32 v214, v8, v214
  v_mul_f32 v215, v8, v215
  v_cvt_pk_bf16_f32 v204, v208, v209
  v_cvt_pk_bf16_f32 v205, v210, v211
  v_cvt_pk_bf16_f32 v206, v212, v213
  v_cvt_pk_bf16_f32 v207, v214, v215
  ds_write_b128 v4, v[204:207] offset:12288
  v_accvgpr_read_b32 v220, a136
  v_accvgpr_read_b32 v221, a137
  v_accvgpr_read_b32 v222, a138
  v_accvgpr_read_b32 v223, a139
  v_accvgpr_read_b32 v224, a140
  v_accvgpr_read_b32 v225, a141
  v_accvgpr_read_b32 v226, a142
  v_accvgpr_read_b32 v227, a143
  v_mul_f32 v220, v8, v220
  v_mul_f32 v221, v8, v221
  v_mul_f32 v222, v8, v222
  v_mul_f32 v223, v8, v223
  v_mul_f32 v224, v8, v224
  v_mul_f32 v225, v8, v225
  v_mul_f32 v226, v8, v226
  v_mul_f32 v227, v8, v227
  v_cvt_pk_bf16_f32 v216, v220, v221
  v_cvt_pk_bf16_f32 v217, v222, v223
  v_cvt_pk_bf16_f32 v218, v224, v225
  v_cvt_pk_bf16_f32 v219, v226, v227
  ds_write_b128 v5, v[216:219] offset:32768
  s_waitcnt lgkmcnt(0)
  s_barrier
fa_kernel_qdone:
fa_kernel_att:
  s_cmp_lg_u32 s25, 0
  s_cbranch_scc1 fa_kernel_q1
  v_mov_b32 v76, 0
  v_mov_b32 v56, 0
  v_mov_b32 v77, 0
  v_mov_b32 v57, 0
  v_mov_b32 v78, 0
  v_mov_b32 v58, 0
  v_mov_b32 v79, 0
  v_mov_b32 v59, 0
  v_mov_b32 v80, 0
  v_mov_b32 v60, 0
  v_mov_b32 v81, 0
  v_mov_b32 v61, 0
  v_mov_b32 v82, 0
  v_mov_b32 v62, 0
  v_mov_b32 v83, 0
  v_mov_b32 v63, 0
  v_mov_b32 v84, 0
  v_mov_b32 v64, 0
  v_mov_b32 v85, 0
  v_mov_b32 v65, 0
  v_mov_b32 v86, 0
  v_mov_b32 v66, 0
  v_mov_b32 v87, 0
  v_mov_b32 v67, 0
  v_mov_b32 v88, 0
  v_mov_b32 v68, 0
  v_mov_b32 v89, 0
  v_mov_b32 v69, 0
  v_mov_b32 v90, 0
  v_mov_b32 v70, 0
  v_mov_b32 v91, 0
  v_mov_b32 v71, 0
  v_mov_b32 v92, 0
  v_mov_b32 v72, 0
  v_mov_b32 v93, 0
  v_mov_b32 v73, 0
  v_mov_b32 v94, 0
  v_mov_b32 v74, 0
  v_mov_b32 v95, 0
  v_mov_b32 v75, 0
  s_nop 1
  v_mfma_f32_16x16x32_bf16 a[0:3], v[76:79], v[76:79], 0
  v_mfma_f32_16x16x32_bf16 a[4:7], v[76:79], v[76:79], 0
  v_mfma_f32_16x16x32_bf16 a[8:11], v[76:79], v[76:79], 0
  v_mfma_f32_16x16x32_bf16 a[12:15], v[76:79], v[76:79], 0
  v_mfma_f32_16x16x32_bf16 a[16:19], v[76:79], v[76:79], 0
  v_mfma_f32_16x16x32_bf16 a[20:23], v[76:79], v[76:79], 0
  v_mfma_f32_16x16x32_bf16 a[24:27], v[76:79], v[76:79], 0
  v_mfma_f32_16x16x32_bf16 a[28:31], v[76:79], v[76:79], 0
  v_mfma_f32_16x16x32_bf16 a[32:35], v[76:79], v[76:79], 0
  v_mfma_f32_16x16x32_bf16 a[36:39], v[76:79], v[76:79], 0
  v_mfma_f32_16x16x32_bf16 a[40:43], v[76:79], v[76:79], 0
  v_mfma_f32_16x16x32_bf16 a[44:47], v[76:79], v[76:79], 0
  v_mfma_f32_16x16x32_bf16 a[48:51], v[76:79], v[76:79], 0
  v_mfma_f32_16x16x32_bf16 a[52:55], v[76:79], v[76:79], 0
  v_mfma_f32_16x16x32_bf16 a[56:59], v[76:79], v[76:79], 0
  v_mfma_f32_16x16x32_bf16 a[60:63], v[76:79], v[76:79], 0
  v_mfma_f32_16x16x32_bf16 a[64:67], v[76:79], v[76:79], 0
  v_mfma_f32_16x16x32_bf16 a[68:71], v[76:79], v[76:79], 0
  v_mfma_f32_16x16x32_bf16 a[72:75], v[76:79], v[76:79], 0
  v_mfma_f32_16x16x32_bf16 a[76:79], v[76:79], v[76:79], 0
  v_mfma_f32_16x16x32_bf16 a[80:83], v[76:79], v[76:79], 0
  v_mfma_f32_16x16x32_bf16 a[84:87], v[76:79], v[76:79], 0
  v_mfma_f32_16x16x32_bf16 a[88:91], v[76:79], v[76:79], 0
  v_mfma_f32_16x16x32_bf16 a[92:95], v[76:79], v[76:79], 0
  v_mfma_f32_16x16x32_bf16 a[96:99], v[76:79], v[76:79], 0
  v_mfma_f32_16x16x32_bf16 a[100:103], v[76:79], v[76:79], 0
  v_mfma_f32_16x16x32_bf16 a[104:107], v[76:79], v[76:79], 0
  v_mfma_f32_16x16x32_bf16 a[108:111], v[76:79], v[76:79], 0
  v_mfma_f32_16x16x32_bf16 a[112:115], v[76:79], v[76:79], 0
  v_mfma_f32_16x16x32_bf16 a[116:119], v[76:79], v[76:79], 0
  v_mfma_f32_16x16x32_bf16 a[120:123], v[76:79], v[76:79], 0
  v_mfma_f32_16x16x32_bf16 a[124:127], v[76:79], v[76:79], 0
  v_mfma_f32_16x16x32_bf16 a[128:131], v[76:79], v[76:79], 0
  v_mfma_f32_16x16x32_bf16 a[132:135], v[76:79], v[76:79], 0
  v_mfma_f32_16x16x32_bf16 a[136:139], v[76:79], v[76:79], 0
  v_mfma_f32_16x16x32_bf16 a[140:143], v[76:79], v[76:79], 0
  v_mfma_f32_16x16x32_bf16 a[144:147], v[76:79], v[76:79], 0
  v_mfma_f32_16x16x32_bf16 a[148:151], v[76:79], v[76:79], 0
  v_mfma_f32_16x16x32_bf16 a[152:155], v[76:79], v[76:79], 0
  v_mfma_f32_16x16x32_bf16 a[156:159], v[76:79], v[76:79], 0
  s_mov_b32 s34, 0xff800000
  s_mov_b32 s35, 0xff800000
  s_mov_b32 s36, 0xff800000
  s_mov_b32 s37, 0xff800000
  s_mov_b32 s38, 0xff800000
  s_waitcnt vmcnt(16)
  s_barrier
  v_add_u32 v28, s32, v20
  v_add_u32 v29, s32, v21
  v_add_u32 v30, s32, v22
  v_add_u32 v31, s32, v23
  v_add_u32 v32, s32, v24
  v_add_u32 v33, s32, v25
  v_add_u32 v34, s32, v26
  v_add_u32 v35, s32, v27
  s_add_u32 s32, s32, 32768
  s_cmp_eq_u32 s32, 98304
  s_cselect_b32 s32, 0, s32
  ds_read_b128 v[120:123], v28 offset:0
  ds_read_b128 v[124:127], v29 offset:0
  ds_read_b128 v[128:131], v30 offset:0
  ds_read_b128 v[132:135], v31 offset:0
  ds_read_b128 v[136:139], v28 offset:4096
  ds_read_b128 v[140:143], v29 offset:4096
  ds_read_b128 v[144:147], v30 offset:4096
  ds_read_b128 v[148:151], v31 offset:4096
  ds_read_b64_tr_b16 v[152:153], v32 offset:0
  ds_read_b64_tr_b16 v[154:155], v32 offset:4096
  ds_read_b64_tr_b16 v[156:157], v32 offset:8
  ds_read_b64_tr_b16 v[158:159], v32 offset:4104
  ds_read_b64_tr_b16 v[160:161], v33 offset:0
  ds_read_b64_tr_b16 v[162:163], v33 offset:4096
  ds_read_b64_tr_b16 v[164:165], v33 offset:8
  s_waitcnt lgkmcnt(14)
  ds_read_b64_tr_b16 v[166:167], v33 offset:4104
  s_waitcnt lgkmcnt(14)
  ds_read_b64_tr_b16 v[168:169], v34 offset:0
  s_waitcnt lgkmcnt(14)
  ds_read_b64_tr_b16 v[170:171], v34 offset:4096
  s_waitcnt lgkmcnt(14)
  ds_read_b64_tr_b16 v[172:173], v34 offset:8
  s_waitcnt lgkmcnt(14)
  ds_read_b64_tr_b16 v[174:175], v34 offset:4104
  s_waitcnt lgkmcnt(14)
  ds_read_b64_tr_b16 v[176:177], v35 offset:0
  s_waitcnt lgkmcnt(14)
  ds_read_b64_tr_b16 v[178:179], v35 offset:4096
  s_waitcnt lgkmcnt(14)
  ds_read_b64_tr_b16 v[180:181], v35 offset:8
  s_waitcnt lgkmcnt(14)
  ds_read_b64_tr_b16 v[182:183], v35 offset:4104
  v_add_u32 v28, s32, v20
  v_add_u32 v29, s32, v21
  v_add_u32 v30, s32, v22
  v_add_u32 v31, s32, v23
  v_add_u32 v252, s32, v24
  v_add_u32 v253, s32, v25
  v_add_u32 v254, s32, v26
  v_add_u32 v255, s32, v27
  s_add_u32 s32, s32, 32768
  s_cmp_eq_u32 s32, 98304
  s_cselect_b32 s32, 0, s32
  v_mfma_f32_16x16x32_bf16 v[96:99], v[120:123], a[160:163], v[56:59]
  v_mfma_f32_16x16x32_bf16 v[96:99], v[124:127], a[164:167], v[96:99]
  v_mfma_f32_16x16x32_bf16 v[96:99], v[128:131], a[168:171], v[96:99]
  v_mfma_f32_16x16x32_bf16 v[96:99], v[132:135], a[172:175], v[96:99]
  v_mfma_f32_16x16x32_bf16 v[100:103], v[136:139], a[160:163], v[56:59]
  v_mfma_f32_16x16x32_bf16 v[100:103], v[140:143], a[164:167], v[100:103]
  v_mfma_f32_16x16x32_bf16 v[100:103], v[144:147], a[168:171], v[100:103]
  v_mfma_f32_16x16x32_bf16 v[100:103], v[148:151], a[172:175], v[100:103]
  v_mfma_f32_16x16x32_bf16 v[104:107], v[120:123], a[176:179], v[60:63]
  v_mfma_f32_16x16x32_bf16 v[104:107], v[124:127], a[180:183], v[104:107]
  v_mfma_f32_16x16x32_bf16 v[104:107], v[128:131], a[184:187], v[104:107]
  v_mfma_f32_16x16x32_bf16 v[104:107], v[132:135], a[188:191], v[104:107]
  v_mfma_f32_16x16x32_bf16 v[108:111], v[136:139], a[176:179], v[60:63]
  v_mfma_f32_16x16x32_bf16 v[108:111], v[140:143], a[180:183], v[108:111]
  v_mfma_f32_16x16x32_bf16 v[108:111], v[144:147], a[184:187], v[108:111]
  v_mfma_f32_16x16x32_bf16 v[108:111], v[148:151], a[188:191], v[108:111]
  v_mfma_f32_16x16x32_bf16 v[112:115], v[120:123], a[192:195], v[64:67]
  v_mfma_f32_16x16x32_bf16 v[112:115], v[124:127], a[196:199], v[112:115]
  v_mfma_f32_16x16x32_bf16 v[112:115], v[128:131], a[200:203], v[112:115]
  v_mfma_f32_16x16x32_bf16 v[112:115], v[132:135], a[204:207], v[112:115]
  v_mfma_f32_16x16x32_bf16 v[116:119], v[136:139], a[192:195], v[64:67]
  v_mfma_f32_16x16x32_bf16 v[116:119], v[140:143], a[196:199], v[116:119]
  v_mfma_f32_16x16x32_bf16 v[116:119], v[144:147], a[200:203], v[116:119]
  v_mfma_f32_16x16x32_bf16 v[116:119], v[148:151], a[204:207], v[116:119]
  v_exp_f32 v96, v96
  v_exp_f32 v97, v97
  v_exp_f32 v98, v98
  v_cvt_pk_bf16_f32 v36, v96, v97
  v_exp_f32 v99, v99
  v_exp_f32 v100, v100
  v_cvt_pk_bf16_f32 v37, v98, v99
  v_exp_f32 v101, v101
  v_exp_f32 v102, v102
  v_cvt_pk_bf16_f32 v38, v100, v101
  v_exp_f32 v103, v103
  s_nop 0
  v_cvt_pk_bf16_f32 v39, v102, v103
  s_waitcnt lgkmcnt(0)
  s_mov_b32 s33, 7
fa_kernel_ata:
  s_waitcnt vmcnt(8) lgkmcnt(0)
  s_barrier
  v_mfma_f32_16x16x32_bf16 v[96:99], v[120:123], a[208:211], v[68:71]
  v_exp_f32 v104, v104
  v_mfma_f32_16x16x32_bf16 v[96:99], v[124:127], a[212:215], v[96:99]
  ds_read_b128 v[184:187], v28 offset:0
  v_mfma_f32_16x16x32_bf16 v[96:99], v[128:131], a[216:219], v[96:99]
  v_exp_f32 v105, v105
  v_mfma_f32_16x16x32_bf16 v[96:99], v[132:135], a[220:223], v[96:99]
  v_exp_f32 v106, v106
  v_mfma_f32_16x16x32_bf16 v[100:103], v[136:139], a[208:211], v[68:71]
  ds_read_b128 v[188:191], v29 offset:0
  v_mfma_f32_16x16x32_bf16 v[100:103], v[140:143], a[212:215], v[100:103]
  v_exp_f32 v107, v107
  v_mfma_f32_16x16x32_bf16 v[100:103], v[144:147], a[216:219], v[100:103]
  v_cvt_pk_bf16_f32 v40, v104, v105
  v_cvt_pk_bf16_f32 v41, v106, v107
  ds_read_b128 v[192:195], v30 offset:0
  v_mfma_f32_16x16x32_bf16 v[100:103], v[148:151], a[220:223], v[100:103]
  ds_read_b128 v[196:199], v31 offset:0
  v_mfma_f32_16x16x32_bf16 a[0:3], v[152:155], v[36:39], a[0:3]
  v_exp_f32 v108, v108
  v_mfma_f32_16x16x32_bf16 a[4:7], v[156:159], v[36:39], a[4:7]
  v_exp_f32 v109, v109
  v_mfma_f32_16x16x32_bf16 a[8:11], v[160:163], v[36:39], a[8:11]
  ds_read_b128 v[200:203], v28 offset:4096
  v_mfma_f32_16x16x32_bf16 a[12:15], v[164:167], v[36:39], a[12:15]
  v_exp_f32 v110, v110
  v_mfma_f32_16x16x32_bf16 a[16:19], v[168:171], v[36:39], a[16:19]
  ds_read_b128 v[204:207], v29 offset:4096
  v_mfma_f32_16x16x32_bf16 a[20:23], v[172:175], v[36:39], a[20:23]
  v_exp_f32 v111, v111
  v_mfma_f32_16x16x32_bf16 a[24:27], v[176:179], v[36:39], a[24:27]
  v_cvt_pk_bf16_f32 v42, v108, v109
  v_cvt_pk_bf16_f32 v43, v110, v111
  v_mfma_f32_16x16x32_bf16 a[28:31], v[180:183], v[36:39], a[28:31]
  ds_read_b128 v[208:211], v30 offset:4096
  v_mfma_f32_16x16x32_bf16 v[76:79], v[52:55], v[36:39], v[76:79]
  ds_read_b128 v[212:215], v31 offset:4096
  v_mfma_f32_16x16x32_bf16 v[104:107], v[120:123], a[224:227], v[72:75]
  v_exp_f32 v112, v112
  v_mfma_f32_16x16x32_bf16 v[104:107], v[124:127], a[228:231], v[104:107]
  ds_read_b64_tr_b16 v[216:217], v252 offset:0
  v_mfma_f32_16x16x32_bf16 v[104:107], v[128:131], a[232:235], v[104:107]
  v_exp_f32 v113, v113
  v_mfma_f32_16x16x32_bf16 v[104:107], v[132:135], a[236:239], v[104:107]
  v_exp_f32 v114, v114
  v_mfma_f32_16x16x32_bf16 v[108:111], v[136:139], a[224:227], v[72:75]
  ds_read_b64_tr_b16 v[218:219], v252 offset:4096
  v_mfma_f32_16x16x32_bf16 v[108:111], v[140:143], a[228:231], v[108:111]
  v_exp_f32 v115, v115
  v_mfma_f32_16x16x32_bf16 v[108:111], v[144:147], a[232:235], v[108:111]
  v_cvt_pk_bf16_f32 v44, v112, v113
  v_cvt_pk_bf16_f32 v45, v114, v115
  ds_read_b64_tr_b16 v[220:221], v252 offset:8
  v_mfma_f32_16x16x32_bf16 v[108:111], v[148:151], a[236:239], v[108:111]
  ds_read_b64_tr_b16 v[222:223], v252 offset:4104
  v_mfma_f32_16x16x32_bf16 a[32:35], v[152:155], v[40:43], a[32:35]
  v_exp_f32 v116, v116
  v_mfma_f32_16x16x32_bf16 a[36:39], v[156:159], v[40:43], a[36:39]
  v_exp_f32 v117, v117
  v_mfma_f32_16x16x32_bf16 a[40:43], v[160:163], v[40:43], a[40:43]
  ds_read_b64_tr_b16 v[224:225], v253 offset:0
  v_mfma_f32_16x16x32_bf16 a[44:47], v[164:167], v[40:43], a[44:47]
  v_exp_f32 v118, v118
  s_mov_b32 m0, s31
  v_mfma_f32_16x16x32_bf16 a[48:51], v[168:171], v[40:43], a[48:51]
  buffer_load_dwordx4 v10, s[8:11], s41 offen offset:0 nt lds
  v_mfma_f32_16x16x32_bf16 a[52:55], v[172:175], v[40:43], a[52:55]
  v_exp_f32 v119, v119
  v_mfma_f32_16x16x32_bf16 a[56:59], v[176:179], v[40:43], a[56:59]
  v_cvt_pk_bf16_f32 v46, v116, v117
  v_cvt_pk_bf16_f32 v47, v118, v119
  v_mfma_f32_16x16x32_bf16 a[60:63], v[180:183], v[40:43], a[60:63]
  buffer_load_dwordx4 v11, s[8:11], s41 offen offset:1024 nt lds
  v_mfma_f32_16x16x32_bf16 v[80:83], v[52:55], v[40:43], v[80:83]
  buffer_load_dwordx4 v12, s[8:11], s41 offen offset:2048 nt lds
  s_waitcnt lgkmcnt(7)
  v_mfma_f32_16x16x32_bf16 v[112:115], v[184:187], a[160:163], v[56:59]
  v_exp_f32 v96, v96
  v_add_u32 v29, s32, v21
  v_mfma_f32_16x16x32_bf16 v[112:115], v[188:191], a[164:167], v[112:115]
  ds_read_b64_tr_b16 v[226:227], v253 offset:4096
  v_mfma_f32_16x16x32_bf16 v[112:115], v[192:195], a[168:171], v[112:115]
  v_exp_f32 v97, v97
  v_add_u32 v30, s32, v22
  v_mfma_f32_16x16x32_bf16 v[112:115], v[196:199], a[172:175], v[112:115]
  v_exp_f32 v98, v98
  v_add_u32 v31, s32, v23
  v_mfma_f32_16x16x32_bf16 v[116:119], v[200:203], a[160:163], v[56:59]
  ds_read_b64_tr_b16 v[228:229], v253 offset:8
  v_mfma_f32_16x16x32_bf16 v[116:119], v[204:207], a[164:167], v[116:119]
  v_exp_f32 v99, v99
  s_waitcnt lgkmcnt(6)
  v_mfma_f32_16x16x32_bf16 v[116:119], v[208:211], a[168:171], v[116:119]
  v_cvt_pk_bf16_f32 v36, v96, v97
  v_cvt_pk_bf16_f32 v37, v98, v99
  ds_read_b64_tr_b16 v[230:231], v253 offset:4104
  v_mfma_f32_16x16x32_bf16 v[116:119], v[212:215], a[172:175], v[116:119]
  ds_read_b64_tr_b16 v[232:233], v254 offset:0
  v_mfma_f32_16x16x32_bf16 a[64:67], v[152:155], v[44:47], a[64:67]
  v_exp_f32 v100, v100
  v_mfma_f32_16x16x32_bf16 a[68:71], v[156:159], v[44:47], a[68:71]
  v_exp_f32 v101, v101
  v_mfma_f32_16x16x32_bf16 a[72:75], v[160:163], v[44:47], a[72:75]
  ds_read_b64_tr_b16 v[234:235], v254 offset:4096
  v_mfma_f32_16x16x32_bf16 a[76:79], v[164:167], v[44:47], a[76:79]
  v_exp_f32 v102, v102
  v_mfma_f32_16x16x32_bf16 a[80:83], v[168:171], v[44:47], a[80:83]
  ds_read_b64_tr_b16 v[236:237], v254 offset:8
  v_mfma_f32_16x16x32_bf16 a[84:87], v[172:175], v[44:47], a[84:87]
  v_exp_f32 v103, v103
  v_mfma_f32_16x16x32_bf16 a[88:91], v[176:179], v[44:47], a[88:91]
  v_cvt_pk_bf16_f32 v38, v100, v101
  v_cvt_pk_bf16_f32 v39, v102, v103
  v_add_u32 v28, s32, v20
  v_mfma_f32_16x16x32_bf16 a[92:95], v[180:183], v[44:47], a[92:95]
  buffer_load_dwordx4 v13, s[8:11], s41 offen offset:3072 nt lds
  v_mfma_f32_16x16x32_bf16 v[84:87], v[52:55], v[44:47], v[84:87]
  s_add_u32 m0, s31, 4096
  s_nop 0
  buffer_load_dwordx4 v248, s[8:11], s41 offen offset:0 nt lds
  v_mfma_f32_16x16x32_bf16 v[96:99], v[184:187], a[176:179], v[60:63]
  v_exp_f32 v104, v104
  v_add_u32 v33, s32, v25
  v_mfma_f32_16x16x32_bf16 v[96:99], v[188:191], a[180:183], v[96:99]
  buffer_load_dwordx4 v249, s[8:11], s41 offen offset:1024 nt lds
  v_mfma_f32_16x16x32_bf16 v[96:99], v[192:195], a[184:187], v[96:99]
  v_exp_f32 v105, v105
  v_add_u32 v34, s32, v26
  v_mfma_f32_16x16x32_bf16 v[96:99], v[196:199], a[188:191], v[96:99]
  v_exp_f32 v106, v106
  v_add_u32 v35, s32, v27
  v_mfma_f32_16x16x32_bf16 v[100:103], v[200:203], a[176:179], v[60:63]
  buffer_load_dwordx4 v250, s[8:11], s41 offen offset:2048 nt lds
  v_mfma_f32_16x16x32_bf16 v[100:103], v[204:207], a[180:183], v[100:103]
  v_exp_f32 v107, v107
  v_mfma_f32_16x16x32_bf16 v[100:103], v[208:211], a[184:187], v[100:103]
  v_cvt_pk_bf16_f32 v40, v104, v105
  v_cvt_pk_bf16_f32 v41, v106, v107
  buffer_load_dwordx4 v251, s[8:11], s41 offen offset:3072 nt lds
  v_mfma_f32_16x16x32_bf16 v[100:103], v[212:215], a[188:191], v[100:103]
  ds_read_b64_tr_b16 v[238:239], v254 offset:4104
  v_mfma_f32_16x16x32_bf16 a[96:99], v[152:155], v[36:39], a[96:99]
  v_exp_f32 v108, v108
  s_add_u32 s41, s41, 16384
  s_add_u32 s31, s31, 32768
  s_cmp_eq_u32 s31, s30
  s_cselect_b32 s31, s42, s31
  v_mfma_f32_16x16x32_bf16 a[100:103], v[156:159], v[36:39], a[100:103]
  v_exp_f32 v109, v109
  v_mfma_f32_16x16x32_bf16 a[104:107], v[160:163], v[36:39], a[104:107]
  ds_read_b64_tr_b16 v[240:241], v255 offset:0
  v_mfma_f32_16x16x32_bf16 a[108:111], v[164:167], v[36:39], a[108:111]
  v_exp_f32 v110, v110
  v_mfma_f32_16x16x32_bf16 a[112:115], v[168:171], v[36:39], a[112:115]
  ds_read_b64_tr_b16 v[242:243], v255 offset:4096
  v_mfma_f32_16x16x32_bf16 a[116:119], v[172:175], v[36:39], a[116:119]
  v_exp_f32 v111, v111
  v_mfma_f32_16x16x32_bf16 a[120:123], v[176:179], v[36:39], a[120:123]
  v_cvt_pk_bf16_f32 v42, v108, v109
  v_cvt_pk_bf16_f32 v43, v110, v111
  v_add_u32 v32, s32, v24
  s_add_u32 s32, s32, 32768
  s_cmp_eq_u32 s32, 98304
  s_cselect_b32 s32, 0, s32
  v_mfma_f32_16x16x32_bf16 a[124:127], v[180:183], v[36:39], a[124:127]
  ds_read_b64_tr_b16 v[244:245], v255 offset:8
  v_mfma_f32_16x16x32_bf16 v[88:91], v[52:55], v[36:39], v[88:91]
  ds_read_b64_tr_b16 v[246:247], v255 offset:4104
  s_waitcnt vmcnt(8) lgkmcnt(0)
  s_barrier
  v_mfma_f32_16x16x32_bf16 v[104:107], v[184:187], a[192:195], v[64:67]
  v_exp_f32 v112, v112
  v_mfma_f32_16x16x32_bf16 v[104:107], v[188:191], a[196:199], v[104:107]
  ds_read_b128 v[120:123], v28 offset:0
  v_mfma_f32_16x16x32_bf16 v[104:107], v[192:195], a[200:203], v[104:107]
  v_exp_f32 v113, v113
  v_mfma_f32_16x16x32_bf16 v[104:107], v[196:199], a[204:207], v[104:107]
  v_exp_f32 v114, v114
  v_mfma_f32_16x16x32_bf16 v[108:111], v[200:203], a[192:195], v[64:67]
  ds_read_b128 v[124:127], v29 offset:0
  v_mfma_f32_16x16x32_bf16 v[108:111], v[204:207], a[196:199], v[108:111]
  v_exp_f32 v115, v115
  v_mfma_f32_16x16x32_bf16 v[108:111], v[208:211], a[200:203], v[108:111]
  v_cvt_pk_bf16_f32 v44, v112, v113
  v_cvt_pk_bf16_f32 v45, v114, v115
  v_mfma_f32_16x16x32_bf16 v[108:111], v[212:215], a[204:207], v[108:111]
  ds_read_b128 v[128:131], v30 offset:0
  v_mfma_f32_16x16x32_bf16 a[128:131], v[152:155], v[40:43], a[128:131]
  v_exp_f32 v116, v116
  v_mfma_f32_16x16x32_bf16 a[132:135], v[156:159], v[40:43], a[132:135]
  v_exp_f32 v117, v117
  v_mfma_f32_16x16x32_bf16 a[136:139], v[160:163], v[40:43], a[136:139]
  ds_read_b128 v[132:135], v31 offset:0
  v_mfma_f32_16x16x32_bf16 a[140:143], v[164:167], v[40:43], a[140:143]
  v_exp_f32 v118, v118
  v_mfma_f32_16x16x32_bf16 a[144:147], v[168:171], v[40:43], a[144:147]
  ds_read_b128 v[136:139], v28 offset:4096
  v_mfma_f32_16x16x32_bf16 a[148:151], v[172:175], v[40:43], a[148:151]
  v_exp_f32 v119, v119
  v_mfma_f32_16x16x32_bf16 a[152:155], v[176:179], v[40:43], a[152:155]
  v_cvt_pk_bf16_f32 v46, v116, v117
  v_cvt_pk_bf16_f32 v47, v118, v119
  v_mfma_f32_16x16x32_bf16 a[156:159], v[180:183], v[40:43], a[156:159]
  ds_read_b128 v[140:143], v29 offset:4096
  v_mfma_f32_16x16x32_bf16 v[92:95], v[52:55], v[40:43], v[92:95]
  ds_read_b128 v[144:147], v30 offset:4096
  v_mfma_f32_16x16x32_bf16 v[112:115], v[184:187], a[208:211], v[68:71]
  v_exp_f32 v96, v96
  v_mfma_f32_16x16x32_bf16 v[112:115], v[188:191], a[212:215], v[112:115]
  ds_read_b128 v[148:151], v31 offset:4096
  v_mfma_f32_16x16x32_bf16 v[112:115], v[192:195], a[216:219], v[112:115]
  v_exp_f32 v97, v97
  v_mfma_f32_16x16x32_bf16 v[112:115], v[196:199], a[220:223], v[112:115]
  v_exp_f32 v98, v98
  s_mov_b32 m0, s31
  v_mfma_f32_16x16x32_bf16 v[116:119], v[200:203], a[208:211], v[68:71]
  buffer_load_dwordx4 v10, s[8:11], s41 offen offset:0 nt lds
  v_mfma_f32_16x16x32_bf16 v[116:119], v[204:207], a[212:215], v[116:119]
  v_exp_f32 v99, v99
  v_mfma_f32_16x16x32_bf16 v[116:119], v[208:211], a[216:219], v[116:119]
  v_cvt_pk_bf16_f32 v36, v96, v97
  v_cvt_pk_bf16_f32 v37, v98, v99
  v_mfma_f32_16x16x32_bf16 v[116:119], v[212:215], a[220:223], v[116:119]
  buffer_load_dwordx4 v11, s[8:11], s41 offen offset:1024 nt lds
  v_mfma_f32_16x16x32_bf16 a[0:3], v[216:219], v[44:47], a[0:3]
  v_exp_f32 v100, v100
  v_mfma_f32_16x16x32_bf16 a[4:7], v[220:223], v[44:47], a[4:7]
  v_exp_f32 v101, v101
  v_mfma_f32_16x16x32_bf16 a[8:11], v[224:227], v[44:47], a[8:11]
  ds_read_b64_tr_b16 v[152:153], v32 offset:0
  v_mfma_f32_16x16x32_bf16 a[12:15], v[228:231], v[44:47], a[12:15]
  v_exp_f32 v102, v102
  v_mfma_f32_16x16x32_bf16 a[16:19], v[232:235], v[44:47], a[16:19]
  ds_read_b64_tr_b16 v[154:155], v32 offset:4096
  v_mfma_f32_16x16x32_bf16 a[20:23], v[236:239], v[44:47], a[20:23]
  v_exp_f32 v103, v103
  v_mfma_f32_16x16x32_bf16 a[24:27], v[240:243], v[44:47], a[24:27]
  v_cvt_pk_bf16_f32 v38, v100, v101
  v_cvt_pk_bf16_f32 v39, v102, v103
  v_mfma_f32_16x16x32_bf16 a[28:31], v[244:247], v[44:47], a[28:31]
  ds_read_b64_tr_b16 v[156:157], v32 offset:8
  v_mfma_f32_16x16x32_bf16 v[76:79], v[52:55], v[44:47], v[76:79]
  ds_read_b64_tr_b16 v[158:159], v32 offset:4104
  s_waitcnt lgkmcnt(8)
  v_mfma_f32_16x16x32_bf16 v[96:99], v[120:123], a[160:163], v[56:59]
  v_exp_f32 v104, v104
  v_add_u32 v30, s32, v22
  v_mfma_f32_16x16x32_bf16 v[96:99], v[124:127], a[164:167], v[96:99]
  buffer_load_dwordx4 v12, s[8:11], s41 offen offset:2048 nt lds
  v_mfma_f32_16x16x32_bf16 v[96:99], v[128:131], a[168:171], v[96:99]
  v_exp_f32 v105, v105
  v_add_u32 v31, s32, v23
  v_mfma_f32_16x16x32_bf16 v[96:99], v[132:135], a[172:175], v[96:99]
  v_exp_f32 v106, v106
  s_waitcnt lgkmcnt(5)
  v_mfma_f32_16x16x32_bf16 v[100:103], v[136:139], a[160:163], v[56:59]
  buffer_load_dwordx4 v13, s[8:11], s41 offen offset:3072 nt lds
  v_mfma_f32_16x16x32_bf16 v[100:103], v[140:143], a[164:167], v[100:103]
  v_exp_f32 v107, v107
  v_mfma_f32_16x16x32_bf16 v[100:103], v[144:147], a[168:171], v[100:103]
  v_cvt_pk_bf16_f32 v40, v104, v105
  v_cvt_pk_bf16_f32 v41, v106, v107
  v_add_u32 v28, s32, v20
  s_waitcnt lgkmcnt(4)
  v_mfma_f32_16x16x32_bf16 v[100:103], v[148:151], a[172:175], v[100:103]
  ds_read_b64_tr_b16 v[160:161], v33 offset:0
  v_mfma_f32_16x16x32_bf16 a[32:35], v[216:219], v[36:39], a[32:35]
  v_exp_f32 v108, v108
  v_mfma_f32_16x16x32_bf16 a[36:39], v[220:223], v[36:39], a[36:39]
  v_exp_f32 v109, v109
  v_mfma_f32_16x16x32_bf16 a[40:43], v[224:227], v[36:39], a[40:43]
  ds_read_b64_tr_b16 v[162:163], v33 offset:4096
  v_mfma_f32_16x16x32_bf16 a[44:47], v[228:231], v[36:39], a[44:47]
  v_exp_f32 v110, v110
  v_mfma_f32_16x16x32_bf16 a[48:51], v[232:235], v[36:39], a[48:51]
  ds_read_b64_tr_b16 v[164:165], v33 offset:8
  v_mfma_f32_16x16x32_bf16 a[52:55], v[236:239], v[36:39], a[52:55]
  v_exp_f32 v111, v111
  v_mfma_f32_16x16x32_bf16 a[56:59], v[240:243], v[36:39], a[56:59]
  v_cvt_pk_bf16_f32 v42, v108, v109
  v_cvt_pk_bf16_f32 v43, v110, v111
  v_add_u32 v29, s32, v21
  v_mfma_f32_16x16x32_bf16 a[60:63], v[244:247], v[36:39], a[60:63]
  ds_read_b64_tr_b16 v[166:167], v33 offset:4104
  v_mfma_f32_16x16x32_bf16 v[80:83], v[52:55], v[36:39], v[80:83]
  ds_read_b64_tr_b16 v[168:169], v34 offset:0
  v_mfma_f32_16x16x32_bf16 v[104:107], v[120:123], a[176:179], v[60:63]
  v_exp_f32 v112, v112
  s_add_u32 m0, s31, 4096
  v_add_u32 v254, s32, v26
  v_mfma_f32_16x16x32_bf16 v[104:107], v[124:127], a[180:183], v[104:107]
  buffer_load_dwordx4 v248, s[8:11], s41 offen offset:0 nt lds
  v_mfma_f32_16x16x32_bf16 v[104:107], v[128:131], a[184:187], v[104:107]
  v_exp_f32 v113, v113
  v_add_u32 v255, s32, v27
  v_mfma_f32_16x16x32_bf16 v[104:107], v[132:135], a[188:191], v[104:107]
  v_exp_f32 v114, v114
  v_mfma_f32_16x16x32_bf16 v[108:111], v[136:139], a[176:179], v[60:63]
  buffer_load_dwordx4 v249, s[8:11], s41 offen offset:1024 nt lds
  v_mfma_f32_16x16x32_bf16 v[108:111], v[140:143], a[180:183], v[108:111]
  v_exp_f32 v115, v115
  v_mfma_f32_16x16x32_bf16 v[108:111], v[144:147], a[184:187], v[108:111]
  v_cvt_pk_bf16_f32 v44, v112, v113
  v_cvt_pk_bf16_f32 v45, v114, v115
  v_add_u32 v252, s32, v24
  v_mfma_f32_16x16x32_bf16 v[108:111], v[148:151], a[188:191], v[108:111]
  ds_read_b64_tr_b16 v[170:171], v34 offset:4096
  v_mfma_f32_16x16x32_bf16 a[64:67], v[216:219], v[40:43], a[64:67]
  v_exp_f32 v116, v116
  v_mfma_f32_16x16x32_bf16 a[68:71], v[220:223], v[40:43], a[68:71]
  v_exp_f32 v117, v117
  v_mfma_f32_16x16x32_bf16 a[72:75], v[224:227], v[40:43], a[72:75]
  ds_read_b64_tr_b16 v[172:173], v34 offset:8
  v_mfma_f32_16x16x32_bf16 a[76:79], v[228:231], v[40:43], a[76:79]
  v_exp_f32 v118, v118
  v_mfma_f32_16x16x32_bf16 a[80:83], v[232:235], v[40:43], a[80:83]
  ds_read_b64_tr_b16 v[174:175], v34 offset:4104
  v_mfma_f32_16x16x32_bf16 a[84:87], v[236:239], v[40:43], a[84:87]
  v_exp_f32 v119, v119
  v_mfma_f32_16x16x32_bf16 a[88:91], v[240:243], v[40:43], a[88:91]
  v_cvt_pk_bf16_f32 v46, v116, v117
  v_cvt_pk_bf16_f32 v47, v118, v119
  v_add_u32 v253, s32, v25
  v_mfma_f32_16x16x32_bf16 a[92:95], v[244:247], v[40:43], a[92:95]
  ds_read_b64_tr_b16 v[176:177], v35 offset:0
  v_mfma_f32_16x16x32_bf16 v[84:87], v[52:55], v[40:43], v[84:87]
  ds_read_b64_tr_b16 v[178:179], v35 offset:4096
  v_mfma_f32_16x16x32_bf16 v[112:115], v[120:123], a[192:195], v[64:67]
  v_exp_f32 v96, v96
  s_add_u32 s32, s32, 32768
  s_cmp_eq_u32 s32, 98304
  s_cselect_b32 s32, 0, s32
  v_mfma_f32_16x16x32_bf16 v[112:115], v[124:127], a[196:199], v[112:115]
  ds_read_b64_tr_b16 v[180:181], v35 offset:8
  v_mfma_f32_16x16x32_bf16 v[112:115], v[128:131], a[200:203], v[112:115]
  v_exp_f32 v97, v97
  v_mfma_f32_16x16x32_bf16 v[112:115], v[132:135], a[204:207], v[112:115]
  v_exp_f32 v98, v98
  v_mfma_f32_16x16x32_bf16 v[116:119], v[136:139], a[192:195], v[64:67]
  s_waitcnt lgkmcnt(6)
  ds_read_b64_tr_b16 v[182:183], v35 offset:4104
  v_mfma_f32_16x16x32_bf16 v[116:119], v[140:143], a[196:199], v[116:119]
  v_exp_f32 v99, v99
  v_mfma_f32_16x16x32_bf16 v[116:119], v[144:147], a[200:203], v[116:119]
  v_cvt_pk_bf16_f32 v36, v96, v97
  v_cvt_pk_bf16_f32 v37, v98, v99
  v_mfma_f32_16x16x32_bf16 v[116:119], v[148:151], a[204:207], v[116:119]
  v_mfma_f32_16x16x32_bf16 a[96:99], v[216:219], v[44:47], a[96:99]
  v_exp_f32 v100, v100
  v_mfma_f32_16x16x32_bf16 a[100:103], v[220:223], v[44:47], a[100:103]
  v_exp_f32 v101, v101
  v_mfma_f32_16x16x32_bf16 a[104:107], v[224:227], v[44:47], a[104:107]
  buffer_load_dwordx4 v250, s[8:11], s41 offen offset:2048 nt lds
  v_mfma_f32_16x16x32_bf16 a[108:111], v[228:231], v[44:47], a[108:111]
  v_exp_f32 v102, v102
  v_mfma_f32_16x16x32_bf16 a[112:115], v[232:235], v[44:47], a[112:115]
  v_mfma_f32_16x16x32_bf16 a[116:119], v[236:239], v[44:47], a[116:119]
  v_exp_f32 v103, v103
  v_mfma_f32_16x16x32_bf16 a[120:123], v[240:243], v[44:47], a[120:123]
  v_cvt_pk_bf16_f32 v38, v100, v101
  v_cvt_pk_bf16_f32 v39, v102, v103
  v_mfma_f32_16x16x32_bf16 a[124:127], v[244:247], v[44:47], a[124:127]
  buffer_load_dwordx4 v251, s[8:11], s41 offen offset:3072 nt lds
  v_mfma_f32_16x16x32_bf16 v[88:91], v[52:55], v[44:47], v[88:91]
  s_add_u32 s41, s41, 16384
  s_add_u32 s31, s31, 32768
  s_cmp_eq_u32 s31, s30
  s_cselect_b32 s31, s42, s31
  s_sub_u32 s33, s33, 1
  s_cmp_lg_u32 s33, 0
  s_cbranch_scc1 fa_kernel_ata
  s_waitcnt vmcnt(8) lgkmcnt(0)
  s_barrier
  v_mfma_f32_16x16x32_bf16 v[96:99], v[120:123], a[208:211], v[68:71]
  v_exp_f32 v104, v104
  v_mfma_f32_16x16x32_bf16 v[96:99], v[124:127], a[212:215], v[96:99]
  ds_read_b128 v[184:187], v28 offset:0
  v_mfma_f32_16x16x32_bf16 v[96:99], v[128:131], a[216:219], v[96:99]
  v_exp_f32 v105, v105
  v_mfma_f32_16x16x32_bf16 v[96:99], v[132:135], a[220:223], v[96:99]
  v_exp_f32 v106, v106
  v_mfma_f32_16x16x32_bf16 v[100:103], v[136:139], a[208:211], v[68:71]
  ds_read_b128 v[188:191], v29 offset:0
  v_mfma_f32_16x16x32_bf16 v[100:103], v[140:143], a[212:215], v[100:103]
  v_exp_f32 v107, v107
  v_mfma_f32_16x16x32_bf16 v[100:103], v[144:147], a[216:219], v[100:103]
  v_cvt_pk_bf16_f32 v40, v104, v105
  v_cvt_pk_bf16_f32 v41, v106, v107
  ds_read_b128 v[192:195], v30 offset:0
  v_mfma_f32_16x16x32_bf16 v[100:103], v[148:151], a[220:223], v[100:103]
  ds_read_b128 v[196:199], v31 offset:0
  v_mfma_f32_16x16x32_bf16 a[0:3], v[152:155], v[36:39], a[0:3]
  v_exp_f32 v108, v108
  v_mfma_f32_16x16x32_bf16 a[4:7], v[156:159], v[36:39], a[4:7]
  v_exp_f32 v109, v109
  v_mfma_f32_16x16x32_bf16 a[8:11], v[160:163], v[36:39], a[8:11]
  ds_read_b128 v[200:203], v28 offset:4096
  v_mfma_f32_16x16x32_bf16 a[12:15], v[164:167], v[36:39], a[12:15]
  v_exp_f32 v110, v110
  v_mfma_f32_16x16x32_bf16 a[16:19], v[168:171], v[36:39], a[16:19]
  ds_read_b128 v[204:207], v29 offset:4096
  v_mfma_f32_16x16x32_bf16 a[20:23], v[172:175], v[36:39], a[20:23]
  v_exp_f32 v111, v111
  v_mfma_f32_16x16x32_bf16 a[24:27], v[176:179], v[36:39], a[24:27]
  v_cvt_pk_bf16_f32 v42, v108, v109
  v_cvt_pk_bf16_f32 v43, v110, v111
  v_mfma_f32_16x16x32_bf16 a[28:31], v[180:183], v[36:39], a[28:31]
  ds_read_b128 v[208:211], v30 offset:4096
  v_mfma_f32_16x16x32_bf16 v[76:79], v[52:55], v[36:39], v[76:79]
  ds_read_b128 v[212:215], v31 offset:4096
  v_mfma_f32_16x16x32_bf16 v[104:107], v[120:123], a[224:227], v[72:75]
  v_exp_f32 v112, v112
  v_mfma_f32_16x16x32_bf16 v[104:107], v[124:127], a[228:231], v[104:107]
  ds_read_b64_tr_b16 v[216:217], v252 offset:0
  v_mfma_f32_16x16x32_bf16 v[104:107], v[128:131], a[232:235], v[104:107]
  v_exp_f32 v113, v113
  v_mfma_f32_16x16x32_bf16 v[104:107], v[132:135], a[236:239], v[104:107]
  v_exp_f32 v114, v114
  v_mfma_f32_16x16x32_bf16 v[108:111], v[136:139], a[224:227], v[72:75]
  ds_read_b64_tr_b16 v[218:219], v252 offset:4096
  v_mfma_f32_16x16x32_bf16 v[108:111], v[140:143], a[228:231], v[108:111]
  v_exp_f32 v115, v115
  v_mfma_f32_16x16x32_bf16 v[108:111], v[144:147], a[232:235], v[108:111]
  v_cvt_pk_bf16_f32 v44, v112, v113
  v_cvt_pk_bf16_f32 v45, v114, v115
  ds_read_b64_tr_b16 v[220:221], v252 offset:8
  v_mfma_f32_16x16x32_bf16 v[108:111], v[148:151], a[236:239], v[108:111]
  ds_read_b64_tr_b16 v[222:223], v252 offset:4104
  v_mfma_f32_16x16x32_bf16 a[32:35], v[152:155], v[40:43], a[32:35]
  v_exp_f32 v116, v116
  v_mfma_f32_16x16x32_bf16 a[36:39], v[156:159], v[40:43], a[36:39]
  v_exp_f32 v117, v117
  v_mfma_f32_16x16x32_bf16 a[40:43], v[160:163], v[40:43], a[40:43]
  ds_read_b64_tr_b16 v[224:225], v253 offset:0
  v_mfma_f32_16x16x32_bf16 a[44:47], v[164:167], v[40:43], a[44:47]
  v_exp_f32 v118, v118
  s_mov_b32 m0, s31
  v_mfma_f32_16x16x32_bf16 a[48:51], v[168:171], v[40:43], a[48:51]
  buffer_load_dwordx4 v10, s[8:11], s41 offen offset:0 nt lds
  v_mfma_f32_16x16x32_bf16 a[52:55], v[172:175], v[40:43], a[52:55]
  v_exp_f32 v119, v119
  v_mfma_f32_16x16x32_bf16 a[56:59], v[176:179], v[40:43], a[56:59]
  v_cvt_pk_bf16_f32 v46, v116, v117
  v_cvt_pk_bf16_f32 v47, v118, v119
  v_mfma_f32_16x16x32_bf16 a[60:63], v[180:183], v[40:43], a[60:63]
  buffer_load_dwordx4 v11, s[8:11], s41 offen offset:1024 nt lds
  v_mfma_f32_16x16x32_bf16 v[80:83], v[52:55], v[40:43], v[80:83]
  buffer_load_dwordx4 v12, s[8:11], s41 offen offset:2048 nt lds
  s_waitcnt lgkmcnt(7)
  v_mfma_f32_16x16x32_bf16 v[112:115], v[184:187], a[160:163], v[56:59]
  v_exp_f32 v96, v96
  v_mfma_f32_16x16x32_bf16 v[112:115], v[188:191], a[164:167], v[112:115]
  ds_read_b64_tr_b16 v[226:227], v253 offset:4096
  v_mfma_f32_16x16x32_bf16 v[112:115], v[192:195], a[168:171], v[112:115]
  v_exp_f32 v97, v97
  v_mfma_f32_16x16x32_bf16 v[112:115], v[196:199], a[172:175], v[112:115]
  v_exp_f32 v98, v98
  v_mfma_f32_16x16x32_bf16 v[116:119], v[200:203], a[160:163], v[56:59]
  ds_read_b64_tr_b16 v[228:229], v253 offset:8
  v_mfma_f32_16x16x32_bf16 v[116:119], v[204:207], a[164:167], v[116:119]
  v_exp_f32 v99, v99
  s_waitcnt lgkmcnt(7)
  v_mfma_f32_16x16x32_bf16 v[116:119], v[208:211], a[168:171], v[116:119]
  v_cvt_pk_bf16_f32 v36, v96, v97
  v_cvt_pk_bf16_f32 v37, v98, v99
  ds_read_b64_tr_b16 v[230:231], v253 offset:4104
  v_mfma_f32_16x16x32_bf16 v[116:119], v[212:215], a[172:175], v[116:119]
  ds_read_b64_tr_b16 v[232:233], v254 offset:0
  v_mfma_f32_16x16x32_bf16 a[64:67], v[152:155], v[44:47], a[64:67]
  v_exp_f32 v100, v100
  v_mfma_f32_16x16x32_bf16 a[68:71], v[156:159], v[44:47], a[68:71]
  v_exp_f32 v101, v101
  v_mfma_f32_16x16x32_bf16 a[72:75], v[160:163], v[44:47], a[72:75]
  ds_read_b64_tr_b16 v[234:235], v254 offset:4096
  v_mfma_f32_16x16x32_bf16 a[76:79], v[164:167], v[44:47], a[76:79]
  v_exp_f32 v102, v102
  v_mfma_f32_16x16x32_bf16 a[80:83], v[168:171], v[44:47], a[80:83]
  ds_read_b64_tr_b16 v[236:237], v254 offset:8
  v_mfma_f32_16x16x32_bf16 a[84:87], v[172:175], v[44:47], a[84:87]
  v_exp_f32 v103, v103
  v_mfma_f32_16x16x32_bf16 a[88:91], v[176:179], v[44:47], a[88:91]
  v_cvt_pk_bf16_f32 v38, v100, v101
  v_cvt_pk_bf16_f32 v39, v102, v103
  v_mfma_f32_16x16x32_bf16 a[92:95], v[180:183], v[44:47], a[92:95]
  buffer_load_dwordx4 v13, s[8:11], s41 offen offset:3072 nt lds
  v_mfma_f32_16x16x32_bf16 v[84:87], v[52:55], v[44:47], v[84:87]
  s_add_u32 m0, s31, 4096
  s_nop 0
  buffer_load_dwordx4 v248, s[8:11], s41 offen offset:0 nt lds
  v_mfma_f32_16x16x32_bf16 v[96:99], v[184:187], a[176:179], v[60:63]
  v_exp_f32 v104, v104
  v_mfma_f32_16x16x32_bf16 v[96:99], v[188:191], a[180:183], v[96:99]
  buffer_load_dwordx4 v249, s[8:11], s41 offen offset:1024 nt lds
  v_mfma_f32_16x16x32_bf16 v[96:99], v[192:195], a[184:187], v[96:99]
  v_exp_f32 v105, v105
  v_mfma_f32_16x16x32_bf16 v[96:99], v[196:199], a[188:191], v[96:99]
  v_exp_f32 v106, v106
  v_mfma_f32_16x16x32_bf16 v[100:103], v[200:203], a[176:179], v[60:63]
  buffer_load_dwordx4 v250, s[8:11], s41 offen offset:2048 nt lds
  v_mfma_f32_16x16x32_bf16 v[100:103], v[204:207], a[180:183], v[100:103]
  v_exp_f32 v107, v107
  v_mfma_f32_16x16x32_bf16 v[100:103], v[208:211], a[184:187], v[100:103]
  v_cvt_pk_bf16_f32 v40, v104, v105
  v_cvt_pk_bf16_f32 v41, v106, v107
  buffer_load_dwordx4 v251, s[8:11], s41 offen offset:3072 nt lds
  v_mfma_f32_16x16x32_bf16 v[100:103], v[212:215], a[188:191], v[100:103]
  ds_read_b64_tr_b16 v[238:239], v254 offset:4104
  v_mfma_f32_16x16x32_bf16 a[96:99], v[152:155], v[36:39], a[96:99]
  v_exp_f32 v108, v108
  v_mfma_f32_16x16x32_bf16 a[100:103], v[156:159], v[36:39], a[100:103]
  v_exp_f32 v109, v109
  v_mfma_f32_16x16x32_bf16 a[104:107], v[160:163], v[36:39], a[104:107]
  ds_read_b64_tr_b16 v[240:241], v255 offset:0
  v_mfma_f32_16x16x32_bf16 a[108:111], v[164:167], v[36:39], a[108:111]
  v_exp_f32 v110, v110
  v_mfma_f32_16x16x32_bf16 a[112:115], v[168:171], v[36:39], a[112:115]
  ds_read_b64_tr_b16 v[242:243], v255 offset:4096
  v_mfma_f32_16x16x32_bf16 a[116:119], v[172:175], v[36:39], a[116:119]
  v_exp_f32 v111, v111
  v_mfma_f32_16x16x32_bf16 a[120:123], v[176:179], v[36:39], a[120:123]
  v_cvt_pk_bf16_f32 v42, v108, v109
  v_cvt_pk_bf16_f32 v43, v110, v111
  s_add_u32 s41, s41, 16384
  s_add_u32 s31, s31, 32768
  s_cmp_eq_u32 s31, s30
  s_cselect_b32 s31, s42, s31
  v_mfma_f32_16x16x32_bf16 a[124:127], v[180:183], v[36:39], a[124:127]
  ds_read_b64_tr_b16 v[244:245], v255 offset:8
  v_mfma_f32_16x16x32_bf16 v[88:91], v[52:55], v[36:39], v[88:91]
  s_waitcnt lgkmcnt(4)
  ds_read_b64_tr_b16 v[246:247], v255 offset:4104
  s_waitcnt vmcnt(8) lgkmcnt(0)
  s_barrier
  v_mfma_f32_16x16x32_bf16 v[104:107], v[184:187], a[192:195], v[64:67]
  v_exp_f32 v112, v112
  v_mfma_f32_16x16x32_bf16 v[104:107], v[188:191], a[196:199], v[104:107]
  s_cmp_eq_u32 s58, 0
  s_cbranch_scc1 fa_kernel_npf15
  s_cmp_ge_u32 s24, 2
  s_cbranch_scc1 fa_kernel_ncpo15
  s_getpc_b64 s[60:61]
fa_kernel_cpo15:
  s_add_u32 s60, s60, oproj_kernel-fa_kernel_cpo15
  s_addc_u32 s61, s61, 0
  s_lshl_b32 s39, s24, 13
  v_add_u32 v2, s39, v19
  s_mov_b32 s39, oproj_kernel_done-oproj_kernel
  v_cmp_gt_u32 vcc, s39, v2
  s_nop 0
  s_and_saveexec_b64 s[72:73], vcc
  s_cbranch_execz fa_kernel_rcpo15
  global_load_dword v16, v2, s[60:61]
fa_kernel_rcpo15:
  s_mov_b64 exec, s[72:73]
fa_kernel_ncpo15:
fa_kernel_npf15:
  s_sub_u32 s49, s31, s42
  v_mfma_f32_16x16x32_bf16 v[104:107], v[192:195], a[200:203], v[104:107]
  v_exp_f32 v113, v113
  v_mfma_f32_16x16x32_bf16 v[104:107], v[196:199], a[204:207], v[104:107]
  v_exp_f32 v114, v114
  v_mfma_f32_16x16x32_bf16 v[108:111], v[200:203], a[192:195], v[64:67]
  v_mfma_f32_16x16x32_bf16 v[108:111], v[204:207], a[196:199], v[108:111]
  v_exp_f32 v115, v115
  v_mfma_f32_16x16x32_bf16 v[108:111], v[208:211], a[200:203], v[108:111]
  v_cvt_pk_bf16_f32 v44, v112, v113
  v_cvt_pk_bf16_f32 v45, v114, v115
  v_mfma_f32_16x16x32_bf16 v[108:111], v[212:215], a[204:207], v[108:111]
  v_mfma_f32_16x16x32_bf16 a[128:131], v[152:155], v[40:43], a[128:131]
  v_exp_f32 v116, v116
  v_mfma_f32_16x16x32_bf16 a[132:135], v[156:159], v[40:43], a[132:135]
  v_exp_f32 v117, v117
  v_mfma_f32_16x16x32_bf16 a[136:139], v[160:163], v[40:43], a[136:139]
  s_cmp_lg_u32 s58, 0
  s_cbranch_scc1 fa_kernel_npc16
  s_cmp_ge_u32 s24, 1
  s_cbranch_scc1 fa_kernel_ncpc16
  s_getpc_b64 s[60:61]
fa_kernel_cpc16:
  s_add_u32 s60, s60, fa_kernel_cmb-fa_kernel_cpc16
  s_addc_u32 s61, s61, 0
  s_lshl_b32 s39, s24, 13
  v_add_u32 v2, s39, v19
  s_mov_b32 s39, fa_kernel_done-fa_kernel_cmb
  v_cmp_gt_u32 vcc, s39, v2
  s_nop 0
  s_and_saveexec_b64 s[72:73], vcc
  s_cbranch_execz fa_kernel_rcpc16
  global_load_dword v16, v2, s[60:61]
fa_kernel_rcpc16:
  s_mov_b64 exec, s[72:73]
fa_kernel_ncpc16:
fa_kernel_npc16:
  v_mfma_f32_16x16x32_bf16 a[140:143], v[164:167], v[40:43], a[140:143]
  v_exp_f32 v118, v118
  v_mfma_f32_16x16x32_bf16 a[144:147], v[168:171], v[40:43], a[144:147]
  v_mfma_f32_16x16x32_bf16 a[148:151], v[172:175], v[40:43], a[148:151]
  v_exp_f32 v119, v119
  v_mfma_f32_16x16x32_bf16 a[152:155], v[176:179], v[40:43], a[152:155]
  v_cvt_pk_bf16_f32 v46, v116, v117
  v_cvt_pk_bf16_f32 v47, v118, v119
  v_mfma_f32_16x16x32_bf16 a[156:159], v[180:183], v[40:43], a[156:159]
  v_mfma_f32_16x16x32_bf16 v[92:95], v[52:55], v[40:43], v[92:95]
  v_mfma_f32_16x16x32_bf16 v[112:115], v[184:187], a[208:211], v[68:71]
  v_exp_f32 v96, v96
  v_mfma_f32_16x16x32_bf16 v[112:115], v[188:191], a[212:215], v[112:115]
  v_mfma_f32_16x16x32_bf16 v[112:115], v[192:195], a[216:219], v[112:115]
  v_exp_f32 v97, v97
  v_mfma_f32_16x16x32_bf16 v[112:115], v[196:199], a[220:223], v[112:115]
  v_exp_f32 v98, v98
  v_mfma_f32_16x16x32_bf16 v[116:119], v[200:203], a[208:211], v[68:71]
  v_mfma_f32_16x16x32_bf16 v[116:119], v[204:207], a[212:215], v[116:119]
  v_exp_f32 v99, v99
  v_mfma_f32_16x16x32_bf16 v[116:119], v[208:211], a[216:219], v[116:119]
  v_cvt_pk_bf16_f32 v36, v96, v97
  v_cvt_pk_bf16_f32 v37, v98, v99
  v_mfma_f32_16x16x32_bf16 v[116:119], v[212:215], a[220:223], v[116:119]
  v_mfma_f32_16x16x32_bf16 a[0:3], v[216:219], v[44:47], a[0:3]
  v_exp_f32 v100, v100
  v_mfma_f32_16x16x32_bf16 a[4:7], v[220:223], v[44:47], a[4:7]
  v_exp_f32 v101, v101
  v_mfma_f32_16x16x32_bf16 a[8:11], v[224:227], v[44:47], a[8:11]
  v_mfma_f32_16x16x32_bf16 a[12:15], v[228:231], v[44:47], a[12:15]
  v_exp_f32 v102, v102
  v_mfma_f32_16x16x32_bf16 a[16:19], v[232:235], v[44:47], a[16:19]
  v_mfma_f32_16x16x32_bf16 a[20:23], v[236:239], v[44:47], a[20:23]
  v_exp_f32 v103, v103
  v_mfma_f32_16x16x32_bf16 a[24:27], v[240:243], v[44:47], a[24:27]
  v_cvt_pk_bf16_f32 v38, v100, v101
  v_cvt_pk_bf16_f32 v39, v102, v103
  v_mfma_f32_16x16x32_bf16 a[28:31], v[244:247], v[44:47], a[28:31]
  v_mfma_f32_16x16x32_bf16 v[76:79], v[52:55], v[44:47], v[76:79]
  v_mfma_f32_16x16x32_bf16 a[32:35], v[216:219], v[36:39], a[32:35]
  v_exp_f32 v104, v104
  v_mfma_f32_16x16x32_bf16 a[36:39], v[220:223], v[36:39], a[36:39]
  v_mfma_f32_16x16x32_bf16 a[40:43], v[224:227], v[36:39], a[40:43]
  v_exp_f32 v105, v105
  v_mfma_f32_16x16x32_bf16 a[44:47], v[228:231], v[36:39], a[44:47]
  v_exp_f32 v106, v106
  v_mfma_f32_16x16x32_bf16 a[48:51], v[232:235], v[36:39], a[48:51]
  v_mfma_f32_16x16x32_bf16 a[52:55], v[236:239], v[36:39], a[52:55]
  v_exp_f32 v107, v107
  v_mfma_f32_16x16x32_bf16 a[56:59], v[240:243], v[36:39], a[56:59]
  v_cvt_pk_bf16_f32 v40, v104, v105
  v_cvt_pk_bf16_f32 v41, v106, v107
  v_mfma_f32_16x16x32_bf16 a[60:63], v[244:247], v[36:39], a[60:63]
  v_mfma_f32_16x16x32_bf16 v[80:83], v[52:55], v[36:39], v[80:83]
  v_exp_f32 v108, v108
  v_exp_f32 v109, v109
  v_exp_f32 v110, v110
  v_exp_f32 v111, v111
  v_cvt_pk_bf16_f32 v42, v108, v109
  v_cvt_pk_bf16_f32 v43, v110, v111
  s_nop 1
  v_mfma_f32_16x16x32_bf16 a[64:67], v[216:219], v[40:43], a[64:67]
  v_exp_f32 v112, v112
  v_mfma_f32_16x16x32_bf16 a[68:71], v[220:223], v[40:43], a[68:71]
  v_mfma_f32_16x16x32_bf16 a[72:75], v[224:227], v[40:43], a[72:75]
  v_exp_f32 v113, v113
  v_mfma_f32_16x16x32_bf16 a[76:79], v[228:231], v[40:43], a[76:79]
  v_exp_f32 v114, v114
  v_mfma_f32_16x16x32_bf16 a[80:83], v[232:235], v[40:43], a[80:83]
  v_mfma_f32_16x16x32_bf16 a[84:87], v[236:239], v[40:43], a[84:87]
  v_exp_f32 v115, v115
  v_mfma_f32_16x16x32_bf16 a[88:91], v[240:243], v[40:43], a[88:91]
  v_cvt_pk_bf16_f32 v44, v112, v113
  v_cvt_pk_bf16_f32 v45, v114, v115
  v_mfma_f32_16x16x32_bf16 a[92:95], v[244:247], v[40:43], a[92:95]
  v_mfma_f32_16x16x32_bf16 v[84:87], v[52:55], v[40:43], v[84:87]
  v_exp_f32 v116, v116
  v_exp_f32 v117, v117
  v_exp_f32 v118, v118
  v_exp_f32 v119, v119
  v_cvt_pk_bf16_f32 v46, v116, v117
  v_cvt_pk_bf16_f32 v47, v118, v119
  s_nop 1
  v_mfma_f32_16x16x32_bf16 a[96:99], v[216:219], v[44:47], a[96:99]
  v_mfma_f32_16x16x32_bf16 a[100:103], v[220:223], v[44:47], a[100:103]
  v_mfma_f32_16x16x32_bf16 a[104:107], v[224:227], v[44:47], a[104:107]
  v_mfma_f32_16x16x32_bf16 a[108:111], v[228:231], v[44:47], a[108:111]
  v_mfma_f32_16x16x32_bf16 a[112:115], v[232:235], v[44:47], a[112:115]
  v_mfma_f32_16x16x32_bf16 a[116:119], v[236:239], v[44:47], a[116:119]
  v_mfma_f32_16x16x32_bf16 a[120:123], v[240:243], v[44:47], a[120:123]
  v_mfma_f32_16x16x32_bf16 a[124:127], v[244:247], v[44:47], a[124:127]
  v_mfma_f32_16x16x32_bf16 v[88:91], v[52:55], v[44:47], v[88:91]
  s_branch fa_kernel_cmb
fa_kernel_q1:
  v_mov_b32 v76, 0
  v_mov_b32 v56, 0
  v_mov_b32 v77, 0
  v_mov_b32 v57, 0
  v_mov_b32 v78, 0
  v_mov_b32 v58, 0
  v_mov_b32 v79, 0
  v_mov_b32 v59, 0
  v_mov_b32 v80, 0
  v_mov_b32 v60, 0
  v_mov_b32 v81, 0
  v_mov_b32 v61, 0
  v_mov_b32 v82, 0
  v_mov_b32 v62, 0
  v_mov_b32 v83, 0
  v_mov_b32 v63, 0
  v_mov_b32 v84, 0
  v_mov_b32 v64, 0
  v_mov_b32 v85, 0
  v_mov_b32 v65, 0
  v_mov_b32 v86, 0
  v_mov_b32 v66, 0
  v_mov_b32 v87, 0
  v_mov_b32 v67, 0
  v_mov_b32 v88, 0
  v_mov_b32 v68, 0
  v_mov_b32 v89, 0
  v_mov_b32 v69, 0
  v_mov_b32 v90, 0
  v_mov_b32 v70, 0
  v_mov_b32 v91, 0
  v_mov_b32 v71, 0
  v_mov_b32 v92, 0
  v_mov_b32 v72, 0
  v_mov_b32 v93, 0
  v_mov_b32 v73, 0
  v_mov_b32 v94, 0
  v_mov_b32 v74, 0
  v_mov_b32 v95, 0
  v_mov_b32 v75, 0
  s_nop 1
  v_mfma_f32_16x16x32_bf16 a[0:3], v[76:79], v[76:79], 0
  v_mfma_f32_16x16x32_bf16 a[4:7], v[76:79], v[76:79], 0
  v_mfma_f32_16x16x32_bf16 a[8:11], v[76:79], v[76:79], 0
  v_mfma_f32_16x16x32_bf16 a[12:15], v[76:79], v[76:79], 0
  v_mfma_f32_16x16x32_bf16 a[16:19], v[76:79], v[76:79], 0
  v_mfma_f32_16x16x32_bf16 a[20:23], v[76:79], v[76:79], 0
  v_mfma_f32_16x16x32_bf16 a[24:27], v[76:79], v[76:79], 0
  v_mfma_f32_16x16x32_bf16 a[28:31], v[76:79], v[76:79], 0
  v_mfma_f32_16x16x32_bf16 a[32:35], v[76:79], v[76:79], 0
  v_mfma_f32_16x16x32_bf16 a[36:39], v[76:79], v[76:79], 0
  v_mfma_f32_16x16x32_bf16 a[40:43], v[76:79], v[76:79], 0
  v_mfma_f32_16x16x32_bf16 a[44:47], v[76:79], v[76:79], 0
  v_mfma_f32_16x16x32_bf16 a[48:51], v[76:79], v[76:79], 0
  v_mfma_f32_16x16x32_bf16 a[52:55], v[76:79], v[76:79], 0
  v_mfma_f32_16x16x32_bf16 a[56:59], v[76:79], v[76:79], 0
  v_mfma_f32_16x16x32_bf16 a[60:63], v[76:79], v[76:79], 0
  v_mfma_f32_16x16x32_bf16 a[64:67], v[76:79], v[76:79], 0
  v_mfma_f32_16x16x32_bf16 a[68:71], v[76:79], v[76:79], 0
  v_mfma_f32_16x16x32_bf16 a[72:75], v[76:79], v[76:79], 0
  v_mfma_f32_16x16x32_bf16 a[76:79], v[76:79], v[76:79], 0
  v_mfma_f32_16x16x32_bf16 a[80:83], v[76:79], v[76:79], 0
  v_mfma_f32_16x16x32_bf16 a[84:87], v[76:79], v[76:79], 0
  v_mfma_f32_16x16x32_bf16 a[88:91], v[76:79], v[76:79], 0
  v_mfma_f32_16x16x32_bf16 a[92:95], v[76:79], v[76:79], 0
  v_mfma_f32_16x16x32_bf16 a[96:99], v[76:79], v[76:79], 0
  v_mfma_f32_16x16x32_bf16 a[100:103], v[76:79], v[76:79], 0
  v_mfma_f32_16x16x32_bf16 a[104:107], v[76:79], v[76:79], 0
  v_mfma_f32_16x16x32_bf16 a[108:111], v[76:79], v[76:79], 0
  v_mfma_f32_16x16x32_bf16 a[112:115], v[76:79], v[76:79], 0
  v_mfma_f32_16x16x32_bf16 a[116:119], v[76:79], v[76:79], 0
  v_mfma_f32_16x16x32_bf16 a[120:123], v[76:79], v[76:79], 0
  v_mfma_f32_16x16x32_bf16 a[124:127], v[76:79], v[76:79], 0
  v_mfma_f32_16x16x32_bf16 a[128:131], v[76:79], v[76:79], 0
  v_mfma_f32_16x16x32_bf16 a[132:135], v[76:79], v[76:79], 0
  v_mfma_f32_16x16x32_bf16 a[136:139], v[76:79], v[76:79], 0
  v_mfma_f32_16x16x32_bf16 a[140:143], v[76:79], v[76:79], 0
  v_mfma_f32_16x16x32_bf16 a[144:147], v[76:79], v[76:79], 0
  v_mfma_f32_16x16x32_bf16 a[148:151], v[76:79], v[76:79], 0
  v_mfma_f32_16x16x32_bf16 a[152:155], v[76:79], v[76:79], 0
  v_mfma_f32_16x16x32_bf16 a[156:159], v[76:79], v[76:79], 0
  s_mov_b32 s34, 0xff800000
  s_mov_b32 s35, 0xff800000
  s_mov_b32 s36, 0xff800000
  s_mov_b32 s37, 0xff800000
  s_mov_b32 s38, 0xff800000
  s_waitcnt vmcnt(16)
  s_barrier
  v_add_u32 v28, s32, v20
  v_add_u32 v29, s32, v21
  v_add_u32 v30, s32, v22
  v_add_u32 v31, s32, v23
  v_add_u32 v32, s32, v24
  v_add_u32 v33, s32, v25
  v_add_u32 v34, s32, v26
  v_add_u32 v35, s32, v27
  s_add_u32 s32, s32, 32768
  s_cmp_eq_u32 s32, 98304
  s_cselect_b32 s32, 0, s32
  ds_read_b128 v[120:123], v28 offset:0
  ds_read_b128 v[124:127], v29 offset:0
  ds_read_b128 v[128:131], v30 offset:0
  ds_read_b128 v[132:135], v31 offset:0
  ds_read_b128 v[136:139], v28 offset:4096
  ds_read_b128 v[140:143], v29 offset:4096
  ds_read_b128 v[144:147], v30 offset:4096
  ds_read_b128 v[148:151], v31 offset:4096
  ds_read_b64_tr_b16 v[152:153], v32 offset:0
  ds_read_b64_tr_b16 v[154:155], v32 offset:4096
  ds_read_b64_tr_b16 v[156:157], v32 offset:8
  ds_read_b64_tr_b16 v[158:159], v32 offset:4104
  ds_read_b64_tr_b16 v[160:161], v33 offset:0
  ds_read_b64_tr_b16 v[162:163], v33 offset:4096
  ds_read_b64_tr_b16 v[164:165], v33 offset:8
  s_waitcnt lgkmcnt(14)
  ds_read_b64_tr_b16 v[166:167], v33 offset:4104
  s_waitcnt lgkmcnt(14)
  ds_read_b64_tr_b16 v[168:169], v34 offset:0
  s_waitcnt lgkmcnt(14)
  ds_read_b64_tr_b16 v[170:171], v34 offset:4096
  s_waitcnt lgkmcnt(14)
  ds_read_b64_tr_b16 v[172:173], v34 offset:8
  s_waitcnt lgkmcnt(14)
  ds_read_b64_tr_b16 v[174:175], v34 offset:4104
  s_waitcnt lgkmcnt(14)
  ds_read_b64_tr_b16 v[176:177], v35 offset:0
  s_waitcnt lgkmcnt(14)
  ds_read_b64_tr_b16 v[178:179], v35 offset:4096
  s_waitcnt lgkmcnt(14)
  ds_read_b64_tr_b16 v[180:181], v35 offset:8
  s_waitcnt lgkmcnt(14)
  ds_read_b64_tr_b16 v[182:183], v35 offset:4104
  v_add_u32 v28, s32, v20
  v_add_u32 v29, s32, v21
  v_add_u32 v30, s32, v22
  v_add_u32 v31, s32, v23
  v_add_u32 v252, s32, v24
  v_add_u32 v253, s32, v25
  v_add_u32 v254, s32, v26
  v_add_u32 v255, s32, v27
  s_add_u32 s32, s32, 32768
  s_cmp_eq_u32 s32, 98304
  s_cselect_b32 s32, 0, s32
  v_mfma_f32_16x16x32_bf16 v[96:99], v[120:123], a[160:163], v[56:59]
  v_mfma_f32_16x16x32_bf16 v[96:99], v[124:127], a[164:167], v[96:99]
  v_mfma_f32_16x16x32_bf16 v[96:99], v[128:131], a[168:171], v[96:99]
  v_mfma_f32_16x16x32_bf16 v[96:99], v[132:135], a[172:175], v[96:99]
  v_mfma_f32_16x16x32_bf16 v[100:103], v[136:139], a[160:163], v[56:59]
  v_mfma_f32_16x16x32_bf16 v[100:103], v[140:143], a[164:167], v[100:103]
  v_mfma_f32_16x16x32_bf16 v[100:103], v[144:147], a[168:171], v[100:103]
  v_mfma_f32_16x16x32_bf16 v[100:103], v[148:151], a[172:175], v[100:103]
  v_mfma_f32_16x16x32_bf16 v[104:107], v[120:123], a[176:179], v[60:63]
  v_mfma_f32_16x16x32_bf16 v[104:107], v[124:127], a[180:183], v[104:107]
  v_mfma_f32_16x16x32_bf16 v[104:107], v[128:131], a[184:187], v[104:107]
  v_mfma_f32_16x16x32_bf16 v[104:107], v[132:135], a[188:191], v[104:107]
  v_mfma_f32_16x16x32_bf16 v[108:111], v[136:139], a[176:179], v[60:63]
  v_mfma_f32_16x16x32_bf16 v[108:111], v[140:143], a[180:183], v[108:111]
  v_mfma_f32_16x16x32_bf16 v[108:111], v[144:147], a[184:187], v[108:111]
  v_mfma_f32_16x16x32_bf16 v[108:111], v[148:151], a[188:191], v[108:111]
  v_mfma_f32_16x16x32_bf16 v[112:115], v[120:123], a[192:195], v[64:67]
  v_mfma_f32_16x16x32_bf16 v[112:115], v[124:127], a[196:199], v[112:115]
  v_mfma_f32_16x16x32_bf16 v[112:115], v[128:131], a[200:203], v[112:115]
  v_mfma_f32_16x16x32_bf16 v[112:115], v[132:135], a[204:207], v[112:115]
  v_mfma_f32_16x16x32_bf16 v[116:119], v[136:139], a[192:195], v[64:67]
  v_mfma_f32_16x16x32_bf16 v[116:119], v[140:143], a[196:199], v[116:119]
  v_mfma_f32_16x16x32_bf16 v[116:119], v[144:147], a[200:203], v[116:119]
  v_mfma_f32_16x16x32_bf16 v[116:119], v[148:151], a[204:207], v[116:119]
  v_exp_f32 v96, v96
  v_exp_f32 v97, v97
  v_exp_f32 v98, v98
  v_cvt_pk_bf16_f32 v36, v96, v97
  v_exp_f32 v99, v99
  v_exp_f32 v100, v100
  v_cvt_pk_bf16_f32 v37, v98, v99
  v_exp_f32 v101, v101
  v_exp_f32 v102, v102
  v_cvt_pk_bf16_f32 v38, v100, v101
  v_exp_f32 v103, v103
  s_nop 0
  v_cvt_pk_bf16_f32 v39, v102, v103
  s_waitcnt lgkmcnt(0)
  s_mov_b32 s33, 7
fa_kernel_atb:
  s_waitcnt vmcnt(8) lgkmcnt(0)
  s_barrier
  v_mfma_f32_16x16x32_bf16 v[96:99], v[120:123], a[208:211], v[68:71]
  v_exp_f32 v104, v104
  v_mfma_f32_16x16x32_bf16 v[96:99], v[124:127], a[212:215], v[96:99]
  ds_read_b128 v[184:187], v28 offset:0
  v_mfma_f32_16x16x32_bf16 v[96:99], v[128:131], a[216:219], v[96:99]
  v_exp_f32 v105, v105
  v_mfma_f32_16x16x32_bf16 v[96:99], v[132:135], a[220:223], v[96:99]
  v_exp_f32 v106, v106
  v_mfma_f32_16x16x32_bf16 v[100:103], v[136:139], a[208:211], v[68:71]
  ds_read_b128 v[188:191], v29 offset:0
  v_mfma_f32_16x16x32_bf16 v[100:103], v[140:143], a[212:215], v[100:103]
  v_exp_f32 v107, v107
  v_mfma_f32_16x16x32_bf16 v[100:103], v[144:147], a[216:219], v[100:103]
  v_cvt_pk_bf16_f32 v40, v104, v105
  v_cvt_pk_bf16_f32 v41, v106, v107
  ds_read_b128 v[192:195], v30 offset:0
  v_mfma_f32_16x16x32_bf16 v[100:103], v[148:151], a[220:223], v[100:103]
  ds_read_b128 v[196:199], v31 offset:0
  v_mfma_f32_16x16x32_bf16 a[0:3], v[152:155], v[36:39], a[0:3]
  v_exp_f32 v108, v108
  v_mfma_f32_16x16x32_bf16 a[4:7], v[156:159], v[36:39], a[4:7]
  v_exp_f32 v109, v109
  v_mfma_f32_16x16x32_bf16 a[8:11], v[160:163], v[36:39], a[8:11]
  ds_read_b128 v[200:203], v28 offset:4096
  v_mfma_f32_16x16x32_bf16 a[12:15], v[164:167], v[36:39], a[12:15]
  v_exp_f32 v110, v110
  v_mfma_f32_16x16x32_bf16 a[16:19], v[168:171], v[36:39], a[16:19]
  ds_read_b128 v[204:207], v29 offset:4096
  v_mfma_f32_16x16x32_bf16 a[20:23], v[172:175], v[36:39], a[20:23]
  v_exp_f32 v111, v111
  v_mfma_f32_16x16x32_bf16 a[24:27], v[176:179], v[36:39], a[24:27]
  v_cvt_pk_bf16_f32 v42, v108, v109
  v_cvt_pk_bf16_f32 v43, v110, v111
  v_mfma_f32_16x16x32_bf16 a[28:31], v[180:183], v[36:39], a[28:31]
  ds_read_b128 v[208:211], v30 offset:4096
  v_mfma_f32_16x16x32_bf16 v[76:79], v[52:55], v[36:39], v[76:79]
  ds_read_b128 v[212:215], v31 offset:4096
  s_waitcnt lgkmcnt(7)
  v_mfma_f32_16x16x32_bf16 v[104:107], v[184:187], a[160:163], v[56:59]
  v_exp_f32 v112, v112
  s_waitcnt lgkmcnt(6)
  v_mfma_f32_16x16x32_bf16 v[104:107], v[188:191], a[164:167], v[104:107]
  ds_read_b64_tr_b16 v[216:217], v252 offset:0
  s_waitcnt lgkmcnt(6)
  v_mfma_f32_16x16x32_bf16 v[104:107], v[192:195], a[168:171], v[104:107]
  v_exp_f32 v113, v113
  s_waitcnt lgkmcnt(5)
  v_mfma_f32_16x16x32_bf16 v[104:107], v[196:199], a[172:175], v[104:107]
  v_exp_f32 v114, v114
  s_waitcnt lgkmcnt(4)
  v_mfma_f32_16x16x32_bf16 v[108:111], v[200:203], a[160:163], v[56:59]
  ds_read_b64_tr_b16 v[218:219], v252 offset:4096
  s_waitcnt lgkmcnt(4)
  v_mfma_f32_16x16x32_bf16 v[108:111], v[204:207], a[164:167], v[108:111]
  v_exp_f32 v115, v115
  s_waitcnt lgkmcnt(3)
  v_mfma_f32_16x16x32_bf16 v[108:111], v[208:211], a[168:171], v[108:111]
  v_cvt_pk_bf16_f32 v44, v112, v113
  v_cvt_pk_bf16_f32 v45, v114, v115
  ds_read_b64_tr_b16 v[220:221], v252 offset:8
  s_waitcnt lgkmcnt(3)
  v_mfma_f32_16x16x32_bf16 v[108:111], v[212:215], a[172:175], v[108:111]
  ds_read_b64_tr_b16 v[222:223], v252 offset:4104
  v_mfma_f32_16x16x32_bf16 a[32:35], v[152:155], v[40:43], a[32:35]
  v_exp_f32 v116, v116
  v_mfma_f32_16x16x32_bf16 a[36:39], v[156:159], v[40:43], a[36:39]
  v_exp_f32 v117, v117
  v_mfma_f32_16x16x32_bf16 a[40:43], v[160:163], v[40:43], a[40:43]
  ds_read_b64_tr_b16 v[224:225], v253 offset:0
  v_mfma_f32_16x16x32_bf16 a[44:47], v[164:167], v[40:43], a[44:47]
  v_exp_f32 v118, v118
  s_mov_b32 m0, s31
  v_mfma_f32_16x16x32_bf16 a[48:51], v[168:171], v[40:43], a[48:51]
  buffer_load_dwordx4 v10, s[8:11], s41 offen offset:0 nt lds
  v_mfma_f32_16x16x32_bf16 a[52:55], v[172:175], v[40:43], a[52:55]
  v_exp_f32 v119, v119
  v_mfma_f32_16x16x32_bf16 a[56:59], v[176:179], v[40:43], a[56:59]
  v_cvt_pk_bf16_f32 v46, v116, v117
  v_cvt_pk_bf16_f32 v47, v118, v119
  v_mfma_f32_16x16x32_bf16 a[60:63], v[180:183], v[40:43], a[60:63]
  buffer_load_dwordx4 v11, s[8:11], s41 offen offset:1024 nt lds
  v_mfma_f32_16x16x32_bf16 v[80:83], v[52:55], v[40:43], v[80:83]
  buffer_load_dwordx4 v12, s[8:11], s41 offen offset:2048 nt lds
  v_mfma_f32_16x16x32_bf16 v[112:115], v[184:187], a[176:179], v[60:63]
  v_exp_f32 v96, v96
  v_add_u32 v29, s32, v21
  v_mfma_f32_16x16x32_bf16 v[112:115], v[188:191], a[180:183], v[112:115]
  ds_read_b64_tr_b16 v[226:227], v253 offset:4096
  v_mfma_f32_16x16x32_bf16 v[112:115], v[192:195], a[184:187], v[112:115]
  v_exp_f32 v97, v97
  v_add_u32 v30, s32, v22
  v_mfma_f32_16x16x32_bf16 v[112:115], v[196:199], a[188:191], v[112:115]
  v_exp_f32 v98, v98
  v_add_u32 v31, s32, v23
  v_mfma_f32_16x16x32_bf16 v[116:119], v[200:203], a[176:179], v[60:63]
  ds_read_b64_tr_b16 v[228:229], v253 offset:8
  v_mfma_f32_16x16x32_bf16 v[116:119], v[204:207], a[180:183], v[116:119]
  v_exp_f32 v99, v99
  v_mfma_f32_16x16x32_bf16 v[116:119], v[208:211], a[184:187], v[116:119]
  v_cvt_pk_bf16_f32 v36, v96, v97
  v_cvt_pk_bf16_f32 v37, v98, v99
  ds_read_b64_tr_b16 v[230:231], v253 offset:4104
  v_mfma_f32_16x16x32_bf16 v[116:119], v[212:215], a[188:191], v[116:119]
  ds_read_b64_tr_b16 v[232:233], v254 offset:0
  v_mfma_f32_16x16x32_bf16 a[64:67], v[152:155], v[44:47], a[64:67]
  v_exp_f32 v100, v100
  v_mfma_f32_16x16x32_bf16 a[68:71], v[156:159], v[44:47], a[68:71]
  v_exp_f32 v101, v101
  v_mfma_f32_16x16x32_bf16 a[72:75], v[160:163], v[44:47], a[72:75]
  ds_read_b64_tr_b16 v[234:235], v254 offset:4096
  v_mfma_f32_16x16x32_bf16 a[76:79], v[164:167], v[44:47], a[76:79]
  v_exp_f32 v102, v102
  v_mfma_f32_16x16x32_bf16 a[80:83], v[168:171], v[44:47], a[80:83]
  ds_read_b64_tr_b16 v[236:237], v254 offset:8
  v_mfma_f32_16x16x32_bf16 a[84:87], v[172:175], v[44:47], a[84:87]
  v_exp_f32 v103, v103
  v_mfma_f32_16x16x32_bf16 a[88:91], v[176:179], v[44:47], a[88:91]
  v_cvt_pk_bf16_f32 v38, v100, v101
  v_cvt_pk_bf16_f32 v39, v102, v103
  v_add_u32 v28, s32, v20
  v_mfma_f32_16x16x32_bf16 a[92:95], v[180:183], v[44:47], a[92:95]
  buffer_load_dwordx4 v13, s[8:11], s41 offen offset:3072 nt lds
  v_mfma_f32_16x16x32_bf16 v[84:87], v[52:55], v[44:47], v[84:87]
  s_add_u32 m0, s31, 4096
  s_nop 0
  buffer_load_dwordx4 v248, s[8:11], s41 offen offset:0 nt lds
  v_mfma_f32_16x16x32_bf16 v[96:99], v[184:187], a[192:195], v[64:67]
  v_exp_f32 v104, v104
  v_add_u32 v33, s32, v25
  v_mfma_f32_16x16x32_bf16 v[96:99], v[188:191], a[196:199], v[96:99]
  buffer_load_dwordx4 v249, s[8:11], s41 offen offset:1024 nt lds
  v_mfma_f32_16x16x32_bf16 v[96:99], v[192:195], a[200:203], v[96:99]
  v_exp_f32 v105, v105
  v_add_u32 v34, s32, v26
  v_mfma_f32_16x16x32_bf16 v[96:99], v[196:199], a[204:207], v[96:99]
  v_exp_f32 v106, v106
  v_add_u32 v35, s32, v27
  v_mfma_f32_16x16x32_bf16 v[100:103], v[200:203], a[192:195], v[64:67]
  buffer_load_dwordx4 v250, s[8:11], s41 offen offset:2048 nt lds
  v_mfma_f32_16x16x32_bf16 v[100:103], v[204:207], a[196:199], v[100:103]
  v_exp_f32 v107, v107
  v_mfma_f32_16x16x32_bf16 v[100:103], v[208:211], a[200:203], v[100:103]
  v_cvt_pk_bf16_f32 v40, v104, v105
  v_cvt_pk_bf16_f32 v41, v106, v107
  buffer_load_dwordx4 v251, s[8:11], s41 offen offset:3072 nt lds
  v_mfma_f32_16x16x32_bf16 v[100:103], v[212:215], a[204:207], v[100:103]
  ds_read_b64_tr_b16 v[238:239], v254 offset:4104
  v_mfma_f32_16x16x32_bf16 a[96:99], v[152:155], v[36:39], a[96:99]
  v_exp_f32 v108, v108
  s_add_u32 s41, s41, 16384
  s_add_u32 s31, s31, 32768
  s_cmp_eq_u32 s31, s30
  s_cselect_b32 s31, s42, s31
  v_mfma_f32_16x16x32_bf16 a[100:103], v[156:159], v[36:39], a[100:103]
  v_exp_f32 v109, v109
  v_mfma_f32_16x16x32_bf16 a[104:107], v[160:163], v[36:39], a[104:107]
  ds_read_b64_tr_b16 v[240:241], v255 offset:0
  v_mfma_f32_16x16x32_bf16 a[108:111], v[164:167], v[36:39], a[108:111]
  v_exp_f32 v110, v110
  v_mfma_f32_16x16x32_bf16 a[112:115], v[168:171], v[36:39], a[112:115]
  ds_read_b64_tr_b16 v[242:243], v255 offset:4096
  v_mfma_f32_16x16x32_bf16 a[116:119], v[172:175], v[36:39], a[116:119]
  v_exp_f32 v111, v111
  v_mfma_f32_16x16x32_bf16 a[120:123], v[176:179], v[36:39], a[120:123]
  v_cvt_pk_bf16_f32 v42, v108, v109
  v_cvt_pk_bf16_f32 v43, v110, v111
  v_add_u32 v32, s32, v24
  s_add_u32 s32, s32, 32768
  s_cmp_eq_u32 s32, 98304
  s_cselect_b32 s32, 0, s32
  v_mfma_f32_16x16x32_bf16 a[124:127], v[180:183], v[36:39], a[124:127]
  ds_read_b64_tr_b16 v[244:245], v255 offset:8
  v_mfma_f32_16x16x32_bf16 v[88:91], v[52:55], v[36:39], v[88:91]
  s_waitcnt lgkmcnt(4)
  ds_read_b64_tr_b16 v[246:247], v255 offset:4104
  s_waitcnt vmcnt(8) lgkmcnt(0)
  s_barrier
  v_mfma_f32_16x16x32_bf16 v[104:107], v[184:187], a[208:211], v[68:71]
  v_exp_f32 v112, v112
  v_mfma_f32_16x16x32_bf16 v[104:107], v[188:191], a[212:215], v[104:107]
  ds_read_b128 v[120:123], v28 offset:0
  v_mfma_f32_16x16x32_bf16 v[104:107], v[192:195], a[216:219], v[104:107]
  v_exp_f32 v113, v113
  v_mfma_f32_16x16x32_bf16 v[104:107], v[196:199], a[220:223], v[104:107]
  v_exp_f32 v114, v114
  v_mfma_f32_16x16x32_bf16 v[108:111], v[200:203], a[208:211], v[68:71]
  ds_read_b128 v[124:127], v29 offset:0
  v_mfma_f32_16x16x32_bf16 v[108:111], v[204:207], a[212:215], v[108:111]
  v_exp_f32 v115, v115
  v_mfma_f32_16x16x32_bf16 v[108:111], v[208:211], a[216:219], v[108:111]
  v_cvt_pk_bf16_f32 v44, v112, v113
  v_cvt_pk_bf16_f32 v45, v114, v115
  v_mfma_f32_16x16x32_bf16 v[108:111], v[212:215], a[220:223], v[108:111]
  ds_read_b128 v[128:131], v30 offset:0
  v_mfma_f32_16x16x32_bf16 a[0:3], v[216:219], v[40:43], a[0:3]
  v_exp_f32 v116, v116
  v_mfma_f32_16x16x32_bf16 a[4:7], v[220:223], v[40:43], a[4:7]
  v_exp_f32 v117, v117
  v_mfma_f32_16x16x32_bf16 a[8:11], v[224:227], v[40:43], a[8:11]
  ds_read_b128 v[132:135], v31 offset:0
  v_mfma_f32_16x16x32_bf16 a[12:15], v[228:231], v[40:43], a[12:15]
  v_exp_f32 v118, v118
  v_mfma_f32_16x16x32_bf16 a[16:19], v[232:235], v[40:43], a[16:19]
  ds_read_b128 v[136:139], v28 offset:4096
  v_mfma_f32_16x16x32_bf16 a[20:23], v[236:239], v[40:43], a[20:23]
  v_exp_f32 v119, v119
  v_mfma_f32_16x16x32_bf16 a[24:27], v[240:243], v[40:43], a[24:27]
  v_cvt_pk_bf16_f32 v46, v116, v117
  v_cvt_pk_bf16_f32 v47, v118, v119
  v_mfma_f32_16x16x32_bf16 a[28:31], v[244:247], v[40:43], a[28:31]
  ds_read_b128 v[140:143], v29 offset:4096
  v_mfma_f32_16x16x32_bf16 v[76:79], v[52:55], v[40:43], v[76:79]
  ds_read_b128 v[144:147], v30 offset:4096
  v_mfma_f32_16x16x32_bf16 v[112:115], v[184:187], a[224:227], v[72:75]
  v_exp_f32 v96, v96
  v_mfma_f32_16x16x32_bf16 v[112:115], v[188:191], a[228:231], v[112:115]
  ds_read_b128 v[148:151], v31 offset:4096
  v_mfma_f32_16x16x32_bf16 v[112:115], v[192:195], a[232:235], v[112:115]
  v_exp_f32 v97, v97
  v_mfma_f32_16x16x32_bf16 v[112:115], v[196:199], a[236:239], v[112:115]
  v_exp_f32 v98, v98
  s_mov_b32 m0, s31
  v_mfma_f32_16x16x32_bf16 v[116:119], v[200:203], a[224:227], v[72:75]
  buffer_load_dwordx4 v10, s[8:11], s41 offen offset:0 nt lds
  v_mfma_f32_16x16x32_bf16 v[116:119], v[204:207], a[228:231], v[116:119]
  v_exp_f32 v99, v99
  v_mfma_f32_16x16x32_bf16 v[116:119], v[208:211], a[232:235], v[116:119]
  v_cvt_pk_bf16_f32 v36, v96, v97
  v_cvt_pk_bf16_f32 v37, v98, v99
  v_mfma_f32_16x16x32_bf16 v[116:119], v[212:215], a[236:239], v[116:119]
  buffer_load_dwordx4 v11, s[8:11], s41 offen offset:1024 nt lds
  v_mfma_f32_16x16x32_bf16 a[32:35], v[216:219], v[44:47], a[32:35]
  v_exp_f32 v100, v100
  v_mfma_f32_16x16x32_bf16 a[36:39], v[220:223], v[44:47], a[36:39]
  v_exp_f32 v101, v101
  v_mfma_f32_16x16x32_bf16 a[40:43], v[224:227], v[44:47], a[40:43]
  ds_read_b64_tr_b16 v[152:153], v32 offset:0
  v_mfma_f32_16x16x32_bf16 a[44:47], v[228:231], v[44:47], a[44:47]
  v_exp_f32 v102, v102
  v_mfma_f32_16x16x32_bf16 a[48:51], v[232:235], v[44:47], a[48:51]
  ds_read_b64_tr_b16 v[154:155], v32 offset:4096
  v_mfma_f32_16x16x32_bf16 a[52:55], v[236:239], v[44:47], a[52:55]
  v_exp_f32 v103, v103
  v_mfma_f32_16x16x32_bf16 a[56:59], v[240:243], v[44:47], a[56:59]
  v_cvt_pk_bf16_f32 v38, v100, v101
  v_cvt_pk_bf16_f32 v39, v102, v103
  v_mfma_f32_16x16x32_bf16 a[60:63], v[244:247], v[44:47], a[60:63]
  ds_read_b64_tr_b16 v[156:157], v32 offset:8
  v_mfma_f32_16x16x32_bf16 v[80:83], v[52:55], v[44:47], v[80:83]
  ds_read_b64_tr_b16 v[158:159], v32 offset:4104
  s_waitcnt lgkmcnt(8)
  v_mfma_f32_16x16x32_bf16 v[96:99], v[120:123], a[160:163], v[56:59]
  v_exp_f32 v104, v104
  v_add_u32 v30, s32, v22
  v_mfma_f32_16x16x32_bf16 v[96:99], v[124:127], a[164:167], v[96:99]
  buffer_load_dwordx4 v12, s[8:11], s41 offen offset:2048 nt lds
  v_mfma_f32_16x16x32_bf16 v[96:99], v[128:131], a[168:171], v[96:99]
  v_exp_f32 v105, v105
  v_add_u32 v31, s32, v23
  v_mfma_f32_16x16x32_bf16 v[96:99], v[132:135], a[172:175], v[96:99]
  v_exp_f32 v106, v106
  s_waitcnt lgkmcnt(5)
  v_mfma_f32_16x16x32_bf16 v[100:103], v[136:139], a[160:163], v[56:59]
  buffer_load_dwordx4 v13, s[8:11], s41 offen offset:3072 nt lds
  v_mfma_f32_16x16x32_bf16 v[100:103], v[140:143], a[164:167], v[100:103]
  v_exp_f32 v107, v107
  v_mfma_f32_16x16x32_bf16 v[100:103], v[144:147], a[168:171], v[100:103]
  v_cvt_pk_bf16_f32 v40, v104, v105
  v_cvt_pk_bf16_f32 v41, v106, v107
  v_add_u32 v28, s32, v20
  s_waitcnt lgkmcnt(4)
  v_mfma_f32_16x16x32_bf16 v[100:103], v[148:151], a[172:175], v[100:103]
  ds_read_b64_tr_b16 v[160:161], v33 offset:0
  v_mfma_f32_16x16x32_bf16 a[64:67], v[216:219], v[36:39], a[64:67]
  v_exp_f32 v108, v108
  v_mfma_f32_16x16x32_bf16 a[68:71], v[220:223], v[36:39], a[68:71]
  v_exp_f32 v109, v109
  v_mfma_f32_16x16x32_bf16 a[72:75], v[224:227], v[36:39], a[72:75]
  ds_read_b64_tr_b16 v[162:163], v33 offset:4096
  v_mfma_f32_16x16x32_bf16 a[76:79], v[228:231], v[36:39], a[76:79]
  v_exp_f32 v110, v110
  v_mfma_f32_16x16x32_bf16 a[80:83], v[232:235], v[36:39], a[80:83]
  ds_read_b64_tr_b16 v[164:165], v33 offset:8
  v_mfma_f32_16x16x32_bf16 a[84:87], v[236:239], v[36:39], a[84:87]
  v_exp_f32 v111, v111
  v_mfma_f32_16x16x32_bf16 a[88:91], v[240:243], v[36:39], a[88:91]
  v_cvt_pk_bf16_f32 v42, v108, v109
  v_cvt_pk_bf16_f32 v43, v110, v111
  v_add_u32 v29, s32, v21
  v_mfma_f32_16x16x32_bf16 a[92:95], v[244:247], v[36:39], a[92:95]
  ds_read_b64_tr_b16 v[166:167], v33 offset:4104
  v_mfma_f32_16x16x32_bf16 v[84:87], v[52:55], v[36:39], v[84:87]
  ds_read_b64_tr_b16 v[168:169], v34 offset:0
  v_mfma_f32_16x16x32_bf16 v[104:107], v[120:123], a[176:179], v[60:63]
  v_exp_f32 v112, v112
  s_add_u32 m0, s31, 4096
  v_add_u32 v254, s32, v26
  v_mfma_f32_16x16x32_bf16 v[104:107], v[124:127], a[180:183], v[104:107]
  buffer_load_dwordx4 v248, s[8:11], s41 offen offset:0 nt lds
  v_mfma_f32_16x16x32_bf16 v[104:107], v[128:131], a[184:187], v[104:107]
  v_exp_f32 v113, v113
  v_add_u32 v255, s32, v27
  v_mfma_f32_16x16x32_bf16 v[104:107], v[132:135], a[188:191], v[104:107]
  v_exp_f32 v114, v114
  v_mfma_f32_16x16x32_bf16 v[108:111], v[136:139], a[176:179], v[60:63]
  buffer_load_dwordx4 v249, s[8:11], s41 offen offset:1024 nt lds
  v_mfma_f32_16x16x32_bf16 v[108:111], v[140:143], a[180:183], v[108:111]
  v_exp_f32 v115, v115
  v_mfma_f32_16x16x32_bf16 v[108:111], v[144:147], a[184:187], v[108:111]
  v_cvt_pk_bf16_f32 v44, v112, v113
  v_cvt_pk_bf16_f32 v45, v114, v115
  v_add_u32 v252, s32, v24
  v_mfma_f32_16x16x32_bf16 v[108:111], v[148:151], a[188:191], v[108:111]
  ds_read_b64_tr_b16 v[170:171], v34 offset:4096
  v_mfma_f32_16x16x32_bf16 a[96:99], v[216:219], v[40:43], a[96:99]
  v_exp_f32 v116, v116
  v_mfma_f32_16x16x32_bf16 a[100:103], v[220:223], v[40:43], a[100:103]
  v_exp_f32 v117, v117
  v_mfma_f32_16x16x32_bf16 a[104:107], v[224:227], v[40:43], a[104:107]
  ds_read_b64_tr_b16 v[172:173], v34 offset:8
  v_mfma_f32_16x16x32_bf16 a[108:111], v[228:231], v[40:43], a[108:111]
  v_exp_f32 v118, v118
  v_mfma_f32_16x16x32_bf16 a[112:115], v[232:235], v[40:43], a[112:115]
  ds_read_b64_tr_b16 v[174:175], v34 offset:4104
  v_mfma_f32_16x16x32_bf16 a[116:119], v[236:239], v[40:43], a[116:119]
  v_exp_f32 v119, v119
  v_mfma_f32_16x16x32_bf16 a[120:123], v[240:243], v[40:43], a[120:123]
  v_cvt_pk_bf16_f32 v46, v116, v117
  v_cvt_pk_bf16_f32 v47, v118, v119
  v_add_u32 v253, s32, v25
  v_mfma_f32_16x16x32_bf16 a[124:127], v[244:247], v[40:43], a[124:127]
  ds_read_b64_tr_b16 v[176:177], v35 offset:0
  v_mfma_f32_16x16x32_bf16 v[88:91], v[52:55], v[40:43], v[88:91]
  ds_read_b64_tr_b16 v[178:179], v35 offset:4096
  v_mfma_f32_16x16x32_bf16 v[112:115], v[120:123], a[192:195], v[64:67]
  v_exp_f32 v96, v96
  s_add_u32 s32, s32, 32768
  s_cmp_eq_u32 s32, 98304
  s_cselect_b32 s32, 0, s32
  v_mfma_f32_16x16x32_bf16 v[112:115], v[124:127], a[196:199], v[112:115]
  ds_read_b64_tr_b16 v[180:181], v35 offset:8
  v_mfma_f32_16x16x32_bf16 v[112:115], v[128:131], a[200:203], v[112:115]
  v_exp_f32 v97, v97
  v_mfma_f32_16x16x32_bf16 v[112:115], v[132:135], a[204:207], v[112:115]
  v_exp_f32 v98, v98
  v_mfma_f32_16x16x32_bf16 v[116:119], v[136:139], a[192:195], v[64:67]
  s_waitcnt lgkmcnt(6)
  ds_read_b64_tr_b16 v[182:183], v35 offset:4104
  v_mfma_f32_16x16x32_bf16 v[116:119], v[140:143], a[196:199], v[116:119]
  v_exp_f32 v99, v99
  v_mfma_f32_16x16x32_bf16 v[116:119], v[144:147], a[200:203], v[116:119]
  v_cvt_pk_bf16_f32 v36, v96, v97
  v_cvt_pk_bf16_f32 v37, v98, v99
  v_mfma_f32_16x16x32_bf16 v[116:119], v[148:151], a[204:207], v[116:119]
  v_mfma_f32_16x16x32_bf16 a[128:131], v[216:219], v[44:47], a[128:131]
  v_exp_f32 v100, v100
  v_mfma_f32_16x16x32_bf16 a[132:135], v[220:223], v[44:47], a[132:135]
  v_exp_f32 v101, v101
  v_mfma_f32_16x16x32_bf16 a[136:139], v[224:227], v[44:47], a[136:139]
  buffer_load_dwordx4 v250, s[8:11], s41 offen offset:2048 nt lds
  v_mfma_f32_16x16x32_bf16 a[140:143], v[228:231], v[44:47], a[140:143]
  v_exp_f32 v102, v102
  v_mfma_f32_16x16x32_bf16 a[144:147], v[232:235], v[44:47], a[144:147]
  v_mfma_f32_16x16x32_bf16 a[148:151], v[236:239], v[44:47], a[148:151]
  v_exp_f32 v103, v103
  v_mfma_f32_16x16x32_bf16 a[152:155], v[240:243], v[44:47], a[152:155]
  v_cvt_pk_bf16_f32 v38, v100, v101
  v_cvt_pk_bf16_f32 v39, v102, v103
  v_mfma_f32_16x16x32_bf16 a[156:159], v[244:247], v[44:47], a[156:159]
  buffer_load_dwordx4 v251, s[8:11], s41 offen offset:3072 nt lds
  v_mfma_f32_16x16x32_bf16 v[92:95], v[52:55], v[44:47], v[92:95]
  s_add_u32 s41, s41, 16384
  s_add_u32 s31, s31, 32768
  s_cmp_eq_u32 s31, s30
  s_cselect_b32 s31, s42, s31
  s_sub_u32 s33, s33, 1
  s_cmp_lg_u32 s33, 0
  s_cbranch_scc1 fa_kernel_atb
  s_waitcnt vmcnt(8) lgkmcnt(0)
  s_barrier
  v_mfma_f32_16x16x32_bf16 v[96:99], v[120:123], a[208:211], v[68:71]
  v_exp_f32 v104, v104
  v_mfma_f32_16x16x32_bf16 v[96:99], v[124:127], a[212:215], v[96:99]
  ds_read_b128 v[184:187], v28 offset:0
  v_mfma_f32_16x16x32_bf16 v[96:99], v[128:131], a[216:219], v[96:99]
  v_exp_f32 v105, v105
  v_mfma_f32_16x16x32_bf16 v[96:99], v[132:135], a[220:223], v[96:99]
  v_exp_f32 v106, v106
  v_mfma_f32_16x16x32_bf16 v[100:103], v[136:139], a[208:211], v[68:71]
  ds_read_b128 v[188:191], v29 offset:0
  v_mfma_f32_16x16x32_bf16 v[100:103], v[140:143], a[212:215], v[100:103]
  v_exp_f32 v107, v107
  v_mfma_f32_16x16x32_bf16 v[100:103], v[144:147], a[216:219], v[100:103]
  v_cvt_pk_bf16_f32 v40, v104, v105
  v_cvt_pk_bf16_f32 v41, v106, v107
  ds_read_b128 v[192:195], v30 offset:0
  v_mfma_f32_16x16x32_bf16 v[100:103], v[148:151], a[220:223], v[100:103]
  ds_read_b128 v[196:199], v31 offset:0
  v_mfma_f32_16x16x32_bf16 a[0:3], v[152:155], v[36:39], a[0:3]
  v_exp_f32 v108, v108
  v_mfma_f32_16x16x32_bf16 a[4:7], v[156:159], v[36:39], a[4:7]
  v_exp_f32 v109, v109
  v_mfma_f32_16x16x32_bf16 a[8:11], v[160:163], v[36:39], a[8:11]
  ds_read_b128 v[200:203], v28 offset:4096
  v_mfma_f32_16x16x32_bf16 a[12:15], v[164:167], v[36:39], a[12:15]
  v_exp_f32 v110, v110
  v_mfma_f32_16x16x32_bf16 a[16:19], v[168:171], v[36:39], a[16:19]
  ds_read_b128 v[204:207], v29 offset:4096
  v_mfma_f32_16x16x32_bf16 a[20:23], v[172:175], v[36:39], a[20:23]
  v_exp_f32 v111, v111
  v_mfma_f32_16x16x32_bf16 a[24:27], v[176:179], v[36:39], a[24:27]
  v_cvt_pk_bf16_f32 v42, v108, v109
  v_cvt_pk_bf16_f32 v43, v110, v111
  v_mfma_f32_16x16x32_bf16 a[28:31], v[180:183], v[36:39], a[28:31]
  ds_read_b128 v[208:211], v30 offset:4096
  v_mfma_f32_16x16x32_bf16 v[76:79], v[52:55], v[36:39], v[76:79]
  ds_read_b128 v[212:215], v31 offset:4096
  s_waitcnt lgkmcnt(7)
  v_mfma_f32_16x16x32_bf16 v[104:107], v[184:187], a[160:163], v[56:59]
  v_exp_f32 v112, v112
  s_waitcnt lgkmcnt(6)
  v_mfma_f32_16x16x32_bf16 v[104:107], v[188:191], a[164:167], v[104:107]
  ds_read_b64_tr_b16 v[216:217], v252 offset:0
  s_waitcnt lgkmcnt(6)
  v_mfma_f32_16x16x32_bf16 v[104:107], v[192:195], a[168:171], v[104:107]
  v_exp_f32 v113, v113
  s_waitcnt lgkmcnt(5)
  v_mfma_f32_16x16x32_bf16 v[104:107], v[196:199], a[172:175], v[104:107]
  v_exp_f32 v114, v114
  s_waitcnt lgkmcnt(4)
  v_mfma_f32_16x16x32_bf16 v[108:111], v[200:203], a[160:163], v[56:59]
  ds_read_b64_tr_b16 v[218:219], v252 offset:4096
  s_waitcnt lgkmcnt(4)
  v_mfma_f32_16x16x32_bf16 v[108:111], v[204:207], a[164:167], v[108:111]
  v_exp_f32 v115, v115
  s_waitcnt lgkmcnt(3)
  v_mfma_f32_16x16x32_bf16 v[108:111], v[208:211], a[168:171], v[108:111]
  v_cvt_pk_bf16_f32 v44, v112, v113
  v_cvt_pk_bf16_f32 v45, v114, v115
  ds_read_b64_tr_b16 v[220:221], v252 offset:8
  s_waitcnt lgkmcnt(3)
  v_mfma_f32_16x16x32_bf16 v[108:111], v[212:215], a[172:175], v[108:111]
  ds_read_b64_tr_b16 v[222:223], v252 offset:4104
  v_mfma_f32_16x16x32_bf16 a[32:35], v[152:155], v[40:43], a[32:35]
  v_exp_f32 v116, v116
  v_mfma_f32_16x16x32_bf16 a[36:39], v[156:159], v[40:43], a[36:39]
  v_exp_f32 v117, v117
  v_mfma_f32_16x16x32_bf16 a[40:43], v[160:163], v[40:43], a[40:43]
  ds_read_b64_tr_b16 v[224:225], v253 offset:0
  v_mfma_f32_16x16x32_bf16 a[44:47], v[164:167], v[40:43], a[44:47]
  v_exp_f32 v118, v118
  s_mov_b32 m0, s31
  v_mfma_f32_16x16x32_bf16 a[48:51], v[168:171], v[40:43], a[48:51]
  buffer_load_dwordx4 v10, s[8:11], s41 offen offset:0 nt lds
  v_mfma_f32_16x16x32_bf16 a[52:55], v[172:175], v[40:43], a[52:55]
  v_exp_f32 v119, v119
  v_mfma_f32_16x16x32_bf16 a[56:59], v[176:179], v[40:43], a[56:59]
  v_cvt_pk_bf16_f32 v46, v116, v117
  v_cvt_pk_bf16_f32 v47, v118, v119
  v_mfma_f32_16x16x32_bf16 a[60:63], v[180:183], v[40:43], a[60:63]
  buffer_load_dwordx4 v11, s[8:11], s41 offen offset:1024 nt lds
  v_mfma_f32_16x16x32_bf16 v[80:83], v[52:55], v[40:43], v[80:83]
  buffer_load_dwordx4 v12, s[8:11], s41 offen offset:2048 nt lds
  v_mfma_f32_16x16x32_bf16 v[112:115], v[184:187], a[176:179], v[60:63]
  v_exp_f32 v96, v96
  v_mfma_f32_16x16x32_bf16 v[112:115], v[188:191], a[180:183], v[112:115]
  ds_read_b64_tr_b16 v[226:227], v253 offset:4096
  v_mfma_f32_16x16x32_bf16 v[112:115], v[192:195], a[184:187], v[112:115]
  v_exp_f32 v97, v97
  v_mfma_f32_16x16x32_bf16 v[112:115], v[196:199], a[188:191], v[112:115]
  v_exp_f32 v98, v98
  v_mfma_f32_16x16x32_bf16 v[116:119], v[200:203], a[176:179], v[60:63]
  ds_read_b64_tr_b16 v[228:229], v253 offset:8
  v_mfma_f32_16x16x32_bf16 v[116:119], v[204:207], a[180:183], v[116:119]
  v_exp_f32 v99, v99
  v_mfma_f32_16x16x32_bf16 v[116:119], v[208:211], a[184:187], v[116:119]
  v_cvt_pk_bf16_f32 v36, v96, v97
  v_cvt_pk_bf16_f32 v37, v98, v99
  ds_read_b64_tr_b16 v[230:231], v253 offset:4104
  v_mfma_f32_16x16x32_bf16 v[116:119], v[212:215], a[188:191], v[116:119]
  ds_read_b64_tr_b16 v[232:233], v254 offset:0
  v_mfma_f32_16x16x32_bf16 a[64:67], v[152:155], v[44:47], a[64:67]
  v_exp_f32 v100, v100
  v_mfma_f32_16x16x32_bf16 a[68:71], v[156:159], v[44:47], a[68:71]
  v_exp_f32 v101, v101
  v_mfma_f32_16x16x32_bf16 a[72:75], v[160:163], v[44:47], a[72:75]
  ds_read_b64_tr_b16 v[234:235], v254 offset:4096
  v_mfma_f32_16x16x32_bf16 a[76:79], v[164:167], v[44:47], a[76:79]
  v_exp_f32 v102, v102
  v_mfma_f32_16x16x32_bf16 a[80:83], v[168:171], v[44:47], a[80:83]
  ds_read_b64_tr_b16 v[236:237], v254 offset:8
  v_mfma_f32_16x16x32_bf16 a[84:87], v[172:175], v[44:47], a[84:87]
  v_exp_f32 v103, v103
  v_mfma_f32_16x16x32_bf16 a[88:91], v[176:179], v[44:47], a[88:91]
  v_cvt_pk_bf16_f32 v38, v100, v101
  v_cvt_pk_bf16_f32 v39, v102, v103
  v_mfma_f32_16x16x32_bf16 a[92:95], v[180:183], v[44:47], a[92:95]
  buffer_load_dwordx4 v13, s[8:11], s41 offen offset:3072 nt lds
  v_mfma_f32_16x16x32_bf16 v[84:87], v[52:55], v[44:47], v[84:87]
  s_add_u32 m0, s31, 4096
  s_nop 0
  buffer_load_dwordx4 v248, s[8:11], s41 offen offset:0 nt lds
  v_mfma_f32_16x16x32_bf16 v[96:99], v[184:187], a[192:195], v[64:67]
  v_exp_f32 v104, v104
  v_mfma_f32_16x16x32_bf16 v[96:99], v[188:191], a[196:199], v[96:99]
  buffer_load_dwordx4 v249, s[8:11], s41 offen offset:1024 nt lds
  v_mfma_f32_16x16x32_bf16 v[96:99], v[192:195], a[200:203], v[96:99]
  v_exp_f32 v105, v105
  v_mfma_f32_16x16x32_bf16 v[96:99], v[196:199], a[204:207], v[96:99]
  v_exp_f32 v106, v106
  v_mfma_f32_16x16x32_bf16 v[100:103], v[200:203], a[192:195], v[64:67]
  buffer_load_dwordx4 v250, s[8:11], s41 offen offset:2048 nt lds
  v_mfma_f32_16x16x32_bf16 v[100:103], v[204:207], a[196:199], v[100:103]
  v_exp_f32 v107, v107
  v_mfma_f32_16x16x32_bf16 v[100:103], v[208:211], a[200:203], v[100:103]
  v_cvt_pk_bf16_f32 v40, v104, v105
  v_cvt_pk_bf16_f32 v41, v106, v107
  buffer_load_dwordx4 v251, s[8:11], s41 offen offset:3072 nt lds
  v_mfma_f32_16x16x32_bf16 v[100:103], v[212:215], a[204:207], v[100:103]
  ds_read_b64_tr_b16 v[238:239], v254 offset:4104
  v_mfma_f32_16x16x32_bf16 a[96:99], v[152:155], v[36:39], a[96:99]
  v_exp_f32 v108, v108
  v_mfma_f32_16x16x32_bf16 a[100:103], v[156:159], v[36:39], a[100:103]
  v_exp_f32 v109, v109
  v_mfma_f32_16x16x32_bf16 a[104:107], v[160:163], v[36:39], a[104:107]
  ds_read_b64_tr_b16 v[240:241], v255 offset:0
  v_mfma_f32_16x16x32_bf16 a[108:111], v[164:167], v[36:39], a[108:111]
  v_exp_f32 v110, v110
  v_mfma_f32_16x16x32_bf16 a[112:115], v[168:171], v[36:39], a[112:115]
  ds_read_b64_tr_b16 v[242:243], v255 offset:4096
  v_mfma_f32_16x16x32_bf16 a[116:119], v[172:175], v[36:39], a[116:119]
  v_exp_f32 v111, v111
  v_mfma_f32_16x16x32_bf16 a[120:123], v[176:179], v[36:39], a[120:123]
  v_cvt_pk_bf16_f32 v42, v108, v109
  v_cvt_pk_bf16_f32 v43, v110, v111
  s_add_u32 s41, s41, 16384
  s_add_u32 s31, s31, 32768
  s_cmp_eq_u32 s31, s30
  s_cselect_b32 s31, s42, s31
  v_mfma_f32_16x16x32_bf16 a[124:127], v[180:183], v[36:39], a[124:127]
  ds_read_b64_tr_b16 v[244:245], v255 offset:8
  v_mfma_f32_16x16x32_bf16 v[88:91], v[52:55], v[36:39], v[88:91]
  s_waitcnt lgkmcnt(4)
  ds_read_b64_tr_b16 v[246:247], v255 offset:4104
  s_waitcnt vmcnt(8) lgkmcnt(0)
  s_barrier
  v_mfma_f32_16x16x32_bf16 v[104:107], v[184:187], a[208:211], v[68:71]
  v_exp_f32 v112, v112
  v_mfma_f32_16x16x32_bf16 v[104:107], v[188:191], a[212:215], v[104:107]
  s_cmp_eq_u32 s58, 0
  s_cbranch_scc1 fa_kernel_npf34
  s_cmp_ge_u32 s24, 2
  s_cbranch_scc1 fa_kernel_ncpo34
  s_getpc_b64 s[60:61]
fa_kernel_cpo34:
  s_add_u32 s60, s60, oproj_kernel-fa_kernel_cpo34
  s_addc_u32 s61, s61, 0
  s_lshl_b32 s39, s24, 13
  v_add_u32 v2, s39, v19
  s_mov_b32 s39, oproj_kernel_done-oproj_kernel
  v_cmp_gt_u32 vcc, s39, v2
  s_nop 0
  s_and_saveexec_b64 s[72:73], vcc
  s_cbranch_execz fa_kernel_rcpo34
  global_load_dword v16, v2, s[60:61]
fa_kernel_rcpo34:
  s_mov_b64 exec, s[72:73]
fa_kernel_ncpo34:
fa_kernel_npf34:
  s_sub_u32 s49, s31, s42
  v_mfma_f32_16x16x32_bf16 v[104:107], v[192:195], a[216:219], v[104:107]
  v_exp_f32 v113, v113
  v_mfma_f32_16x16x32_bf16 v[104:107], v[196:199], a[220:223], v[104:107]
  v_exp_f32 v114, v114
  v_mfma_f32_16x16x32_bf16 v[108:111], v[200:203], a[208:211], v[68:71]
  v_mfma_f32_16x16x32_bf16 v[108:111], v[204:207], a[212:215], v[108:111]
  v_exp_f32 v115, v115
  v_mfma_f32_16x16x32_bf16 v[108:111], v[208:211], a[216:219], v[108:111]
  v_cvt_pk_bf16_f32 v44, v112, v113
  v_cvt_pk_bf16_f32 v45, v114, v115
  v_mfma_f32_16x16x32_bf16 v[108:111], v[212:215], a[220:223], v[108:111]
  v_mfma_f32_16x16x32_bf16 a[0:3], v[216:219], v[40:43], a[0:3]
  v_exp_f32 v116, v116
  v_mfma_f32_16x16x32_bf16 a[4:7], v[220:223], v[40:43], a[4:7]
  v_exp_f32 v117, v117
  v_mfma_f32_16x16x32_bf16 a[8:11], v[224:227], v[40:43], a[8:11]
  s_cmp_lg_u32 s58, 0
  s_cbranch_scc1 fa_kernel_npc35
  s_cmp_ge_u32 s24, 1
  s_cbranch_scc1 fa_kernel_ncpc35
  s_getpc_b64 s[60:61]
fa_kernel_cpc35:
  s_add_u32 s60, s60, fa_kernel_cmb-fa_kernel_cpc35
  s_addc_u32 s61, s61, 0
  s_lshl_b32 s39, s24, 13
  v_add_u32 v2, s39, v19
  s_mov_b32 s39, fa_kernel_done-fa_kernel_cmb
  v_cmp_gt_u32 vcc, s39, v2
  s_nop 0
  s_and_saveexec_b64 s[72:73], vcc
  s_cbranch_execz fa_kernel_rcpc35
  global_load_dword v16, v2, s[60:61]
fa_kernel_rcpc35:
  s_mov_b64 exec, s[72:73]
fa_kernel_ncpc35:
fa_kernel_npc35:
  v_mfma_f32_16x16x32_bf16 a[12:15], v[228:231], v[40:43], a[12:15]
  v_exp_f32 v118, v118
  v_mfma_f32_16x16x32_bf16 a[16:19], v[232:235], v[40:43], a[16:19]
  v_mfma_f32_16x16x32_bf16 a[20:23], v[236:239], v[40:43], a[20:23]
  v_exp_f32 v119, v119
  v_mfma_f32_16x16x32_bf16 a[24:27], v[240:243], v[40:43], a[24:27]
  v_cvt_pk_bf16_f32 v46, v116, v117
  v_cvt_pk_bf16_f32 v47, v118, v119
  v_mfma_f32_16x16x32_bf16 a[28:31], v[244:247], v[40:43], a[28:31]
  v_mfma_f32_16x16x32_bf16 v[76:79], v[52:55], v[40:43], v[76:79]
  v_mfma_f32_16x16x32_bf16 v[112:115], v[184:187], a[224:227], v[72:75]
  v_exp_f32 v96, v96
  v_mfma_f32_16x16x32_bf16 v[112:115], v[188:191], a[228:231], v[112:115]
  v_mfma_f32_16x16x32_bf16 v[112:115], v[192:195], a[232:235], v[112:115]
  v_exp_f32 v97, v97
  v_mfma_f32_16x16x32_bf16 v[112:115], v[196:199], a[236:239], v[112:115]
  v_exp_f32 v98, v98
  v_mfma_f32_16x16x32_bf16 v[116:119], v[200:203], a[224:227], v[72:75]
  v_mfma_f32_16x16x32_bf16 v[116:119], v[204:207], a[228:231], v[116:119]
  v_exp_f32 v99, v99
  v_mfma_f32_16x16x32_bf16 v[116:119], v[208:211], a[232:235], v[116:119]
  v_cvt_pk_bf16_f32 v36, v96, v97
  v_cvt_pk_bf16_f32 v37, v98, v99
  v_mfma_f32_16x16x32_bf16 v[116:119], v[212:215], a[236:239], v[116:119]
  v_mfma_f32_16x16x32_bf16 a[32:35], v[216:219], v[44:47], a[32:35]
  v_exp_f32 v100, v100
  v_mfma_f32_16x16x32_bf16 a[36:39], v[220:223], v[44:47], a[36:39]
  v_exp_f32 v101, v101
  v_mfma_f32_16x16x32_bf16 a[40:43], v[224:227], v[44:47], a[40:43]
  v_mfma_f32_16x16x32_bf16 a[44:47], v[228:231], v[44:47], a[44:47]
  v_exp_f32 v102, v102
  v_mfma_f32_16x16x32_bf16 a[48:51], v[232:235], v[44:47], a[48:51]
  v_mfma_f32_16x16x32_bf16 a[52:55], v[236:239], v[44:47], a[52:55]
  v_exp_f32 v103, v103
  v_mfma_f32_16x16x32_bf16 a[56:59], v[240:243], v[44:47], a[56:59]
  v_cvt_pk_bf16_f32 v38, v100, v101
  v_cvt_pk_bf16_f32 v39, v102, v103
  v_mfma_f32_16x16x32_bf16 a[60:63], v[244:247], v[44:47], a[60:63]
  v_mfma_f32_16x16x32_bf16 v[80:83], v[52:55], v[44:47], v[80:83]
  v_mfma_f32_16x16x32_bf16 a[64:67], v[216:219], v[36:39], a[64:67]
  v_exp_f32 v104, v104
  v_mfma_f32_16x16x32_bf16 a[68:71], v[220:223], v[36:39], a[68:71]
  v_mfma_f32_16x16x32_bf16 a[72:75], v[224:227], v[36:39], a[72:75]
  v_exp_f32 v105, v105
  v_mfma_f32_16x16x32_bf16 a[76:79], v[228:231], v[36:39], a[76:79]
  v_exp_f32 v106, v106
  v_mfma_f32_16x16x32_bf16 a[80:83], v[232:235], v[36:39], a[80:83]
  v_mfma_f32_16x16x32_bf16 a[84:87], v[236:239], v[36:39], a[84:87]
  v_exp_f32 v107, v107
  v_mfma_f32_16x16x32_bf16 a[88:91], v[240:243], v[36:39], a[88:91]
  v_cvt_pk_bf16_f32 v40, v104, v105
  v_cvt_pk_bf16_f32 v41, v106, v107
  v_mfma_f32_16x16x32_bf16 a[92:95], v[244:247], v[36:39], a[92:95]
  v_mfma_f32_16x16x32_bf16 v[84:87], v[52:55], v[36:39], v[84:87]
  v_exp_f32 v108, v108
  v_exp_f32 v109, v109
  v_exp_f32 v110, v110
  v_exp_f32 v111, v111
  v_cvt_pk_bf16_f32 v42, v108, v109
  v_cvt_pk_bf16_f32 v43, v110, v111
  s_nop 1
  v_mfma_f32_16x16x32_bf16 a[96:99], v[216:219], v[40:43], a[96:99]
  v_exp_f32 v112, v112
  v_mfma_f32_16x16x32_bf16 a[100:103], v[220:223], v[40:43], a[100:103]
  v_mfma_f32_16x16x32_bf16 a[104:107], v[224:227], v[40:43], a[104:107]
  v_exp_f32 v113, v113
  v_mfma_f32_16x16x32_bf16 a[108:111], v[228:231], v[40:43], a[108:111]
  v_exp_f32 v114, v114
  v_mfma_f32_16x16x32_bf16 a[112:115], v[232:235], v[40:43], a[112:115]
  v_mfma_f32_16x16x32_bf16 a[116:119], v[236:239], v[40:43], a[116:119]
  v_exp_f32 v115, v115
  v_mfma_f32_16x16x32_bf16 a[120:123], v[240:243], v[40:43], a[120:123]
  v_cvt_pk_bf16_f32 v44, v112, v113
  v_cvt_pk_bf16_f32 v45, v114, v115
  v_mfma_f32_16x16x32_bf16 a[124:127], v[244:247], v[40:43], a[124:127]
  v_mfma_f32_16x16x32_bf16 v[88:91], v[52:55], v[40:43], v[88:91]
  v_exp_f32 v116, v116
  v_exp_f32 v117, v117
  v_exp_f32 v118, v118
  v_exp_f32 v119, v119
  v_cvt_pk_bf16_f32 v46, v116, v117
  v_cvt_pk_bf16_f32 v47, v118, v119
  s_nop 1
  v_mfma_f32_16x16x32_bf16 a[128:131], v[216:219], v[44:47], a[128:131]
  v_mfma_f32_16x16x32_bf16 a[132:135], v[220:223], v[44:47], a[132:135]
  v_mfma_f32_16x16x32_bf16 a[136:139], v[224:227], v[44:47], a[136:139]
  v_mfma_f32_16x16x32_bf16 a[140:143], v[228:231], v[44:47], a[140:143]
  v_mfma_f32_16x16x32_bf16 a[144:147], v[232:235], v[44:47], a[144:147]
  v_mfma_f32_16x16x32_bf16 a[148:151], v[236:239], v[44:47], a[148:151]
  v_mfma_f32_16x16x32_bf16 a[152:155], v[240:243], v[44:47], a[152:155]
  v_mfma_f32_16x16x32_bf16 a[156:159], v[244:247], v[44:47], a[156:159]
  v_mfma_f32_16x16x32_bf16 v[92:95], v[52:55], v[44:47], v[92:95]
fa_kernel_cmb:
  s_cmp_lg_u32 s58, 0
  s_cbranch_scc1 fa_kernel_nolq
  v_lshlrev_b32 v2, 4, v1
  v_add_u32 v2, 98304, v2
  s_lshl_b32 s39, s25, 14
  v_add_u32 v3, s39, v2
  ds_read_b128 a[160:163], v3 offset:0
  ds_read_b128 a[164:167], v3 offset:1024
  ds_read_b128 a[168:171], v3 offset:2048
  ds_read_b128 a[172:175], v3 offset:3072
  ds_read_b128 a[176:179], v3 offset:4096
  ds_read_b128 a[180:183], v3 offset:5120
  ds_read_b128 a[184:187], v3 offset:6144
  ds_read_b128 a[188:191], v3 offset:7168
  ds_read_b128 a[192:195], v3 offset:8192
  ds_read_b128 a[196:199], v3 offset:9216
  ds_read_b128 a[200:203], v3 offset:10240
  ds_read_b128 a[204:207], v3 offset:11264
  ds_read_b128 a[208:211], v3 offset:12288
  ds_read_b128 a[212:215], v3 offset:13312
  ds_read_b128 a[216:219], v3 offset:14336
  s_waitcnt lgkmcnt(14)
  ds_read_b128 a[220:223], v3 offset:15360
  s_waitcnt lgkmcnt(14)
  ds_read_b128 a[224:227], v2 offset:32768
  s_waitcnt lgkmcnt(14)
  ds_read_b128 a[228:231], v2 offset:33792
  s_waitcnt lgkmcnt(14)
  ds_read_b128 a[232:235], v2 offset:34816
  s_waitcnt lgkmcnt(14)
  ds_read_b128 a[236:239], v2 offset:35840
  s_waitcnt lgkmcnt(0)
fa_kernel_nolq:
  s_nop 7
  s_waitcnt lgkmcnt(0)
  s_barrier
  v_lshlrev_b32 v8, 4, v1
  s_lshl_b32 s39, s24, 14
  s_add_u32 s39, s39, 98304
  v_add_u32 v3, s39, v8
  s_xor_b32 s40, s24, 2
  s_lshl_b32 s40, s40, 14
  s_add_u32 s40, s40, 98304
  v_add_u32 v4, s40, v8
  ds_write_b128 v3, a[16:19] offset:0
  v_accvgpr_read_b32 v192, a0
  v_accvgpr_read_b32 v193, a1
  v_accvgpr_read_b32 v194, a2
  v_accvgpr_read_b32 v195, a3
  ds_write_b128 v3, a[20:23] offset:1024
  v_accvgpr_read_b32 v196, a4
  v_accvgpr_read_b32 v197, a5
  v_accvgpr_read_b32 v198, a6
  v_accvgpr_read_b32 v199, a7
  ds_write_b128 v3, a[24:27] offset:2048
  v_accvgpr_read_b32 v200, a8
  v_accvgpr_read_b32 v201, a9
  v_accvgpr_read_b32 v202, a10
  v_accvgpr_read_b32 v203, a11
  ds_write_b128 v3, a[28:31] offset:3072
  v_accvgpr_read_b32 v204, a12
  v_accvgpr_read_b32 v205, a13
  v_accvgpr_read_b32 v206, a14
  v_accvgpr_read_b32 v207, a15
  ds_write_b128 v3, a[48:51] offset:4096
  v_accvgpr_read_b32 v208, a32
  v_accvgpr_read_b32 v209, a33
  v_accvgpr_read_b32 v210, a34
  v_accvgpr_read_b32 v211, a35
  ds_write_b128 v3, a[52:55] offset:5120
  v_accvgpr_read_b32 v212, a36
  v_accvgpr_read_b32 v213, a37
  v_accvgpr_read_b32 v214, a38
  v_accvgpr_read_b32 v215, a39
  ds_write_b128 v3, a[56:59] offset:6144
  v_accvgpr_read_b32 v216, a40
  v_accvgpr_read_b32 v217, a41
  v_accvgpr_read_b32 v218, a42
  v_accvgpr_read_b32 v219, a43
  ds_write_b128 v3, a[60:63] offset:7168
  v_accvgpr_read_b32 v220, a44
  v_accvgpr_read_b32 v221, a45
  v_accvgpr_read_b32 v222, a46
  v_accvgpr_read_b32 v223, a47
  ds_write_b128 v3, a[80:83] offset:8192
  v_accvgpr_read_b32 v224, a64
  v_accvgpr_read_b32 v225, a65
  v_accvgpr_read_b32 v226, a66
  v_accvgpr_read_b32 v227, a67
  ds_write_b128 v3, a[84:87] offset:9216
  v_accvgpr_read_b32 v228, a68
  v_accvgpr_read_b32 v229, a69
  v_accvgpr_read_b32 v230, a70
  v_accvgpr_read_b32 v231, a71
  ds_write_b128 v3, a[88:91] offset:10240
  v_accvgpr_read_b32 v232, a72
  v_accvgpr_read_b32 v233, a73
  v_accvgpr_read_b32 v234, a74
  v_accvgpr_read_b32 v235, a75
  ds_write_b128 v3, a[92:95] offset:11264
  v_accvgpr_read_b32 v236, a76
  v_accvgpr_read_b32 v237, a77
  v_accvgpr_read_b32 v238, a78
  v_accvgpr_read_b32 v239, a79
  ds_write_b128 v3, a[112:115] offset:12288
  v_accvgpr_read_b32 v96, a96
  v_accvgpr_read_b32 v97, a97
  v_accvgpr_read_b32 v98, a98
  v_accvgpr_read_b32 v99, a99
  ds_write_b128 v3, a[116:119] offset:13312
  v_accvgpr_read_b32 v100, a100
  v_accvgpr_read_b32 v101, a101
  v_accvgpr_read_b32 v102, a102
  v_accvgpr_read_b32 v103, a103
  ds_write_b128 v3, a[120:123] offset:14336
  v_accvgpr_read_b32 v104, a104
  v_accvgpr_read_b32 v105, a105
  v_accvgpr_read_b32 v106, a106
  v_accvgpr_read_b32 v107, a107
  s_waitcnt lgkmcnt(9)
  ds_write_b128 v3, a[124:127] offset:15360
  v_accvgpr_read_b32 v108, a108
  v_accvgpr_read_b32 v109, a109
  v_accvgpr_read_b32 v110, a110
  v_accvgpr_read_b32 v111, a111
  s_lshl_b32 s39, s26, 1
  s_xor_b32 s39, s39, 0
  s_sub_u32 s40, s24, s39
  s_sub_u32 s40, s40, 1
  s_and_b32 s40, s40, 3
  s_mul_i32 s39, s39, 3
  s_add_u32 s39, s39, s40
  s_lshl_b32 s39, s39, 11
  s_cmp_eq_u32 s40, 3
  s_cselect_b32 s39, 24576, s39
  s_add_u32 s39, s39, s49
  v_add_u32 v120, s39, v8
  ds_write_b128 v120, a[128:131] offset:0
  ds_write_b128 v120, a[132:135] offset:1024
  s_lshl_b32 s39, s26, 1
  s_xor_b32 s39, s39, 1
  s_sub_u32 s40, s24, s39
  s_sub_u32 s40, s40, 1
  s_and_b32 s40, s40, 3
  s_mul_i32 s39, s39, 3
  s_add_u32 s39, s39, s40
  s_lshl_b32 s39, s39, 11
  s_cmp_eq_u32 s40, 3
  s_cselect_b32 s39, 24576, s39
  s_add_u32 s39, s39, s49
  v_add_u32 v121, s39, v8
  ds_write_b128 v121, a[136:139] offset:0
  ds_write_b128 v121, a[140:143] offset:1024
  s_lshl_b32 s39, s26, 1
  s_xor_b32 s39, s39, 2
  s_sub_u32 s40, s24, s39
  s_sub_u32 s40, s40, 1
  s_and_b32 s40, s40, 3
  s_mul_i32 s39, s39, 3
  s_add_u32 s39, s39, s40
  s_lshl_b32 s39, s39, 11
  s_cmp_eq_u32 s40, 3
  s_cselect_b32 s39, 24576, s39
  s_add_u32 s39, s39, s49
  v_add_u32 v122, s39, v8
  ds_write_b128 v122, a[144:147] offset:0
  s_waitcnt lgkmcnt(6)
  ds_write_b128 v122, a[148:151] offset:1024
  s_lshl_b32 s39, s26, 1
  s_xor_b32 s39, s39, 3
  s_sub_u32 s40, s24, s39
  s_sub_u32 s40, s40, 1
  s_and_b32 s40, s40, 3
  s_mul_i32 s39, s39, 3
  s_add_u32 s39, s39, s40
  s_lshl_b32 s39, s39, 11
  s_cmp_eq_u32 s40, 3
  s_cselect_b32 s39, 24576, s39
  s_add_u32 s39, s39, s49
  v_add_u32 v123, s39, v8
  ds_write_b128 v123, a[152:155] offset:0
  ds_write_b128 v123, a[156:159] offset:1024
  v_lshlrev_b32 v2, 2, v1
  s_add_u32 s39, s49, 26624
  v_add_u32 v2, s39, v2
  s_mul_i32 s39, s24, 1280
  v_add_u32 v5, s39, v2
  ds_write_b32 v5, v76 offset:0
  ds_write_b32 v5, v80 offset:256
  ds_write_b32 v5, v84 offset:512
  ds_write_b32 v5, v88 offset:768
  ds_write_b32 v5, v92 offset:1024
  s_cmp_lg_u32 s25, 0
  s_cbranch_scc1 fa_kernel_cf1
  v_accvgpr_read_b32 v112, a128
  v_accvgpr_read_b32 v113, a129
  v_accvgpr_read_b32 v114, a130
  v_accvgpr_read_b32 v115, a131
  v_accvgpr_read_b32 v116, a132
  v_accvgpr_read_b32 v117, a133
  v_accvgpr_read_b32 v118, a134
  v_accvgpr_read_b32 v119, a135
  s_branch fa_kernel_cf2
fa_kernel_cf1:
  v_accvgpr_read_b32 v112, a136
  v_accvgpr_read_b32 v113, a137
  v_accvgpr_read_b32 v114, a138
  v_accvgpr_read_b32 v115, a139
  v_accvgpr_read_b32 v116, a140
  v_accvgpr_read_b32 v117, a141
  v_accvgpr_read_b32 v118, a142
  v_accvgpr_read_b32 v119, a143
fa_kernel_cf2:
  s_mov_b64 s[72:73], 0
  s_mov_b32 s50, 0x21800000
  v_mov_b32 v51, 0x5d800000
  v_mov_b32 v36, 0
  v_mov_b32 v38, 0
  v_mov_b32 v39, 0
  s_xor_b32 s39, s24, 2
  s_mul_i32 s39, s39, 1280
  v_add_u32 v5, s39, v2
  s_mul_i32 s39, s24, 6144
  s_add_u32 s39, s39, s49
  v_add_u32 v6, s39, v8
  v_lshlrev_b32 v7, 4, v1
  s_mul_i32 s46, s58, 36864
  s_mul_i32 s47, s24, 9216
  s_add_u32 s47, s47, 8192
  s_add_u32 s47, s47, s46
  s_lshl_b32 s39, s25, 12
  s_mul_i32 s40, s26, 18432
  s_add_u32 s39, s39, s40
  s_add_u32 s46, s46, s39
  s_waitcnt lgkmcnt(0)
  s_barrier
  ds_read_b32 v124, v5 offset:0
  ds_read_b32 v125, v5 offset:256
  ds_read_b32 v126, v5 offset:512
  ds_read_b32 v127, v5 offset:768
  ds_read_b32 v128, v2 offset:1024
  ds_read_b32 v129, v2 offset:2304
  ds_read_b32 v130, v2 offset:3584
  ds_read_b32 v131, v2 offset:4864
  ds_read_b128 v[136:139], v6 offset:0
  ds_read_b128 v[140:143], v6 offset:1024
  ds_read_b128 v[144:147], v6 offset:2048
  ds_read_b128 v[148:151], v6 offset:3072
  ds_read_b128 v[152:155], v6 offset:4096
  ds_read_b128 v[156:159], v6 offset:5120
  ds_read_b128 v[160:163], v4 offset:0
  s_waitcnt lgkmcnt(14)
  ds_read_b128 v[164:167], v4 offset:1024
  s_waitcnt lgkmcnt(14)
  ds_read_b128 v[168:171], v4 offset:2048
  s_waitcnt lgkmcnt(14)
  ds_read_b128 v[172:175], v4 offset:3072
  v_add_f32 v124, v124, v76
  v_cmp_nge_f32 s[60:61], v124, s50
  v_cmp_nle_f32 vcc, v124, v51
  v_rcp_f32 v124, v124
  s_or_b64 s[72:73], s[72:73], s[60:61]
  s_or_b64 s[72:73], s[72:73], vcc
  v_add_f32 v125, v125, v80
  v_cmp_nge_f32 s[60:61], v125, s50
  v_cmp_nle_f32 vcc, v125, v51
  v_rcp_f32 v125, v125
  s_or_b64 s[72:73], s[72:73], s[60:61]
  s_or_b64 s[72:73], s[72:73], vcc
  v_add_f32 v126, v126, v84
  v_cmp_nge_f32 s[60:61], v126, s50
  v_cmp_nle_f32 vcc, v126, v51
  v_rcp_f32 v126, v126
  s_or_b64 s[72:73], s[72:73], s[60:61]
  s_or_b64 s[72:73], s[72:73], vcc
  s_waitcnt lgkmcnt(14)
  v_add_f32 v127, v127, v88
  v_cmp_nge_f32 s[60:61], v127, s50
  v_cmp_nle_f32 vcc, v127, v51
  v_rcp_f32 v127, v127
  s_or_b64 s[72:73], s[72:73], s[60:61]
  s_or_b64 s[72:73], s[72:73], vcc
  s_waitcnt lgkmcnt(12)
  v_add_f32 v128, v128, v129
  s_waitcnt lgkmcnt(10)
  v_add_f32 v130, v130, v131
  v_add_f32 v128, v128, v130
  v_cmp_nge_f32 s[60:61], v128, s50
  v_cmp_nle_f32 vcc, v128, v51
  v_rcp_f32 v128, v128
  s_or_b64 s[72:73], s[72:73], s[60:61]
  s_or_b64 s[72:73], s[72:73], vcc
  ds_read_b128 v[176:179], v4 offset:4096
  ds_read_b128 v[180:183], v4 offset:5120
  ds_read_b128 v[184:187], v4 offset:6144
  ds_read_b128 v[188:191], v4 offset:7168
  s_waitcnt lgkmcnt(13)
  v_add_f32 v112, v112, v136
  v_add_f32 v113, v113, v137
  v_add_f32 v114, v114, v138
  v_add_f32 v115, v115, v139
  s_waitcnt lgkmcnt(11)
  v_add_f32 v116, v116, v140
  v_add_f32 v117, v117, v141
  v_add_f32 v118, v118, v142
  v_add_f32 v119, v119, v143
  v_add_f32 v112, v112, v144
  v_add_f32 v113, v113, v145
  v_add_f32 v114, v114, v146
  v_add_f32 v115, v115, v147
  s_waitcnt lgkmcnt(4)
  v_add_f32 v116, v116, v148
  v_add_f32 v117, v117, v149
  v_add_f32 v118, v118, v150
  v_add_f32 v119, v119, v151
  v_add_f32 v112, v112, v152
  v_add_f32 v113, v113, v153
  v_add_f32 v114, v114, v154
  v_add_f32 v115, v115, v155
  v_add_f32 v116, v116, v156
  v_add_f32 v117, v117, v157
  v_add_f32 v118, v118, v158
  v_add_f32 v119, v119, v159
  v_mul_f32 v112, v112, v128
  v_mul_f32 v113, v113, v128
  v_mul_f32 v114, v114, v128
  v_mul_f32 v115, v115, v128
  v_mul_f32 v116, v116, v128
  v_mul_f32 v117, v117, v128
  v_mul_f32 v118, v118, v128
  v_mul_f32 v119, v119, v128
  v_fma_f32 v38, v112, v36, v38
  v_fma_f32 v39, v113, v36, v39
  v_cvt_pk_bf16_f32 v40, v112, v113
  v_fma_f32 v38, v114, v36, v38
  v_fma_f32 v39, v115, v36, v39
  v_cvt_pk_bf16_f32 v41, v114, v115
  v_fma_f32 v38, v116, v36, v38
  v_fma_f32 v39, v117, v36, v39
  v_cvt_pk_bf16_f32 v42, v116, v117
  v_fma_f32 v38, v118, v36, v38
  v_fma_f32 v39, v119, v36, v39
  v_cvt_pk_bf16_f32 v43, v118, v119
  buffer_store_dwordx4 v[40:43], v7, s[20:23], s47 offen sc1
  v_add_f32 v192, v192, v160
  v_add_f32 v193, v193, v161
  v_add_f32 v194, v194, v162
  v_add_f32 v195, v195, v163
  v_add_f32 v196, v196, v164
  v_add_f32 v197, v197, v165
  v_add_f32 v198, v198, v166
  v_add_f32 v199, v199, v167
  v_add_f32 v200, v200, v168
  v_add_f32 v201, v201, v169
  v_add_f32 v202, v202, v170
  v_add_f32 v203, v203, v171
  v_add_f32 v204, v204, v172
  v_add_f32 v205, v205, v173
  v_add_f32 v206, v206, v174
  v_add_f32 v207, v207, v175
  ds_read_b128 v[160:163], v4 offset:8192
  ds_read_b128 v[164:167], v4 offset:9216
  ds_read_b128 v[168:171], v4 offset:10240
  ds_read_b128 v[172:175], v4 offset:11264
  v_mul_f32 v192, v192, v124
  v_mul_f32 v193, v193, v124
  v_mul_f32 v194, v194, v124
  v_mul_f32 v195, v195, v124
  v_mul_f32 v196, v196, v124
  v_mul_f32 v197, v197, v124
  v_mul_f32 v198, v198, v124
  v_mul_f32 v199, v199, v124
  v_mul_f32 v200, v200, v124
  v_mul_f32 v201, v201, v124
  v_mul_f32 v202, v202, v124
  v_mul_f32 v203, v203, v124
  v_mul_f32 v204, v204, v124
  v_mul_f32 v205, v205, v124
  v_mul_f32 v206, v206, v124
  v_mul_f32 v207, v207, v124
  v_fma_f32 v38, v192, v36, v38
  v_fma_f32 v39, v193, v36, v39
  v_cvt_pk_bf16_f32 v56, v192, v193
  v_fma_f32 v38, v194, v36, v38
  v_fma_f32 v39, v195, v36, v39
  v_cvt_pk_bf16_f32 v57, v194, v195
  v_fma_f32 v38, v196, v36, v38
  v_fma_f32 v39, v197, v36, v39
  v_cvt_pk_bf16_f32 v58, v196, v197
  v_fma_f32 v38, v198, v36, v38
  v_fma_f32 v39, v199, v36, v39
  v_cvt_pk_bf16_f32 v59, v198, v199
  v_fma_f32 v38, v200, v36, v38
  v_fma_f32 v39, v201, v36, v39
  v_cvt_pk_bf16_f32 v60, v200, v201
  v_fma_f32 v38, v202, v36, v38
  v_fma_f32 v39, v203, v36, v39
  v_cvt_pk_bf16_f32 v61, v202, v203
  v_fma_f32 v38, v204, v36, v38
  v_fma_f32 v39, v205, v36, v39
  v_cvt_pk_bf16_f32 v62, v204, v205
  v_fma_f32 v38, v206, v36, v38
  v_fma_f32 v39, v207, v36, v39
  v_cvt_pk_bf16_f32 v63, v206, v207
  s_add_u32 s39, s46, 0
  s_add_u32 s40, s39, 9216
  buffer_store_dwordx4 v[56:59], v7, s[20:23], s39 offen offset:0 sc1
  buffer_store_dwordx4 v[60:63], v7, s[20:23], s40 offen offset:0 sc1
  s_waitcnt lgkmcnt(3)
  v_add_f32 v208, v208, v176
  v_add_f32 v209, v209, v177
  v_add_f32 v210, v210, v178
  v_add_f32 v211, v211, v179
  v_add_f32 v212, v212, v180
  v_add_f32 v213, v213, v181
  v_add_f32 v214, v214, v182
  v_add_f32 v215, v215, v183
  v_add_f32 v216, v216, v184
  v_add_f32 v217, v217, v185
  v_add_f32 v218, v218, v186
  v_add_f32 v219, v219, v187
  v_add_f32 v220, v220, v188
  v_add_f32 v221, v221, v189
  v_add_f32 v222, v222, v190
  v_add_f32 v223, v223, v191
  ds_read_b128 v[176:179], v4 offset:12288
  ds_read_b128 v[180:183], v4 offset:13312
  ds_read_b128 v[184:187], v4 offset:14336
  ds_read_b128 v[188:191], v4 offset:15360
  v_mul_f32 v208, v208, v125
  v_mul_f32 v209, v209, v125
  v_mul_f32 v210, v210, v125
  v_mul_f32 v211, v211, v125
  v_mul_f32 v212, v212, v125
  v_mul_f32 v213, v213, v125
  v_mul_f32 v214, v214, v125
  v_mul_f32 v215, v215, v125
  v_mul_f32 v216, v216, v125
  v_mul_f32 v217, v217, v125
  v_mul_f32 v218, v218, v125
  v_mul_f32 v219, v219, v125
  v_mul_f32 v220, v220, v125
  v_mul_f32 v221, v221, v125
  v_mul_f32 v222, v222, v125
  v_mul_f32 v223, v223, v125
  v_fma_f32 v38, v208, v36, v38
  v_fma_f32 v39, v209, v36, v39
  v_cvt_pk_bf16_f32 v64, v208, v209
  v_fma_f32 v38, v210, v36, v38
  v_fma_f32 v39, v211, v36, v39
  v_cvt_pk_bf16_f32 v65, v210, v211
  v_fma_f32 v38, v212, v36, v38
  v_fma_f32 v39, v213, v36, v39
  v_cvt_pk_bf16_f32 v66, v212, v213
  v_fma_f32 v38, v214, v36, v38
  v_fma_f32 v39, v215, v36, v39
  v_cvt_pk_bf16_f32 v67, v214, v215
  v_fma_f32 v38, v216, v36, v38
  v_fma_f32 v39, v217, v36, v39
  v_cvt_pk_bf16_f32 v68, v216, v217
  v_fma_f32 v38, v218, v36, v38
  v_fma_f32 v39, v219, v36, v39
  v_cvt_pk_bf16_f32 v69, v218, v219
  v_fma_f32 v38, v220, v36, v38
  v_fma_f32 v39, v221, v36, v39
  v_cvt_pk_bf16_f32 v70, v220, v221
  v_fma_f32 v38, v222, v36, v38
  v_fma_f32 v39, v223, v36, v39
  v_cvt_pk_bf16_f32 v71, v222, v223
  s_add_u32 s39, s46, 1024
  s_add_u32 s40, s39, 9216
  buffer_store_dwordx4 v[64:67], v7, s[20:23], s39 offen offset:0 sc1
  buffer_store_dwordx4 v[68:71], v7, s[20:23], s40 offen offset:0 sc1
  v_add_f32 v224, v224, v160
  v_add_f32 v225, v225, v161
  v_add_f32 v226, v226, v162
  v_add_f32 v227, v227, v163
  s_waitcnt lgkmcnt(0)
  v_add_f32 v228, v228, v164
  v_add_f32 v229, v229, v165
  v_add_f32 v230, v230, v166
  v_add_f32 v231, v231, v167
  v_add_f32 v232, v232, v168
  v_add_f32 v233, v233, v169
  v_add_f32 v234, v234, v170
  v_add_f32 v235, v235, v171
  v_add_f32 v236, v236, v172
  v_add_f32 v237, v237, v173
  v_add_f32 v238, v238, v174
  v_add_f32 v239, v239, v175
  v_mul_f32 v224, v224, v126
  v_mul_f32 v225, v225, v126
  v_mul_f32 v226, v226, v126
  v_mul_f32 v227, v227, v126
  v_mul_f32 v228, v228, v126
  v_mul_f32 v229, v229, v126
  v_mul_f32 v230, v230, v126
  v_mul_f32 v231, v231, v126
  v_mul_f32 v232, v232, v126
  v_mul_f32 v233, v233, v126
  v_mul_f32 v234, v234, v126
  v_mul_f32 v235, v235, v126
  v_mul_f32 v236, v236, v126
  v_mul_f32 v237, v237, v126
  v_mul_f32 v238, v238, v126
  v_mul_f32 v239, v239, v126
  v_fma_f32 v38, v224, v36, v38
  v_fma_f32 v39, v225, v36, v39
  v_cvt_pk_bf16_f32 v72, v224, v225
  v_fma_f32 v38, v226, v36, v38
  v_fma_f32 v39, v227, v36, v39
  v_cvt_pk_bf16_f32 v73, v226, v227
  v_fma_f32 v38, v228, v36, v38
  v_fma_f32 v39, v229, v36, v39
  v_cvt_pk_bf16_f32 v74, v228, v229
  v_fma_f32 v38, v230, v36, v38
  v_fma_f32 v39, v231, v36, v39
  v_cvt_pk_bf16_f32 v75, v230, v231
  v_fma_f32 v38, v232, v36, v38
  v_fma_f32 v39, v233, v36, v39
  v_cvt_pk_bf16_f32 v76, v232, v233
  v_fma_f32 v38, v234, v36, v38
  v_fma_f32 v39, v235, v36, v39
  v_cvt_pk_bf16_f32 v77, v234, v235
  v_fma_f32 v38, v236, v36, v38
  v_fma_f32 v39, v237, v36, v39
  v_cvt_pk_bf16_f32 v78, v236, v237
  v_fma_f32 v38, v238, v36, v38
  v_fma_f32 v39, v239, v36, v39
  v_cvt_pk_bf16_f32 v79, v238, v239
  s_add_u32 s39, s46, 2048
  s_add_u32 s40, s39, 9216
  buffer_store_dwordx4 v[72:75], v7, s[20:23], s39 offen offset:0 sc1
  buffer_store_dwordx4 v[76:79], v7, s[20:23], s40 offen offset:0 sc1
  v_add_f32 v96, v96, v176
  v_add_f32 v97, v97, v177
  v_add_f32 v98, v98, v178
  v_add_f32 v99, v99, v179
  v_add_f32 v100, v100, v180
  v_add_f32 v101, v101, v181
  v_add_f32 v102, v102, v182
  v_add_f32 v103, v103, v183
  v_add_f32 v104, v104, v184
  v_add_f32 v105, v105, v185
  v_add_f32 v106, v106, v186
  v_add_f32 v107, v107, v187
  v_add_f32 v108, v108, v188
  v_add_f32 v109, v109, v189
  v_add_f32 v110, v110, v190
  v_add_f32 v111, v111, v191
  v_mul_f32 v96, v96, v127
  v_mul_f32 v97, v97, v127
  v_mul_f32 v98, v98, v127
  v_mul_f32 v99, v99, v127
  v_mul_f32 v100, v100, v127
  v_mul_f32 v101, v101, v127
  v_mul_f32 v102, v102, v127
  v_mul_f32 v103, v103, v127
  v_mul_f32 v104, v104, v127
  v_mul_f32 v105, v105, v127
  v_mul_f32 v106, v106, v127
  v_mul_f32 v107, v107, v127
  v_mul_f32 v108, v108, v127
  v_mul_f32 v109, v109, v127
  v_mul_f32 v110, v110, v127
  v_mul_f32 v111, v111, v127
  v_fma_f32 v38, v96, v36, v38
  v_fma_f32 v39, v97, v36, v39
  v_cvt_pk_bf16_f32 v80, v96, v97
  v_fma_f32 v38, v98, v36, v38
  v_fma_f32 v39, v99, v36, v39
  v_cvt_pk_bf16_f32 v81, v98, v99
  v_fma_f32 v38, v100, v36, v38
  v_fma_f32 v39, v101, v36, v39
  v_cvt_pk_bf16_f32 v82, v100, v101
  v_fma_f32 v38, v102, v36, v38
  v_fma_f32 v39, v103, v36, v39
  v_cvt_pk_bf16_f32 v83, v102, v103
  v_fma_f32 v38, v104, v36, v38
  v_fma_f32 v39, v105, v36, v39
  v_cvt_pk_bf16_f32 v84, v104, v105
  v_fma_f32 v38, v106, v36, v38
  v_fma_f32 v39, v107, v36, v39
  v_cvt_pk_bf16_f32 v85, v106, v107
  v_fma_f32 v38, v108, v36, v38
  v_fma_f32 v39, v109, v36, v39
  v_cvt_pk_bf16_f32 v86, v108, v109
  v_fma_f32 v38, v110, v36, v38
  v_fma_f32 v39, v111, v36, v39
  v_cvt_pk_bf16_f32 v87, v110, v111
  s_add_u32 s39, s46, 3072
  s_add_u32 s40, s39, 9216
  buffer_store_dwordx4 v[80:83], v7, s[20:23], s39 offen offset:0 sc1
  buffer_store_dwordx4 v[84:87], v7, s[20:23], s40 offen offset:0 sc1
  v_cmp_u_f32 vcc, v38, v39
  s_nop 1
  s_or_b64 s[72:73], s[72:73], vcc
  s_cmp_lg_u64 s[72:73], 0
  s_cselect_b32 s39, 1, 0
  s_lshl_b32 s39, s39, s58
  s_or_b32 s44, s44, s39
  s_waitcnt lgkmcnt(0)
  s_cmp_lg_u32 s58, 0
  s_cbranch_scc1 fa_kernel_cf3
  s_barrier
  s_mov_b32 m0, s31
  s_nop 0
  buffer_load_dwordx4 v10, s[8:11], s41 offen offset:0 nt lds
  buffer_load_dwordx4 v11, s[8:11], s41 offen offset:1024 nt lds
  buffer_load_dwordx4 v12, s[8:11], s41 offen offset:2048 nt lds
  buffer_load_dwordx4 v13, s[8:11], s41 offen offset:3072 nt lds
  s_add_u32 m0, s31, 4096
  s_nop 0
  buffer_load_dwordx4 v248, s[8:11], s41 offen offset:0 nt lds
  buffer_load_dwordx4 v249, s[8:11], s41 offen offset:1024 nt lds
  buffer_load_dwordx4 v250, s[8:11], s41 offen offset:2048 nt lds
  buffer_load_dwordx4 v251, s[8:11], s41 offen offset:3072 nt lds
  s_add_u32 s41, s41, 16384
  s_add_u32 s31, s31, 32768
  s_cmp_eq_u32 s31, s30
  s_cselect_b32 s31, s42, s31
fa_kernel_cf3:
  s_add_u32 s58, s58, 1
  s_cmp_ge_u32 s58, 2
  s_cbranch_scc1 fa_kernel_agree
  s_branch fa_kernel_att
fa_kernel_agree:
  s_barrier
  v_mov_b32 v5, 98304
  s_lshl_b32 s40, s24, 2
  v_add_u32 v6, s40, v5
  v_mov_b32 v3, s44
  ds_write_b32 v6, v3
  s_waitcnt lgkmcnt(0)
  s_barrier
  ds_read_b128 v[120:123], v5
  s_waitcnt lgkmcnt(0)
  v_or_b32 v120, v120, v121
  v_or_b32 v122, v122, v123
  v_or_b32 v120, v120, v122
  s_nop 0
  v_readfirstlane_b32 s44, v120
  s_nop 3
fa_kernel_redo:
  s_cmp_eq_u32 s44, 0
  s_cbranch_scc1 fa_kernel_fin
  s_and_b32 s39, s44, 1
  s_xor_b32 s58, s39, 1
  s_lshl_b32 s39, 1, s58
  s_andn2_b32 s44, s44, s39
  s_mov_b32 s45, 1
  s_lshl_b32 s41, s58, 18
  s_add_u32 s31, s42, 32768
  s_mov_b32 s32, 32768
  s_branch fa_kernel_qpL
fa_kernel_fin:
  s_lshl_b32 s39, s2, 7
  s_add_u32 s39, s39, 50331648
  s_add_u32 s72, s68, s39
  s_addc_u32 s73, s69, 0
  v_mov_b32 v2, 0
  v_lshlrev_b32 v3, 2, v1
  s_mov_b32 exec_hi, 0
  global_store_dword v3, v2, s[72:73]
  s_mov_b32 exec_hi, -1
  s_lshl_b32 s39, s24, 14
  s_add_u32 s39, s39, 0
  buffer_load_dword v16, v19, s[76:79], s39 offen
  s_lshl_b32 s39, s24, 14
  s_add_u32 s39, s39, 8192
  buffer_load_dword v16, v19, s[76:79], s39 offen
fa_kernel_done:
  s_endpgm
fa_kernel_qredo:
  s_cmp_lg_u32 s58, 0
  s_cbranch_scc1 fa_kernel_qredo1
  v_mov_b32 v8, 0x3e0293ee
  v_lshlrev_b32 v2, 4, v1
  v_add_u32 v2, 98304, v2
  s_lshl_b32 s40, s25, 14
  s_lshl_b32 s43, s26, 11
  s_add_u32 s40, s40, s43
  s_lshl_b32 s43, s25, 10
  s_add_u32 s46, s40, s43
  s_xor_b32 s43, s43, 1024
  s_add_u32 s47, s40, s43
  v_add_u32 v3, s46, v2
  v_add_u32 v4, s47, v2
  s_lshl_b32 s40, s26, 11
  s_lshl_b32 s43, s25, 10
  s_add_u32 s40, s40, s43
  v_add_u32 v5, s40, v2
  v_accvgpr_read_b32 v124, a0
  v_accvgpr_read_b32 v125, a1
  v_accvgpr_read_b32 v126, a2
  v_accvgpr_read_b32 v127, a3
  v_accvgpr_read_b32 v128, a4
  v_accvgpr_read_b32 v129, a5
  v_accvgpr_read_b32 v130, a6
  v_accvgpr_read_b32 v131, a7
  v_mul_f32 v124, v8, v124
  v_mul_f32 v125, v8, v125
  v_mul_f32 v126, v8, v126
  v_mul_f32 v127, v8, v127
  v_mul_f32 v128, v8, v128
  v_mul_f32 v129, v8, v129
  v_mul_f32 v130, v8, v130
  v_mul_f32 v131, v8, v131
  v_cvt_pk_bf16_f32 v120, v124, v125
  v_cvt_pk_bf16_f32 v121, v126, v127
  v_cvt_pk_bf16_f32 v122, v128, v129
  v_cvt_pk_bf16_f32 v123, v130, v131
  ds_write_b128 v3, v[120:123] offset:0
  v_accvgpr_read_b32 v136, a8
  v_accvgpr_read_b32 v137, a9
  v_accvgpr_read_b32 v138, a10
  v_accvgpr_read_b32 v139, a11
  v_accvgpr_read_b32 v140, a12
  v_accvgpr_read_b32 v141, a13
  v_accvgpr_read_b32 v142, a14
  v_accvgpr_read_b32 v143, a15
  v_mul_f32 v136, v8, v136
  v_mul_f32 v137, v8, v137
  v_mul_f32 v138, v8, v138
  v_mul_f32 v139, v8, v139
  v_mul_f32 v140, v8, v140
  v_mul_f32 v141, v8, v141
  v_mul_f32 v142, v8, v142
  v_mul_f32 v143, v8, v143
  v_cvt_pk_bf16_f32 v132, v136, v137
  v_cvt_pk_bf16_f32 v133, v138, v139
  v_cvt_pk_bf16_f32 v134, v140, v141
  v_cvt_pk_bf16_f32 v135, v142, v143
  ds_write_b128 v4, v[132:135] offset:0
  v_accvgpr_read_b32 v148, a16
  v_accvgpr_read_b32 v149, a17
  v_accvgpr_read_b32 v150, a18
  v_accvgpr_read_b32 v151, a19
  v_accvgpr_read_b32 v152, a20
  v_accvgpr_read_b32 v153, a21
  v_accvgpr_read_b32 v154, a22
  v_accvgpr_read_b32 v155, a23
  v_mul_f32 v148, v8, v148
  v_mul_f32 v149, v8, v149
  v_mul_f32 v150, v8, v150
  v_mul_f32 v151, v8, v151
  v_mul_f32 v152, v8, v152
  v_mul_f32 v153, v8, v153
  v_mul_f32 v154, v8, v154
  v_mul_f32 v155, v8, v155
  v_cvt_pk_bf16_f32 v144, v148, v149
  v_cvt_pk_bf16_f32 v145, v150, v151
  v_cvt_pk_bf16_f32 v146, v152, v153
  v_cvt_pk_bf16_f32 v147, v154, v155
  ds_write_b128 v3, v[144:147] offset:4096
  v_accvgpr_read_b32 v160, a24
  v_accvgpr_read_b32 v161, a25
  v_accvgpr_read_b32 v162, a26
  v_accvgpr_read_b32 v163, a27
  v_accvgpr_read_b32 v164, a28
  v_accvgpr_read_b32 v165, a29
  v_accvgpr_read_b32 v166, a30
  v_accvgpr_read_b32 v167, a31
  v_mul_f32 v160, v8, v160
  v_mul_f32 v161, v8, v161
  v_mul_f32 v162, v8, v162
  v_mul_f32 v163, v8, v163
  v_mul_f32 v164, v8, v164
  v_mul_f32 v165, v8, v165
  v_mul_f32 v166, v8, v166
  v_mul_f32 v167, v8, v167
  v_cvt_pk_bf16_f32 v156, v160, v161
  v_cvt_pk_bf16_f32 v157, v162, v163
  v_cvt_pk_bf16_f32 v158, v164, v165
  v_cvt_pk_bf16_f32 v159, v166, v167
  ds_write_b128 v4, v[156:159] offset:4096
  v_accvgpr_read_b32 v172, a32
  v_accvgpr_read_b32 v173, a33
  v_accvgpr_read_b32 v174, a34
  v_accvgpr_read_b32 v175, a35
  v_accvgpr_read_b32 v176, a36
  v_accvgpr_read_b32 v177, a37
  v_accvgpr_read_b32 v178, a38
  v_accvgpr_read_b32 v179, a39
  v_mul_f32 v172, v8, v172
  v_mul_f32 v173, v8, v173
  v_mul_f32 v174, v8, v174
  v_mul_f32 v175, v8, v175
  v_mul_f32 v176, v8, v176
  v_mul_f32 v177, v8, v177
  v_mul_f32 v178, v8, v178
  v_mul_f32 v179, v8, v179
  v_cvt_pk_bf16_f32 v168, v172, v173
  v_cvt_pk_bf16_f32 v169, v174, v175
  v_cvt_pk_bf16_f32 v170, v176, v177
  v_cvt_pk_bf16_f32 v171, v178, v179
  ds_write_b128 v3, v[168:171] offset:8192
  v_accvgpr_read_b32 v184, a40
  v_accvgpr_read_b32 v185, a41
  v_accvgpr_read_b32 v186, a42
  v_accvgpr_read_b32 v187, a43
  v_accvgpr_read_b32 v188, a44
  v_accvgpr_read_b32 v189, a45
  v_accvgpr_read_b32 v190, a46
  v_accvgpr_read_b32 v191, a47
  v_mul_f32 v184, v8, v184
  v_mul_f32 v185, v8, v185
  v_mul_f32 v186, v8, v186
  v_mul_f32 v187, v8, v187
  v_mul_f32 v188, v8, v188
  v_mul_f32 v189, v8, v189
  v_mul_f32 v190, v8, v190
  v_mul_f32 v191, v8, v191
  v_cvt_pk_bf16_f32 v180, v184, v185
  v_cvt_pk_bf16_f32 v181, v186, v187
  v_cvt_pk_bf16_f32 v182, v188, v189
  v_cvt_pk_bf16_f32 v183, v190, v191
  ds_write_b128 v4, v[180:183] offset:8192
  v_accvgpr_read_b32 v196, a48
  v_accvgpr_read_b32 v197, a49
  v_accvgpr_read_b32 v198, a50
  v_accvgpr_read_b32 v199, a51
  v_accvgpr_read_b32 v200, a52
  v_accvgpr_read_b32 v201, a53
  v_accvgpr_read_b32 v202, a54
  v_accvgpr_read_b32 v203, a55
  v_mul_f32 v196, v8, v196
  v_mul_f32 v197, v8, v197
  v_mul_f32 v198, v8, v198
  v_mul_f32 v199, v8, v199
  v_mul_f32 v200, v8, v200
  v_mul_f32 v201, v8, v201
  v_mul_f32 v202, v8, v202
  v_mul_f32 v203, v8, v203
  v_cvt_pk_bf16_f32 v192, v196, v197
  v_cvt_pk_bf16_f32 v193, v198, v199
  v_cvt_pk_bf16_f32 v194, v200, v201
  v_cvt_pk_bf16_f32 v195, v202, v203
  ds_write_b128 v3, v[192:195] offset:12288
  v_accvgpr_read_b32 v208, a56
  v_accvgpr_read_b32 v209, a57
  v_accvgpr_read_b32 v210, a58
  v_accvgpr_read_b32 v211, a59
  v_accvgpr_read_b32 v212, a60
  v_accvgpr_read_b32 v213, a61
  v_accvgpr_read_b32 v214, a62
  v_accvgpr_read_b32 v215, a63
  v_mul_f32 v208, v8, v208
  v_mul_f32 v209, v8, v209
  v_mul_f32 v210, v8, v210
  v_mul_f32 v211, v8, v211
  v_mul_f32 v212, v8, v212
  v_mul_f32 v213, v8, v213
  v_mul_f32 v214, v8, v214
  v_mul_f32 v215, v8, v215
  v_cvt_pk_bf16_f32 v204, v208, v209
  v_cvt_pk_bf16_f32 v205, v210, v211
  v_cvt_pk_bf16_f32 v206, v212, v213
  v_cvt_pk_bf16_f32 v207, v214, v215
  ds_write_b128 v4, v[204:207] offset:12288
  v_accvgpr_read_b32 v220, a64
  v_accvgpr_read_b32 v221, a65
  v_accvgpr_read_b32 v222, a66
  v_accvgpr_read_b32 v223, a67
  v_accvgpr_read_b32 v224, a68
  v_accvgpr_read_b32 v225, a69
  v_accvgpr_read_b32 v226, a70
  v_accvgpr_read_b32 v227, a71
  v_mul_f32 v220, v8, v220
  v_mul_f32 v221, v8, v221
  v_mul_f32 v222, v8, v222
  v_mul_f32 v223, v8, v223
  v_mul_f32 v224, v8, v224
  v_mul_f32 v225, v8, v225
  v_mul_f32 v226, v8, v226
  v_mul_f32 v227, v8, v227
  v_cvt_pk_bf16_f32 v216, v220, v221
  v_cvt_pk_bf16_f32 v217, v222, v223
  v_cvt_pk_bf16_f32 v218, v224, v225
  v_cvt_pk_bf16_f32 v219, v226, v227
  ds_write_b128 v5, v[216:219] offset:32768
  s_waitcnt lgkmcnt(0)
  s_barrier
  s_branch fa_kernel_qredo2
fa_kernel_qredo1:
  v_mov_b32 v8, 0x3e0293ee
  v_lshlrev_b32 v2, 4, v1
  v_add_u32 v2, 98304, v2
  s_lshl_b32 s40, s25, 14
  s_lshl_b32 s43, s26, 11
  s_add_u32 s40, s40, s43
  s_lshl_b32 s43, s25, 10
  s_add_u32 s46, s40, s43
  s_xor_b32 s43, s43, 1024
  s_add_u32 s47, s40, s43
  v_add_u32 v3, s46, v2
  v_add_u32 v4, s47, v2
  s_lshl_b32 s40, s26, 11
  s_lshl_b32 s43, s25, 10
  s_add_u32 s40, s40, s43
  v_add_u32 v5, s40, v2
  v_accvgpr_read_b32 v124, a72
  v_accvgpr_read_b32 v125, a73
  v_accvgpr_read_b32 v126, a74
  v_accvgpr_read_b32 v127, a75
  v_accvgpr_read_b32 v128, a76
  v_accvgpr_read_b32 v129, a77
  v_accvgpr_read_b32 v130, a78
  v_accvgpr_read_b32 v131, a79
  v_mul_f32 v124, v8, v124
  v_mul_f32 v125, v8, v125
  v_mul_f32 v126, v8, v126
  v_mul_f32 v127, v8, v127
  v_mul_f32 v128, v8, v128
  v_mul_f32 v129, v8, v129
  v_mul_f32 v130, v8, v130
  v_mul_f32 v131, v8, v131
  v_cvt_pk_bf16_f32 v120, v124, v125
  v_cvt_pk_bf16_f32 v121, v126, v127
  v_cvt_pk_bf16_f32 v122, v128, v129
  v_cvt_pk_bf16_f32 v123, v130, v131
  ds_write_b128 v3, v[120:123] offset:0
  v_accvgpr_read_b32 v136, a80
  v_accvgpr_read_b32 v137, a81
  v_accvgpr_read_b32 v138, a82
  v_accvgpr_read_b32 v139, a83
  v_accvgpr_read_b32 v140, a84
  v_accvgpr_read_b32 v141, a85
  v_accvgpr_read_b32 v142, a86
  v_accvgpr_read_b32 v143, a87
  v_mul_f32 v136, v8, v136
  v_mul_f32 v137, v8, v137
  v_mul_f32 v138, v8, v138
  v_mul_f32 v139, v8, v139
  v_mul_f32 v140, v8, v140
  v_mul_f32 v141, v8, v141
  v_mul_f32 v142, v8, v142
  v_mul_f32 v143, v8, v143
  v_cvt_pk_bf16_f32 v132, v136, v137
  v_cvt_pk_bf16_f32 v133, v138, v139
  v_cvt_pk_bf16_f32 v134, v140, v141
  v_cvt_pk_bf16_f32 v135, v142, v143
  ds_write_b128 v4, v[132:135] offset:0
  v_accvgpr_read_b32 v148, a88
  v_accvgpr_read_b32 v149, a89
  v_accvgpr_read_b32 v150, a90
  v_accvgpr_read_b32 v151, a91
  v_accvgpr_read_b32 v152, a92
  v_accvgpr_read_b32 v153, a93
  v_accvgpr_read_b32 v154, a94
  v_accvgpr_read_b32 v155, a95
  v_mul_f32 v148, v8, v148
  v_mul_f32 v149, v8, v149
  v_mul_f32 v150, v8, v150
  v_mul_f32 v151, v8, v151
  v_mul_f32 v152, v8, v152
  v_mul_f32 v153, v8, v153
  v_mul_f32 v154, v8, v154
  v_mul_f32 v155, v8, v155
  v_cvt_pk_bf16_f32 v144, v148, v149
  v_cvt_pk_bf16_f32 v145, v150, v151
  v_cvt_pk_bf16_f32 v146, v152, v153
  v_cvt_pk_bf16_f32 v147, v154, v155
  ds_write_b128 v3, v[144:147] offset:4096
  v_accvgpr_read_b32 v160, a96
  v_accvgpr_read_b32 v161, a97
  v_accvgpr_read_b32 v162, a98
  v_accvgpr_read_b32 v163, a99
  v_accvgpr_read_b32 v164, a100
  v_accvgpr_read_b32 v165, a101
  v_accvgpr_read_b32 v166, a102
  v_accvgpr_read_b32 v167, a103
  v_mul_f32 v160, v8, v160
  v_mul_f32 v161, v8, v161
  v_mul_f32 v162, v8, v162
  v_mul_f32 v163, v8, v163
  v_mul_f32 v164, v8, v164
  v_mul_f32 v165, v8, v165
  v_mul_f32 v166, v8, v166
  v_mul_f32 v167, v8, v167
  v_cvt_pk_bf16_f32 v156, v160, v161
  v_cvt_pk_bf16_f32 v157, v162, v163
  v_cvt_pk_bf16_f32 v158, v164, v165
  v_cvt_pk_bf16_f32 v159, v166, v167
  ds_write_b128 v4, v[156:159] offset:4096
  v_accvgpr_read_b32 v172, a104
  v_accvgpr_read_b32 v173, a105
  v_accvgpr_read_b32 v174, a106
  v_accvgpr_read_b32 v175, a107
  v_accvgpr_read_b32 v176, a108
  v_accvgpr_read_b32 v177, a109
  v_accvgpr_read_b32 v178, a110
  v_accvgpr_read_b32 v179, a111
  v_mul_f32 v172, v8, v172
  v_mul_f32 v173, v8, v173
  v_mul_f32 v174, v8, v174
  v_mul_f32 v175, v8, v175
  v_mul_f32 v176, v8, v176
  v_mul_f32 v177, v8, v177
  v_mul_f32 v178, v8, v178
  v_mul_f32 v179, v8, v179
  v_cvt_pk_bf16_f32 v168, v172, v173
  v_cvt_pk_bf16_f32 v169, v174, v175
  v_cvt_pk_bf16_f32 v170, v176, v177
  v_cvt_pk_bf16_f32 v171, v178, v179
  ds_write_b128 v3, v[168:171] offset:8192
  v_accvgpr_read_b32 v184, a112
  v_accvgpr_read_b32 v185, a113
  v_accvgpr_read_b32 v186, a114
  v_accvgpr_read_b32 v187, a115
  v_accvgpr_read_b32 v188, a116
  v_accvgpr_read_b32 v189, a117
  v_accvgpr_read_b32 v190, a118
  v_accvgpr_read_b32 v191, a119
  v_mul_f32 v184, v8, v184
  v_mul_f32 v185, v8, v185
  v_mul_f32 v186, v8, v186
  v_mul_f32 v187, v8, v187
  v_mul_f32 v188, v8, v188
  v_mul_f32 v189, v8, v189
  v_mul_f32 v190, v8, v190
  v_mul_f32 v191, v8, v191
  v_cvt_pk_bf16_f32 v180, v184, v185
  v_cvt_pk_bf16_f32 v181, v186, v187
  v_cvt_pk_bf16_f32 v182, v188, v189
  v_cvt_pk_bf16_f32 v183, v190, v191
  ds_write_b128 v4, v[180:183] offset:8192
  v_accvgpr_read_b32 v196, a120
  v_accvgpr_read_b32 v197, a121
  v_accvgpr_read_b32 v198, a122
  v_accvgpr_read_b32 v199, a123
  v_accvgpr_read_b32 v200, a124
  v_accvgpr_read_b32 v201, a125
  v_accvgpr_read_b32 v202, a126
  v_accvgpr_read_b32 v203, a127
  v_mul_f32 v196, v8, v196
  v_mul_f32 v197, v8, v197
  v_mul_f32 v198, v8, v198
  v_mul_f32 v199, v8, v199
  v_mul_f32 v200, v8, v200
  v_mul_f32 v201, v8, v201
  v_mul_f32 v202, v8, v202
  v_mul_f32 v203, v8, v203
  v_cvt_pk_bf16_f32 v192, v196, v197
  v_cvt_pk_bf16_f32 v193, v198, v199
  v_cvt_pk_bf16_f32 v194, v200, v201
  v_cvt_pk_bf16_f32 v195, v202, v203
  ds_write_b128 v3, v[192:195] offset:12288
  v_accvgpr_read_b32 v208, a128
  v_accvgpr_read_b32 v209, a129
  v_accvgpr_read_b32 v210, a130
  v_accvgpr_read_b32 v211, a131
  v_accvgpr_read_b32 v212, a132
  v_accvgpr_read_b32 v213, a133
  v_accvgpr_read_b32 v214, a134
  v_accvgpr_read_b32 v215, a135
  v_mul_f32 v208, v8, v208
  v_mul_f32 v209, v8, v209
  v_mul_f32 v210, v8, v210
  v_mul_f32 v211, v8, v211
  v_mul_f32 v212, v8, v212
  v_mul_f32 v213, v8, v213
  v_mul_f32 v214, v8, v214
  v_mul_f32 v215, v8, v215
  v_cvt_pk_bf16_f32 v204, v208, v209
  v_cvt_pk_bf16_f32 v205, v210, v211
  v_cvt_pk_bf16_f32 v206, v212, v213
  v_cvt_pk_bf16_f32 v207, v214, v215
  ds_write_b128 v4, v[204:207] offset:12288
  v_accvgpr_read_b32 v220, a136
  v_accvgpr_read_b32 v221, a137
  v_accvgpr_read_b32 v222, a138
  v_accvgpr_read_b32 v223, a139
  v_accvgpr_read_b32 v224, a140
  v_accvgpr_read_b32 v225, a141
  v_accvgpr_read_b32 v226, a142
  v_accvgpr_read_b32 v227, a143
  v_mul_f32 v220, v8, v220
  v_mul_f32 v221, v8, v221
  v_mul_f32 v222, v8, v222
  v_mul_f32 v223, v8, v223
  v_mul_f32 v224, v8, v224
  v_mul_f32 v225, v8, v225
  v_mul_f32 v226, v8, v226
  v_mul_f32 v227, v8, v227
  v_cvt_pk_bf16_f32 v216, v220, v221
  v_cvt_pk_bf16_f32 v217, v222, v223
  v_cvt_pk_bf16_f32 v218, v224, v225
  v_cvt_pk_bf16_f32 v219, v226, v227
  ds_write_b128 v5, v[216:219] offset:32768
  s_waitcnt lgkmcnt(0)
  s_barrier
fa_kernel_qredo2:
  v_lshlrev_b32 v2, 4, v1
  v_add_u32 v2, 98304, v2
  s_lshl_b32 s39, s25, 14
  v_add_u32 v3, s39, v2
  ds_read_b128 a[160:163], v3 offset:0
  ds_read_b128 a[164:167], v3 offset:1024
  ds_read_b128 a[168:171], v3 offset:2048
  ds_read_b128 a[172:175], v3 offset:3072
  ds_read_b128 a[176:179], v3 offset:4096
  ds_read_b128 a[180:183], v3 offset:5120
  ds_read_b128 a[184:187], v3 offset:6144
  ds_read_b128 a[188:191], v3 offset:7168
  ds_read_b128 a[192:195], v3 offset:8192
  ds_read_b128 a[196:199], v3 offset:9216
  ds_read_b128 a[200:203], v3 offset:10240
  ds_read_b128 a[204:207], v3 offset:11264
  ds_read_b128 a[208:211], v3 offset:12288
  ds_read_b128 a[212:215], v3 offset:13312
  ds_read_b128 a[216:219], v3 offset:14336
  s_waitcnt lgkmcnt(14)
  ds_read_b128 a[220:223], v3 offset:15360
  s_waitcnt lgkmcnt(14)
  ds_read_b128 a[224:227], v2 offset:32768
  s_waitcnt lgkmcnt(14)
  ds_read_b128 a[228:231], v2 offset:33792
  s_waitcnt lgkmcnt(14)
  ds_read_b128 a[232:235], v2 offset:34816
  s_waitcnt lgkmcnt(14)
  ds_read_b128 a[236:239], v2 offset:35840
  s_waitcnt lgkmcnt(0)
  s_branch fa_kernel_safe
fa_kernel_safe:
  s_cmp_lg_u32 s25, 0
  s_cbranch_scc1 fa_kernel_sq1
  v_mov_b32 v76, 0
  v_mov_b32 v56, 0
  v_mov_b32 v77, 0
  v_mov_b32 v57, 0
  v_mov_b32 v78, 0
  v_mov_b32 v58, 0
  v_mov_b32 v79, 0
  v_mov_b32 v59, 0
  v_mov_b32 v80, 0
  v_mov_b32 v60, 0
  v_mov_b32 v81, 0
  v_mov_b32 v61, 0
  v_mov_b32 v82, 0
  v_mov_b32 v62, 0
  v_mov_b32 v83, 0
  v_mov_b32 v63, 0
  v_mov_b32 v84, 0
  v_mov_b32 v64, 0
  v_mov_b32 v85, 0
  v_mov_b32 v65, 0
  v_mov_b32 v86, 0
  v_mov_b32 v66, 0
  v_mov_b32 v87, 0
  v_mov_b32 v67, 0
  v_mov_b32 v88, 0
  v_mov_b32 v68, 0
  v_mov_b32 v89, 0
  v_mov_b32 v69, 0
  v_mov_b32 v90, 0
  v_mov_b32 v70, 0
  v_mov_b32 v91, 0
  v_mov_b32 v71, 0
  v_mov_b32 v92, 0
  v_mov_b32 v72, 0
  v_mov_b32 v93, 0
  v_mov_b32 v73, 0
  v_mov_b32 v94, 0
  v_mov_b32 v74, 0
  v_mov_b32 v95, 0
  v_mov_b32 v75, 0
  s_nop 1
  v_mfma_f32_16x16x32_bf16 a[0:3], v[76:79], v[76:79], 0
  v_mfma_f32_16x16x32_bf16 a[4:7], v[76:79], v[76:79], 0
  v_mfma_f32_16x16x32_bf16 a[8:11], v[76:79], v[76:79], 0
  v_mfma_f32_16x16x32_bf16 a[12:15], v[76:79], v[76:79], 0
  v_mfma_f32_16x16x32_bf16 a[16:19], v[76:79], v[76:79], 0
  v_mfma_f32_16x16x32_bf16 a[20:23], v[76:79], v[76:79], 0
  v_mfma_f32_16x16x32_bf16 a[24:27], v[76:79], v[76:79], 0
  v_mfma_f32_16x16x32_bf16 a[28:31], v[76:79], v[76:79], 0
  v_mfma_f32_16x16x32_bf16 a[32:35], v[76:79], v[76:79], 0
  v_mfma_f32_16x16x32_bf16 a[36:39], v[76:79], v[76:79], 0
  v_mfma_f32_16x16x32_bf16 a[40:43], v[76:79], v[76:79], 0
  v_mfma_f32_16x16x32_bf16 a[44:47], v[76:79], v[76:79], 0
  v_mfma_f32_16x16x32_bf16 a[48:51], v[76:79], v[76:79], 0
  v_mfma_f32_16x16x32_bf16 a[52:55], v[76:79], v[76:79], 0
  v_mfma_f32_16x16x32_bf16 a[56:59], v[76:79], v[76:79], 0
  v_mfma_f32_16x16x32_bf16 a[60:63], v[76:79], v[76:79], 0
  v_mfma_f32_16x16x32_bf16 a[64:67], v[76:79], v[76:79], 0
  v_mfma_f32_16x16x32_bf16 a[68:71], v[76:79], v[76:79], 0
  v_mfma_f32_16x16x32_bf16 a[72:75], v[76:79], v[76:79], 0
  v_mfma_f32_16x16x32_bf16 a[76:79], v[76:79], v[76:79], 0
  v_mfma_f32_16x16x32_bf16 a[80:83], v[76:79], v[76:79], 0
  v_mfma_f32_16x16x32_bf16 a[84:87], v[76:79], v[76:79], 0
  v_mfma_f32_16x16x32_bf16 a[88:91], v[76:79], v[76:79], 0
  v_mfma_f32_16x16x32_bf16 a[92:95], v[76:79], v[76:79], 0
  v_mfma_f32_16x16x32_bf16 a[96:99], v[76:79], v[76:79], 0
  v_mfma_f32_16x16x32_bf16 a[100:103], v[76:79], v[76:79], 0
  v_mfma_f32_16x16x32_bf16 a[104:107], v[76:79], v[76:79], 0
  v_mfma_f32_16x16x32_bf16 a[108:111], v[76:79], v[76:79], 0
  v_mfma_f32_16x16x32_bf16 a[112:115], v[76:79], v[76:79], 0
  v_mfma_f32_16x16x32_bf16 a[116:119], v[76:79], v[76:79], 0
  v_mfma_f32_16x16x32_bf16 a[120:123], v[76:79], v[76:79], 0
  v_mfma_f32_16x16x32_bf16 a[124:127], v[76:79], v[76:79], 0
  v_mfma_f32_16x16x32_bf16 a[128:131], v[76:79], v[76:79], 0
  v_mfma_f32_16x16x32_bf16 a[132:135], v[76:79], v[76:79], 0
  v_mfma_f32_16x16x32_bf16 a[136:139], v[76:79], v[76:79], 0
  v_mfma_f32_16x16x32_bf16 a[140:143], v[76:79], v[76:79], 0
  v_mfma_f32_16x16x32_bf16 a[144:147], v[76:79], v[76:79], 0
  v_mfma_f32_16x16x32_bf16 a[148:151], v[76:79], v[76:79], 0
  v_mfma_f32_16x16x32_bf16 a[152:155], v[76:79], v[76:79], 0
  v_mfma_f32_16x16x32_bf16 a[156:159], v[76:79], v[76:79], 0
  s_mov_b32 s34, 0xff800000
  s_mov_b32 s35, 0xff800000
  s_mov_b32 s36, 0xff800000
  s_mov_b32 s37, 0xff800000
  s_mov_b32 s38, 0xff800000
  s_waitcnt vmcnt(16)
  s_barrier
  v_add_u32 v28, s32, v20
  v_add_u32 v29, s32, v21
  v_add_u32 v30, s32, v22
  v_add_u32 v31, s32, v23
  v_add_u32 v32, s32, v24
  v_add_u32 v33, s32, v25
  v_add_u32 v34, s32, v26
  v_add_u32 v35, s32, v27
  s_add_u32 s32, s32, 32768
  s_cmp_eq_u32 s32, 98304
  s_cselect_b32 s32, 0, s32
  ds_read_b128 v[120:123], v28 offset:0
  ds_read_b128 v[124:127], v29 offset:0
  ds_read_b128 v[128:131], v30 offset:0
  ds_read_b128 v[132:135], v31 offset:0
  ds_read_b128 v[136:139], v28 offset:4096
  ds_read_b128 v[140:143], v29 offset:4096
  ds_read_b128 v[144:147], v30 offset:4096
  ds_read_b128 v[148:151], v31 offset:4096
  ds_read_b64_tr_b16 v[152:153], v32 offset:0
  ds_read_b64_tr_b16 v[154:155], v32 offset:4096
  ds_read_b64_tr_b16 v[156:157], v32 offset:8
  ds_read_b64_tr_b16 v[158:159], v32 offset:4104
  ds_read_b64_tr_b16 v[160:161], v33 offset:0
  ds_read_b64_tr_b16 v[162:163], v33 offset:4096
  ds_read_b64_tr_b16 v[164:165], v33 offset:8
  s_waitcnt lgkmcnt(14)
  ds_read_b64_tr_b16 v[166:167], v33 offset:4104
  s_waitcnt lgkmcnt(14)
  ds_read_b64_tr_b16 v[168:169], v34 offset:0
  s_waitcnt lgkmcnt(14)
  ds_read_b64_tr_b16 v[170:171], v34 offset:4096
  s_waitcnt lgkmcnt(14)
  ds_read_b64_tr_b16 v[172:173], v34 offset:8
  s_waitcnt lgkmcnt(14)
  ds_read_b64_tr_b16 v[174:175], v34 offset:4104
  s_waitcnt lgkmcnt(14)
  ds_read_b64_tr_b16 v[176:177], v35 offset:0
  s_waitcnt lgkmcnt(14)
  ds_read_b64_tr_b16 v[178:179], v35 offset:4096
  s_waitcnt lgkmcnt(14)
  ds_read_b64_tr_b16 v[180:181], v35 offset:8
  s_waitcnt lgkmcnt(14)
  ds_read_b64_tr_b16 v[182:183], v35 offset:4104
  v_add_u32 v28, s32, v20
  v_add_u32 v29, s32, v21
  v_add_u32 v30, s32, v22
  v_add_u32 v31, s32, v23
  v_add_u32 v252, s32, v24
  v_add_u32 v253, s32, v25
  v_add_u32 v254, s32, v26
  v_add_u32 v255, s32, v27
  s_add_u32 s32, s32, 32768
  s_cmp_eq_u32 s32, 98304
  s_cselect_b32 s32, 0, s32
  v_mfma_f32_16x16x32_bf16 v[96:99], v[120:123], a[160:163], v[56:59]
  v_mfma_f32_16x16x32_bf16 v[96:99], v[124:127], a[164:167], v[96:99]
  v_mfma_f32_16x16x32_bf16 v[96:99], v[128:131], a[168:171], v[96:99]
  v_mfma_f32_16x16x32_bf16 v[96:99], v[132:135], a[172:175], v[96:99]
  v_mfma_f32_16x16x32_bf16 v[100:103], v[136:139], a[160:163], v[56:59]
  v_mfma_f32_16x16x32_bf16 v[100:103], v[140:143], a[164:167], v[100:103]
  v_mfma_f32_16x16x32_bf16 v[100:103], v[144:147], a[168:171], v[100:103]
  v_mfma_f32_16x16x32_bf16 v[100:103], v[148:151], a[172:175], v[100:103]
  v_mfma_f32_16x16x32_bf16 v[104:107], v[120:123], a[176:179], v[60:63]
  v_mfma_f32_16x16x32_bf16 v[104:107], v[124:127], a[180:183], v[104:107]
  v_mfma_f32_16x16x32_bf16 v[104:107], v[128:131], a[184:187], v[104:107]
  v_mfma_f32_16x16x32_bf16 v[104:107], v[132:135], a[188:191], v[104:107]
  v_mfma_f32_16x16x32_bf16 v[108:111], v[136:139], a[176:179], v[60:63]
  v_mfma_f32_16x16x32_bf16 v[108:111], v[140:143], a[180:183], v[108:111]
  v_mfma_f32_16x16x32_bf16 v[108:111], v[144:147], a[184:187], v[108:111]
  v_mfma_f32_16x16x32_bf16 v[108:111], v[148:151], a[188:191], v[108:111]
  v_mfma_f32_16x16x32_bf16 v[112:115], v[120:123], a[192:195], v[64:67]
  v_mfma_f32_16x16x32_bf16 v[112:115], v[124:127], a[196:199], v[112:115]
  v_mfma_f32_16x16x32_bf16 v[112:115], v[128:131], a[200:203], v[112:115]
  v_mfma_f32_16x16x32_bf16 v[112:115], v[132:135], a[204:207], v[112:115]
  v_mfma_f32_16x16x32_bf16 v[116:119], v[136:139], a[192:195], v[64:67]
  v_mfma_f32_16x16x32_bf16 v[116:119], v[140:143], a[196:199], v[116:119]
  v_mfma_f32_16x16x32_bf16 v[116:119], v[144:147], a[200:203], v[116:119]
  v_mfma_f32_16x16x32_bf16 v[116:119], v[148:151], a[204:207], v[116:119]
  v_max3_f32 v48, v96, v97, v98
  v_max3_f32 v48, v48, v99, v100
  v_max3_f32 v48, v48, v101, v102
  v_max_f32 v48, v48, v103
  v_cmp_lt_f32 vcc, s34, v48
  s_nop 3
  s_cbranch_vccnz fa_kernel_rare39
fa_kernel_back39:
  v_exp_f32 v96, v96
  v_exp_f32 v97, v97
  v_exp_f32 v98, v98
  v_cvt_pk_bf16_f32 v36, v96, v97
  v_exp_f32 v99, v99
  v_exp_f32 v100, v100
  v_cvt_pk_bf16_f32 v37, v98, v99
  v_exp_f32 v101, v101
  v_exp_f32 v102, v102
  v_cvt_pk_bf16_f32 v38, v100, v101
  v_exp_f32 v103, v103
  s_nop 0
  v_cvt_pk_bf16_f32 v39, v102, v103
  v_max3_f32 v48, v104, v105, v106
  v_max3_f32 v48, v48, v107, v108
  v_max3_f32 v48, v48, v109, v110
  v_max_f32 v48, v48, v111
  v_cmp_lt_f32 vcc, s35, v48
  s_waitcnt lgkmcnt(0)
  s_mov_b32 s33, 7
fa_kernel_atc:
  s_waitcnt vmcnt(8) lgkmcnt(0)
  s_barrier
  s_cbranch_vccnz fa_kernel_rare40
fa_kernel_back40:
  v_mfma_f32_16x16x32_bf16 v[96:99], v[120:123], a[208:211], v[68:71]
  v_exp_f32 v104, v104
  v_mfma_f32_16x16x32_bf16 v[96:99], v[124:127], a[212:215], v[96:99]
  v_max3_f32 v48, v112, v113, v114
  ds_read_b128 v[184:187], v28 offset:0
  v_mfma_f32_16x16x32_bf16 v[96:99], v[128:131], a[216:219], v[96:99]
  v_exp_f32 v105, v105
  v_mfma_f32_16x16x32_bf16 v[96:99], v[132:135], a[220:223], v[96:99]
  v_max3_f32 v48, v48, v115, v116
  ds_read_b128 v[188:191], v29 offset:0
  v_mfma_f32_16x16x32_bf16 v[100:103], v[136:139], a[208:211], v[68:71]
  v_exp_f32 v106, v106
  v_mfma_f32_16x16x32_bf16 v[100:103], v[140:143], a[212:215], v[100:103]
  v_max3_f32 v48, v48, v117, v118
  ds_read_b128 v[192:195], v30 offset:0
  v_mfma_f32_16x16x32_bf16 v[100:103], v[144:147], a[216:219], v[100:103]
  v_cvt_pk_bf16_f32 v40, v104, v105
  ds_read_b128 v[196:199], v31 offset:0
  v_mfma_f32_16x16x32_bf16 v[100:103], v[148:151], a[220:223], v[100:103]
  v_max_f32 v48, v48, v119
  ds_read_b128 v[200:203], v28 offset:4096
  v_mfma_f32_16x16x32_bf16 a[0:3], v[152:155], v[36:39], a[0:3]
  v_exp_f32 v107, v107
  v_mfma_f32_16x16x32_bf16 a[4:7], v[156:159], v[36:39], a[4:7]
  v_cmp_lt_f32 vcc, s36, v48
  ds_read_b128 v[204:207], v29 offset:4096
  v_mfma_f32_16x16x32_bf16 a[8:11], v[160:163], v[36:39], a[8:11]
  v_exp_f32 v108, v108
  v_mfma_f32_16x16x32_bf16 a[12:15], v[164:167], v[36:39], a[12:15]
  v_cvt_pk_bf16_f32 v41, v106, v107
  ds_read_b128 v[208:211], v30 offset:4096
  v_mfma_f32_16x16x32_bf16 a[16:19], v[168:171], v[36:39], a[16:19]
  v_exp_f32 v109, v109
  v_mfma_f32_16x16x32_bf16 a[20:23], v[172:175], v[36:39], a[20:23]
  v_exp_f32 v110, v110
  v_mfma_f32_16x16x32_bf16 a[24:27], v[176:179], v[36:39], a[24:27]
  v_cvt_pk_bf16_f32 v42, v108, v109
  ds_read_b128 v[212:215], v31 offset:4096
  v_mfma_f32_16x16x32_bf16 a[28:31], v[180:183], v[36:39], a[28:31]
  v_exp_f32 v111, v111
  s_mov_b32 m0, s31
  v_mfma_f32_16x16x32_bf16 v[76:79], v[52:55], v[36:39], v[76:79]
  v_cvt_pk_bf16_f32 v43, v110, v111
  buffer_load_dwordx4 v10, s[8:11], s41 offen offset:0 nt lds
  s_cbranch_vccnz fa_kernel_rare41
fa_kernel_back41:
  v_mfma_f32_16x16x32_bf16 v[104:107], v[120:123], a[224:227], v[72:75]
  v_exp_f32 v112, v112
  v_mfma_f32_16x16x32_bf16 v[104:107], v[124:127], a[228:231], v[104:107]
  v_max3_f32 v48, v96, v97, v98
  ds_read_b64_tr_b16 v[216:217], v252 offset:0
  v_mfma_f32_16x16x32_bf16 v[104:107], v[128:131], a[232:235], v[104:107]
  v_exp_f32 v113, v113
  v_mfma_f32_16x16x32_bf16 v[104:107], v[132:135], a[236:239], v[104:107]
  v_max3_f32 v48, v48, v99, v100
  ds_read_b64_tr_b16 v[218:219], v252 offset:4096
  v_mfma_f32_16x16x32_bf16 v[108:111], v[136:139], a[224:227], v[72:75]
  v_exp_f32 v114, v114
  v_mfma_f32_16x16x32_bf16 v[108:111], v[140:143], a[228:231], v[108:111]
  v_max3_f32 v48, v48, v101, v102
  ds_read_b64_tr_b16 v[220:221], v252 offset:8
  v_mfma_f32_16x16x32_bf16 v[108:111], v[144:147], a[232:235], v[108:111]
  v_cvt_pk_bf16_f32 v44, v112, v113
  ds_read_b64_tr_b16 v[222:223], v252 offset:4104
  v_mfma_f32_16x16x32_bf16 v[108:111], v[148:151], a[236:239], v[108:111]
  v_max_f32 v48, v48, v103
  ds_read_b64_tr_b16 v[224:225], v253 offset:0
  v_mfma_f32_16x16x32_bf16 a[32:35], v[152:155], v[40:43], a[32:35]
  v_exp_f32 v115, v115
  v_mfma_f32_16x16x32_bf16 a[36:39], v[156:159], v[40:43], a[36:39]
  v_cmp_lt_f32 vcc, s37, v48
  ds_read_b64_tr_b16 v[226:227], v253 offset:4096
  v_mfma_f32_16x16x32_bf16 a[40:43], v[160:163], v[40:43], a[40:43]
  v_exp_f32 v116, v116
  v_mfma_f32_16x16x32_bf16 a[44:47], v[164:167], v[40:43], a[44:47]
  v_cvt_pk_bf16_f32 v45, v114, v115
  buffer_load_dwordx4 v11, s[8:11], s41 offen offset:1024 nt lds
  v_mfma_f32_16x16x32_bf16 a[48:51], v[168:171], v[40:43], a[48:51]
  v_exp_f32 v117, v117
  v_mfma_f32_16x16x32_bf16 a[52:55], v[172:175], v[40:43], a[52:55]
  v_exp_f32 v118, v118
  v_mfma_f32_16x16x32_bf16 a[56:59], v[176:179], v[40:43], a[56:59]
  v_cvt_pk_bf16_f32 v46, v116, v117
  buffer_load_dwordx4 v12, s[8:11], s41 offen offset:2048 nt lds
  v_mfma_f32_16x16x32_bf16 a[60:63], v[180:183], v[40:43], a[60:63]
  v_exp_f32 v119, v119
  v_mfma_f32_16x16x32_bf16 v[80:83], v[52:55], v[40:43], v[80:83]
  v_cvt_pk_bf16_f32 v47, v118, v119
  buffer_load_dwordx4 v13, s[8:11], s41 offen offset:3072 nt lds
  s_cbranch_vccnz fa_kernel_rare42
fa_kernel_back42:
  s_waitcnt lgkmcnt(6)
  v_mfma_f32_16x16x32_bf16 v[112:115], v[184:187], a[160:163], v[56:59]
  v_exp_f32 v96, v96
  v_add_u32 v30, s32, v22
  v_mfma_f32_16x16x32_bf16 v[112:115], v[188:191], a[164:167], v[112:115]
  v_max3_f32 v48, v104, v105, v106
  ds_read_b64_tr_b16 v[228:229], v253 offset:8
  v_mfma_f32_16x16x32_bf16 v[112:115], v[192:195], a[168:171], v[112:115]
  v_exp_f32 v97, v97
  v_add_u32 v31, s32, v23
  v_mfma_f32_16x16x32_bf16 v[112:115], v[196:199], a[172:175], v[112:115]
  v_max3_f32 v48, v48, v107, v108
  ds_read_b64_tr_b16 v[230:231], v253 offset:4104
  v_mfma_f32_16x16x32_bf16 v[116:119], v[200:203], a[160:163], v[56:59]
  v_exp_f32 v98, v98
  v_mfma_f32_16x16x32_bf16 v[116:119], v[204:207], a[164:167], v[116:119]
  v_max3_f32 v48, v48, v109, v110
  ds_read_b64_tr_b16 v[232:233], v254 offset:0
  v_mfma_f32_16x16x32_bf16 v[116:119], v[208:211], a[168:171], v[116:119]
  v_cvt_pk_bf16_f32 v36, v96, v97
  ds_read_b64_tr_b16 v[234:235], v254 offset:4096
  v_mfma_f32_16x16x32_bf16 v[116:119], v[212:215], a[172:175], v[116:119]
  v_max_f32 v48, v48, v111
  v_add_u32 v28, s32, v20
  v_mfma_f32_16x16x32_bf16 a[64:67], v[152:155], v[44:47], a[64:67]
  v_exp_f32 v99, v99
  v_mfma_f32_16x16x32_bf16 a[68:71], v[156:159], v[44:47], a[68:71]
  v_cmp_lt_f32 vcc, s38, v48
  ds_read_b64_tr_b16 v[236:237], v254 offset:8
  v_mfma_f32_16x16x32_bf16 a[72:75], v[160:163], v[44:47], a[72:75]
  v_exp_f32 v100, v100
  s_add_u32 m0, s31, 4096
  v_mfma_f32_16x16x32_bf16 a[76:79], v[164:167], v[44:47], a[76:79]
  v_cvt_pk_bf16_f32 v37, v98, v99
  buffer_load_dwordx4 v248, s[8:11], s41 offen offset:0 nt lds
  v_mfma_f32_16x16x32_bf16 a[80:83], v[168:171], v[44:47], a[80:83]
  v_exp_f32 v101, v101
  v_mfma_f32_16x16x32_bf16 a[84:87], v[172:175], v[44:47], a[84:87]
  v_exp_f32 v102, v102
  v_mfma_f32_16x16x32_bf16 a[88:91], v[176:179], v[44:47], a[88:91]
  v_cvt_pk_bf16_f32 v38, v100, v101
  buffer_load_dwordx4 v249, s[8:11], s41 offen offset:1024 nt lds
  v_mfma_f32_16x16x32_bf16 a[92:95], v[180:183], v[44:47], a[92:95]
  v_exp_f32 v103, v103
  v_mfma_f32_16x16x32_bf16 v[84:87], v[52:55], v[44:47], v[84:87]
  v_cvt_pk_bf16_f32 v39, v102, v103
  v_add_u32 v29, s32, v21
  s_cbranch_vccnz fa_kernel_rare43
fa_kernel_back43:
  v_mfma_f32_16x16x32_bf16 v[96:99], v[184:187], a[176:179], v[60:63]
  v_exp_f32 v104, v104
  v_add_u32 v34, s32, v26
  v_mfma_f32_16x16x32_bf16 v[96:99], v[188:191], a[180:183], v[96:99]
  v_max3_f32 v48, v112, v113, v114
  buffer_load_dwordx4 v250, s[8:11], s41 offen offset:2048 nt lds
  v_mfma_f32_16x16x32_bf16 v[96:99], v[192:195], a[184:187], v[96:99]
  v_exp_f32 v105, v105
  v_add_u32 v35, s32, v27
  v_mfma_f32_16x16x32_bf16 v[96:99], v[196:199], a[188:191], v[96:99]
  v_max3_f32 v48, v48, v115, v116
  buffer_load_dwordx4 v251, s[8:11], s41 offen offset:3072 nt lds
  v_mfma_f32_16x16x32_bf16 v[100:103], v[200:203], a[176:179], v[60:63]
  v_exp_f32 v106, v106
  s_add_u32 s41, s41, 16384
  s_add_u32 s31, s31, 32768
  s_cmp_eq_u32 s31, s30
  s_cselect_b32 s31, s42, s31
  v_mfma_f32_16x16x32_bf16 v[100:103], v[204:207], a[180:183], v[100:103]
  v_max3_f32 v48, v48, v117, v118
  ds_read_b64_tr_b16 v[238:239], v254 offset:4104
  v_mfma_f32_16x16x32_bf16 v[100:103], v[208:211], a[184:187], v[100:103]
  v_cvt_pk_bf16_f32 v40, v104, v105
  ds_read_b64_tr_b16 v[240:241], v255 offset:0
  v_mfma_f32_16x16x32_bf16 v[100:103], v[212:215], a[188:191], v[100:103]
  v_max_f32 v48, v48, v119
  v_add_u32 v32, s32, v24
  v_mfma_f32_16x16x32_bf16 a[96:99], v[152:155], v[36:39], a[96:99]
  v_exp_f32 v107, v107
  v_mfma_f32_16x16x32_bf16 a[100:103], v[156:159], v[36:39], a[100:103]
  v_cmp_lt_f32 vcc, s34, v48
  ds_read_b64_tr_b16 v[242:243], v255 offset:4096
  v_mfma_f32_16x16x32_bf16 a[104:107], v[160:163], v[36:39], a[104:107]
  v_exp_f32 v108, v108
  v_mfma_f32_16x16x32_bf16 a[108:111], v[164:167], v[36:39], a[108:111]
  v_cvt_pk_bf16_f32 v41, v106, v107
  ds_read_b64_tr_b16 v[244:245], v255 offset:8
  v_mfma_f32_16x16x32_bf16 a[112:115], v[168:171], v[36:39], a[112:115]
  v_exp_f32 v109, v109
  v_mfma_f32_16x16x32_bf16 a[116:119], v[172:175], v[36:39], a[116:119]
  v_exp_f32 v110, v110
  v_mfma_f32_16x16x32_bf16 a[120:123], v[176:179], v[36:39], a[120:123]
  v_cvt_pk_bf16_f32 v42, v108, v109
  s_waitcnt lgkmcnt(4)
  ds_read_b64_tr_b16 v[246:247], v255 offset:4104
  v_mfma_f32_16x16x32_bf16 a[124:127], v[180:183], v[36:39], a[124:127]
  v_exp_f32 v111, v111
  v_mfma_f32_16x16x32_bf16 v[88:91], v[52:55], v[36:39], v[88:91]
  v_cvt_pk_bf16_f32 v43, v110, v111
  v_add_u32 v33, s32, v25
  s_add_u32 s32, s32, 32768
  s_cmp_eq_u32 s32, 98304
  s_cselect_b32 s32, 0, s32
  s_waitcnt vmcnt(8) lgkmcnt(0)
  s_barrier
  s_cbranch_vccnz fa_kernel_rare44
fa_kernel_back44:
  v_mfma_f32_16x16x32_bf16 v[104:107], v[184:187], a[192:195], v[64:67]
  v_exp_f32 v112, v112
  v_mfma_f32_16x16x32_bf16 v[104:107], v[188:191], a[196:199], v[104:107]
  v_max3_f32 v48, v96, v97, v98
  ds_read_b128 v[120:123], v28 offset:0
  v_mfma_f32_16x16x32_bf16 v[104:107], v[192:195], a[200:203], v[104:107]
  v_exp_f32 v113, v113
  v_mfma_f32_16x16x32_bf16 v[104:107], v[196:199], a[204:207], v[104:107]
  v_max3_f32 v48, v48, v99, v100
  ds_read_b128 v[124:127], v29 offset:0
  v_mfma_f32_16x16x32_bf16 v[108:111], v[200:203], a[192:195], v[64:67]
  v_exp_f32 v114, v114
  v_mfma_f32_16x16x32_bf16 v[108:111], v[204:207], a[196:199], v[108:111]
  v_max3_f32 v48, v48, v101, v102
  ds_read_b128 v[128:131], v30 offset:0
  v_mfma_f32_16x16x32_bf16 v[108:111], v[208:211], a[200:203], v[108:111]
  v_cvt_pk_bf16_f32 v44, v112, v113
  ds_read_b128 v[132:135], v31 offset:0
  v_mfma_f32_16x16x32_bf16 v[108:111], v[212:215], a[204:207], v[108:111]
  v_max_f32 v48, v48, v103
  ds_read_b128 v[136:139], v28 offset:4096
  v_mfma_f32_16x16x32_bf16 a[128:131], v[152:155], v[40:43], a[128:131]
  v_exp_f32 v115, v115
  v_mfma_f32_16x16x32_bf16 a[132:135], v[156:159], v[40:43], a[132:135]
  v_cmp_lt_f32 vcc, s35, v48
  ds_read_b128 v[140:143], v29 offset:4096
  v_mfma_f32_16x16x32_bf16 a[136:139], v[160:163], v[40:43], a[136:139]
  v_exp_f32 v116, v116
  v_mfma_f32_16x16x32_bf16 a[140:143], v[164:167], v[40:43], a[140:143]
  v_cvt_pk_bf16_f32 v45, v114, v115
  ds_read_b128 v[144:147], v30 offset:4096
  v_mfma_f32_16x16x32_bf16 a[144:147], v[168:171], v[40:43], a[144:147]
  v_exp_f32 v117, v117
  v_mfma_f32_16x16x32_bf16 a[148:151], v[172:175], v[40:43], a[148:151]
  v_exp_f32 v118, v118
  v_mfma_f32_16x16x32_bf16 a[152:155], v[176:179], v[40:43], a[152:155]
  v_cvt_pk_bf16_f32 v46, v116, v117
  ds_read_b128 v[148:151], v31 offset:4096
  v_mfma_f32_16x16x32_bf16 a[156:159], v[180:183], v[40:43], a[156:159]
  v_exp_f32 v119, v119
  s_mov_b32 m0, s31
  v_mfma_f32_16x16x32_bf16 v[92:95], v[52:55], v[40:43], v[92:95]
  v_cvt_pk_bf16_f32 v47, v118, v119
  buffer_load_dwordx4 v10, s[8:11], s41 offen offset:0 nt lds
  s_cbranch_vccnz fa_kernel_rare45
fa_kernel_back45:
  v_mfma_f32_16x16x32_bf16 v[112:115], v[184:187], a[208:211], v[68:71]
  v_exp_f32 v96, v96
  v_mfma_f32_16x16x32_bf16 v[112:115], v[188:191], a[212:215], v[112:115]
  v_max3_f32 v48, v104, v105, v106
  ds_read_b64_tr_b16 v[152:153], v32 offset:0
  v_mfma_f32_16x16x32_bf16 v[112:115], v[192:195], a[216:219], v[112:115]
  v_exp_f32 v97, v97
  v_mfma_f32_16x16x32_bf16 v[112:115], v[196:199], a[220:223], v[112:115]
  v_max3_f32 v48, v48, v107, v108
  ds_read_b64_tr_b16 v[154:155], v32 offset:4096
  v_mfma_f32_16x16x32_bf16 v[116:119], v[200:203], a[208:211], v[68:71]
  v_exp_f32 v98, v98
  v_mfma_f32_16x16x32_bf16 v[116:119], v[204:207], a[212:215], v[116:119]
  v_max3_f32 v48, v48, v109, v110
  ds_read_b64_tr_b16 v[156:157], v32 offset:8
  v_mfma_f32_16x16x32_bf16 v[116:119], v[208:211], a[216:219], v[116:119]
  v_cvt_pk_bf16_f32 v36, v96, v97
  ds_read_b64_tr_b16 v[158:159], v32 offset:4104
  v_mfma_f32_16x16x32_bf16 v[116:119], v[212:215], a[220:223], v[116:119]
  v_max_f32 v48, v48, v111
  ds_read_b64_tr_b16 v[160:161], v33 offset:0
  v_mfma_f32_16x16x32_bf16 a[0:3], v[216:219], v[44:47], a[0:3]
  v_exp_f32 v99, v99
  v_mfma_f32_16x16x32_bf16 a[4:7], v[220:223], v[44:47], a[4:7]
  v_cmp_lt_f32 vcc, s36, v48
  buffer_load_dwordx4 v11, s[8:11], s41 offen offset:1024 nt lds
  v_mfma_f32_16x16x32_bf16 a[8:11], v[224:227], v[44:47], a[8:11]
  v_exp_f32 v100, v100
  v_mfma_f32_16x16x32_bf16 a[12:15], v[228:231], v[44:47], a[12:15]
  v_cvt_pk_bf16_f32 v37, v98, v99
  buffer_load_dwordx4 v12, s[8:11], s41 offen offset:2048 nt lds
  v_mfma_f32_16x16x32_bf16 a[16:19], v[232:235], v[44:47], a[16:19]
  v_exp_f32 v101, v101
  v_mfma_f32_16x16x32_bf16 a[20:23], v[236:239], v[44:47], a[20:23]
  v_exp_f32 v102, v102
  v_mfma_f32_16x16x32_bf16 a[24:27], v[240:243], v[44:47], a[24:27]
  v_cvt_pk_bf16_f32 v38, v100, v101
  buffer_load_dwordx4 v13, s[8:11], s41 offen offset:3072 nt lds
  v_mfma_f32_16x16x32_bf16 a[28:31], v[244:247], v[44:47], a[28:31]
  v_exp_f32 v103, v103
  v_mfma_f32_16x16x32_bf16 v[76:79], v[52:55], v[44:47], v[76:79]
  v_cvt_pk_bf16_f32 v39, v102, v103
  s_cbranch_vccnz fa_kernel_rare46
fa_kernel_back46:
  s_waitcnt lgkmcnt(5)
  v_mfma_f32_16x16x32_bf16 v[96:99], v[120:123], a[160:163], v[56:59]
  v_exp_f32 v104, v104
  v_add_u32 v30, s32, v22
  v_mfma_f32_16x16x32_bf16 v[96:99], v[124:127], a[164:167], v[96:99]
  v_max3_f32 v48, v112, v113, v114
  ds_read_b64_tr_b16 v[162:163], v33 offset:4096
  v_mfma_f32_16x16x32_bf16 v[96:99], v[128:131], a[168:171], v[96:99]
  v_exp_f32 v105, v105
  v_add_u32 v31, s32, v23
  v_mfma_f32_16x16x32_bf16 v[96:99], v[132:135], a[172:175], v[96:99]
  v_max3_f32 v48, v48, v115, v116
  ds_read_b64_tr_b16 v[164:165], v33 offset:8
  v_mfma_f32_16x16x32_bf16 v[100:103], v[136:139], a[160:163], v[56:59]
  v_exp_f32 v106, v106
  v_mfma_f32_16x16x32_bf16 v[100:103], v[140:143], a[164:167], v[100:103]
  v_max3_f32 v48, v48, v117, v118
  ds_read_b64_tr_b16 v[166:167], v33 offset:4104
  v_mfma_f32_16x16x32_bf16 v[100:103], v[144:147], a[168:171], v[100:103]
  v_cvt_pk_bf16_f32 v40, v104, v105
  ds_read_b64_tr_b16 v[168:169], v34 offset:0
  v_mfma_f32_16x16x32_bf16 v[100:103], v[148:151], a[172:175], v[100:103]
  v_max_f32 v48, v48, v119
  v_add_u32 v28, s32, v20
  v_mfma_f32_16x16x32_bf16 a[32:35], v[216:219], v[36:39], a[32:35]
  v_exp_f32 v107, v107
  v_mfma_f32_16x16x32_bf16 a[36:39], v[220:223], v[36:39], a[36:39]
  v_cmp_lt_f32 vcc, s37, v48
  ds_read_b64_tr_b16 v[170:171], v34 offset:4096
  v_mfma_f32_16x16x32_bf16 a[40:43], v[224:227], v[36:39], a[40:43]
  v_exp_f32 v108, v108
  s_add_u32 m0, s31, 4096
  v_mfma_f32_16x16x32_bf16 a[44:47], v[228:231], v[36:39], a[44:47]
  v_cvt_pk_bf16_f32 v41, v106, v107
  buffer_load_dwordx4 v248, s[8:11], s41 offen offset:0 nt lds
  v_mfma_f32_16x16x32_bf16 a[48:51], v[232:235], v[36:39], a[48:51]
  v_exp_f32 v109, v109
  v_mfma_f32_16x16x32_bf16 a[52:55], v[236:239], v[36:39], a[52:55]
  v_exp_f32 v110, v110
  v_mfma_f32_16x16x32_bf16 a[56:59], v[240:243], v[36:39], a[56:59]
  v_cvt_pk_bf16_f32 v42, v108, v109
  buffer_load_dwordx4 v249, s[8:11], s41 offen offset:1024 nt lds
  v_mfma_f32_16x16x32_bf16 a[60:63], v[244:247], v[36:39], a[60:63]
  v_exp_f32 v111, v111
  v_mfma_f32_16x16x32_bf16 v[80:83], v[52:55], v[36:39], v[80:83]
  v_cvt_pk_bf16_f32 v43, v110, v111
  v_add_u32 v29, s32, v21
  s_cbranch_vccnz fa_kernel_rare47
fa_kernel_back47:
  v_mfma_f32_16x16x32_bf16 v[104:107], v[120:123], a[176:179], v[60:63]
  v_exp_f32 v112, v112
  v_add_u32 v253, s32, v25
  v_mfma_f32_16x16x32_bf16 v[104:107], v[124:127], a[180:183], v[104:107]
  v_max3_f32 v48, v96, v97, v98
  buffer_load_dwordx4 v250, s[8:11], s41 offen offset:2048 nt lds
  v_mfma_f32_16x16x32_bf16 v[104:107], v[128:131], a[184:187], v[104:107]
  v_exp_f32 v113, v113
  v_add_u32 v254, s32, v26
  v_mfma_f32_16x16x32_bf16 v[104:107], v[132:135], a[188:191], v[104:107]
  v_max3_f32 v48, v48, v99, v100
  buffer_load_dwordx4 v251, s[8:11], s41 offen offset:3072 nt lds
  v_mfma_f32_16x16x32_bf16 v[108:111], v[136:139], a[176:179], v[60:63]
  v_exp_f32 v114, v114
  v_add_u32 v255, s32, v27
  v_mfma_f32_16x16x32_bf16 v[108:111], v[140:143], a[180:183], v[108:111]
  v_max3_f32 v48, v48, v101, v102
  ds_read_b64_tr_b16 v[172:173], v34 offset:8
  v_mfma_f32_16x16x32_bf16 v[108:111], v[144:147], a[184:187], v[108:111]
  v_cvt_pk_bf16_f32 v44, v112, v113
  ds_read_b64_tr_b16 v[174:175], v34 offset:4104
  v_mfma_f32_16x16x32_bf16 v[108:111], v[148:151], a[188:191], v[108:111]
  v_max_f32 v48, v48, v103
  ds_read_b64_tr_b16 v[176:177], v35 offset:0
  v_mfma_f32_16x16x32_bf16 a[64:67], v[216:219], v[40:43], a[64:67]
  v_exp_f32 v115, v115
  v_mfma_f32_16x16x32_bf16 a[68:71], v[220:223], v[40:43], a[68:71]
  v_cmp_lt_f32 vcc, s34, v48
  ds_read_b64_tr_b16 v[178:179], v35 offset:4096
  v_mfma_f32_16x16x32_bf16 a[72:75], v[224:227], v[40:43], a[72:75]
  v_exp_f32 v116, v116
  v_mfma_f32_16x16x32_bf16 a[76:79], v[228:231], v[40:43], a[76:79]
  v_cvt_pk_bf16_f32 v45, v114, v115
  ds_read_b64_tr_b16 v[180:181], v35 offset:8
  v_mfma_f32_16x16x32_bf16 a[80:83], v[232:235], v[40:43], a[80:83]
  v_exp_f32 v117, v117
  v_mfma_f32_16x16x32_bf16 a[84:87], v[236:239], v[40:43], a[84:87]
  v_exp_f32 v118, v118
  v_mfma_f32_16x16x32_bf16 a[88:91], v[240:243], v[40:43], a[88:91]
  v_cvt_pk_bf16_f32 v46, v116, v117
  s_waitcnt lgkmcnt(5)
  ds_read_b64_tr_b16 v[182:183], v35 offset:4104
  v_mfma_f32_16x16x32_bf16 a[92:95], v[244:247], v[40:43], a[92:95]
  v_exp_f32 v119, v119
  v_mfma_f32_16x16x32_bf16 v[84:87], v[52:55], v[40:43], v[84:87]
  v_cvt_pk_bf16_f32 v47, v118, v119
  v_add_u32 v252, s32, v24
  s_cbranch_vccnz fa_kernel_rare48
fa_kernel_back48:
  v_mfma_f32_16x16x32_bf16 v[112:115], v[120:123], a[192:195], v[64:67]
  v_exp_f32 v96, v96
  s_add_u32 s32, s32, 32768
  s_cmp_eq_u32 s32, 98304
  s_cselect_b32 s32, 0, s32
  v_mfma_f32_16x16x32_bf16 v[112:115], v[124:127], a[196:199], v[112:115]
  v_max3_f32 v48, v104, v105, v106
  s_add_u32 s41, s41, 16384
  s_add_u32 s31, s31, 32768
  s_cmp_eq_u32 s31, s30
  s_cselect_b32 s31, s42, s31
  v_mfma_f32_16x16x32_bf16 v[112:115], v[128:131], a[200:203], v[112:115]
  v_exp_f32 v97, v97
  v_mfma_f32_16x16x32_bf16 v[112:115], v[132:135], a[204:207], v[112:115]
  v_max3_f32 v48, v48, v107, v108
  v_mfma_f32_16x16x32_bf16 v[116:119], v[136:139], a[192:195], v[64:67]
  v_exp_f32 v98, v98
  v_mfma_f32_16x16x32_bf16 v[116:119], v[140:143], a[196:199], v[116:119]
  v_max3_f32 v48, v48, v109, v110
  v_mfma_f32_16x16x32_bf16 v[116:119], v[144:147], a[200:203], v[116:119]
  v_cvt_pk_bf16_f32 v36, v96, v97
  v_mfma_f32_16x16x32_bf16 v[116:119], v[148:151], a[204:207], v[116:119]
  v_max_f32 v48, v48, v111
  v_mfma_f32_16x16x32_bf16 a[96:99], v[216:219], v[44:47], a[96:99]
  v_exp_f32 v99, v99
  v_mfma_f32_16x16x32_bf16 a[100:103], v[220:223], v[44:47], a[100:103]
  v_cmp_lt_f32 vcc, s35, v48
  v_mfma_f32_16x16x32_bf16 a[104:107], v[224:227], v[44:47], a[104:107]
  v_exp_f32 v100, v100
  v_mfma_f32_16x16x32_bf16 a[108:111], v[228:231], v[44:47], a[108:111]
  v_cvt_pk_bf16_f32 v37, v98, v99
  v_mfma_f32_16x16x32_bf16 a[112:115], v[232:235], v[44:47], a[112:115]
  v_exp_f32 v101, v101
  v_mfma_f32_16x16x32_bf16 a[116:119], v[236:239], v[44:47], a[116:119]
  v_exp_f32 v102, v102
  v_mfma_f32_16x16x32_bf16 a[120:123], v[240:243], v[44:47], a[120:123]
  v_cvt_pk_bf16_f32 v38, v100, v101
  v_mfma_f32_16x16x32_bf16 a[124:127], v[244:247], v[44:47], a[124:127]
  v_exp_f32 v103, v103
  v_mfma_f32_16x16x32_bf16 v[88:91], v[52:55], v[44:47], v[88:91]
  v_cvt_pk_bf16_f32 v39, v102, v103
  s_sub_u32 s33, s33, 1
  s_cmp_lg_u32 s33, 0
  s_cbranch_scc1 fa_kernel_atc
  s_waitcnt vmcnt(8) lgkmcnt(0)
  s_barrier
  s_cbranch_vccnz fa_kernel_rare49
fa_kernel_back49:
  v_mfma_f32_16x16x32_bf16 v[96:99], v[120:123], a[208:211], v[68:71]
  v_exp_f32 v104, v104
  v_mfma_f32_16x16x32_bf16 v[96:99], v[124:127], a[212:215], v[96:99]
  v_max3_f32 v48, v112, v113, v114
  ds_read_b128 v[184:187], v28 offset:0
  v_mfma_f32_16x16x32_bf16 v[96:99], v[128:131], a[216:219], v[96:99]
  v_exp_f32 v105, v105
  v_mfma_f32_16x16x32_bf16 v[96:99], v[132:135], a[220:223], v[96:99]
  v_max3_f32 v48, v48, v115, v116
  ds_read_b128 v[188:191], v29 offset:0
  v_mfma_f32_16x16x32_bf16 v[100:103], v[136:139], a[208:211], v[68:71]
  v_exp_f32 v106, v106
  v_mfma_f32_16x16x32_bf16 v[100:103], v[140:143], a[212:215], v[100:103]
  v_max3_f32 v48, v48, v117, v118
  ds_read_b128 v[192:195], v30 offset:0
  v_mfma_f32_16x16x32_bf16 v[100:103], v[144:147], a[216:219], v[100:103]
  v_cvt_pk_bf16_f32 v40, v104, v105
  ds_read_b128 v[196:199], v31 offset:0
  v_mfma_f32_16x16x32_bf16 v[100:103], v[148:151], a[220:223], v[100:103]
  v_max_f32 v48, v48, v119
  ds_read_b128 v[200:203], v28 offset:4096
  v_mfma_f32_16x16x32_bf16 a[0:3], v[152:155], v[36:39], a[0:3]
  v_exp_f32 v107, v107
  v_mfma_f32_16x16x32_bf16 a[4:7], v[156:159], v[36:39], a[4:7]
  v_cmp_lt_f32 vcc, s36, v48
  ds_read_b128 v[204:207], v29 offset:4096
  v_mfma_f32_16x16x32_bf16 a[8:11], v[160:163], v[36:39], a[8:11]
  v_exp_f32 v108, v108
  v_mfma_f32_16x16x32_bf16 a[12:15], v[164:167], v[36:39], a[12:15]
  v_cvt_pk_bf16_f32 v41, v106, v107
  ds_read_b128 v[208:211], v30 offset:4096
  v_mfma_f32_16x16x32_bf16 a[16:19], v[168:171], v[36:39], a[16:19]
  v_exp_f32 v109, v109
  v_mfma_f32_16x16x32_bf16 a[20:23], v[172:175], v[36:39], a[20:23]
  v_exp_f32 v110, v110
  v_mfma_f32_16x16x32_bf16 a[24:27], v[176:179], v[36:39], a[24:27]
  v_cvt_pk_bf16_f32 v42, v108, v109
  ds_read_b128 v[212:215], v31 offset:4096
  v_mfma_f32_16x16x32_bf16 a[28:31], v[180:183], v[36:39], a[28:31]
  v_exp_f32 v111, v111
  s_mov_b32 m0, s31
  v_mfma_f32_16x16x32_bf16 v[76:79], v[52:55], v[36:39], v[76:79]
  v_cvt_pk_bf16_f32 v43, v110, v111
  buffer_load_dwordx4 v10, s[8:11], s41 offen offset:0 nt lds
  s_cbranch_vccnz fa_kernel_rare50
fa_kernel_back50:
  v_mfma_f32_16x16x32_bf16 v[104:107], v[120:123], a[224:227], v[72:75]
  v_exp_f32 v112, v112
  v_mfma_f32_16x16x32_bf16 v[104:107], v[124:127], a[228:231], v[104:107]
  v_max3_f32 v48, v96, v97, v98
  ds_read_b64_tr_b16 v[216:217], v252 offset:0
  v_mfma_f32_16x16x32_bf16 v[104:107], v[128:131], a[232:235], v[104:107]
  v_exp_f32 v113, v113
  v_mfma_f32_16x16x32_bf16 v[104:107], v[132:135], a[236:239], v[104:107]
  v_max3_f32 v48, v48, v99, v100
  ds_read_b64_tr_b16 v[218:219], v252 offset:4096
  v_mfma_f32_16x16x32_bf16 v[108:111], v[136:139], a[224:227], v[72:75]
  v_exp_f32 v114, v114
  v_mfma_f32_16x16x32_bf16 v[108:111], v[140:143], a[228:231], v[108:111]
  v_max3_f32 v48, v48, v101, v102
  ds_read_b64_tr_b16 v[220:221], v252 offset:8
  v_mfma_f32_16x16x32_bf16 v[108:111], v[144:147], a[232:235], v[108:111]
  v_cvt_pk_bf16_f32 v44, v112, v113
  ds_read_b64_tr_b16 v[222:223], v252 offset:4104
  v_mfma_f32_16x16x32_bf16 v[108:111], v[148:151], a[236:239], v[108:111]
  v_max_f32 v48, v48, v103
  ds_read_b64_tr_b16 v[224:225], v253 offset:0
  v_mfma_f32_16x16x32_bf16 a[32:35], v[152:155], v[40:43], a[32:35]
  v_exp_f32 v115, v115
  v_mfma_f32_16x16x32_bf16 a[36:39], v[156:159], v[40:43], a[36:39]
  v_cmp_lt_f32 vcc, s37, v48
  ds_read_b64_tr_b16 v[226:227], v253 offset:4096
  v_mfma_f32_16x16x32_bf16 a[40:43], v[160:163], v[40:43], a[40:43]
  v_exp_f32 v116, v116
  v_mfma_f32_16x16x32_bf16 a[44:47], v[164:167], v[40:43], a[44:47]
  v_cvt_pk_bf16_f32 v45, v114, v115
  buffer_load_dwordx4 v11, s[8:11], s41 offen offset:1024 nt lds
  v_mfma_f32_16x16x32_bf16 a[48:51], v[168:171], v[40:43], a[48:51]
  v_exp_f32 v117, v117
  v_mfma_f32_16x16x32_bf16 a[52:55], v[172:175], v[40:43], a[52:55]
  v_exp_f32 v118, v118
  v_mfma_f32_16x16x32_bf16 a[56:59], v[176:179], v[40:43], a[56:59]
  v_cvt_pk_bf16_f32 v46, v116, v117
  buffer_load_dwordx4 v12, s[8:11], s41 offen offset:2048 nt lds
  v_mfma_f32_16x16x32_bf16 a[60:63], v[180:183], v[40:43], a[60:63]
  v_exp_f32 v119, v119
  v_mfma_f32_16x16x32_bf16 v[80:83], v[52:55], v[40:43], v[80:83]
  v_cvt_pk_bf16_f32 v47, v118, v119
  buffer_load_dwordx4 v13, s[8:11], s41 offen offset:3072 nt lds
  s_cbranch_vccnz fa_kernel_rare51
fa_kernel_back51:
  s_waitcnt lgkmcnt(6)
  v_mfma_f32_16x16x32_bf16 v[112:115], v[184:187], a[160:163], v[56:59]
  v_exp_f32 v96, v96
  v_mfma_f32_16x16x32_bf16 v[112:115], v[188:191], a[164:167], v[112:115]
  v_max3_f32 v48, v104, v105, v106
  ds_read_b64_tr_b16 v[228:229], v253 offset:8
  v_mfma_f32_16x16x32_bf16 v[112:115], v[192:195], a[168:171], v[112:115]
  v_exp_f32 v97, v97
  v_mfma_f32_16x16x32_bf16 v[112:115], v[196:199], a[172:175], v[112:115]
  v_max3_f32 v48, v48, v107, v108
  ds_read_b64_tr_b16 v[230:231], v253 offset:4104
  v_mfma_f32_16x16x32_bf16 v[116:119], v[200:203], a[160:163], v[56:59]
  v_exp_f32 v98, v98
  v_mfma_f32_16x16x32_bf16 v[116:119], v[204:207], a[164:167], v[116:119]
  v_max3_f32 v48, v48, v109, v110
  ds_read_b64_tr_b16 v[232:233], v254 offset:0
  v_mfma_f32_16x16x32_bf16 v[116:119], v[208:211], a[168:171], v[116:119]
  v_cvt_pk_bf16_f32 v36, v96, v97
  ds_read_b64_tr_b16 v[234:235], v254 offset:4096
  v_mfma_f32_16x16x32_bf16 v[116:119], v[212:215], a[172:175], v[116:119]
  v_max_f32 v48, v48, v111
  v_mfma_f32_16x16x32_bf16 a[64:67], v[152:155], v[44:47], a[64:67]
  v_exp_f32 v99, v99
  v_mfma_f32_16x16x32_bf16 a[68:71], v[156:159], v[44:47], a[68:71]
  v_cmp_lt_f32 vcc, s38, v48
  ds_read_b64_tr_b16 v[236:237], v254 offset:8
  v_mfma_f32_16x16x32_bf16 a[72:75], v[160:163], v[44:47], a[72:75]
  v_exp_f32 v100, v100
  s_add_u32 m0, s31, 4096
  v_mfma_f32_16x16x32_bf16 a[76:79], v[164:167], v[44:47], a[76:79]
  v_cvt_pk_bf16_f32 v37, v98, v99
  buffer_load_dwordx4 v248, s[8:11], s41 offen offset:0 nt lds
  v_mfma_f32_16x16x32_bf16 a[80:83], v[168:171], v[44:47], a[80:83]
  v_exp_f32 v101, v101
  v_mfma_f32_16x16x32_bf16 a[84:87], v[172:175], v[44:47], a[84:87]
  v_exp_f32 v102, v102
  v_mfma_f32_16x16x32_bf16 a[88:91], v[176:179], v[44:47], a[88:91]
  v_cvt_pk_bf16_f32 v38, v100, v101
  buffer_load_dwordx4 v249, s[8:11], s41 offen offset:1024 nt lds
  v_mfma_f32_16x16x32_bf16 a[92:95], v[180:183], v[44:47], a[92:95]
  v_exp_f32 v103, v103
  v_mfma_f32_16x16x32_bf16 v[84:87], v[52:55], v[44:47], v[84:87]
  v_cvt_pk_bf16_f32 v39, v102, v103
  s_cbranch_vccnz fa_kernel_rare52
fa_kernel_back52:
  v_mfma_f32_16x16x32_bf16 v[96:99], v[184:187], a[176:179], v[60:63]
  v_exp_f32 v104, v104
  v_mfma_f32_16x16x32_bf16 v[96:99], v[188:191], a[180:183], v[96:99]
  v_max3_f32 v48, v112, v113, v114
  buffer_load_dwordx4 v250, s[8:11], s41 offen offset:2048 nt lds
  v_mfma_f32_16x16x32_bf16 v[96:99], v[192:195], a[184:187], v[96:99]
  v_exp_f32 v105, v105
  v_mfma_f32_16x16x32_bf16 v[96:99], v[196:199], a[188:191], v[96:99]
  v_max3_f32 v48, v48, v115, v116
  buffer_load_dwordx4 v251, s[8:11], s41 offen offset:3072 nt lds
  v_mfma_f32_16x16x32_bf16 v[100:103], v[200:203], a[176:179], v[60:63]
  v_exp_f32 v106, v106
  v_mfma_f32_16x16x32_bf16 v[100:103], v[204:207], a[180:183], v[100:103]
  v_max3_f32 v48, v48, v117, v118
  ds_read_b64_tr_b16 v[238:239], v254 offset:4104
  v_mfma_f32_16x16x32_bf16 v[100:103], v[208:211], a[184:187], v[100:103]
  v_cvt_pk_bf16_f32 v40, v104, v105
  ds_read_b64_tr_b16 v[240:241], v255 offset:0
  v_mfma_f32_16x16x32_bf16 v[100:103], v[212:215], a[188:191], v[100:103]
  v_max_f32 v48, v48, v119
  s_add_u32 s41, s41, 16384
  s_add_u32 s31, s31, 32768
  s_cmp_eq_u32 s31, s30
  s_cselect_b32 s31, s42, s31
  v_mfma_f32_16x16x32_bf16 a[96:99], v[152:155], v[36:39], a[96:99]
  v_exp_f32 v107, v107
  v_mfma_f32_16x16x32_bf16 a[100:103], v[156:159], v[36:39], a[100:103]
  v_cmp_lt_f32 vcc, s34, v48
  ds_read_b64_tr_b16 v[242:243], v255 offset:4096
  v_mfma_f32_16x16x32_bf16 a[104:107], v[160:163], v[36:39], a[104:107]
  v_exp_f32 v108, v108
  v_mfma_f32_16x16x32_bf16 a[108:111], v[164:167], v[36:39], a[108:111]
  v_cvt_pk_bf16_f32 v41, v106, v107
  ds_read_b64_tr_b16 v[244:245], v255 offset:8
  v_mfma_f32_16x16x32_bf16 a[112:115], v[168:171], v[36:39], a[112:115]
  v_exp_f32 v109, v109
  v_mfma_f32_16x16x32_bf16 a[116:119], v[172:175], v[36:39], a[116:119]
  v_exp_f32 v110, v110
  v_mfma_f32_16x16x32_bf16 a[120:123], v[176:179], v[36:39], a[120:123]
  v_cvt_pk_bf16_f32 v42, v108, v109
  s_waitcnt lgkmcnt(4)
  ds_read_b64_tr_b16 v[246:247], v255 offset:4104
  v_mfma_f32_16x16x32_bf16 a[124:127], v[180:183], v[36:39], a[124:127]
  v_exp_f32 v111, v111
  v_mfma_f32_16x16x32_bf16 v[88:91], v[52:55], v[36:39], v[88:91]
  v_cvt_pk_bf16_f32 v43, v110, v111
  s_waitcnt vmcnt(8) lgkmcnt(0)
  s_barrier
  s_cbranch_vccnz fa_kernel_rare53
fa_kernel_back53:
  v_mfma_f32_16x16x32_bf16 v[104:107], v[184:187], a[192:195], v[64:67]
  v_exp_f32 v112, v112
  s_mov_b32 m0, s31
  v_mfma_f32_16x16x32_bf16 v[104:107], v[188:191], a[196:199], v[104:107]
  v_max3_f32 v48, v96, v97, v98
  buffer_load_dwordx4 v10, s[8:11], s41 offen offset:0 nt lds
  v_mfma_f32_16x16x32_bf16 v[104:107], v[192:195], a[200:203], v[104:107]
  v_exp_f32 v113, v113
  v_mfma_f32_16x16x32_bf16 v[104:107], v[196:199], a[204:207], v[104:107]
  v_max3_f32 v48, v48, v99, v100
  v_mfma_f32_16x16x32_bf16 v[108:111], v[200:203], a[192:195], v[64:67]
  v_exp_f32 v114, v114
  v_mfma_f32_16x16x32_bf16 v[108:111], v[204:207], a[196:199], v[108:111]
  v_max3_f32 v48, v48, v101, v102
  v_mfma_f32_16x16x32_bf16 v[108:111], v[208:211], a[200:203], v[108:111]
  v_cvt_pk_bf16_f32 v44, v112, v113
  v_mfma_f32_16x16x32_bf16 v[108:111], v[212:215], a[204:207], v[108:111]
  v_max_f32 v48, v48, v103
  v_mfma_f32_16x16x32_bf16 a[128:131], v[152:155], v[40:43], a[128:131]
  v_exp_f32 v115, v115
  v_mfma_f32_16x16x32_bf16 a[132:135], v[156:159], v[40:43], a[132:135]
  v_cmp_lt_f32 vcc, s35, v48
  v_mfma_f32_16x16x32_bf16 a[136:139], v[160:163], v[40:43], a[136:139]
  v_exp_f32 v116, v116
  v_mfma_f32_16x16x32_bf16 a[140:143], v[164:167], v[40:43], a[140:143]
  v_cvt_pk_bf16_f32 v45, v114, v115
  v_mfma_f32_16x16x32_bf16 a[144:147], v[168:171], v[40:43], a[144:147]
  v_exp_f32 v117, v117
  v_mfma_f32_16x16x32_bf16 a[148:151], v[172:175], v[40:43], a[148:151]
  v_exp_f32 v118, v118
  v_mfma_f32_16x16x32_bf16 a[152:155], v[176:179], v[40:43], a[152:155]
  v_cvt_pk_bf16_f32 v46, v116, v117
  v_mfma_f32_16x16x32_bf16 a[156:159], v[180:183], v[40:43], a[156:159]
  v_exp_f32 v119, v119
  v_mfma_f32_16x16x32_bf16 v[92:95], v[52:55], v[40:43], v[92:95]
  v_cvt_pk_bf16_f32 v47, v118, v119
  s_cbranch_vccnz fa_kernel_rare54
fa_kernel_back54:
  v_mfma_f32_16x16x32_bf16 v[112:115], v[184:187], a[208:211], v[68:71]
  v_exp_f32 v96, v96
  v_mfma_f32_16x16x32_bf16 v[112:115], v[188:191], a[212:215], v[112:115]
  v_max3_f32 v48, v104, v105, v106
  buffer_load_dwordx4 v11, s[8:11], s41 offen offset:1024 nt lds
  v_mfma_f32_16x16x32_bf16 v[112:115], v[192:195], a[216:219], v[112:115]
  v_exp_f32 v97, v97
  v_mfma_f32_16x16x32_bf16 v[112:115], v[196:199], a[220:223], v[112:115]
  v_max3_f32 v48, v48, v107, v108
  v_mfma_f32_16x16x32_bf16 v[116:119], v[200:203], a[208:211], v[68:71]
  v_exp_f32 v98, v98
  v_mfma_f32_16x16x32_bf16 v[116:119], v[204:207], a[212:215], v[116:119]
  v_max3_f32 v48, v48, v109, v110
  v_mfma_f32_16x16x32_bf16 v[116:119], v[208:211], a[216:219], v[116:119]
  v_cvt_pk_bf16_f32 v36, v96, v97
  buffer_load_dwordx4 v12, s[8:11], s41 offen offset:2048 nt lds
  v_mfma_f32_16x16x32_bf16 v[116:119], v[212:215], a[220:223], v[116:119]
  v_max_f32 v48, v48, v111
  v_mfma_f32_16x16x32_bf16 a[0:3], v[216:219], v[44:47], a[0:3]
  v_exp_f32 v99, v99
  v_mfma_f32_16x16x32_bf16 a[4:7], v[220:223], v[44:47], a[4:7]
  v_cmp_lt_f32 vcc, s36, v48
  v_mfma_f32_16x16x32_bf16 a[8:11], v[224:227], v[44:47], a[8:11]
  v_exp_f32 v100, v100
  v_mfma_f32_16x16x32_bf16 a[12:15], v[228:231], v[44:47], a[12:15]
  v_cvt_pk_bf16_f32 v37, v98, v99
  buffer_load_dwordx4 v13, s[8:11], s41 offen offset:3072 nt lds
  v_mfma_f32_16x16x32_bf16 a[16:19], v[232:235], v[44:47], a[16:19]
  v_exp_f32 v101, v101
  v_mfma_f32_16x16x32_bf16 a[20:23], v[236:239], v[44:47], a[20:23]
  v_exp_f32 v102, v102
  v_mfma_f32_16x16x32_bf16 a[24:27], v[240:243], v[44:47], a[24:27]
  v_cvt_pk_bf16_f32 v38, v100, v101
  v_mfma_f32_16x16x32_bf16 a[28:31], v[244:247], v[44:47], a[28:31]
  v_exp_f32 v103, v103
  v_mfma_f32_16x16x32_bf16 v[76:79], v[52:55], v[44:47], v[76:79]
  v_cvt_pk_bf16_f32 v39, v102, v103
  s_cbranch_vccnz fa_kernel_rare55
fa_kernel_back55:
  s_nop 0
  v_mfma_f32_16x16x32_bf16 a[32:35], v[216:219], v[36:39], a[32:35]
  v_exp_f32 v104, v104
  s_add_u32 m0, s31, 4096
  v_mfma_f32_16x16x32_bf16 a[36:39], v[220:223], v[36:39], a[36:39]
  v_max3_f32 v48, v112, v113, v114
  buffer_load_dwordx4 v248, s[8:11], s41 offen offset:0 nt lds
  v_mfma_f32_16x16x32_bf16 a[40:43], v[224:227], v[36:39], a[40:43]
  v_exp_f32 v105, v105
  v_mfma_f32_16x16x32_bf16 a[44:47], v[228:231], v[36:39], a[44:47]
  v_max3_f32 v48, v48, v115, v116
  v_mfma_f32_16x16x32_bf16 a[48:51], v[232:235], v[36:39], a[48:51]
  v_exp_f32 v106, v106
  v_mfma_f32_16x16x32_bf16 a[52:55], v[236:239], v[36:39], a[52:55]
  v_max3_f32 v48, v48, v117, v118
  buffer_load_dwordx4 v249, s[8:11], s41 offen offset:1024 nt lds
  v_mfma_f32_16x16x32_bf16 a[56:59], v[240:243], v[36:39], a[56:59]
  v_cvt_pk_bf16_f32 v40, v104, v105
  v_mfma_f32_16x16x32_bf16 a[60:63], v[244:247], v[36:39], a[60:63]
  v_max_f32 v48, v48, v119
  v_mfma_f32_16x16x32_bf16 v[80:83], v[52:55], v[36:39], v[80:83]
  v_exp_f32 v107, v107
  v_cmp_lt_f32 vcc, s37, v48
  v_exp_f32 v108, v108
  v_cvt_pk_bf16_f32 v41, v106, v107
  v_exp_f32 v109, v109
  v_exp_f32 v110, v110
  v_cvt_pk_bf16_f32 v42, v108, v109
  v_exp_f32 v111, v111
  s_nop 0
  v_cvt_pk_bf16_f32 v43, v110, v111
  s_cbranch_vccnz fa_kernel_rare56
fa_kernel_back56:
  s_nop 0
  v_mfma_f32_16x16x32_bf16 a[64:67], v[216:219], v[40:43], a[64:67]
  v_exp_f32 v112, v112
  v_mfma_f32_16x16x32_bf16 a[68:71], v[220:223], v[40:43], a[68:71]
  v_exp_f32 v113, v113
  v_mfma_f32_16x16x32_bf16 a[72:75], v[224:227], v[40:43], a[72:75]
  v_exp_f32 v114, v114
  v_mfma_f32_16x16x32_bf16 a[76:79], v[228:231], v[40:43], a[76:79]
  v_cvt_pk_bf16_f32 v44, v112, v113
  buffer_load_dwordx4 v250, s[8:11], s41 offen offset:2048 nt lds
  v_mfma_f32_16x16x32_bf16 a[80:83], v[232:235], v[40:43], a[80:83]
  v_exp_f32 v115, v115
  v_mfma_f32_16x16x32_bf16 a[84:87], v[236:239], v[40:43], a[84:87]
  v_exp_f32 v116, v116
  v_mfma_f32_16x16x32_bf16 a[88:91], v[240:243], v[40:43], a[88:91]
  v_cvt_pk_bf16_f32 v45, v114, v115
  buffer_load_dwordx4 v251, s[8:11], s41 offen offset:3072 nt lds
  v_mfma_f32_16x16x32_bf16 a[92:95], v[244:247], v[40:43], a[92:95]
  v_exp_f32 v117, v117
  v_mfma_f32_16x16x32_bf16 v[84:87], v[52:55], v[40:43], v[84:87]
  v_exp_f32 v118, v118
  v_cvt_pk_bf16_f32 v46, v116, v117
  v_exp_f32 v119, v119
  s_nop 0
  v_cvt_pk_bf16_f32 v47, v118, v119
  s_nop 1
  v_mfma_f32_16x16x32_bf16 a[96:99], v[216:219], v[44:47], a[96:99]
  s_add_u32 s41, s41, 16384
  s_add_u32 s31, s31, 32768
  s_cmp_eq_u32 s31, s30
  s_cselect_b32 s31, s42, s31
  v_mfma_f32_16x16x32_bf16 a[100:103], v[220:223], v[44:47], a[100:103]
  v_mfma_f32_16x16x32_bf16 a[104:107], v[224:227], v[44:47], a[104:107]
  v_mfma_f32_16x16x32_bf16 a[108:111], v[228:231], v[44:47], a[108:111]
  v_mfma_f32_16x16x32_bf16 a[112:115], v[232:235], v[44:47], a[112:115]
  v_mfma_f32_16x16x32_bf16 a[116:119], v[236:239], v[44:47], a[116:119]
  v_mfma_f32_16x16x32_bf16 a[120:123], v[240:243], v[44:47], a[120:123]
  v_mfma_f32_16x16x32_bf16 a[124:127], v[244:247], v[44:47], a[124:127]
  v_mfma_f32_16x16x32_bf16 v[88:91], v[52:55], v[44:47], v[88:91]
  s_branch fa_kernel_scmb
fa_kernel_sq1:
  v_mov_b32 v76, 0
  v_mov_b32 v56, 0
  v_mov_b32 v77, 0
  v_mov_b32 v57, 0
  v_mov_b32 v78, 0
  v_mov_b32 v58, 0
  v_mov_b32 v79, 0
  v_mov_b32 v59, 0
  v_mov_b32 v80, 0
  v_mov_b32 v60, 0
  v_mov_b32 v81, 0
  v_mov_b32 v61, 0
  v_mov_b32 v82, 0
  v_mov_b32 v62, 0
  v_mov_b32 v83, 0
  v_mov_b32 v63, 0
  v_mov_b32 v84, 0
  v_mov_b32 v64, 0
  v_mov_b32 v85, 0
  v_mov_b32 v65, 0
  v_mov_b32 v86, 0
  v_mov_b32 v66, 0
  v_mov_b32 v87, 0
  v_mov_b32 v67, 0
  v_mov_b32 v88, 0
  v_mov_b32 v68, 0
  v_mov_b32 v89, 0
  v_mov_b32 v69, 0
  v_mov_b32 v90, 0
  v_mov_b32 v70, 0
  v_mov_b32 v91, 0
  v_mov_b32 v71, 0
  v_mov_b32 v92, 0
  v_mov_b32 v72, 0
  v_mov_b32 v93, 0
  v_mov_b32 v73, 0
  v_mov_b32 v94, 0
  v_mov_b32 v74, 0
  v_mov_b32 v95, 0
  v_mov_b32 v75, 0
  s_nop 1
  v_mfma_f32_16x16x32_bf16 a[0:3], v[76:79], v[76:79], 0
  v_mfma_f32_16x16x32_bf16 a[4:7], v[76:79], v[76:79], 0
  v_mfma_f32_16x16x32_bf16 a[8:11], v[76:79], v[76:79], 0
  v_mfma_f32_16x16x32_bf16 a[12:15], v[76:79], v[76:79], 0
  v_mfma_f32_16x16x32_bf16 a[16:19], v[76:79], v[76:79], 0
  v_mfma_f32_16x16x32_bf16 a[20:23], v[76:79], v[76:79], 0
  v_mfma_f32_16x16x32_bf16 a[24:27], v[76:79], v[76:79], 0
  v_mfma_f32_16x16x32_bf16 a[28:31], v[76:79], v[76:79], 0
  v_mfma_f32_16x16x32_bf16 a[32:35], v[76:79], v[76:79], 0
  v_mfma_f32_16x16x32_bf16 a[36:39], v[76:79], v[76:79], 0
  v_mfma_f32_16x16x32_bf16 a[40:43], v[76:79], v[76:79], 0
  v_mfma_f32_16x16x32_bf16 a[44:47], v[76:79], v[76:79], 0
  v_mfma_f32_16x16x32_bf16 a[48:51], v[76:79], v[76:79], 0
  v_mfma_f32_16x16x32_bf16 a[52:55], v[76:79], v[76:79], 0
  v_mfma_f32_16x16x32_bf16 a[56:59], v[76:79], v[76:79], 0
  v_mfma_f32_16x16x32_bf16 a[60:63], v[76:79], v[76:79], 0
  v_mfma_f32_16x16x32_bf16 a[64:67], v[76:79], v[76:79], 0
  v_mfma_f32_16x16x32_bf16 a[68:71], v[76:79], v[76:79], 0
  v_mfma_f32_16x16x32_bf16 a[72:75], v[76:79], v[76:79], 0
  v_mfma_f32_16x16x32_bf16 a[76:79], v[76:79], v[76:79], 0
  v_mfma_f32_16x16x32_bf16 a[80:83], v[76:79], v[76:79], 0
  v_mfma_f32_16x16x32_bf16 a[84:87], v[76:79], v[76:79], 0
  v_mfma_f32_16x16x32_bf16 a[88:91], v[76:79], v[76:79], 0
  v_mfma_f32_16x16x32_bf16 a[92:95], v[76:79], v[76:79], 0
  v_mfma_f32_16x16x32_bf16 a[96:99], v[76:79], v[76:79], 0
  v_mfma_f32_16x16x32_bf16 a[100:103], v[76:79], v[76:79], 0
  v_mfma_f32_16x16x32_bf16 a[104:107], v[76:79], v[76:79], 0
  v_mfma_f32_16x16x32_bf16 a[108:111], v[76:79], v[76:79], 0
  v_mfma_f32_16x16x32_bf16 a[112:115], v[76:79], v[76:79], 0
  v_mfma_f32_16x16x32_bf16 a[116:119], v[76:79], v[76:79], 0
  v_mfma_f32_16x16x32_bf16 a[120:123], v[76:79], v[76:79], 0
  v_mfma_f32_16x16x32_bf16 a[124:127], v[76:79], v[76:79], 0
  v_mfma_f32_16x16x32_bf16 a[128:131], v[76:79], v[76:79], 0
  v_mfma_f32_16x16x32_bf16 a[132:135], v[76:79], v[76:79], 0
  v_mfma_f32_16x16x32_bf16 a[136:139], v[76:79], v[76:79], 0
  v_mfma_f32_16x16x32_bf16 a[140:143], v[76:79], v[76:79], 0
  v_mfma_f32_16x16x32_bf16 a[144:147], v[76:79], v[76:79], 0
  v_mfma_f32_16x16x32_bf16 a[148:151], v[76:79], v[76:79], 0
  v_mfma_f32_16x16x32_bf16 a[152:155], v[76:79], v[76:79], 0
  v_mfma_f32_16x16x32_bf16 a[156:159], v[76:79], v[76:79], 0
  s_mov_b32 s34, 0xff800000
  s_mov_b32 s35, 0xff800000
  s_mov_b32 s36, 0xff800000
  s_mov_b32 s37, 0xff800000
  s_mov_b32 s38, 0xff800000
  s_waitcnt vmcnt(16)
  s_barrier
  v_add_u32 v28, s32, v20
  v_add_u32 v29, s32, v21
  v_add_u32 v30, s32, v22
  v_add_u32 v31, s32, v23
  v_add_u32 v32, s32, v24
  v_add_u32 v33, s32, v25
  v_add_u32 v34, s32, v26
  v_add_u32 v35, s32, v27
  s_add_u32 s32, s32, 32768
  s_cmp_eq_u32 s32, 98304
  s_cselect_b32 s32, 0, s32
  ds_read_b128 v[120:123], v28 offset:0
  ds_read_b128 v[124:127], v29 offset:0
  ds_read_b128 v[128:131], v30 offset:0
  ds_read_b128 v[132:135], v31 offset:0
  ds_read_b128 v[136:139], v28 offset:4096
  ds_read_b128 v[140:143], v29 offset:4096
  ds_read_b128 v[144:147], v30 offset:4096
  ds_read_b128 v[148:151], v31 offset:4096
  ds_read_b64_tr_b16 v[152:153], v32 offset:0
  ds_read_b64_tr_b16 v[154:155], v32 offset:4096
  ds_read_b64_tr_b16 v[156:157], v32 offset:8
  ds_read_b64_tr_b16 v[158:159], v32 offset:4104
  ds_read_b64_tr_b16 v[160:161], v33 offset:0
  ds_read_b64_tr_b16 v[162:163], v33 offset:4096
  ds_read_b64_tr_b16 v[164:165], v33 offset:8
  s_waitcnt lgkmcnt(14)
  ds_read_b64_tr_b16 v[166:167], v33 offset:4104
  s_waitcnt lgkmcnt(14)
  ds_read_b64_tr_b16 v[168:169], v34 offset:0
  s_waitcnt lgkmcnt(14)
  ds_read_b64_tr_b16 v[170:171], v34 offset:4096
  s_waitcnt lgkmcnt(14)
  ds_read_b64_tr_b16 v[172:173], v34 offset:8
  s_waitcnt lgkmcnt(14)
  ds_read_b64_tr_b16 v[174:175], v34 offset:4104
  s_waitcnt lgkmcnt(14)
  ds_read_b64_tr_b16 v[176:177], v35 offset:0
  s_waitcnt lgkmcnt(14)
  ds_read_b64_tr_b16 v[178:179], v35 offset:4096
  s_waitcnt lgkmcnt(14)
  ds_read_b64_tr_b16 v[180:181], v35 offset:8
  s_waitcnt lgkmcnt(14)
  ds_read_b64_tr_b16 v[182:183], v35 offset:4104
  v_add_u32 v28, s32, v20
  v_add_u32 v29, s32, v21
  v_add_u32 v30, s32, v22
  v_add_u32 v31, s32, v23
  v_add_u32 v252, s32, v24
  v_add_u32 v253, s32, v25
  v_add_u32 v254, s32, v26
  v_add_u32 v255, s32, v27
  s_add_u32 s32, s32, 32768
  s_cmp_eq_u32 s32, 98304
  s_cselect_b32 s32, 0, s32
  v_mfma_f32_16x16x32_bf16 v[96:99], v[120:123], a[160:163], v[56:59]
  v_mfma_f32_16x16x32_bf16 v[96:99], v[124:127], a[164:167], v[96:99]
  v_mfma_f32_16x16x32_bf16 v[96:99], v[128:131], a[168:171], v[96:99]
  v_mfma_f32_16x16x32_bf16 v[96:99], v[132:135], a[172:175], v[96:99]
  v_mfma_f32_16x16x32_bf16 v[100:103], v[136:139], a[160:163], v[56:59]
  v_mfma_f32_16x16x32_bf16 v[100:103], v[140:143], a[164:167], v[100:103]
  v_mfma_f32_16x16x32_bf16 v[100:103], v[144:147], a[168:171], v[100:103]
  v_mfma_f32_16x16x32_bf16 v[100:103], v[148:151], a[172:175], v[100:103]
  v_mfma_f32_16x16x32_bf16 v[104:107], v[120:123], a[176:179], v[60:63]
  v_mfma_f32_16x16x32_bf16 v[104:107], v[124:127], a[180:183], v[104:107]
  v_mfma_f32_16x16x32_bf16 v[104:107], v[128:131], a[184:187], v[104:107]
  v_mfma_f32_16x16x32_bf16 v[104:107], v[132:135], a[188:191], v[104:107]
  v_mfma_f32_16x16x32_bf16 v[108:111], v[136:139], a[176:179], v[60:63]
  v_mfma_f32_16x16x32_bf16 v[108:111], v[140:143], a[180:183], v[108:111]
  v_mfma_f32_16x16x32_bf16 v[108:111], v[144:147], a[184:187], v[108:111]
  v_mfma_f32_16x16x32_bf16 v[108:111], v[148:151], a[188:191], v[108:111]
  v_mfma_f32_16x16x32_bf16 v[112:115], v[120:123], a[192:195], v[64:67]
  v_mfma_f32_16x16x32_bf16 v[112:115], v[124:127], a[196:199], v[112:115]
  v_mfma_f32_16x16x32_bf16 v[112:115], v[128:131], a[200:203], v[112:115]
  v_mfma_f32_16x16x32_bf16 v[112:115], v[132:135], a[204:207], v[112:115]
  v_mfma_f32_16x16x32_bf16 v[116:119], v[136:139], a[192:195], v[64:67]
  v_mfma_f32_16x16x32_bf16 v[116:119], v[140:143], a[196:199], v[116:119]
  v_mfma_f32_16x16x32_bf16 v[116:119], v[144:147], a[200:203], v[116:119]
  v_mfma_f32_16x16x32_bf16 v[116:119], v[148:151], a[204:207], v[116:119]
  v_max3_f32 v48, v96, v97, v98
  v_max3_f32 v48, v48, v99, v100
  v_max3_f32 v48, v48, v101, v102
  v_max_f32 v48, v48, v103
  v_cmp_lt_f32 vcc, s34, v48
  s_nop 3
  s_cbranch_vccnz fa_kernel_rare57
fa_kernel_back57:
  v_exp_f32 v96, v96
  v_exp_f32 v97, v97
  v_exp_f32 v98, v98
  v_cvt_pk_bf16_f32 v36, v96, v97
  v_exp_f32 v99, v99
  v_exp_f32 v100, v100
  v_cvt_pk_bf16_f32 v37, v98, v99
  v_exp_f32 v101, v101
  v_exp_f32 v102, v102
  v_cvt_pk_bf16_f32 v38, v100, v101
  v_exp_f32 v103, v103
  s_nop 0
  v_cvt_pk_bf16_f32 v39, v102, v103
  v_max3_f32 v48, v104, v105, v106
  v_max3_f32 v48, v48, v107, v108
  v_max3_f32 v48, v48, v109, v110
  v_max_f32 v48, v48, v111
  v_cmp_lt_f32 vcc, s35, v48
  s_waitcnt lgkmcnt(0)
  s_mov_b32 s33, 7
fa_kernel_atd:
  s_waitcnt vmcnt(8) lgkmcnt(0)
  s_barrier
  s_cbranch_vccnz fa_kernel_rare58
fa_kernel_back58:
  v_mfma_f32_16x16x32_bf16 v[96:99], v[120:123], a[208:211], v[68:71]
  v_exp_f32 v104, v104
  v_mfma_f32_16x16x32_bf16 v[96:99], v[124:127], a[212:215], v[96:99]
  v_max3_f32 v48, v112, v113, v114
  ds_read_b128 v[184:187], v28 offset:0
  v_mfma_f32_16x16x32_bf16 v[96:99], v[128:131], a[216:219], v[96:99]
  v_exp_f32 v105, v105
  v_mfma_f32_16x16x32_bf16 v[96:99], v[132:135], a[220:223], v[96:99]
  v_max3_f32 v48, v48, v115, v116
  ds_read_b128 v[188:191], v29 offset:0
  v_mfma_f32_16x16x32_bf16 v[100:103], v[136:139], a[208:211], v[68:71]
  v_exp_f32 v106, v106
  v_mfma_f32_16x16x32_bf16 v[100:103], v[140:143], a[212:215], v[100:103]
  v_max3_f32 v48, v48, v117, v118
  ds_read_b128 v[192:195], v30 offset:0
  v_mfma_f32_16x16x32_bf16 v[100:103], v[144:147], a[216:219], v[100:103]
  v_cvt_pk_bf16_f32 v40, v104, v105
  ds_read_b128 v[196:199], v31 offset:0
  v_mfma_f32_16x16x32_bf16 v[100:103], v[148:151], a[220:223], v[100:103]
  v_max_f32 v48, v48, v119
  ds_read_b128 v[200:203], v28 offset:4096
  v_mfma_f32_16x16x32_bf16 a[0:3], v[152:155], v[36:39], a[0:3]
  v_exp_f32 v107, v107
  v_mfma_f32_16x16x32_bf16 a[4:7], v[156:159], v[36:39], a[4:7]
  v_cmp_lt_f32 vcc, s36, v48
  ds_read_b128 v[204:207], v29 offset:4096
  v_mfma_f32_16x16x32_bf16 a[8:11], v[160:163], v[36:39], a[8:11]
  v_exp_f32 v108, v108
  v_mfma_f32_16x16x32_bf16 a[12:15], v[164:167], v[36:39], a[12:15]
  v_cvt_pk_bf16_f32 v41, v106, v107
  ds_read_b128 v[208:211], v30 offset:4096
  v_mfma_f32_16x16x32_bf16 a[16:19], v[168:171], v[36:39], a[16:19]
  v_exp_f32 v109, v109
  v_mfma_f32_16x16x32_bf16 a[20:23], v[172:175], v[36:39], a[20:23]
  v_exp_f32 v110, v110
  v_mfma_f32_16x16x32_bf16 a[24:27], v[176:179], v[36:39], a[24:27]
  v_cvt_pk_bf16_f32 v42, v108, v109
  ds_read_b128 v[212:215], v31 offset:4096
  v_mfma_f32_16x16x32_bf16 a[28:31], v[180:183], v[36:39], a[28:31]
  v_exp_f32 v111, v111
  s_mov_b32 m0, s31
  v_mfma_f32_16x16x32_bf16 v[76:79], v[52:55], v[36:39], v[76:79]
  v_cvt_pk_bf16_f32 v43, v110, v111
  buffer_load_dwordx4 v10, s[8:11], s41 offen offset:0 nt lds
  s_cbranch_vccnz fa_kernel_rare59
fa_kernel_back59:
  s_waitcnt lgkmcnt(7)
  v_mfma_f32_16x16x32_bf16 v[104:107], v[184:187], a[160:163], v[56:59]
  v_exp_f32 v112, v112
  s_waitcnt lgkmcnt(6)
  v_mfma_f32_16x16x32_bf16 v[104:107], v[188:191], a[164:167], v[104:107]
  v_max3_f32 v48, v96, v97, v98
  ds_read_b64_tr_b16 v[216:217], v252 offset:0
  s_waitcnt lgkmcnt(6)
  v_mfma_f32_16x16x32_bf16 v[104:107], v[192:195], a[168:171], v[104:107]
  v_exp_f32 v113, v113
  s_waitcnt lgkmcnt(5)
  v_mfma_f32_16x16x32_bf16 v[104:107], v[196:199], a[172:175], v[104:107]
  v_max3_f32 v48, v48, v99, v100
  ds_read_b64_tr_b16 v[218:219], v252 offset:4096
  s_waitcnt lgkmcnt(5)
  v_mfma_f32_16x16x32_bf16 v[108:111], v[200:203], a[160:163], v[56:59]
  v_exp_f32 v114, v114
  s_waitcnt lgkmcnt(4)
  v_mfma_f32_16x16x32_bf16 v[108:111], v[204:207], a[164:167], v[108:111]
  v_max3_f32 v48, v48, v101, v102
  ds_read_b64_tr_b16 v[220:221], v252 offset:8
  s_waitcnt lgkmcnt(4)
  v_mfma_f32_16x16x32_bf16 v[108:111], v[208:211], a[168:171], v[108:111]
  v_cvt_pk_bf16_f32 v44, v112, v113
  ds_read_b64_tr_b16 v[222:223], v252 offset:4104
  s_waitcnt lgkmcnt(4)
  v_mfma_f32_16x16x32_bf16 v[108:111], v[212:215], a[172:175], v[108:111]
  v_max_f32 v48, v48, v103
  ds_read_b64_tr_b16 v[224:225], v253 offset:0
  v_mfma_f32_16x16x32_bf16 a[32:35], v[152:155], v[40:43], a[32:35]
  v_exp_f32 v115, v115
  v_mfma_f32_16x16x32_bf16 a[36:39], v[156:159], v[40:43], a[36:39]
  v_cmp_lt_f32 vcc, s37, v48
  ds_read_b64_tr_b16 v[226:227], v253 offset:4096
  v_mfma_f32_16x16x32_bf16 a[40:43], v[160:163], v[40:43], a[40:43]
  v_exp_f32 v116, v116
  v_mfma_f32_16x16x32_bf16 a[44:47], v[164:167], v[40:43], a[44:47]
  v_cvt_pk_bf16_f32 v45, v114, v115
  buffer_load_dwordx4 v11, s[8:11], s41 offen offset:1024 nt lds
  v_mfma_f32_16x16x32_bf16 a[48:51], v[168:171], v[40:43], a[48:51]
  v_exp_f32 v117, v117
  v_mfma_f32_16x16x32_bf16 a[52:55], v[172:175], v[40:43], a[52:55]
  v_exp_f32 v118, v118
  v_mfma_f32_16x16x32_bf16 a[56:59], v[176:179], v[40:43], a[56:59]
  v_cvt_pk_bf16_f32 v46, v116, v117
  buffer_load_dwordx4 v12, s[8:11], s41 offen offset:2048 nt lds
  v_mfma_f32_16x16x32_bf16 a[60:63], v[180:183], v[40:43], a[60:63]
  v_exp_f32 v119, v119
  v_mfma_f32_16x16x32_bf16 v[80:83], v[52:55], v[40:43], v[80:83]
  v_cvt_pk_bf16_f32 v47, v118, v119
  buffer_load_dwordx4 v13, s[8:11], s41 offen offset:3072 nt lds
  s_cbranch_vccnz fa_kernel_rare60
fa_kernel_back60:
  v_mfma_f32_16x16x32_bf16 v[112:115], v[184:187], a[176:179], v[60:63]
  v_exp_f32 v96, v96
  v_add_u32 v30, s32, v22
  v_mfma_f32_16x16x32_bf16 v[112:115], v[188:191], a[180:183], v[112:115]
  v_max3_f32 v48, v104, v105, v106
  ds_read_b64_tr_b16 v[228:229], v253 offset:8
  v_mfma_f32_16x16x32_bf16 v[112:115], v[192:195], a[184:187], v[112:115]
  v_exp_f32 v97, v97
  v_add_u32 v31, s32, v23
  v_mfma_f32_16x16x32_bf16 v[112:115], v[196:199], a[188:191], v[112:115]
  v_max3_f32 v48, v48, v107, v108
  ds_read_b64_tr_b16 v[230:231], v253 offset:4104
  v_mfma_f32_16x16x32_bf16 v[116:119], v[200:203], a[176:179], v[60:63]
  v_exp_f32 v98, v98
  v_mfma_f32_16x16x32_bf16 v[116:119], v[204:207], a[180:183], v[116:119]
  v_max3_f32 v48, v48, v109, v110
  ds_read_b64_tr_b16 v[232:233], v254 offset:0
  v_mfma_f32_16x16x32_bf16 v[116:119], v[208:211], a[184:187], v[116:119]
  v_cvt_pk_bf16_f32 v36, v96, v97
  ds_read_b64_tr_b16 v[234:235], v254 offset:4096
  v_mfma_f32_16x16x32_bf16 v[116:119], v[212:215], a[188:191], v[116:119]
  v_max_f32 v48, v48, v111
  v_add_u32 v28, s32, v20
  v_mfma_f32_16x16x32_bf16 a[64:67], v[152:155], v[44:47], a[64:67]
  v_exp_f32 v99, v99
  v_mfma_f32_16x16x32_bf16 a[68:71], v[156:159], v[44:47], a[68:71]
  v_cmp_lt_f32 vcc, s34, v48
  ds_read_b64_tr_b16 v[236:237], v254 offset:8
  v_mfma_f32_16x16x32_bf16 a[72:75], v[160:163], v[44:47], a[72:75]
  v_exp_f32 v100, v100
  s_add_u32 m0, s31, 4096
  v_mfma_f32_16x16x32_bf16 a[76:79], v[164:167], v[44:47], a[76:79]
  v_cvt_pk_bf16_f32 v37, v98, v99
  buffer_load_dwordx4 v248, s[8:11], s41 offen offset:0 nt lds
  v_mfma_f32_16x16x32_bf16 a[80:83], v[168:171], v[44:47], a[80:83]
  v_exp_f32 v101, v101
  v_mfma_f32_16x16x32_bf16 a[84:87], v[172:175], v[44:47], a[84:87]
  v_exp_f32 v102, v102
  v_mfma_f32_16x16x32_bf16 a[88:91], v[176:179], v[44:47], a[88:91]
  v_cvt_pk_bf16_f32 v38, v100, v101
  buffer_load_dwordx4 v249, s[8:11], s41 offen offset:1024 nt lds
  v_mfma_f32_16x16x32_bf16 a[92:95], v[180:183], v[44:47], a[92:95]
  v_exp_f32 v103, v103
  v_mfma_f32_16x16x32_bf16 v[84:87], v[52:55], v[44:47], v[84:87]
  v_cvt_pk_bf16_f32 v39, v102, v103
  v_add_u32 v29, s32, v21
  s_cbranch_vccnz fa_kernel_rare61
fa_kernel_back61:
  v_mfma_f32_16x16x32_bf16 v[96:99], v[184:187], a[192:195], v[64:67]
  v_exp_f32 v104, v104
  v_add_u32 v34, s32, v26
  v_mfma_f32_16x16x32_bf16 v[96:99], v[188:191], a[196:199], v[96:99]
  v_max3_f32 v48, v112, v113, v114
  buffer_load_dwordx4 v250, s[8:11], s41 offen offset:2048 nt lds
  v_mfma_f32_16x16x32_bf16 v[96:99], v[192:195], a[200:203], v[96:99]
  v_exp_f32 v105, v105
  v_add_u32 v35, s32, v27
  v_mfma_f32_16x16x32_bf16 v[96:99], v[196:199], a[204:207], v[96:99]
  v_max3_f32 v48, v48, v115, v116
  buffer_load_dwordx4 v251, s[8:11], s41 offen offset:3072 nt lds
  v_mfma_f32_16x16x32_bf16 v[100:103], v[200:203], a[192:195], v[64:67]
  v_exp_f32 v106, v106
  s_add_u32 s41, s41, 16384
  s_add_u32 s31, s31, 32768
  s_cmp_eq_u32 s31, s30
  s_cselect_b32 s31, s42, s31
  v_mfma_f32_16x16x32_bf16 v[100:103], v[204:207], a[196:199], v[100:103]
  v_max3_f32 v48, v48, v117, v118
  ds_read_b64_tr_b16 v[238:239], v254 offset:4104
  v_mfma_f32_16x16x32_bf16 v[100:103], v[208:211], a[200:203], v[100:103]
  v_cvt_pk_bf16_f32 v40, v104, v105
  ds_read_b64_tr_b16 v[240:241], v255 offset:0
  v_mfma_f32_16x16x32_bf16 v[100:103], v[212:215], a[204:207], v[100:103]
  v_max_f32 v48, v48, v119
  v_add_u32 v32, s32, v24
  v_mfma_f32_16x16x32_bf16 a[96:99], v[152:155], v[36:39], a[96:99]
  v_exp_f32 v107, v107
  v_mfma_f32_16x16x32_bf16 a[100:103], v[156:159], v[36:39], a[100:103]
  v_cmp_lt_f32 vcc, s35, v48
  ds_read_b64_tr_b16 v[242:243], v255 offset:4096
  v_mfma_f32_16x16x32_bf16 a[104:107], v[160:163], v[36:39], a[104:107]
  v_exp_f32 v108, v108
  v_mfma_f32_16x16x32_bf16 a[108:111], v[164:167], v[36:39], a[108:111]
  v_cvt_pk_bf16_f32 v41, v106, v107
  ds_read_b64_tr_b16 v[244:245], v255 offset:8
  v_mfma_f32_16x16x32_bf16 a[112:115], v[168:171], v[36:39], a[112:115]
  v_exp_f32 v109, v109
  v_mfma_f32_16x16x32_bf16 a[116:119], v[172:175], v[36:39], a[116:119]
  v_exp_f32 v110, v110
  v_mfma_f32_16x16x32_bf16 a[120:123], v[176:179], v[36:39], a[120:123]
  v_cvt_pk_bf16_f32 v42, v108, v109
  s_waitcnt lgkmcnt(4)
  ds_read_b64_tr_b16 v[246:247], v255 offset:4104
  v_mfma_f32_16x16x32_bf16 a[124:127], v[180:183], v[36:39], a[124:127]
  v_exp_f32 v111, v111
  v_mfma_f32_16x16x32_bf16 v[88:91], v[52:55], v[36:39], v[88:91]
  v_cvt_pk_bf16_f32 v43, v110, v111
  v_add_u32 v33, s32, v25
  s_add_u32 s32, s32, 32768
  s_cmp_eq_u32 s32, 98304
  s_cselect_b32 s32, 0, s32
  s_waitcnt vmcnt(8) lgkmcnt(0)
  s_barrier
  s_cbranch_vccnz fa_kernel_rare62
fa_kernel_back62:
  v_mfma_f32_16x16x32_bf16 v[104:107], v[184:187], a[208:211], v[68:71]
  v_exp_f32 v112, v112
  v_mfma_f32_16x16x32_bf16 v[104:107], v[188:191], a[212:215], v[104:107]
  v_max3_f32 v48, v96, v97, v98
  ds_read_b128 v[120:123], v28 offset:0
  v_mfma_f32_16x16x32_bf16 v[104:107], v[192:195], a[216:219], v[104:107]
  v_exp_f32 v113, v113
  v_mfma_f32_16x16x32_bf16 v[104:107], v[196:199], a[220:223], v[104:107]
  v_max3_f32 v48, v48, v99, v100
  ds_read_b128 v[124:127], v29 offset:0
  v_mfma_f32_16x16x32_bf16 v[108:111], v[200:203], a[208:211], v[68:71]
  v_exp_f32 v114, v114
  v_mfma_f32_16x16x32_bf16 v[108:111], v[204:207], a[212:215], v[108:111]
  v_max3_f32 v48, v48, v101, v102
  ds_read_b128 v[128:131], v30 offset:0
  v_mfma_f32_16x16x32_bf16 v[108:111], v[208:211], a[216:219], v[108:111]
  v_cvt_pk_bf16_f32 v44, v112, v113
  ds_read_b128 v[132:135], v31 offset:0
  v_mfma_f32_16x16x32_bf16 v[108:111], v[212:215], a[220:223], v[108:111]
  v_max_f32 v48, v48, v103
  ds_read_b128 v[136:139], v28 offset:4096
  v_mfma_f32_16x16x32_bf16 a[0:3], v[216:219], v[40:43], a[0:3]
  v_exp_f32 v115, v115
  v_mfma_f32_16x16x32_bf16 a[4:7], v[220:223], v[40:43], a[4:7]
  v_cmp_lt_f32 vcc, s36, v48
  ds_read_b128 v[140:143], v29 offset:4096
  v_mfma_f32_16x16x32_bf16 a[8:11], v[224:227], v[40:43], a[8:11]
  v_exp_f32 v116, v116
  v_mfma_f32_16x16x32_bf16 a[12:15], v[228:231], v[40:43], a[12:15]
  v_cvt_pk_bf16_f32 v45, v114, v115
  ds_read_b128 v[144:147], v30 offset:4096
  v_mfma_f32_16x16x32_bf16 a[16:19], v[232:235], v[40:43], a[16:19]
  v_exp_f32 v117, v117
  v_mfma_f32_16x16x32_bf16 a[20:23], v[236:239], v[40:43], a[20:23]
  v_exp_f32 v118, v118
  v_mfma_f32_16x16x32_bf16 a[24:27], v[240:243], v[40:43], a[24:27]
  v_cvt_pk_bf16_f32 v46, v116, v117
  ds_read_b128 v[148:151], v31 offset:4096
  v_mfma_f32_16x16x32_bf16 a[28:31], v[244:247], v[40:43], a[28:31]
  v_exp_f32 v119, v119
  s_mov_b32 m0, s31
  v_mfma_f32_16x16x32_bf16 v[76:79], v[52:55], v[40:43], v[76:79]
  v_cvt_pk_bf16_f32 v47, v118, v119
  buffer_load_dwordx4 v10, s[8:11], s41 offen offset:0 nt lds
  s_cbranch_vccnz fa_kernel_rare63
fa_kernel_back63:
  v_mfma_f32_16x16x32_bf16 v[112:115], v[184:187], a[224:227], v[72:75]
  v_exp_f32 v96, v96
  v_mfma_f32_16x16x32_bf16 v[112:115], v[188:191], a[228:231], v[112:115]
  v_max3_f32 v48, v104, v105, v106
  ds_read_b64_tr_b16 v[152:153], v32 offset:0
  v_mfma_f32_16x16x32_bf16 v[112:115], v[192:195], a[232:235], v[112:115]
  v_exp_f32 v97, v97
  v_mfma_f32_16x16x32_bf16 v[112:115], v[196:199], a[236:239], v[112:115]
  v_max3_f32 v48, v48, v107, v108
  ds_read_b64_tr_b16 v[154:155], v32 offset:4096
  v_mfma_f32_16x16x32_bf16 v[116:119], v[200:203], a[224:227], v[72:75]
  v_exp_f32 v98, v98
  v_mfma_f32_16x16x32_bf16 v[116:119], v[204:207], a[228:231], v[116:119]
  v_max3_f32 v48, v48, v109, v110
  ds_read_b64_tr_b16 v[156:157], v32 offset:8
  v_mfma_f32_16x16x32_bf16 v[116:119], v[208:211], a[232:235], v[116:119]
  v_cvt_pk_bf16_f32 v36, v96, v97
  ds_read_b64_tr_b16 v[158:159], v32 offset:4104
  v_mfma_f32_16x16x32_bf16 v[116:119], v[212:215], a[236:239], v[116:119]
  v_max_f32 v48, v48, v111
  ds_read_b64_tr_b16 v[160:161], v33 offset:0
  v_mfma_f32_16x16x32_bf16 a[32:35], v[216:219], v[44:47], a[32:35]
  v_exp_f32 v99, v99
  v_mfma_f32_16x16x32_bf16 a[36:39], v[220:223], v[44:47], a[36:39]
  v_cmp_lt_f32 vcc, s37, v48
  buffer_load_dwordx4 v11, s[8:11], s41 offen offset:1024 nt lds
  v_mfma_f32_16x16x32_bf16 a[40:43], v[224:227], v[44:47], a[40:43]
  v_exp_f32 v100, v100
  v_mfma_f32_16x16x32_bf16 a[44:47], v[228:231], v[44:47], a[44:47]
  v_cvt_pk_bf16_f32 v37, v98, v99
  buffer_load_dwordx4 v12, s[8:11], s41 offen offset:2048 nt lds
  v_mfma_f32_16x16x32_bf16 a[48:51], v[232:235], v[44:47], a[48:51]
  v_exp_f32 v101, v101
  v_mfma_f32_16x16x32_bf16 a[52:55], v[236:239], v[44:47], a[52:55]
  v_exp_f32 v102, v102
  v_mfma_f32_16x16x32_bf16 a[56:59], v[240:243], v[44:47], a[56:59]
  v_cvt_pk_bf16_f32 v38, v100, v101
  buffer_load_dwordx4 v13, s[8:11], s41 offen offset:3072 nt lds
  v_mfma_f32_16x16x32_bf16 a[60:63], v[244:247], v[44:47], a[60:63]
  v_exp_f32 v103, v103
  v_mfma_f32_16x16x32_bf16 v[80:83], v[52:55], v[44:47], v[80:83]
  v_cvt_pk_bf16_f32 v39, v102, v103
  s_cbranch_vccnz fa_kernel_rare64
fa_kernel_back64:
  s_waitcnt lgkmcnt(5)
  v_mfma_f32_16x16x32_bf16 v[96:99], v[120:123], a[160:163], v[56:59]
  v_exp_f32 v104, v104
  v_add_u32 v30, s32, v22
  v_mfma_f32_16x16x32_bf16 v[96:99], v[124:127], a[164:167], v[96:99]
  v_max3_f32 v48, v112, v113, v114
  ds_read_b64_tr_b16 v[162:163], v33 offset:4096
  v_mfma_f32_16x16x32_bf16 v[96:99], v[128:131], a[168:171], v[96:99]
  v_exp_f32 v105, v105
  v_add_u32 v31, s32, v23
  v_mfma_f32_16x16x32_bf16 v[96:99], v[132:135], a[172:175], v[96:99]
  v_max3_f32 v48, v48, v115, v116
  ds_read_b64_tr_b16 v[164:165], v33 offset:8
  v_mfma_f32_16x16x32_bf16 v[100:103], v[136:139], a[160:163], v[56:59]
  v_exp_f32 v106, v106
  v_mfma_f32_16x16x32_bf16 v[100:103], v[140:143], a[164:167], v[100:103]
  v_max3_f32 v48, v48, v117, v118
  ds_read_b64_tr_b16 v[166:167], v33 offset:4104
  v_mfma_f32_16x16x32_bf16 v[100:103], v[144:147], a[168:171], v[100:103]
  v_cvt_pk_bf16_f32 v40, v104, v105
  ds_read_b64_tr_b16 v[168:169], v34 offset:0
  v_mfma_f32_16x16x32_bf16 v[100:103], v[148:151], a[172:175], v[100:103]
  v_max_f32 v48, v48, v119
  v_add_u32 v28, s32, v20
  v_mfma_f32_16x16x32_bf16 a[64:67], v[216:219], v[36:39], a[64:67]
  v_exp_f32 v107, v107
  v_mfma_f32_16x16x32_bf16 a[68:71], v[220:223], v[36:39], a[68:71]
  v_cmp_lt_f32 vcc, s38, v48
  ds_read_b64_tr_b16 v[170:171], v34 offset:4096
  v_mfma_f32_16x16x32_bf16 a[72:75], v[224:227], v[36:39], a[72:75]
  v_exp_f32 v108, v108
  s_add_u32 m0, s31, 4096
  v_mfma_f32_16x16x32_bf16 a[76:79], v[228:231], v[36:39], a[76:79]
  v_cvt_pk_bf16_f32 v41, v106, v107
  buffer_load_dwordx4 v248, s[8:11], s41 offen offset:0 nt lds
  v_mfma_f32_16x16x32_bf16 a[80:83], v[232:235], v[36:39], a[80:83]
  v_exp_f32 v109, v109
  v_mfma_f32_16x16x32_bf16 a[84:87], v[236:239], v[36:39], a[84:87]
  v_exp_f32 v110, v110
  v_mfma_f32_16x16x32_bf16 a[88:91], v[240:243], v[36:39], a[88:91]
  v_cvt_pk_bf16_f32 v42, v108, v109
  buffer_load_dwordx4 v249, s[8:11], s41 offen offset:1024 nt lds
  v_mfma_f32_16x16x32_bf16 a[92:95], v[244:247], v[36:39], a[92:95]
  v_exp_f32 v111, v111
  v_mfma_f32_16x16x32_bf16 v[84:87], v[52:55], v[36:39], v[84:87]
  v_cvt_pk_bf16_f32 v43, v110, v111
  v_add_u32 v29, s32, v21
  s_cbranch_vccnz fa_kernel_rare65
fa_kernel_back65:
  v_mfma_f32_16x16x32_bf16 v[104:107], v[120:123], a[176:179], v[60:63]
  v_exp_f32 v112, v112
  v_add_u32 v253, s32, v25
  v_mfma_f32_16x16x32_bf16 v[104:107], v[124:127], a[180:183], v[104:107]
  v_max3_f32 v48, v96, v97, v98
  buffer_load_dwordx4 v250, s[8:11], s41 offen offset:2048 nt lds
  v_mfma_f32_16x16x32_bf16 v[104:107], v[128:131], a[184:187], v[104:107]
  v_exp_f32 v113, v113
  v_add_u32 v254, s32, v26
  v_mfma_f32_16x16x32_bf16 v[104:107], v[132:135], a[188:191], v[104:107]
  v_max3_f32 v48, v48, v99, v100
  buffer_load_dwordx4 v251, s[8:11], s41 offen offset:3072 nt lds
  v_mfma_f32_16x16x32_bf16 v[108:111], v[136:139], a[176:179], v[60:63]
  v_exp_f32 v114, v114
  v_add_u32 v255, s32, v27
  v_mfma_f32_16x16x32_bf16 v[108:111], v[140:143], a[180:183], v[108:111]
  v_max3_f32 v48, v48, v101, v102
  ds_read_b64_tr_b16 v[172:173], v34 offset:8
  v_mfma_f32_16x16x32_bf16 v[108:111], v[144:147], a[184:187], v[108:111]
  v_cvt_pk_bf16_f32 v44, v112, v113
  ds_read_b64_tr_b16 v[174:175], v34 offset:4104
  v_mfma_f32_16x16x32_bf16 v[108:111], v[148:151], a[188:191], v[108:111]
  v_max_f32 v48, v48, v103
  ds_read_b64_tr_b16 v[176:177], v35 offset:0
  v_mfma_f32_16x16x32_bf16 a[96:99], v[216:219], v[40:43], a[96:99]
  v_exp_f32 v115, v115
  v_mfma_f32_16x16x32_bf16 a[100:103], v[220:223], v[40:43], a[100:103]
  v_cmp_lt_f32 vcc, s34, v48
  ds_read_b64_tr_b16 v[178:179], v35 offset:4096
  v_mfma_f32_16x16x32_bf16 a[104:107], v[224:227], v[40:43], a[104:107]
  v_exp_f32 v116, v116
  v_mfma_f32_16x16x32_bf16 a[108:111], v[228:231], v[40:43], a[108:111]
  v_cvt_pk_bf16_f32 v45, v114, v115
  ds_read_b64_tr_b16 v[180:181], v35 offset:8
  v_mfma_f32_16x16x32_bf16 a[112:115], v[232:235], v[40:43], a[112:115]
  v_exp_f32 v117, v117
  v_mfma_f32_16x16x32_bf16 a[116:119], v[236:239], v[40:43], a[116:119]
  v_exp_f32 v118, v118
  v_mfma_f32_16x16x32_bf16 a[120:123], v[240:243], v[40:43], a[120:123]
  v_cvt_pk_bf16_f32 v46, v116, v117
  s_waitcnt lgkmcnt(5)
  ds_read_b64_tr_b16 v[182:183], v35 offset:4104
  v_mfma_f32_16x16x32_bf16 a[124:127], v[244:247], v[40:43], a[124:127]
  v_exp_f32 v119, v119
  v_mfma_f32_16x16x32_bf16 v[88:91], v[52:55], v[40:43], v[88:91]
  v_cvt_pk_bf16_f32 v47, v118, v119
  v_add_u32 v252, s32, v24
  s_cbranch_vccnz fa_kernel_rare66
fa_kernel_back66:
  v_mfma_f32_16x16x32_bf16 v[112:115], v[120:123], a[192:195], v[64:67]
  v_exp_f32 v96, v96
  s_add_u32 s32, s32, 32768
  s_cmp_eq_u32 s32, 98304
  s_cselect_b32 s32, 0, s32
  v_mfma_f32_16x16x32_bf16 v[112:115], v[124:127], a[196:199], v[112:115]
  v_max3_f32 v48, v104, v105, v106
  s_add_u32 s41, s41, 16384
  s_add_u32 s31, s31, 32768
  s_cmp_eq_u32 s31, s30
  s_cselect_b32 s31, s42, s31
  v_mfma_f32_16x16x32_bf16 v[112:115], v[128:131], a[200:203], v[112:115]
  v_exp_f32 v97, v97
  v_mfma_f32_16x16x32_bf16 v[112:115], v[132:135], a[204:207], v[112:115]
  v_max3_f32 v48, v48, v107, v108
  v_mfma_f32_16x16x32_bf16 v[116:119], v[136:139], a[192:195], v[64:67]
  v_exp_f32 v98, v98
  v_mfma_f32_16x16x32_bf16 v[116:119], v[140:143], a[196:199], v[116:119]
  v_max3_f32 v48, v48, v109, v110
  v_mfma_f32_16x16x32_bf16 v[116:119], v[144:147], a[200:203], v[116:119]
  v_cvt_pk_bf16_f32 v36, v96, v97
  v_mfma_f32_16x16x32_bf16 v[116:119], v[148:151], a[204:207], v[116:119]
  v_max_f32 v48, v48, v111
  v_mfma_f32_16x16x32_bf16 a[128:131], v[216:219], v[44:47], a[128:131]
  v_exp_f32 v99, v99
  v_mfma_f32_16x16x32_bf16 a[132:135], v[220:223], v[44:47], a[132:135]
  v_cmp_lt_f32 vcc, s35, v48
  v_mfma_f32_16x16x32_bf16 a[136:139], v[224:227], v[44:47], a[136:139]
  v_exp_f32 v100, v100
  v_mfma_f32_16x16x32_bf16 a[140:143], v[228:231], v[44:47], a[140:143]
  v_cvt_pk_bf16_f32 v37, v98, v99
  v_mfma_f32_16x16x32_bf16 a[144:147], v[232:235], v[44:47], a[144:147]
  v_exp_f32 v101, v101
  v_mfma_f32_16x16x32_bf16 a[148:151], v[236:239], v[44:47], a[148:151]
  v_exp_f32 v102, v102
  v_mfma_f32_16x16x32_bf16 a[152:155], v[240:243], v[44:47], a[152:155]
  v_cvt_pk_bf16_f32 v38, v100, v101
  v_mfma_f32_16x16x32_bf16 a[156:159], v[244:247], v[44:47], a[156:159]
  v_exp_f32 v103, v103
  v_mfma_f32_16x16x32_bf16 v[92:95], v[52:55], v[44:47], v[92:95]
  v_cvt_pk_bf16_f32 v39, v102, v103
  s_sub_u32 s33, s33, 1
  s_cmp_lg_u32 s33, 0
  s_cbranch_scc1 fa_kernel_atd
  s_waitcnt vmcnt(8) lgkmcnt(0)
  s_barrier
  s_cbranch_vccnz fa_kernel_rare67
fa_kernel_back67:
  v_mfma_f32_16x16x32_bf16 v[96:99], v[120:123], a[208:211], v[68:71]
  v_exp_f32 v104, v104
  v_mfma_f32_16x16x32_bf16 v[96:99], v[124:127], a[212:215], v[96:99]
  v_max3_f32 v48, v112, v113, v114
  ds_read_b128 v[184:187], v28 offset:0
  v_mfma_f32_16x16x32_bf16 v[96:99], v[128:131], a[216:219], v[96:99]
  v_exp_f32 v105, v105
  v_mfma_f32_16x16x32_bf16 v[96:99], v[132:135], a[220:223], v[96:99]
  v_max3_f32 v48, v48, v115, v116
  ds_read_b128 v[188:191], v29 offset:0
  v_mfma_f32_16x16x32_bf16 v[100:103], v[136:139], a[208:211], v[68:71]
  v_exp_f32 v106, v106
  v_mfma_f32_16x16x32_bf16 v[100:103], v[140:143], a[212:215], v[100:103]
  v_max3_f32 v48, v48, v117, v118
  ds_read_b128 v[192:195], v30 offset:0
  v_mfma_f32_16x16x32_bf16 v[100:103], v[144:147], a[216:219], v[100:103]
  v_cvt_pk_bf16_f32 v40, v104, v105
  ds_read_b128 v[196:199], v31 offset:0
  v_mfma_f32_16x16x32_bf16 v[100:103], v[148:151], a[220:223], v[100:103]
  v_max_f32 v48, v48, v119
  ds_read_b128 v[200:203], v28 offset:4096
  v_mfma_f32_16x16x32_bf16 a[0:3], v[152:155], v[36:39], a[0:3]
  v_exp_f32 v107, v107
  v_mfma_f32_16x16x32_bf16 a[4:7], v[156:159], v[36:39], a[4:7]
  v_cmp_lt_f32 vcc, s36, v48
  ds_read_b128 v[204:207], v29 offset:4096
  v_mfma_f32_16x16x32_bf16 a[8:11], v[160:163], v[36:39], a[8:11]
  v_exp_f32 v108, v108
  v_mfma_f32_16x16x32_bf16 a[12:15], v[164:167], v[36:39], a[12:15]
  v_cvt_pk_bf16_f32 v41, v106, v107
  ds_read_b128 v[208:211], v30 offset:4096
  v_mfma_f32_16x16x32_bf16 a[16:19], v[168:171], v[36:39], a[16:19]
  v_exp_f32 v109, v109
  v_mfma_f32_16x16x32_bf16 a[20:23], v[172:175], v[36:39], a[20:23]
  v_exp_f32 v110, v110
  v_mfma_f32_16x16x32_bf16 a[24:27], v[176:179], v[36:39], a[24:27]
  v_cvt_pk_bf16_f32 v42, v108, v109
  ds_read_b128 v[212:215], v31 offset:4096
  v_mfma_f32_16x16x32_bf16 a[28:31], v[180:183], v[36:39], a[28:31]
  v_exp_f32 v111, v111
  s_mov_b32 m0, s31
  v_mfma_f32_16x16x32_bf16 v[76:79], v[52:55], v[36:39], v[76:79]
  v_cvt_pk_bf16_f32 v43, v110, v111
  buffer_load_dwordx4 v10, s[8:11], s41 offen offset:0 nt lds
  s_cbranch_vccnz fa_kernel_rare68
fa_kernel_back68:
  s_waitcnt lgkmcnt(7)
  v_mfma_f32_16x16x32_bf16 v[104:107], v[184:187], a[160:163], v[56:59]
  v_exp_f32 v112, v112
  s_waitcnt lgkmcnt(6)
  v_mfma_f32_16x16x32_bf16 v[104:107], v[188:191], a[164:167], v[104:107]
  v_max3_f32 v48, v96, v97, v98
  ds_read_b64_tr_b16 v[216:217], v252 offset:0
  s_waitcnt lgkmcnt(6)
  v_mfma_f32_16x16x32_bf16 v[104:107], v[192:195], a[168:171], v[104:107]
  v_exp_f32 v113, v113
  s_waitcnt lgkmcnt(5)
  v_mfma_f32_16x16x32_bf16 v[104:107], v[196:199], a[172:175], v[104:107]
  v_max3_f32 v48, v48, v99, v100
  ds_read_b64_tr_b16 v[218:219], v252 offset:4096
  s_waitcnt lgkmcnt(5)
  v_mfma_f32_16x16x32_bf16 v[108:111], v[200:203], a[160:163], v[56:59]
  v_exp_f32 v114, v114
  s_waitcnt lgkmcnt(4)
  v_mfma_f32_16x16x32_bf16 v[108:111], v[204:207], a[164:167], v[108:111]
  v_max3_f32 v48, v48, v101, v102
  ds_read_b64_tr_b16 v[220:221], v252 offset:8
  s_waitcnt lgkmcnt(4)
  v_mfma_f32_16x16x32_bf16 v[108:111], v[208:211], a[168:171], v[108:111]
  v_cvt_pk_bf16_f32 v44, v112, v113
  ds_read_b64_tr_b16 v[222:223], v252 offset:4104
  s_waitcnt lgkmcnt(4)
  v_mfma_f32_16x16x32_bf16 v[108:111], v[212:215], a[172:175], v[108:111]
  v_max_f32 v48, v48, v103
  ds_read_b64_tr_b16 v[224:225], v253 offset:0
  v_mfma_f32_16x16x32_bf16 a[32:35], v[152:155], v[40:43], a[32:35]
  v_exp_f32 v115, v115
  v_mfma_f32_16x16x32_bf16 a[36:39], v[156:159], v[40:43], a[36:39]
  v_cmp_lt_f32 vcc, s37, v48
  ds_read_b64_tr_b16 v[226:227], v253 offset:4096
  v_mfma_f32_16x16x32_bf16 a[40:43], v[160:163], v[40:43], a[40:43]
  v_exp_f32 v116, v116
  v_mfma_f32_16x16x32_bf16 a[44:47], v[164:167], v[40:43], a[44:47]
  v_cvt_pk_bf16_f32 v45, v114, v115
  buffer_load_dwordx4 v11, s[8:11], s41 offen offset:1024 nt lds
  v_mfma_f32_16x16x32_bf16 a[48:51], v[168:171], v[40:43], a[48:51]
  v_exp_f32 v117, v117
  v_mfma_f32_16x16x32_bf16 a[52:55], v[172:175], v[40:43], a[52:55]
  v_exp_f32 v118, v118
  v_mfma_f32_16x16x32_bf16 a[56:59], v[176:179], v[40:43], a[56:59]
  v_cvt_pk_bf16_f32 v46, v116, v117
  buffer_load_dwordx4 v12, s[8:11], s41 offen offset:2048 nt lds
  v_mfma_f32_16x16x32_bf16 a[60:63], v[180:183], v[40:43], a[60:63]
  v_exp_f32 v119, v119
  v_mfma_f32_16x16x32_bf16 v[80:83], v[52:55], v[40:43], v[80:83]
  v_cvt_pk_bf16_f32 v47, v118, v119
  buffer_load_dwordx4 v13, s[8:11], s41 offen offset:3072 nt lds
  s_cbranch_vccnz fa_kernel_rare69
fa_kernel_back69:
  v_mfma_f32_16x16x32_bf16 v[112:115], v[184:187], a[176:179], v[60:63]
  v_exp_f32 v96, v96
  v_mfma_f32_16x16x32_bf16 v[112:115], v[188:191], a[180:183], v[112:115]
  v_max3_f32 v48, v104, v105, v106
  ds_read_b64_tr_b16 v[228:229], v253 offset:8
  v_mfma_f32_16x16x32_bf16 v[112:115], v[192:195], a[184:187], v[112:115]
  v_exp_f32 v97, v97
  v_mfma_f32_16x16x32_bf16 v[112:115], v[196:199], a[188:191], v[112:115]
  v_max3_f32 v48, v48, v107, v108
  ds_read_b64_tr_b16 v[230:231], v253 offset:4104
  v_mfma_f32_16x16x32_bf16 v[116:119], v[200:203], a[176:179], v[60:63]
  v_exp_f32 v98, v98
  v_mfma_f32_16x16x32_bf16 v[116:119], v[204:207], a[180:183], v[116:119]
  v_max3_f32 v48, v48, v109, v110
  ds_read_b64_tr_b16 v[232:233], v254 offset:0
  v_mfma_f32_16x16x32_bf16 v[116:119], v[208:211], a[184:187], v[116:119]
  v_cvt_pk_bf16_f32 v36, v96, v97
  ds_read_b64_tr_b16 v[234:235], v254 offset:4096
  v_mfma_f32_16x16x32_bf16 v[116:119], v[212:215], a[188:191], v[116:119]
  v_max_f32 v48, v48, v111
  v_mfma_f32_16x16x32_bf16 a[64:67], v[152:155], v[44:47], a[64:67]
  v_exp_f32 v99, v99
  v_mfma_f32_16x16x32_bf16 a[68:71], v[156:159], v[44:47], a[68:71]
  v_cmp_lt_f32 vcc, s34, v48
  ds_read_b64_tr_b16 v[236:237], v254 offset:8
  v_mfma_f32_16x16x32_bf16 a[72:75], v[160:163], v[44:47], a[72:75]
  v_exp_f32 v100, v100
  s_add_u32 m0, s31, 4096
  v_mfma_f32_16x16x32_bf16 a[76:79], v[164:167], v[44:47], a[76:79]
  v_cvt_pk_bf16_f32 v37, v98, v99
  buffer_load_dwordx4 v248, s[8:11], s41 offen offset:0 nt lds
  v_mfma_f32_16x16x32_bf16 a[80:83], v[168:171], v[44:47], a[80:83]
  v_exp_f32 v101, v101
  v_mfma_f32_16x16x32_bf16 a[84:87], v[172:175], v[44:47], a[84:87]
  v_exp_f32 v102, v102
  v_mfma_f32_16x16x32_bf16 a[88:91], v[176:179], v[44:47], a[88:91]
  v_cvt_pk_bf16_f32 v38, v100, v101
  buffer_load_dwordx4 v249, s[8:11], s41 offen offset:1024 nt lds
  v_mfma_f32_16x16x32_bf16 a[92:95], v[180:183], v[44:47], a[92:95]
  v_exp_f32 v103, v103
  v_mfma_f32_16x16x32_bf16 v[84:87], v[52:55], v[44:47], v[84:87]
  v_cvt_pk_bf16_f32 v39, v102, v103
  s_cbranch_vccnz fa_kernel_rare70
fa_kernel_back70:
  v_mfma_f32_16x16x32_bf16 v[96:99], v[184:187], a[192:195], v[64:67]
  v_exp_f32 v104, v104
  v_mfma_f32_16x16x32_bf16 v[96:99], v[188:191], a[196:199], v[96:99]
  v_max3_f32 v48, v112, v113, v114
  buffer_load_dwordx4 v250, s[8:11], s41 offen offset:2048 nt lds
  v_mfma_f32_16x16x32_bf16 v[96:99], v[192:195], a[200:203], v[96:99]
  v_exp_f32 v105, v105
  v_mfma_f32_16x16x32_bf16 v[96:99], v[196:199], a[204:207], v[96:99]
  v_max3_f32 v48, v48, v115, v116
  buffer_load_dwordx4 v251, s[8:11], s41 offen offset:3072 nt lds
  v_mfma_f32_16x16x32_bf16 v[100:103], v[200:203], a[192:195], v[64:67]
  v_exp_f32 v106, v106
  v_mfma_f32_16x16x32_bf16 v[100:103], v[204:207], a[196:199], v[100:103]
  v_max3_f32 v48, v48, v117, v118
  ds_read_b64_tr_b16 v[238:239], v254 offset:4104
  v_mfma_f32_16x16x32_bf16 v[100:103], v[208:211], a[200:203], v[100:103]
  v_cvt_pk_bf16_f32 v40, v104, v105
  ds_read_b64_tr_b16 v[240:241], v255 offset:0
  v_mfma_f32_16x16x32_bf16 v[100:103], v[212:215], a[204:207], v[100:103]
  v_max_f32 v48, v48, v119
  s_add_u32 s41, s41, 16384
  s_add_u32 s31, s31, 32768
  s_cmp_eq_u32 s31, s30
  s_cselect_b32 s31, s42, s31
  v_mfma_f32_16x16x32_bf16 a[96:99], v[152:155], v[36:39], a[96:99]
  v_exp_f32 v107, v107
  v_mfma_f32_16x16x32_bf16 a[100:103], v[156:159], v[36:39], a[100:103]
  v_cmp_lt_f32 vcc, s35, v48
  ds_read_b64_tr_b16 v[242:243], v255 offset:4096
  v_mfma_f32_16x16x32_bf16 a[104:107], v[160:163], v[36:39], a[104:107]
  v_exp_f32 v108, v108
  v_mfma_f32_16x16x32_bf16 a[108:111], v[164:167], v[36:39], a[108:111]
  v_cvt_pk_bf16_f32 v41, v106, v107
  ds_read_b64_tr_b16 v[244:245], v255 offset:8
  v_mfma_f32_16x16x32_bf16 a[112:115], v[168:171], v[36:39], a[112:115]
  v_exp_f32 v109, v109
  v_mfma_f32_16x16x32_bf16 a[116:119], v[172:175], v[36:39], a[116:119]
  v_exp_f32 v110, v110
  v_mfma_f32_16x16x32_bf16 a[120:123], v[176:179], v[36:39], a[120:123]
  v_cvt_pk_bf16_f32 v42, v108, v109
  s_waitcnt lgkmcnt(4)
  ds_read_b64_tr_b16 v[246:247], v255 offset:4104
  v_mfma_f32_16x16x32_bf16 a[124:127], v[180:183], v[36:39], a[124:127]
  v_exp_f32 v111, v111
  v_mfma_f32_16x16x32_bf16 v[88:91], v[52:55], v[36:39], v[88:91]
  v_cvt_pk_bf16_f32 v43, v110, v111
  s_waitcnt vmcnt(8) lgkmcnt(0)
  s_barrier
  s_cbranch_vccnz fa_kernel_rare71
fa_kernel_back71:
  v_mfma_f32_16x16x32_bf16 v[104:107], v[184:187], a[208:211], v[68:71]
  v_exp_f32 v112, v112
  s_mov_b32 m0, s31
  v_mfma_f32_16x16x32_bf16 v[104:107], v[188:191], a[212:215], v[104:107]
  v_max3_f32 v48, v96, v97, v98
  buffer_load_dwordx4 v10, s[8:11], s41 offen offset:0 nt lds
  v_mfma_f32_16x16x32_bf16 v[104:107], v[192:195], a[216:219], v[104:107]
  v_exp_f32 v113, v113
  v_mfma_f32_16x16x32_bf16 v[104:107], v[196:199], a[220:223], v[104:107]
  v_max3_f32 v48, v48, v99, v100
  v_mfma_f32_16x16x32_bf16 v[108:111], v[200:203], a[208:211], v[68:71]
  v_exp_f32 v114, v114
  v_mfma_f32_16x16x32_bf16 v[108:111], v[204:207], a[212:215], v[108:111]
  v_max3_f32 v48, v48, v101, v102
  v_mfma_f32_16x16x32_bf16 v[108:111], v[208:211], a[216:219], v[108:111]
  v_cvt_pk_bf16_f32 v44, v112, v113
  v_mfma_f32_16x16x32_bf16 v[108:111], v[212:215], a[220:223], v[108:111]
  v_max_f32 v48, v48, v103
  v_mfma_f32_16x16x32_bf16 a[0:3], v[216:219], v[40:43], a[0:3]
  v_exp_f32 v115, v115
  v_mfma_f32_16x16x32_bf16 a[4:7], v[220:223], v[40:43], a[4:7]
  v_cmp_lt_f32 vcc, s36, v48
  v_mfma_f32_16x16x32_bf16 a[8:11], v[224:227], v[40:43], a[8:11]
  v_exp_f32 v116, v116
  v_mfma_f32_16x16x32_bf16 a[12:15], v[228:231], v[40:43], a[12:15]
  v_cvt_pk_bf16_f32 v45, v114, v115
  v_mfma_f32_16x16x32_bf16 a[16:19], v[232:235], v[40:43], a[16:19]
  v_exp_f32 v117, v117
  v_mfma_f32_16x16x32_bf16 a[20:23], v[236:239], v[40:43], a[20:23]
  v_exp_f32 v118, v118
  v_mfma_f32_16x16x32_bf16 a[24:27], v[240:243], v[40:43], a[24:27]
  v_cvt_pk_bf16_f32 v46, v116, v117
  v_mfma_f32_16x16x32_bf16 a[28:31], v[244:247], v[40:43], a[28:31]
  v_exp_f32 v119, v119
  v_mfma_f32_16x16x32_bf16 v[76:79], v[52:55], v[40:43], v[76:79]
  v_cvt_pk_bf16_f32 v47, v118, v119
  s_cbranch_vccnz fa_kernel_rare72
fa_kernel_back72:
  v_mfma_f32_16x16x32_bf16 v[112:115], v[184:187], a[224:227], v[72:75]
  v_exp_f32 v96, v96
  v_mfma_f32_16x16x32_bf16 v[112:115], v[188:191], a[228:231], v[112:115]
  v_max3_f32 v48, v104, v105, v106
  buffer_load_dwordx4 v11, s[8:11], s41 offen offset:1024 nt lds
  v_mfma_f32_16x16x32_bf16 v[112:115], v[192:195], a[232:235], v[112:115]
  v_exp_f32 v97, v97
  v_mfma_f32_16x16x32_bf16 v[112:115], v[196:199], a[236:239], v[112:115]
  v_max3_f32 v48, v48, v107, v108
  v_mfma_f32_16x16x32_bf16 v[116:119], v[200:203], a[224:227], v[72:75]
  v_exp_f32 v98, v98
  v_mfma_f32_16x16x32_bf16 v[116:119], v[204:207], a[228:231], v[116:119]
  v_max3_f32 v48, v48, v109, v110
  v_mfma_f32_16x16x32_bf16 v[116:119], v[208:211], a[232:235], v[116:119]
  v_cvt_pk_bf16_f32 v36, v96, v97
  buffer_load_dwordx4 v12, s[8:11], s41 offen offset:2048 nt lds
  v_mfma_f32_16x16x32_bf16 v[116:119], v[212:215], a[236:239], v[116:119]
  v_max_f32 v48, v48, v111
  v_mfma_f32_16x16x32_bf16 a[32:35], v[216:219], v[44:47], a[32:35]
  v_exp_f32 v99, v99
  v_mfma_f32_16x16x32_bf16 a[36:39], v[220:223], v[44:47], a[36:39]
  v_cmp_lt_f32 vcc, s37, v48
  v_mfma_f32_16x16x32_bf16 a[40:43], v[224:227], v[44:47], a[40:43]
  v_exp_f32 v100, v100
  v_mfma_f32_16x16x32_bf16 a[44:47], v[228:231], v[44:47], a[44:47]
  v_cvt_pk_bf16_f32 v37, v98, v99
  buffer_load_dwordx4 v13, s[8:11], s41 offen offset:3072 nt lds
  v_mfma_f32_16x16x32_bf16 a[48:51], v[232:235], v[44:47], a[48:51]
  v_exp_f32 v101, v101
  v_mfma_f32_16x16x32_bf16 a[52:55], v[236:239], v[44:47], a[52:55]
  v_exp_f32 v102, v102
  v_mfma_f32_16x16x32_bf16 a[56:59], v[240:243], v[44:47], a[56:59]
  v_cvt_pk_bf16_f32 v38, v100, v101
  v_mfma_f32_16x16x32_bf16 a[60:63], v[244:247], v[44:47], a[60:63]
  v_exp_f32 v103, v103
  v_mfma_f32_16x16x32_bf16 v[80:83], v[52:55], v[44:47], v[80:83]
  v_cvt_pk_bf16_f32 v39, v102, v103
  s_cbranch_vccnz fa_kernel_rare73
fa_kernel_back73:
  s_nop 0
  v_mfma_f32_16x16x32_bf16 a[64:67], v[216:219], v[36:39], a[64:67]
  v_exp_f32 v104, v104
  s_add_u32 m0, s31, 4096
  v_mfma_f32_16x16x32_bf16 a[68:71], v[220:223], v[36:39], a[68:71]
  v_max3_f32 v48, v112, v113, v114
  buffer_load_dwordx4 v248, s[8:11], s41 offen offset:0 nt lds
  v_mfma_f32_16x16x32_bf16 a[72:75], v[224:227], v[36:39], a[72:75]
  v_exp_f32 v105, v105
  v_mfma_f32_16x16x32_bf16 a[76:79], v[228:231], v[36:39], a[76:79]
  v_max3_f32 v48, v48, v115, v116
  v_mfma_f32_16x16x32_bf16 a[80:83], v[232:235], v[36:39], a[80:83]
  v_exp_f32 v106, v106
  v_mfma_f32_16x16x32_bf16 a[84:87], v[236:239], v[36:39], a[84:87]
  v_max3_f32 v48, v48, v117, v118
  buffer_load_dwordx4 v249, s[8:11], s41 offen offset:1024 nt lds
  v_mfma_f32_16x16x32_bf16 a[88:91], v[240:243], v[36:39], a[88:91]
  v_cvt_pk_bf16_f32 v40, v104, v105
  v_mfma_f32_16x16x32_bf16 a[92:95], v[244:247], v[36:39], a[92:95]
  v_max_f32 v48, v48, v119
  v_mfma_f32_16x16x32_bf16 v[84:87], v[52:55], v[36:39], v[84:87]
  v_exp_f32 v107, v107
  v_cmp_lt_f32 vcc, s38, v48
  v_exp_f32 v108, v108
  v_cvt_pk_bf16_f32 v41, v106, v107
  v_exp_f32 v109, v109
  v_exp_f32 v110, v110
  v_cvt_pk_bf16_f32 v42, v108, v109
  v_exp_f32 v111, v111
  s_nop 0
  v_cvt_pk_bf16_f32 v43, v110, v111
  s_cbranch_vccnz fa_kernel_rare74
fa_kernel_back74:
  s_nop 0
  v_mfma_f32_16x16x32_bf16 a[96:99], v[216:219], v[40:43], a[96:99]
  v_exp_f32 v112, v112
  v_mfma_f32_16x16x32_bf16 a[100:103], v[220:223], v[40:43], a[100:103]
  v_exp_f32 v113, v113
  v_mfma_f32_16x16x32_bf16 a[104:107], v[224:227], v[40:43], a[104:107]
  v_exp_f32 v114, v114
  v_mfma_f32_16x16x32_bf16 a[108:111], v[228:231], v[40:43], a[108:111]
  v_cvt_pk_bf16_f32 v44, v112, v113
  buffer_load_dwordx4 v250, s[8:11], s41 offen offset:2048 nt lds
  v_mfma_f32_16x16x32_bf16 a[112:115], v[232:235], v[40:43], a[112:115]
  v_exp_f32 v115, v115
  v_mfma_f32_16x16x32_bf16 a[116:119], v[236:239], v[40:43], a[116:119]
  v_exp_f32 v116, v116
  v_mfma_f32_16x16x32_bf16 a[120:123], v[240:243], v[40:43], a[120:123]
  v_cvt_pk_bf16_f32 v45, v114, v115
  buffer_load_dwordx4 v251, s[8:11], s41 offen offset:3072 nt lds
  v_mfma_f32_16x16x32_bf16 a[124:127], v[244:247], v[40:43], a[124:127]
  v_exp_f32 v117, v117
  v_mfma_f32_16x16x32_bf16 v[88:91], v[52:55], v[40:43], v[88:91]
  v_exp_f32 v118, v118
  v_cvt_pk_bf16_f32 v46, v116, v117
  v_exp_f32 v119, v119
  s_nop 0
  v_cvt_pk_bf16_f32 v47, v118, v119
  s_nop 1
  v_mfma_f32_16x16x32_bf16 a[128:131], v[216:219], v[44:47], a[128:131]
  s_add_u32 s41, s41, 16384
  s_add_u32 s31, s31, 32768
  s_cmp_eq_u32 s31, s30
  s_cselect_b32 s31, s42, s31
  v_mfma_f32_16x16x32_bf16 a[132:135], v[220:223], v[44:47], a[132:135]
  v_mfma_f32_16x16x32_bf16 a[136:139], v[224:227], v[44:47], a[136:139]
  v_mfma_f32_16x16x32_bf16 a[140:143], v[228:231], v[44:47], a[140:143]
  v_mfma_f32_16x16x32_bf16 a[144:147], v[232:235], v[44:47], a[144:147]
  v_mfma_f32_16x16x32_bf16 a[148:151], v[236:239], v[44:47], a[148:151]
  v_mfma_f32_16x16x32_bf16 a[152:155], v[240:243], v[44:47], a[152:155]
  v_mfma_f32_16x16x32_bf16 a[156:159], v[244:247], v[44:47], a[156:159]
  v_mfma_f32_16x16x32_bf16 v[92:95], v[52:55], v[44:47], v[92:95]
  s_branch fa_kernel_scmb
fa_kernel_scmb:
  s_nop 7
  s_waitcnt lgkmcnt(0)
  s_barrier
  v_lshlrev_b32 v2, 2, v1
  v_add_u32 v2, 131072, v2
  s_mul_i32 s39, s24, 2560
  v_add_u32 v3, s39, v2
  v_lshlrev_b32 v8, 4, v1
  v_add_u32 v8, 98304, v8
  s_lshl_b32 s39, s24, 13
  s_lshl_b32 s40, s26, 12
  s_add_u32 s43, s39, s40
  v_add_u32 v5, s43, v8
  s_xor_b32 s43, s43, 4096
  v_add_u32 v6, s43, v8
  ds_write_b32 v3, v56 offset:0
  ds_write_b32 v3, v76 offset:256
  ds_write_b32 v3, v60 offset:512
  ds_write_b32 v3, v80 offset:768
  ds_write_b32 v3, v64 offset:1024
  ds_write_b32 v3, v84 offset:1280
  ds_write_b32 v3, v68 offset:1536
  ds_write_b32 v3, v88 offset:1792
  ds_write_b32 v3, v72 offset:2048
  ds_write_b32 v3, v92 offset:2304
  ds_write_b128 v5, a[128:131] offset:0
  ds_write_b128 v5, a[132:135] offset:1024
  ds_write_b128 v5, a[136:139] offset:2048
  ds_write_b128 v5, a[140:143] offset:3072
  ds_write_b128 v6, a[144:147] offset:0
  s_waitcnt lgkmcnt(14)
  ds_write_b128 v6, a[148:151] offset:1024
  s_waitcnt lgkmcnt(14)
  ds_write_b128 v6, a[152:155] offset:2048
  s_waitcnt lgkmcnt(14)
  ds_write_b128 v6, a[156:159] offset:3072
  s_mov_b64 s[72:73], 0
  s_mov_b32 s50, 0x21800000
  v_mov_b32 v51, 0x5d800000
  v_mov_b32 v36, 0
  v_mov_b32 v37, 0
  v_mov_b32 v38, 0
  v_mov_b32 v39, 0
  s_xor_b32 s39, s24, 2
  s_mul_i32 s39, s39, 2560
  v_add_u32 v4, s39, v2
  s_lshl_b32 s39, s24, 11
  v_add_u32 v5, s39, v8
  v_lshlrev_b32 v7, 4, v1
  s_mul_i32 s46, s58, 36864
  s_mul_i32 s47, s24, 9216
  s_add_u32 s47, s47, 8192
  s_add_u32 s47, s47, s46
  s_lshl_b32 s39, s25, 12
  s_mul_i32 s40, s26, 18432
  s_add_u32 s39, s39, s40
  s_add_u32 s46, s46, s39
  s_waitcnt lgkmcnt(0)
  s_barrier
  ds_read_b32 v120, v4 offset:0
  ds_read_b32 v121, v4 offset:256
  ds_read_b32 v122, v4 offset:512
  ds_read_b32 v123, v4 offset:768
  ds_read_b32 v124, v4 offset:1024
  ds_read_b32 v125, v4 offset:1280
  ds_read_b32 v126, v4 offset:1536
  ds_read_b32 v127, v4 offset:1792
  ds_read_b32 v128, v2 offset:2048
  ds_read_b32 v129, v2 offset:2304
  ds_read_b32 v130, v2 offset:4608
  ds_read_b32 v131, v2 offset:4864
  ds_read_b32 v132, v2 offset:7168
  ds_read_b32 v133, v2 offset:7424
  ds_read_b32 v134, v2 offset:9728
  s_waitcnt lgkmcnt(14)
  ds_read_b32 v135, v2 offset:9984
  s_waitcnt lgkmcnt(14)
  ds_read_b128 v[160:163], v5 offset:0
  s_waitcnt lgkmcnt(14)
  ds_read_b128 v[164:167], v5 offset:1024
  s_waitcnt lgkmcnt(14)
  ds_read_b128 v[168:171], v5 offset:8192
  s_waitcnt lgkmcnt(14)
  ds_read_b128 v[172:175], v5 offset:9216
  s_waitcnt lgkmcnt(14)
  ds_read_b128 v[176:179], v5 offset:16384
  s_waitcnt lgkmcnt(14)
  ds_read_b128 v[180:183], v5 offset:17408
  s_waitcnt lgkmcnt(14)
  ds_read_b128 v[184:187], v5 offset:24576
  s_waitcnt lgkmcnt(14)
  ds_read_b128 v[188:191], v5 offset:25600
  s_lshl_b32 s39, s24, 14
  v_add_u32 v3, s39, v8
  s_xor_b32 s39, s39, 32768
  v_add_u32 v4, s39, v8
  v_accvgpr_read_b32 v192, a0
  v_accvgpr_read_b32 v193, a1
  v_accvgpr_read_b32 v194, a2
  v_accvgpr_read_b32 v195, a3
  v_accvgpr_read_b32 v196, a4
  v_accvgpr_read_b32 v197, a5
  v_accvgpr_read_b32 v198, a6
  v_accvgpr_read_b32 v199, a7
  v_accvgpr_read_b32 v200, a8
  v_accvgpr_read_b32 v201, a9
  v_accvgpr_read_b32 v202, a10
  v_accvgpr_read_b32 v203, a11
  v_accvgpr_read_b32 v204, a12
  v_accvgpr_read_b32 v205, a13
  v_accvgpr_read_b32 v206, a14
  v_accvgpr_read_b32 v207, a15
  v_accvgpr_read_b32 v208, a32
  v_accvgpr_read_b32 v209, a33
  v_accvgpr_read_b32 v210, a34
  v_accvgpr_read_b32 v211, a35
  v_accvgpr_read_b32 v212, a36
  v_accvgpr_read_b32 v213, a37
  v_accvgpr_read_b32 v214, a38
  v_accvgpr_read_b32 v215, a39
  v_accvgpr_read_b32 v216, a40
  v_accvgpr_read_b32 v217, a41
  v_accvgpr_read_b32 v218, a42
  v_accvgpr_read_b32 v219, a43
  v_accvgpr_read_b32 v220, a44
  v_accvgpr_read_b32 v221, a45
  v_accvgpr_read_b32 v222, a46
  v_accvgpr_read_b32 v223, a47
  v_accvgpr_read_b32 v224, a64
  v_accvgpr_read_b32 v225, a65
  v_accvgpr_read_b32 v226, a66
  v_accvgpr_read_b32 v227, a67
  v_accvgpr_read_b32 v228, a68
  v_accvgpr_read_b32 v229, a69
  v_accvgpr_read_b32 v230, a70
  v_accvgpr_read_b32 v231, a71
  v_accvgpr_read_b32 v232, a72
  v_accvgpr_read_b32 v233, a73
  v_accvgpr_read_b32 v234, a74
  v_accvgpr_read_b32 v235, a75
  v_accvgpr_read_b32 v236, a76
  v_accvgpr_read_b32 v237, a77
  v_accvgpr_read_b32 v238, a78
  v_accvgpr_read_b32 v239, a79
  v_accvgpr_read_b32 v96, a96
  v_accvgpr_read_b32 v97, a97
  v_accvgpr_read_b32 v98, a98
  v_accvgpr_read_b32 v99, a99
  v_accvgpr_read_b32 v100, a100
  v_accvgpr_read_b32 v101, a101
  v_accvgpr_read_b32 v102, a102
  v_accvgpr_read_b32 v103, a103
  v_accvgpr_read_b32 v104, a104
  v_accvgpr_read_b32 v105, a105
  v_accvgpr_read_b32 v106, a106
  v_accvgpr_read_b32 v107, a107
  v_accvgpr_read_b32 v108, a108
  v_accvgpr_read_b32 v109, a109
  v_accvgpr_read_b32 v110, a110
  v_accvgpr_read_b32 v111, a111
  s_waitcnt lgkmcnt(0)
  s_barrier
  ds_write_b128 v3, a[16:19] offset:0
  ds_write_b128 v3, a[20:23] offset:1024
  ds_write_b128 v3, a[24:27] offset:2048
  ds_write_b128 v3, a[28:31] offset:3072
  ds_write_b128 v3, a[48:51] offset:4096
  ds_write_b128 v3, a[52:55] offset:5120
  ds_write_b128 v3, a[56:59] offset:6144
  ds_write_b128 v3, a[60:63] offset:7168
  ds_write_b128 v3, a[80:83] offset:8192
  ds_write_b128 v3, a[84:87] offset:9216
  ds_write_b128 v3, a[88:91] offset:10240
  ds_write_b128 v3, a[92:95] offset:11264
  ds_write_b128 v3, a[112:115] offset:12288
  ds_write_b128 v3, a[116:119] offset:13312
  ds_write_b128 v3, a[120:123] offset:14336
  s_waitcnt lgkmcnt(14)
  ds_write_b128 v3, a[124:127] offset:15360
  v_min_f32 v2, v56, v120
  v_sub_f32 v6, v2, v56
  v_sub_f32 v5, v2, v120
  v_exp_f32 v6, v6
  v_exp_f32 v5, v5
  s_nop 0
  v_mul_f32 v9, v6, v76
  v_fma_f32 v9, v5, v121, v9
  v_cmp_nge_f32 s[60:61], v9, s50
  v_cmp_nle_f32 vcc, v9, v51
  v_rcp_f32 v9, v9
  s_or_b64 s[72:73], s[72:73], s[60:61]
  s_or_b64 s[72:73], s[72:73], vcc
  v_mul_f32 v136, v6, v9
  v_mul_f32 v137, v6, v9
  v_mul_f32 v138, v5, v9
  v_mul_f32 v139, v5, v9
  v_min_f32 v2, v60, v122
  v_sub_f32 v6, v2, v60
  v_sub_f32 v5, v2, v122
  v_exp_f32 v6, v6
  v_exp_f32 v5, v5
  s_nop 0
  v_mul_f32 v9, v6, v80
  v_fma_f32 v9, v5, v123, v9
  v_cmp_nge_f32 s[60:61], v9, s50
  v_cmp_nle_f32 vcc, v9, v51
  v_rcp_f32 v9, v9
  s_or_b64 s[72:73], s[72:73], s[60:61]
  s_or_b64 s[72:73], s[72:73], vcc
  v_mul_f32 v140, v6, v9
  v_mul_f32 v141, v6, v9
  v_mul_f32 v142, v5, v9
  v_mul_f32 v143, v5, v9
  v_min_f32 v2, v64, v124
  v_sub_f32 v6, v2, v64
  v_sub_f32 v5, v2, v124
  v_exp_f32 v6, v6
  v_exp_f32 v5, v5
  s_nop 0
  v_mul_f32 v9, v6, v84
  v_fma_f32 v9, v5, v125, v9
  v_cmp_nge_f32 s[60:61], v9, s50
  v_cmp_nle_f32 vcc, v9, v51
  v_rcp_f32 v9, v9
  s_or_b64 s[72:73], s[72:73], s[60:61]
  s_or_b64 s[72:73], s[72:73], vcc
  v_mul_f32 v144, v6, v9
  v_mul_f32 v145, v6, v9
  v_mul_f32 v146, v5, v9
  v_mul_f32 v147, v5, v9
  v_min_f32 v2, v68, v126
  v_sub_f32 v6, v2, v68
  v_sub_f32 v5, v2, v126
  v_exp_f32 v6, v6
  v_exp_f32 v5, v5
  s_nop 0
  v_mul_f32 v9, v6, v88
  v_fma_f32 v9, v5, v127, v9
  v_cmp_nge_f32 s[60:61], v9, s50
  v_cmp_nle_f32 vcc, v9, v51
  v_rcp_f32 v9, v9
  s_or_b64 s[72:73], s[72:73], s[60:61]
  s_or_b64 s[72:73], s[72:73], vcc
  v_mul_f32 v148, v6, v9
  v_mul_f32 v149, v6, v9
  v_mul_f32 v150, v5, v9
  v_mul_f32 v151, v5, v9
  v_min_f32 v2, v128, v130
  v_min_f32 v6, v132, v134
  v_min_f32 v2, v2, v6
  v_sub_f32 v152, v2, v128
  v_exp_f32 v152, v152
  v_sub_f32 v154, v2, v130
  v_exp_f32 v154, v154
  v_sub_f32 v156, v2, v132
  v_exp_f32 v156, v156
  v_sub_f32 v158, v2, v134
  v_exp_f32 v158, v158
  s_nop 0
  v_mul_f32 v9, v152, v129
  v_fma_f32 v9, v154, v131, v9
  v_fma_f32 v9, v156, v133, v9
  v_fma_f32 v9, v158, v135, v9
  v_cmp_nge_f32 s[60:61], v9, s50
  v_cmp_nle_f32 vcc, v9, v51
  v_rcp_f32 v9, v9
  s_or_b64 s[72:73], s[72:73], s[60:61]
  s_or_b64 s[72:73], s[72:73], vcc
  v_mul_f32 v152, v152, v9
  v_mov_b32 v153, v152
  v_mul_f32 v154, v154, v9
  v_mov_b32 v155, v154
  v_mul_f32 v156, v156, v9
  v_mov_b32 v157, v156
  v_mul_f32 v158, v158, v9
  v_mov_b32 v159, v158
  v_mul_f32 v112, v160, v152
  v_mul_f32 v113, v161, v152
  v_mul_f32 v114, v162, v152
  v_mul_f32 v115, v163, v152
  v_mul_f32 v116, v164, v152
  v_mul_f32 v117, v165, v152
  v_mul_f32 v118, v166, v152
  v_mul_f32 v119, v167, v152
  v_fma_f32 v112, v168, v154, v112
  v_fma_f32 v113, v169, v154, v113
  v_fma_f32 v114, v170, v154, v114
  v_fma_f32 v115, v171, v154, v115
  v_fma_f32 v116, v172, v154, v116
  v_fma_f32 v117, v173, v154, v117
  v_fma_f32 v118, v174, v154, v118
  v_fma_f32 v119, v175, v154, v119
  v_fma_f32 v112, v176, v156, v112
  v_fma_f32 v113, v177, v156, v113
  v_fma_f32 v114, v178, v156, v114
  v_fma_f32 v115, v179, v156, v115
  v_fma_f32 v116, v180, v156, v116
  v_fma_f32 v117, v181, v156, v117
  v_fma_f32 v118, v182, v156, v118
  v_fma_f32 v119, v183, v156, v119
  v_fma_f32 v112, v184, v158, v112
  v_fma_f32 v113, v185, v158, v113
  v_fma_f32 v114, v186, v158, v114
  v_fma_f32 v115, v187, v158, v115
  v_fma_f32 v116, v188, v158, v116
  v_fma_f32 v117, v189, v158, v117
  v_fma_f32 v118, v190, v158, v118
  v_fma_f32 v119, v191, v158, v119
  v_fma_f32 v38, v112, v36, v38
  v_fma_f32 v39, v113, v36, v39
  v_cvt_pk_bf16_f32 v40, v112, v113
  v_fma_f32 v38, v114, v36, v38
  v_fma_f32 v39, v115, v36, v39
  v_cvt_pk_bf16_f32 v41, v114, v115
  v_fma_f32 v38, v116, v36, v38
  v_fma_f32 v39, v117, v36, v39
  v_cvt_pk_bf16_f32 v42, v116, v117
  v_fma_f32 v38, v118, v36, v38
  v_fma_f32 v39, v119, v36, v39
  v_cvt_pk_bf16_f32 v43, v118, v119
  buffer_store_dwordx4 v[40:43], v7, s[20:23], s47 offen sc1
  v_mul_f32 v192, v192, v136
  v_mul_f32 v193, v193, v136
  v_mul_f32 v194, v194, v136
  v_mul_f32 v195, v195, v136
  v_mul_f32 v196, v196, v136
  v_mul_f32 v197, v197, v136
  v_mul_f32 v198, v198, v136
  v_mul_f32 v199, v199, v136
  v_mul_f32 v200, v200, v136
  v_mul_f32 v201, v201, v136
  v_mul_f32 v202, v202, v136
  v_mul_f32 v203, v203, v136
  v_mul_f32 v204, v204, v136
  v_mul_f32 v205, v205, v136
  v_mul_f32 v206, v206, v136
  v_mul_f32 v207, v207, v136
  v_mul_f32 v208, v208, v140
  v_mul_f32 v209, v209, v140
  v_mul_f32 v210, v210, v140
  v_mul_f32 v211, v211, v140
  v_mul_f32 v212, v212, v140
  v_mul_f32 v213, v213, v140
  v_mul_f32 v214, v214, v140
  v_mul_f32 v215, v215, v140
  v_mul_f32 v216, v216, v140
  v_mul_f32 v217, v217, v140
  v_mul_f32 v218, v218, v140
  v_mul_f32 v219, v219, v140
  v_mul_f32 v220, v220, v140
  v_mul_f32 v221, v221, v140
  v_mul_f32 v222, v222, v140
  v_mul_f32 v223, v223, v140
  v_mul_f32 v224, v224, v144
  v_mul_f32 v225, v225, v144
  v_mul_f32 v226, v226, v144
  v_mul_f32 v227, v227, v144
  v_mul_f32 v228, v228, v144
  v_mul_f32 v229, v229, v144
  v_mul_f32 v230, v230, v144
  v_mul_f32 v231, v231, v144
  v_mul_f32 v232, v232, v144
  v_mul_f32 v233, v233, v144
  v_mul_f32 v234, v234, v144
  v_mul_f32 v235, v235, v144
  v_mul_f32 v236, v236, v144
  v_mul_f32 v237, v237, v144
  v_mul_f32 v238, v238, v144
  v_mul_f32 v239, v239, v144
  v_mul_f32 v96, v96, v148
  v_mul_f32 v97, v97, v148
  v_mul_f32 v98, v98, v148
  v_mul_f32 v99, v99, v148
  v_mul_f32 v100, v100, v148
  v_mul_f32 v101, v101, v148
  v_mul_f32 v102, v102, v148
  v_mul_f32 v103, v103, v148
  v_mul_f32 v104, v104, v148
  v_mul_f32 v105, v105, v148
  v_mul_f32 v106, v106, v148
  v_mul_f32 v107, v107, v148
  v_mul_f32 v108, v108, v148
  v_mul_f32 v109, v109, v148
  v_mul_f32 v110, v110, v148
  v_mul_f32 v111, v111, v148
  s_waitcnt lgkmcnt(0)
  s_barrier
  ds_read_b128 v[160:163], v4 offset:0
  ds_read_b128 v[164:167], v4 offset:1024
  ds_read_b128 v[168:171], v4 offset:2048
  ds_read_b128 v[172:175], v4 offset:3072
  ds_read_b128 v[176:179], v4 offset:4096
  ds_read_b128 v[180:183], v4 offset:5120
  ds_read_b128 v[184:187], v4 offset:6144
  ds_read_b128 v[188:191], v4 offset:7168
  s_waitcnt lgkmcnt(7)
  v_fma_f32 v192, v160, v138, v192
  v_fma_f32 v193, v161, v138, v193
  v_fma_f32 v194, v162, v138, v194
  v_fma_f32 v195, v163, v138, v195
  s_waitcnt lgkmcnt(6)
  v_fma_f32 v196, v164, v138, v196
  v_fma_f32 v197, v165, v138, v197
  v_fma_f32 v198, v166, v138, v198
  v_fma_f32 v199, v167, v138, v199
  s_waitcnt lgkmcnt(5)
  v_fma_f32 v200, v168, v138, v200
  v_fma_f32 v201, v169, v138, v201
  v_fma_f32 v202, v170, v138, v202
  v_fma_f32 v203, v171, v138, v203
  s_waitcnt lgkmcnt(4)
  v_fma_f32 v204, v172, v138, v204
  v_fma_f32 v205, v173, v138, v205
  v_fma_f32 v206, v174, v138, v206
  v_fma_f32 v207, v175, v138, v207
  ds_read_b128 v[160:163], v4 offset:8192
  ds_read_b128 v[164:167], v4 offset:9216
  ds_read_b128 v[168:171], v4 offset:10240
  ds_read_b128 v[172:175], v4 offset:11264
  v_fma_f32 v38, v192, v36, v38
  v_fma_f32 v39, v193, v36, v39
  v_cvt_pk_bf16_f32 v56, v192, v193
  v_fma_f32 v38, v194, v36, v38
  v_fma_f32 v39, v195, v36, v39
  v_cvt_pk_bf16_f32 v57, v194, v195
  v_fma_f32 v38, v196, v36, v38
  v_fma_f32 v39, v197, v36, v39
  v_cvt_pk_bf16_f32 v58, v196, v197
  v_fma_f32 v38, v198, v36, v38
  v_fma_f32 v39, v199, v36, v39
  v_cvt_pk_bf16_f32 v59, v198, v199
  v_fma_f32 v38, v200, v36, v38
  v_fma_f32 v39, v201, v36, v39
  v_cvt_pk_bf16_f32 v60, v200, v201
  v_fma_f32 v38, v202, v36, v38
  v_fma_f32 v39, v203, v36, v39
  v_cvt_pk_bf16_f32 v61, v202, v203
  v_fma_f32 v38, v204, v36, v38
  v_fma_f32 v39, v205, v36, v39
  v_cvt_pk_bf16_f32 v62, v204, v205
  v_fma_f32 v38, v206, v36, v38
  v_fma_f32 v39, v207, v36, v39
  v_cvt_pk_bf16_f32 v63, v206, v207
  s_add_u32 s39, s46, 0
  s_add_u32 s40, s39, 9216
  buffer_store_dwordx4 v[56:59], v7, s[20:23], s39 offen offset:0 sc1
  buffer_store_dwordx4 v[60:63], v7, s[20:23], s40 offen offset:0 sc1
  s_waitcnt lgkmcnt(4)
  v_fma_f32 v208, v176, v142, v208
  v_fma_f32 v209, v177, v142, v209
  v_fma_f32 v210, v178, v142, v210
  v_fma_f32 v211, v179, v142, v211
  v_fma_f32 v212, v180, v142, v212
  v_fma_f32 v213, v181, v142, v213
  v_fma_f32 v214, v182, v142, v214
  v_fma_f32 v215, v183, v142, v215
  v_fma_f32 v216, v184, v142, v216
  v_fma_f32 v217, v185, v142, v217
  v_fma_f32 v218, v186, v142, v218
  v_fma_f32 v219, v187, v142, v219
  v_fma_f32 v220, v188, v142, v220
  v_fma_f32 v221, v189, v142, v221
  v_fma_f32 v222, v190, v142, v222
  v_fma_f32 v223, v191, v142, v223
  ds_read_b128 v[176:179], v4 offset:12288
  ds_read_b128 v[180:183], v4 offset:13312
  ds_read_b128 v[184:187], v4 offset:14336
  ds_read_b128 v[188:191], v4 offset:15360
  v_fma_f32 v38, v208, v36, v38
  v_fma_f32 v39, v209, v36, v39
  v_cvt_pk_bf16_f32 v64, v208, v209
  v_fma_f32 v38, v210, v36, v38
  v_fma_f32 v39, v211, v36, v39
  v_cvt_pk_bf16_f32 v65, v210, v211
  v_fma_f32 v38, v212, v36, v38
  v_fma_f32 v39, v213, v36, v39
  v_cvt_pk_bf16_f32 v66, v212, v213
  v_fma_f32 v38, v214, v36, v38
  v_fma_f32 v39, v215, v36, v39
  v_cvt_pk_bf16_f32 v67, v214, v215
  v_fma_f32 v38, v216, v36, v38
  v_fma_f32 v39, v217, v36, v39
  v_cvt_pk_bf16_f32 v68, v216, v217
  v_fma_f32 v38, v218, v36, v38
  v_fma_f32 v39, v219, v36, v39
  v_cvt_pk_bf16_f32 v69, v218, v219
  v_fma_f32 v38, v220, v36, v38
  v_fma_f32 v39, v221, v36, v39
  v_cvt_pk_bf16_f32 v70, v220, v221
  v_fma_f32 v38, v222, v36, v38
  v_fma_f32 v39, v223, v36, v39
  v_cvt_pk_bf16_f32 v71, v222, v223
  s_add_u32 s39, s46, 1024
  s_add_u32 s40, s39, 9216
  buffer_store_dwordx4 v[64:67], v7, s[20:23], s39 offen offset:0 sc1
  buffer_store_dwordx4 v[68:71], v7, s[20:23], s40 offen offset:0 sc1
  s_waitcnt lgkmcnt(4)
  v_fma_f32 v224, v160, v146, v224
  v_fma_f32 v225, v161, v146, v225
  v_fma_f32 v226, v162, v146, v226
  v_fma_f32 v227, v163, v146, v227
  v_fma_f32 v228, v164, v146, v228
  v_fma_f32 v229, v165, v146, v229
  v_fma_f32 v230, v166, v146, v230
  v_fma_f32 v231, v167, v146, v231
  v_fma_f32 v232, v168, v146, v232
  v_fma_f32 v233, v169, v146, v233
  v_fma_f32 v234, v170, v146, v234
  v_fma_f32 v235, v171, v146, v235
  v_fma_f32 v236, v172, v146, v236
  v_fma_f32 v237, v173, v146, v237
  v_fma_f32 v238, v174, v146, v238
  v_fma_f32 v239, v175, v146, v239
  v_fma_f32 v38, v224, v36, v38
  v_fma_f32 v39, v225, v36, v39
  v_cvt_pk_bf16_f32 v72, v224, v225
  v_fma_f32 v38, v226, v36, v38
  v_fma_f32 v39, v227, v36, v39
  v_cvt_pk_bf16_f32 v73, v226, v227
  v_fma_f32 v38, v228, v36, v38
  v_fma_f32 v39, v229, v36, v39
  v_cvt_pk_bf16_f32 v74, v228, v229
  v_fma_f32 v38, v230, v36, v38
  v_fma_f32 v39, v231, v36, v39
  v_cvt_pk_bf16_f32 v75, v230, v231
  v_fma_f32 v38, v232, v36, v38
  v_fma_f32 v39, v233, v36, v39
  v_cvt_pk_bf16_f32 v76, v232, v233
  v_fma_f32 v38, v234, v36, v38
  v_fma_f32 v39, v235, v36, v39
  v_cvt_pk_bf16_f32 v77, v234, v235
  v_fma_f32 v38, v236, v36, v38
  v_fma_f32 v39, v237, v36, v39
  v_cvt_pk_bf16_f32 v78, v236, v237
  v_fma_f32 v38, v238, v36, v38
  v_fma_f32 v39, v239, v36, v39
  v_cvt_pk_bf16_f32 v79, v238, v239
  s_add_u32 s39, s46, 2048
  s_add_u32 s40, s39, 9216
  buffer_store_dwordx4 v[72:75], v7, s[20:23], s39 offen offset:0 sc1
  buffer_store_dwordx4 v[76:79], v7, s[20:23], s40 offen offset:0 sc1
  s_waitcnt lgkmcnt(0)
  v_fma_f32 v96, v176, v150, v96
  v_fma_f32 v97, v177, v150, v97
  v_fma_f32 v98, v178, v150, v98
  v_fma_f32 v99, v179, v150, v99
  v_fma_f32 v100, v180, v150, v100
  v_fma_f32 v101, v181, v150, v101
  v_fma_f32 v102, v182, v150, v102
  v_fma_f32 v103, v183, v150, v103
  v_fma_f32 v104, v184, v150, v104
  v_fma_f32 v105, v185, v150, v105
  v_fma_f32 v106, v186, v150, v106
  v_fma_f32 v107, v187, v150, v107
  v_fma_f32 v108, v188, v150, v108
  v_fma_f32 v109, v189, v150, v109
  v_fma_f32 v110, v190, v150, v110
  v_fma_f32 v111, v191, v150, v111
  v_fma_f32 v38, v96, v36, v38
  v_fma_f32 v39, v97, v36, v39
  v_cvt_pk_bf16_f32 v80, v96, v97
  v_fma_f32 v38, v98, v36, v38
  v_fma_f32 v39, v99, v36, v39
  v_cvt_pk_bf16_f32 v81, v98, v99
  v_fma_f32 v38, v100, v36, v38
  v_fma_f32 v39, v101, v36, v39
  v_cvt_pk_bf16_f32 v82, v100, v101
  v_fma_f32 v38, v102, v36, v38
  v_fma_f32 v39, v103, v36, v39
  v_cvt_pk_bf16_f32 v83, v102, v103
  v_fma_f32 v38, v104, v36, v38
  v_fma_f32 v39, v105, v36, v39
  v_cvt_pk_bf16_f32 v84, v104, v105
  v_fma_f32 v38, v106, v36, v38
  v_fma_f32 v39, v107, v36, v39
  v_cvt_pk_bf16_f32 v85, v106, v107
  v_fma_f32 v38, v108, v36, v38
  v_fma_f32 v39, v109, v36, v39
  v_cvt_pk_bf16_f32 v86, v108, v109
  v_fma_f32 v38, v110, v36, v38
  v_fma_f32 v39, v111, v36, v39
  v_cvt_pk_bf16_f32 v87, v110, v111
  s_add_u32 s39, s46, 3072
  s_add_u32 s40, s39, 9216
  buffer_store_dwordx4 v[80:83], v7, s[20:23], s39 offen offset:0 sc1
  buffer_store_dwordx4 v[84:87], v7, s[20:23], s40 offen offset:0 sc1
  v_cmp_u_f32 vcc, v38, v39
  s_nop 1
  s_or_b64 s[72:73], s[72:73], vcc
  s_cmp_lg_u64 s[72:73], 0
  s_cselect_b32 s39, 1, 0
  s_xor_b32 s40, s45, 1
  s_and_b32 s39, s39, s40
  s_lshl_b32 s39, s39, s58
  s_or_b32 s44, s44, s39
  s_waitcnt lgkmcnt(0)
  s_branch fa_kernel_redo
fa_kernel_rare39:
  s_nop 7
  v_mov_b32 v49, v48
  s_nop 1
  v_permlane16_swap_b32 v48, v49
  s_nop 1
  v_max_f32 v48, v48, v49
  v_mov_b32 v49, v48
  s_nop 1
  v_permlane32_swap_b32 v48, v49
  s_nop 1
  v_max_f32 v48, v48, v49
  s_ashr_i32 s59, s34, 31
  s_and_b32 s59, s59, 0xff800000
  s_mov_b32 s34, 0x41000000
  v_max_f32 v48, s59, v48
  v_sub_f32 v96, v96, v48
  v_sub_f32 v97, v97, v48
  v_sub_f32 v98, v98, v48
  v_sub_f32 v99, v99, v48
  v_sub_f32 v100, v100, v48
  v_sub_f32 v101, v101, v48
  v_sub_f32 v102, v102, v48
  v_sub_f32 v103, v103, v48
  v_sub_f32 v56, v56, v48
  v_sub_f32 v57, v57, v48
  v_sub_f32 v58, v58, v48
  v_sub_f32 v59, v59, v48
  s_cmp_lg_u32 s59, 0
  s_cbranch_scc1 fa_kernel_back39
  v_sub_f32 v49, 0, v48
  v_exp_f32 v49, v49
  s_nop 1
  v_mul_f32 v76, v76, v49
  v_mul_f32 v77, v77, v49
  v_mul_f32 v78, v78, v49
  v_mul_f32 v79, v79, v49
  v_accvgpr_read_b32 v50, a0
  v_accvgpr_read_b32 v51, a1
  v_mul_f32 v50, v50, v49
  v_mul_f32 v51, v51, v49
  v_accvgpr_write_b32 a0, v50
  v_accvgpr_write_b32 a1, v51
  v_accvgpr_read_b32 v50, a2
  v_accvgpr_read_b32 v51, a3
  v_mul_f32 v50, v50, v49
  v_mul_f32 v51, v51, v49
  v_accvgpr_write_b32 a2, v50
  v_accvgpr_write_b32 a3, v51
  v_accvgpr_read_b32 v50, a4
  v_accvgpr_read_b32 v51, a5
  v_mul_f32 v50, v50, v49
  v_mul_f32 v51, v51, v49
  v_accvgpr_write_b32 a4, v50
  v_accvgpr_write_b32 a5, v51
  v_accvgpr_read_b32 v50, a6
  v_accvgpr_read_b32 v51, a7
  v_mul_f32 v50, v50, v49
  v_mul_f32 v51, v51, v49
  v_accvgpr_write_b32 a6, v50
  v_accvgpr_write_b32 a7, v51
  v_accvgpr_read_b32 v50, a8
  v_accvgpr_read_b32 v51, a9
  v_mul_f32 v50, v50, v49
  v_mul_f32 v51, v51, v49
  v_accvgpr_write_b32 a8, v50
  v_accvgpr_write_b32 a9, v51
  v_accvgpr_read_b32 v50, a10
  v_accvgpr_read_b32 v51, a11
  v_mul_f32 v50, v50, v49
  v_mul_f32 v51, v51, v49
  v_accvgpr_write_b32 a10, v50
  v_accvgpr_write_b32 a11, v51
  v_accvgpr_read_b32 v50, a12
  v_accvgpr_read_b32 v51, a13
  v_mul_f32 v50, v50, v49
  v_mul_f32 v51, v51, v49
  v_accvgpr_write_b32 a12, v50
  v_accvgpr_write_b32 a13, v51
  v_accvgpr_read_b32 v50, a14
  v_accvgpr_read_b32 v51, a15
  v_mul_f32 v50, v50, v49
  v_mul_f32 v51, v51, v49
  v_accvgpr_write_b32 a14, v50
  v_accvgpr_write_b32 a15, v51
  v_accvgpr_read_b32 v50, a16
  v_accvgpr_read_b32 v51, a17
  v_mul_f32 v50, v50, v49
  v_mul_f32 v51, v51, v49
  v_accvgpr_write_b32 a16, v50
  v_accvgpr_write_b32 a17, v51
  v_accvgpr_read_b32 v50, a18
  v_accvgpr_read_b32 v51, a19
  v_mul_f32 v50, v50, v49
  v_mul_f32 v51, v51, v49
  v_accvgpr_write_b32 a18, v50
  v_accvgpr_write_b32 a19, v51
  v_accvgpr_read_b32 v50, a20
  v_accvgpr_read_b32 v51, a21
  v_mul_f32 v50, v50, v49
  v_mul_f32 v51, v51, v49
  v_accvgpr_write_b32 a20, v50
  v_accvgpr_write_b32 a21, v51
  v_accvgpr_read_b32 v50, a22
  v_accvgpr_read_b32 v51, a23
  v_mul_f32 v50, v50, v49
  v_mul_f32 v51, v51, v49
  v_accvgpr_write_b32 a22, v50
  v_accvgpr_write_b32 a23, v51
  v_accvgpr_read_b32 v50, a24
  v_accvgpr_read_b32 v51, a25
  v_mul_f32 v50, v50, v49
  v_mul_f32 v51, v51, v49
  v_accvgpr_write_b32 a24, v50
  v_accvgpr_write_b32 a25, v51
  v_accvgpr_read_b32 v50, a26
  v_accvgpr_read_b32 v51, a27
  v_mul_f32 v50, v50, v49
  v_mul_f32 v51, v51, v49
  v_accvgpr_write_b32 a26, v50
  v_accvgpr_write_b32 a27, v51
  v_accvgpr_read_b32 v50, a28
  v_accvgpr_read_b32 v51, a29
  v_mul_f32 v50, v50, v49
  v_mul_f32 v51, v51, v49
  v_accvgpr_write_b32 a28, v50
  v_accvgpr_write_b32 a29, v51
  v_accvgpr_read_b32 v50, a30
  v_accvgpr_read_b32 v51, a31
  v_mul_f32 v50, v50, v49
  v_mul_f32 v51, v51, v49
  v_accvgpr_write_b32 a30, v50
  v_accvgpr_write_b32 a31, v51
  s_nop 2
  s_branch fa_kernel_back39
fa_kernel_rare40:
  s_nop 7
  v_mov_b32 v49, v48
  s_nop 1
  v_permlane16_swap_b32 v48, v49
  s_nop 1
  v_max_f32 v48, v48, v49
  v_mov_b32 v49, v48
  s_nop 1
  v_permlane32_swap_b32 v48, v49
  s_nop 1
  v_max_f32 v48, v48, v49
  s_ashr_i32 s59, s35, 31
  s_and_b32 s59, s59, 0xff800000
  s_mov_b32 s35, 0x41000000
  v_max_f32 v48, s59, v48
  v_sub_f32 v104, v104, v48
  v_sub_f32 v105, v105, v48
  v_sub_f32 v106, v106, v48
  v_sub_f32 v107, v107, v48
  v_sub_f32 v108, v108, v48
  v_sub_f32 v109, v109, v48
  v_sub_f32 v110, v110, v48
  v_sub_f32 v111, v111, v48
  v_sub_f32 v60, v60, v48
  v_sub_f32 v61, v61, v48
  v_sub_f32 v62, v62, v48
  v_sub_f32 v63, v63, v48
  s_cmp_lg_u32 s59, 0
  s_cbranch_scc1 fa_kernel_back40
  v_sub_f32 v49, 0, v48
  v_exp_f32 v49, v49
  s_nop 1
  v_mul_f32 v80, v80, v49
  v_mul_f32 v81, v81, v49
  v_mul_f32 v82, v82, v49
  v_mul_f32 v83, v83, v49
  v_accvgpr_read_b32 v50, a32
  v_accvgpr_read_b32 v51, a33
  v_mul_f32 v50, v50, v49
  v_mul_f32 v51, v51, v49
  v_accvgpr_write_b32 a32, v50
  v_accvgpr_write_b32 a33, v51
  v_accvgpr_read_b32 v50, a34
  v_accvgpr_read_b32 v51, a35
  v_mul_f32 v50, v50, v49
  v_mul_f32 v51, v51, v49
  v_accvgpr_write_b32 a34, v50
  v_accvgpr_write_b32 a35, v51
  v_accvgpr_read_b32 v50, a36
  v_accvgpr_read_b32 v51, a37
  v_mul_f32 v50, v50, v49
  v_mul_f32 v51, v51, v49
  v_accvgpr_write_b32 a36, v50
  v_accvgpr_write_b32 a37, v51
  v_accvgpr_read_b32 v50, a38
  v_accvgpr_read_b32 v51, a39
  v_mul_f32 v50, v50, v49
  v_mul_f32 v51, v51, v49
  v_accvgpr_write_b32 a38, v50
  v_accvgpr_write_b32 a39, v51
  v_accvgpr_read_b32 v50, a40
  v_accvgpr_read_b32 v51, a41
  v_mul_f32 v50, v50, v49
  v_mul_f32 v51, v51, v49
  v_accvgpr_write_b32 a40, v50
  v_accvgpr_write_b32 a41, v51
  v_accvgpr_read_b32 v50, a42
  v_accvgpr_read_b32 v51, a43
  v_mul_f32 v50, v50, v49
  v_mul_f32 v51, v51, v49
  v_accvgpr_write_b32 a42, v50
  v_accvgpr_write_b32 a43, v51
  v_accvgpr_read_b32 v50, a44
  v_accvgpr_read_b32 v51, a45
  v_mul_f32 v50, v50, v49
  v_mul_f32 v51, v51, v49
  v_accvgpr_write_b32 a44, v50
  v_accvgpr_write_b32 a45, v51
  v_accvgpr_read_b32 v50, a46
  v_accvgpr_read_b32 v51, a47
  v_mul_f32 v50, v50, v49
  v_mul_f32 v51, v51, v49
  v_accvgpr_write_b32 a46, v50
  v_accvgpr_write_b32 a47, v51
  v_accvgpr_read_b32 v50, a48
  v_accvgpr_read_b32 v51, a49
  v_mul_f32 v50, v50, v49
  v_mul_f32 v51, v51, v49
  v_accvgpr_write_b32 a48, v50
  v_accvgpr_write_b32 a49, v51
  v_accvgpr_read_b32 v50, a50
  v_accvgpr_read_b32 v51, a51
  v_mul_f32 v50, v50, v49
  v_mul_f32 v51, v51, v49
  v_accvgpr_write_b32 a50, v50
  v_accvgpr_write_b32 a51, v51
  v_accvgpr_read_b32 v50, a52
  v_accvgpr_read_b32 v51, a53
  v_mul_f32 v50, v50, v49
  v_mul_f32 v51, v51, v49
  v_accvgpr_write_b32 a52, v50
  v_accvgpr_write_b32 a53, v51
  v_accvgpr_read_b32 v50, a54
  v_accvgpr_read_b32 v51, a55
  v_mul_f32 v50, v50, v49
  v_mul_f32 v51, v51, v49
  v_accvgpr_write_b32 a54, v50
  v_accvgpr_write_b32 a55, v51
  v_accvgpr_read_b32 v50, a56
  v_accvgpr_read_b32 v51, a57
  v_mul_f32 v50, v50, v49
  v_mul_f32 v51, v51, v49
  v_accvgpr_write_b32 a56, v50
  v_accvgpr_write_b32 a57, v51
  v_accvgpr_read_b32 v50, a58
  v_accvgpr_read_b32 v51, a59
  v_mul_f32 v50, v50, v49
  v_mul_f32 v51, v51, v49
  v_accvgpr_write_b32 a58, v50
  v_accvgpr_write_b32 a59, v51
  v_accvgpr_read_b32 v50, a60
  v_accvgpr_read_b32 v51, a61
  v_mul_f32 v50, v50, v49
  v_mul_f32 v51, v51, v49
  v_accvgpr_write_b32 a60, v50
  v_accvgpr_write_b32 a61, v51
  v_accvgpr_read_b32 v50, a62
  v_accvgpr_read_b32 v51, a63
  v_mul_f32 v50, v50, v49
  v_mul_f32 v51, v51, v49
  v_accvgpr_write_b32 a62, v50
  v_accvgpr_write_b32 a63, v51
  s_nop 2
  s_branch fa_kernel_back40
fa_kernel_rare41:
  s_nop 7
  v_mov_b32 v49, v48
  s_nop 1
  v_permlane16_swap_b32 v48, v49
  s_nop 1
  v_max_f32 v48, v48, v49
  v_mov_b32 v49, v48
  s_nop 1
  v_permlane32_swap_b32 v48, v49
  s_nop 1
  v_max_f32 v48, v48, v49
  s_ashr_i32 s59, s36, 31
  s_and_b32 s59, s59, 0xff800000
  s_mov_b32 s36, 0x41000000
  v_max_f32 v48, s59, v48
  v_sub_f32 v112, v112, v48
  v_sub_f32 v113, v113, v48
  v_sub_f32 v114, v114, v48
  v_sub_f32 v115, v115, v48
  v_sub_f32 v116, v116, v48
  v_sub_f32 v117, v117, v48
  v_sub_f32 v118, v118, v48
  v_sub_f32 v119, v119, v48
  v_sub_f32 v64, v64, v48
  v_sub_f32 v65, v65, v48
  v_sub_f32 v66, v66, v48
  v_sub_f32 v67, v67, v48
  s_cmp_lg_u32 s59, 0
  s_cbranch_scc1 fa_kernel_back41
  v_sub_f32 v49, 0, v48
  v_exp_f32 v49, v49
  s_nop 1
  v_mul_f32 v84, v84, v49
  v_mul_f32 v85, v85, v49
  v_mul_f32 v86, v86, v49
  v_mul_f32 v87, v87, v49
  v_accvgpr_read_b32 v50, a64
  v_accvgpr_read_b32 v51, a65
  v_mul_f32 v50, v50, v49
  v_mul_f32 v51, v51, v49
  v_accvgpr_write_b32 a64, v50
  v_accvgpr_write_b32 a65, v51
  v_accvgpr_read_b32 v50, a66
  v_accvgpr_read_b32 v51, a67
  v_mul_f32 v50, v50, v49
  v_mul_f32 v51, v51, v49
  v_accvgpr_write_b32 a66, v50
  v_accvgpr_write_b32 a67, v51
  v_accvgpr_read_b32 v50, a68
  v_accvgpr_read_b32 v51, a69
  v_mul_f32 v50, v50, v49
  v_mul_f32 v51, v51, v49
  v_accvgpr_write_b32 a68, v50
  v_accvgpr_write_b32 a69, v51
  v_accvgpr_read_b32 v50, a70
  v_accvgpr_read_b32 v51, a71
  v_mul_f32 v50, v50, v49
  v_mul_f32 v51, v51, v49
  v_accvgpr_write_b32 a70, v50
  v_accvgpr_write_b32 a71, v51
  v_accvgpr_read_b32 v50, a72
  v_accvgpr_read_b32 v51, a73
  v_mul_f32 v50, v50, v49
  v_mul_f32 v51, v51, v49
  v_accvgpr_write_b32 a72, v50
  v_accvgpr_write_b32 a73, v51
  v_accvgpr_read_b32 v50, a74
  v_accvgpr_read_b32 v51, a75
  v_mul_f32 v50, v50, v49
  v_mul_f32 v51, v51, v49
  v_accvgpr_write_b32 a74, v50
  v_accvgpr_write_b32 a75, v51
  v_accvgpr_read_b32 v50, a76
  v_accvgpr_read_b32 v51, a77
  v_mul_f32 v50, v50, v49
  v_mul_f32 v51, v51, v49
  v_accvgpr_write_b32 a76, v50
  v_accvgpr_write_b32 a77, v51
  v_accvgpr_read_b32 v50, a78
  v_accvgpr_read_b32 v51, a79
  v_mul_f32 v50, v50, v49
  v_mul_f32 v51, v51, v49
  v_accvgpr_write_b32 a78, v50
  v_accvgpr_write_b32 a79, v51
  v_accvgpr_read_b32 v50, a80
  v_accvgpr_read_b32 v51, a81
  v_mul_f32 v50, v50, v49
  v_mul_f32 v51, v51, v49
  v_accvgpr_write_b32 a80, v50
  v_accvgpr_write_b32 a81, v51
  v_accvgpr_read_b32 v50, a82
  v_accvgpr_read_b32 v51, a83
  v_mul_f32 v50, v50, v49
  v_mul_f32 v51, v51, v49
  v_accvgpr_write_b32 a82, v50
  v_accvgpr_write_b32 a83, v51
  v_accvgpr_read_b32 v50, a84
  v_accvgpr_read_b32 v51, a85
  v_mul_f32 v50, v50, v49
  v_mul_f32 v51, v51, v49
  v_accvgpr_write_b32 a84, v50
  v_accvgpr_write_b32 a85, v51
  v_accvgpr_read_b32 v50, a86
  v_accvgpr_read_b32 v51, a87
  v_mul_f32 v50, v50, v49
  v_mul_f32 v51, v51, v49
  v_accvgpr_write_b32 a86, v50
  v_accvgpr_write_b32 a87, v51
  v_accvgpr_read_b32 v50, a88
  v_accvgpr_read_b32 v51, a89
  v_mul_f32 v50, v50, v49
  v_mul_f32 v51, v51, v49
  v_accvgpr_write_b32 a88, v50
  v_accvgpr_write_b32 a89, v51
  v_accvgpr_read_b32 v50, a90
  v_accvgpr_read_b32 v51, a91
  v_mul_f32 v50, v50, v49
  v_mul_f32 v51, v51, v49
  v_accvgpr_write_b32 a90, v50
  v_accvgpr_write_b32 a91, v51
  v_accvgpr_read_b32 v50, a92
  v_accvgpr_read_b32 v51, a93
  v_mul_f32 v50, v50, v49
  v_mul_f32 v51, v51, v49
  v_accvgpr_write_b32 a92, v50
  v_accvgpr_write_b32 a93, v51
  v_accvgpr_read_b32 v50, a94
  v_accvgpr_read_b32 v51, a95
  v_mul_f32 v50, v50, v49
  v_mul_f32 v51, v51, v49
  v_accvgpr_write_b32 a94, v50
  v_accvgpr_write_b32 a95, v51
  s_nop 2
  s_branch fa_kernel_back41
fa_kernel_rare42:
  s_nop 7
  v_mov_b32 v49, v48
  s_nop 1
  v_permlane16_swap_b32 v48, v49
  s_nop 1
  v_max_f32 v48, v48, v49
  v_mov_b32 v49, v48
  s_nop 1
  v_permlane32_swap_b32 v48, v49
  s_nop 1
  v_max_f32 v48, v48, v49
  s_ashr_i32 s59, s37, 31
  s_and_b32 s59, s59, 0xff800000
  s_mov_b32 s37, 0x41000000
  v_max_f32 v48, s59, v48
  v_sub_f32 v96, v96, v48
  v_sub_f32 v97, v97, v48
  v_sub_f32 v98, v98, v48
  v_sub_f32 v99, v99, v48
  v_sub_f32 v100, v100, v48
  v_sub_f32 v101, v101, v48
  v_sub_f32 v102, v102, v48
  v_sub_f32 v103, v103, v48
  v_sub_f32 v68, v68, v48
  v_sub_f32 v69, v69, v48
  v_sub_f32 v70, v70, v48
  v_sub_f32 v71, v71, v48
  s_cmp_lg_u32 s59, 0
  s_cbranch_scc1 fa_kernel_back42
  v_sub_f32 v49, 0, v48
  v_exp_f32 v49, v49
  s_nop 1
  v_mul_f32 v88, v88, v49
  v_mul_f32 v89, v89, v49
  v_mul_f32 v90, v90, v49
  v_mul_f32 v91, v91, v49
  v_accvgpr_read_b32 v50, a96
  v_accvgpr_read_b32 v51, a97
  v_mul_f32 v50, v50, v49
  v_mul_f32 v51, v51, v49
  v_accvgpr_write_b32 a96, v50
  v_accvgpr_write_b32 a97, v51
  v_accvgpr_read_b32 v50, a98
  v_accvgpr_read_b32 v51, a99
  v_mul_f32 v50, v50, v49
  v_mul_f32 v51, v51, v49
  v_accvgpr_write_b32 a98, v50
  v_accvgpr_write_b32 a99, v51
  v_accvgpr_read_b32 v50, a100
  v_accvgpr_read_b32 v51, a101
  v_mul_f32 v50, v50, v49
  v_mul_f32 v51, v51, v49
  v_accvgpr_write_b32 a100, v50
  v_accvgpr_write_b32 a101, v51
  v_accvgpr_read_b32 v50, a102
  v_accvgpr_read_b32 v51, a103
  v_mul_f32 v50, v50, v49
  v_mul_f32 v51, v51, v49
  v_accvgpr_write_b32 a102, v50
  v_accvgpr_write_b32 a103, v51
  v_accvgpr_read_b32 v50, a104
  v_accvgpr_read_b32 v51, a105
  v_mul_f32 v50, v50, v49
  v_mul_f32 v51, v51, v49
  v_accvgpr_write_b32 a104, v50
  v_accvgpr_write_b32 a105, v51
  v_accvgpr_read_b32 v50, a106
  v_accvgpr_read_b32 v51, a107
  v_mul_f32 v50, v50, v49
  v_mul_f32 v51, v51, v49
  v_accvgpr_write_b32 a106, v50
  v_accvgpr_write_b32 a107, v51
  v_accvgpr_read_b32 v50, a108
  v_accvgpr_read_b32 v51, a109
  v_mul_f32 v50, v50, v49
  v_mul_f32 v51, v51, v49
  v_accvgpr_write_b32 a108, v50
  v_accvgpr_write_b32 a109, v51
  v_accvgpr_read_b32 v50, a110
  v_accvgpr_read_b32 v51, a111
  v_mul_f32 v50, v50, v49
  v_mul_f32 v51, v51, v49
  v_accvgpr_write_b32 a110, v50
  v_accvgpr_write_b32 a111, v51
  v_accvgpr_read_b32 v50, a112
  v_accvgpr_read_b32 v51, a113
  v_mul_f32 v50, v50, v49
  v_mul_f32 v51, v51, v49
  v_accvgpr_write_b32 a112, v50
  v_accvgpr_write_b32 a113, v51
  v_accvgpr_read_b32 v50, a114
  v_accvgpr_read_b32 v51, a115
  v_mul_f32 v50, v50, v49
  v_mul_f32 v51, v51, v49
  v_accvgpr_write_b32 a114, v50
  v_accvgpr_write_b32 a115, v51
  v_accvgpr_read_b32 v50, a116
  v_accvgpr_read_b32 v51, a117
  v_mul_f32 v50, v50, v49
  v_mul_f32 v51, v51, v49
  v_accvgpr_write_b32 a116, v50
  v_accvgpr_write_b32 a117, v51
  v_accvgpr_read_b32 v50, a118
  v_accvgpr_read_b32 v51, a119
  v_mul_f32 v50, v50, v49
  v_mul_f32 v51, v51, v49
  v_accvgpr_write_b32 a118, v50
  v_accvgpr_write_b32 a119, v51
  v_accvgpr_read_b32 v50, a120
  v_accvgpr_read_b32 v51, a121
  v_mul_f32 v50, v50, v49
  v_mul_f32 v51, v51, v49
  v_accvgpr_write_b32 a120, v50
  v_accvgpr_write_b32 a121, v51
  v_accvgpr_read_b32 v50, a122
  v_accvgpr_read_b32 v51, a123
  v_mul_f32 v50, v50, v49
  v_mul_f32 v51, v51, v49
  v_accvgpr_write_b32 a122, v50
  v_accvgpr_write_b32 a123, v51
  v_accvgpr_read_b32 v50, a124
  v_accvgpr_read_b32 v51, a125
  v_mul_f32 v50, v50, v49
  v_mul_f32 v51, v51, v49
  v_accvgpr_write_b32 a124, v50
  v_accvgpr_write_b32 a125, v51
  v_accvgpr_read_b32 v50, a126
  v_accvgpr_read_b32 v51, a127
  v_mul_f32 v50, v50, v49
  v_mul_f32 v51, v51, v49
  v_accvgpr_write_b32 a126, v50
  v_accvgpr_write_b32 a127, v51
  s_nop 2
  s_branch fa_kernel_back42
fa_kernel_rare43:
  s_nop 7
  v_mov_b32 v49, v48
  s_nop 1
  v_permlane16_swap_b32 v48, v49
  s_nop 1
  v_max_f32 v48, v48, v49
  v_mov_b32 v49, v48
  s_nop 1
  v_permlane32_swap_b32 v48, v49
  s_nop 1
  v_max_f32 v48, v48, v49
  s_ashr_i32 s59, s38, 31
  s_and_b32 s59, s59, 0xff800000
  s_mov_b32 s38, 0x41000000
  v_max_f32 v48, s59, v48
  v_sub_f32 v104, v104, v48
  v_sub_f32 v105, v105, v48
  v_sub_f32 v106, v106, v48
  v_sub_f32 v107, v107, v48
  v_sub_f32 v108, v108, v48
  v_sub_f32 v109, v109, v48
  v_sub_f32 v110, v110, v48
  v_sub_f32 v111, v111, v48
  v_sub_f32 v72, v72, v48
  v_sub_f32 v73, v73, v48
  v_sub_f32 v74, v74, v48
  v_sub_f32 v75, v75, v48
  s_cmp_lg_u32 s59, 0
  s_cbranch_scc1 fa_kernel_back43
  v_sub_f32 v49, 0, v48
  v_exp_f32 v49, v49
  s_nop 1
  v_mul_f32 v92, v92, v49
  v_mul_f32 v93, v93, v49
  v_mul_f32 v94, v94, v49
  v_mul_f32 v95, v95, v49
  v_accvgpr_read_b32 v50, a128
  v_accvgpr_read_b32 v51, a129
  v_mul_f32 v50, v50, v49
  v_mul_f32 v51, v51, v49
  v_accvgpr_write_b32 a128, v50
  v_accvgpr_write_b32 a129, v51
  v_accvgpr_read_b32 v50, a130
  v_accvgpr_read_b32 v51, a131
  v_mul_f32 v50, v50, v49
  v_mul_f32 v51, v51, v49
  v_accvgpr_write_b32 a130, v50
  v_accvgpr_write_b32 a131, v51
  v_accvgpr_read_b32 v50, a132
  v_accvgpr_read_b32 v51, a133
  v_mul_f32 v50, v50, v49
  v_mul_f32 v51, v51, v49
  v_accvgpr_write_b32 a132, v50
  v_accvgpr_write_b32 a133, v51
  v_accvgpr_read_b32 v50, a134
  v_accvgpr_read_b32 v51, a135
  v_mul_f32 v50, v50, v49
  v_mul_f32 v51, v51, v49
  v_accvgpr_write_b32 a134, v50
  v_accvgpr_write_b32 a135, v51
  v_accvgpr_read_b32 v50, a136
  v_accvgpr_read_b32 v51, a137
  v_mul_f32 v50, v50, v49
  v_mul_f32 v51, v51, v49
  v_accvgpr_write_b32 a136, v50
  v_accvgpr_write_b32 a137, v51
  v_accvgpr_read_b32 v50, a138
  v_accvgpr_read_b32 v51, a139
  v_mul_f32 v50, v50, v49
  v_mul_f32 v51, v51, v49
  v_accvgpr_write_b32 a138, v50
  v_accvgpr_write_b32 a139, v51
  v_accvgpr_read_b32 v50, a140
  v_accvgpr_read_b32 v51, a141
  v_mul_f32 v50, v50, v49
  v_mul_f32 v51, v51, v49
  v_accvgpr_write_b32 a140, v50
  v_accvgpr_write_b32 a141, v51
  v_accvgpr_read_b32 v50, a142
  v_accvgpr_read_b32 v51, a143
  v_mul_f32 v50, v50, v49
  v_mul_f32 v51, v51, v49
  v_accvgpr_write_b32 a142, v50
  v_accvgpr_write_b32 a143, v51
  v_accvgpr_read_b32 v50, a144
  v_accvgpr_read_b32 v51, a145
  v_mul_f32 v50, v50, v49
  v_mul_f32 v51, v51, v49
  v_accvgpr_write_b32 a144, v50
  v_accvgpr_write_b32 a145, v51
  v_accvgpr_read_b32 v50, a146
  v_accvgpr_read_b32 v51, a147
  v_mul_f32 v50, v50, v49
  v_mul_f32 v51, v51, v49
  v_accvgpr_write_b32 a146, v50
  v_accvgpr_write_b32 a147, v51
  v_accvgpr_read_b32 v50, a148
  v_accvgpr_read_b32 v51, a149
  v_mul_f32 v50, v50, v49
  v_mul_f32 v51, v51, v49
  v_accvgpr_write_b32 a148, v50
  v_accvgpr_write_b32 a149, v51
  v_accvgpr_read_b32 v50, a150
  v_accvgpr_read_b32 v51, a151
  v_mul_f32 v50, v50, v49
  v_mul_f32 v51, v51, v49
  v_accvgpr_write_b32 a150, v50
  v_accvgpr_write_b32 a151, v51
  v_accvgpr_read_b32 v50, a152
  v_accvgpr_read_b32 v51, a153
  v_mul_f32 v50, v50, v49
  v_mul_f32 v51, v51, v49
  v_accvgpr_write_b32 a152, v50
  v_accvgpr_write_b32 a153, v51
  v_accvgpr_read_b32 v50, a154
  v_accvgpr_read_b32 v51, a155
  v_mul_f32 v50, v50, v49
  v_mul_f32 v51, v51, v49
  v_accvgpr_write_b32 a154, v50
  v_accvgpr_write_b32 a155, v51
  v_accvgpr_read_b32 v50, a156
  v_accvgpr_read_b32 v51, a157
  v_mul_f32 v50, v50, v49
  v_mul_f32 v51, v51, v49
  v_accvgpr_write_b32 a156, v50
  v_accvgpr_write_b32 a157, v51
  v_accvgpr_read_b32 v50, a158
  v_accvgpr_read_b32 v51, a159
  v_mul_f32 v50, v50, v49
  v_mul_f32 v51, v51, v49
  v_accvgpr_write_b32 a158, v50
  v_accvgpr_write_b32 a159, v51
  s_nop 2
  s_branch fa_kernel_back43
fa_kernel_rare44:
  s_nop 7
  v_mov_b32 v49, v48
  s_nop 1
  v_permlane16_swap_b32 v48, v49
  s_nop 1
  v_max_f32 v48, v48, v49
  v_mov_b32 v49, v48
  s_nop 1
  v_permlane32_swap_b32 v48, v49
  s_nop 1
  v_max_f32 v48, v48, v49
  s_ashr_i32 s59, s34, 31
  s_and_b32 s59, s59, 0xff800000
  s_mov_b32 s34, 0x41000000
  v_max_f32 v48, s59, v48
  v_sub_f32 v112, v112, v48
  v_sub_f32 v113, v113, v48
  v_sub_f32 v114, v114, v48
  v_sub_f32 v115, v115, v48
  v_sub_f32 v116, v116, v48
  v_sub_f32 v117, v117, v48
  v_sub_f32 v118, v118, v48
  v_sub_f32 v119, v119, v48
  v_sub_f32 v56, v56, v48
  v_sub_f32 v57, v57, v48
  v_sub_f32 v58, v58, v48
  v_sub_f32 v59, v59, v48
  s_cmp_lg_u32 s59, 0
  s_cbranch_scc1 fa_kernel_back44
  v_sub_f32 v49, 0, v48
  v_exp_f32 v49, v49
  s_nop 1
  v_mul_f32 v76, v76, v49
  v_mul_f32 v77, v77, v49
  v_mul_f32 v78, v78, v49
  v_mul_f32 v79, v79, v49
  v_accvgpr_read_b32 v50, a0
  v_accvgpr_read_b32 v51, a1
  v_mul_f32 v50, v50, v49
  v_mul_f32 v51, v51, v49
  v_accvgpr_write_b32 a0, v50
  v_accvgpr_write_b32 a1, v51
  v_accvgpr_read_b32 v50, a2
  v_accvgpr_read_b32 v51, a3
  v_mul_f32 v50, v50, v49
  v_mul_f32 v51, v51, v49
  v_accvgpr_write_b32 a2, v50
  v_accvgpr_write_b32 a3, v51
  v_accvgpr_read_b32 v50, a4
  v_accvgpr_read_b32 v51, a5
  v_mul_f32 v50, v50, v49
  v_mul_f32 v51, v51, v49
  v_accvgpr_write_b32 a4, v50
  v_accvgpr_write_b32 a5, v51
  v_accvgpr_read_b32 v50, a6
  v_accvgpr_read_b32 v51, a7
  v_mul_f32 v50, v50, v49
  v_mul_f32 v51, v51, v49
  v_accvgpr_write_b32 a6, v50
  v_accvgpr_write_b32 a7, v51
  v_accvgpr_read_b32 v50, a8
  v_accvgpr_read_b32 v51, a9
  v_mul_f32 v50, v50, v49
  v_mul_f32 v51, v51, v49
  v_accvgpr_write_b32 a8, v50
  v_accvgpr_write_b32 a9, v51
  v_accvgpr_read_b32 v50, a10
  v_accvgpr_read_b32 v51, a11
  v_mul_f32 v50, v50, v49
  v_mul_f32 v51, v51, v49
  v_accvgpr_write_b32 a10, v50
  v_accvgpr_write_b32 a11, v51
  v_accvgpr_read_b32 v50, a12
  v_accvgpr_read_b32 v51, a13
  v_mul_f32 v50, v50, v49
  v_mul_f32 v51, v51, v49
  v_accvgpr_write_b32 a12, v50
  v_accvgpr_write_b32 a13, v51
  v_accvgpr_read_b32 v50, a14
  v_accvgpr_read_b32 v51, a15
  v_mul_f32 v50, v50, v49
  v_mul_f32 v51, v51, v49
  v_accvgpr_write_b32 a14, v50
  v_accvgpr_write_b32 a15, v51
  v_accvgpr_read_b32 v50, a16
  v_accvgpr_read_b32 v51, a17
  v_mul_f32 v50, v50, v49
  v_mul_f32 v51, v51, v49
  v_accvgpr_write_b32 a16, v50
  v_accvgpr_write_b32 a17, v51
  v_accvgpr_read_b32 v50, a18
  v_accvgpr_read_b32 v51, a19
  v_mul_f32 v50, v50, v49
  v_mul_f32 v51, v51, v49
  v_accvgpr_write_b32 a18, v50
  v_accvgpr_write_b32 a19, v51
  v_accvgpr_read_b32 v50, a20
  v_accvgpr_read_b32 v51, a21
  v_mul_f32 v50, v50, v49
  v_mul_f32 v51, v51, v49
  v_accvgpr_write_b32 a20, v50
  v_accvgpr_write_b32 a21, v51
  v_accvgpr_read_b32 v50, a22
  v_accvgpr_read_b32 v51, a23
  v_mul_f32 v50, v50, v49
  v_mul_f32 v51, v51, v49
  v_accvgpr_write_b32 a22, v50
  v_accvgpr_write_b32 a23, v51
  v_accvgpr_read_b32 v50, a24
  v_accvgpr_read_b32 v51, a25
  v_mul_f32 v50, v50, v49
  v_mul_f32 v51, v51, v49
  v_accvgpr_write_b32 a24, v50
  v_accvgpr_write_b32 a25, v51
  v_accvgpr_read_b32 v50, a26
  v_accvgpr_read_b32 v51, a27
  v_mul_f32 v50, v50, v49
  v_mul_f32 v51, v51, v49
  v_accvgpr_write_b32 a26, v50
  v_accvgpr_write_b32 a27, v51
  v_accvgpr_read_b32 v50, a28
  v_accvgpr_read_b32 v51, a29
  v_mul_f32 v50, v50, v49
  v_mul_f32 v51, v51, v49
  v_accvgpr_write_b32 a28, v50
  v_accvgpr_write_b32 a29, v51
  v_accvgpr_read_b32 v50, a30
  v_accvgpr_read_b32 v51, a31
  v_mul_f32 v50, v50, v49
  v_mul_f32 v51, v51, v49
  v_accvgpr_write_b32 a30, v50
  v_accvgpr_write_b32 a31, v51
  s_nop 2
  s_branch fa_kernel_back44
fa_kernel_rare45:
  s_nop 7
  v_mov_b32 v49, v48
  s_nop 1
  v_permlane16_swap_b32 v48, v49
  s_nop 1
  v_max_f32 v48, v48, v49
  v_mov_b32 v49, v48
  s_nop 1
  v_permlane32_swap_b32 v48, v49
  s_nop 1
  v_max_f32 v48, v48, v49
  s_ashr_i32 s59, s35, 31
  s_and_b32 s59, s59, 0xff800000
  s_mov_b32 s35, 0x41000000
  v_max_f32 v48, s59, v48
  v_sub_f32 v96, v96, v48
  v_sub_f32 v97, v97, v48
  v_sub_f32 v98, v98, v48
  v_sub_f32 v99, v99, v48
  v_sub_f32 v100, v100, v48
  v_sub_f32 v101, v101, v48
  v_sub_f32 v102, v102, v48
  v_sub_f32 v103, v103, v48
  v_sub_f32 v60, v60, v48
  v_sub_f32 v61, v61, v48
  v_sub_f32 v62, v62, v48
  v_sub_f32 v63, v63, v48
  s_cmp_lg_u32 s59, 0
  s_cbranch_scc1 fa_kernel_back45
  v_sub_f32 v49, 0, v48
  v_exp_f32 v49, v49
  s_nop 1
  v_mul_f32 v80, v80, v49
  v_mul_f32 v81, v81, v49
  v_mul_f32 v82, v82, v49
  v_mul_f32 v83, v83, v49
  v_accvgpr_read_b32 v50, a32
  v_accvgpr_read_b32 v51, a33
  v_mul_f32 v50, v50, v49
  v_mul_f32 v51, v51, v49
  v_accvgpr_write_b32 a32, v50
  v_accvgpr_write_b32 a33, v51
  v_accvgpr_read_b32 v50, a34
  v_accvgpr_read_b32 v51, a35
  v_mul_f32 v50, v50, v49
  v_mul_f32 v51, v51, v49
  v_accvgpr_write_b32 a34, v50
  v_accvgpr_write_b32 a35, v51
  v_accvgpr_read_b32 v50, a36
  v_accvgpr_read_b32 v51, a37
  v_mul_f32 v50, v50, v49
  v_mul_f32 v51, v51, v49
  v_accvgpr_write_b32 a36, v50
  v_accvgpr_write_b32 a37, v51
  v_accvgpr_read_b32 v50, a38
  v_accvgpr_read_b32 v51, a39
  v_mul_f32 v50, v50, v49
  v_mul_f32 v51, v51, v49
  v_accvgpr_write_b32 a38, v50
  v_accvgpr_write_b32 a39, v51
  v_accvgpr_read_b32 v50, a40
  v_accvgpr_read_b32 v51, a41
  v_mul_f32 v50, v50, v49
  v_mul_f32 v51, v51, v49
  v_accvgpr_write_b32 a40, v50
  v_accvgpr_write_b32 a41, v51
  v_accvgpr_read_b32 v50, a42
  v_accvgpr_read_b32 v51, a43
  v_mul_f32 v50, v50, v49
  v_mul_f32 v51, v51, v49
  v_accvgpr_write_b32 a42, v50
  v_accvgpr_write_b32 a43, v51
  v_accvgpr_read_b32 v50, a44
  v_accvgpr_read_b32 v51, a45
  v_mul_f32 v50, v50, v49
  v_mul_f32 v51, v51, v49
  v_accvgpr_write_b32 a44, v50
  v_accvgpr_write_b32 a45, v51
  v_accvgpr_read_b32 v50, a46
  v_accvgpr_read_b32 v51, a47
  v_mul_f32 v50, v50, v49
  v_mul_f32 v51, v51, v49
  v_accvgpr_write_b32 a46, v50
  v_accvgpr_write_b32 a47, v51
  v_accvgpr_read_b32 v50, a48
  v_accvgpr_read_b32 v51, a49
  v_mul_f32 v50, v50, v49
  v_mul_f32 v51, v51, v49
  v_accvgpr_write_b32 a48, v50
  v_accvgpr_write_b32 a49, v51
  v_accvgpr_read_b32 v50, a50
  v_accvgpr_read_b32 v51, a51
  v_mul_f32 v50, v50, v49
  v_mul_f32 v51, v51, v49
  v_accvgpr_write_b32 a50, v50
  v_accvgpr_write_b32 a51, v51
  v_accvgpr_read_b32 v50, a52
  v_accvgpr_read_b32 v51, a53
  v_mul_f32 v50, v50, v49
  v_mul_f32 v51, v51, v49
  v_accvgpr_write_b32 a52, v50
  v_accvgpr_write_b32 a53, v51
  v_accvgpr_read_b32 v50, a54
  v_accvgpr_read_b32 v51, a55
  v_mul_f32 v50, v50, v49
  v_mul_f32 v51, v51, v49
  v_accvgpr_write_b32 a54, v50
  v_accvgpr_write_b32 a55, v51
  v_accvgpr_read_b32 v50, a56
  v_accvgpr_read_b32 v51, a57
  v_mul_f32 v50, v50, v49
  v_mul_f32 v51, v51, v49
  v_accvgpr_write_b32 a56, v50
  v_accvgpr_write_b32 a57, v51
  v_accvgpr_read_b32 v50, a58
  v_accvgpr_read_b32 v51, a59
  v_mul_f32 v50, v50, v49
  v_mul_f32 v51, v51, v49
  v_accvgpr_write_b32 a58, v50
  v_accvgpr_write_b32 a59, v51
  v_accvgpr_read_b32 v50, a60
  v_accvgpr_read_b32 v51, a61
  v_mul_f32 v50, v50, v49
  v_mul_f32 v51, v51, v49
  v_accvgpr_write_b32 a60, v50
  v_accvgpr_write_b32 a61, v51
  v_accvgpr_read_b32 v50, a62
  v_accvgpr_read_b32 v51, a63
  v_mul_f32 v50, v50, v49
  v_mul_f32 v51, v51, v49
  v_accvgpr_write_b32 a62, v50
  v_accvgpr_write_b32 a63, v51
  s_nop 2
  s_branch fa_kernel_back45
fa_kernel_rare46:
  s_nop 7
  v_mov_b32 v49, v48
  s_nop 1
  v_permlane16_swap_b32 v48, v49
  s_nop 1
  v_max_f32 v48, v48, v49
  v_mov_b32 v49, v48
  s_nop 1
  v_permlane32_swap_b32 v48, v49
  s_nop 1
  v_max_f32 v48, v48, v49
  s_ashr_i32 s59, s36, 31
  s_and_b32 s59, s59, 0xff800000
  s_mov_b32 s36, 0x41000000
  v_max_f32 v48, s59, v48
  v_sub_f32 v104, v104, v48
  v_sub_f32 v105, v105, v48
  v_sub_f32 v106, v106, v48
  v_sub_f32 v107, v107, v48
  v_sub_f32 v108, v108, v48
  v_sub_f32 v109, v109, v48
  v_sub_f32 v110, v110, v48
  v_sub_f32 v111, v111, v48
  v_sub_f32 v64, v64, v48
  v_sub_f32 v65, v65, v48
  v_sub_f32 v66, v66, v48
  v_sub_f32 v67, v67, v48
  s_cmp_lg_u32 s59, 0
  s_cbranch_scc1 fa_kernel_back46
  v_sub_f32 v49, 0, v48
  v_exp_f32 v49, v49
  s_nop 1
  v_mul_f32 v84, v84, v49
  v_mul_f32 v85, v85, v49
  v_mul_f32 v86, v86, v49
  v_mul_f32 v87, v87, v49
  v_accvgpr_read_b32 v50, a64
  v_accvgpr_read_b32 v51, a65
  v_mul_f32 v50, v50, v49
  v_mul_f32 v51, v51, v49
  v_accvgpr_write_b32 a64, v50
  v_accvgpr_write_b32 a65, v51
  v_accvgpr_read_b32 v50, a66
  v_accvgpr_read_b32 v51, a67
  v_mul_f32 v50, v50, v49
  v_mul_f32 v51, v51, v49
  v_accvgpr_write_b32 a66, v50
  v_accvgpr_write_b32 a67, v51
  v_accvgpr_read_b32 v50, a68
  v_accvgpr_read_b32 v51, a69
  v_mul_f32 v50, v50, v49
  v_mul_f32 v51, v51, v49
  v_accvgpr_write_b32 a68, v50
  v_accvgpr_write_b32 a69, v51
  v_accvgpr_read_b32 v50, a70
  v_accvgpr_read_b32 v51, a71
  v_mul_f32 v50, v50, v49
  v_mul_f32 v51, v51, v49
  v_accvgpr_write_b32 a70, v50
  v_accvgpr_write_b32 a71, v51
  v_accvgpr_read_b32 v50, a72
  v_accvgpr_read_b32 v51, a73
  v_mul_f32 v50, v50, v49
  v_mul_f32 v51, v51, v49
  v_accvgpr_write_b32 a72, v50
  v_accvgpr_write_b32 a73, v51
  v_accvgpr_read_b32 v50, a74
  v_accvgpr_read_b32 v51, a75
  v_mul_f32 v50, v50, v49
  v_mul_f32 v51, v51, v49
  v_accvgpr_write_b32 a74, v50
  v_accvgpr_write_b32 a75, v51
  v_accvgpr_read_b32 v50, a76
  v_accvgpr_read_b32 v51, a77
  v_mul_f32 v50, v50, v49
  v_mul_f32 v51, v51, v49
  v_accvgpr_write_b32 a76, v50
  v_accvgpr_write_b32 a77, v51
  v_accvgpr_read_b32 v50, a78
  v_accvgpr_read_b32 v51, a79
  v_mul_f32 v50, v50, v49
  v_mul_f32 v51, v51, v49
  v_accvgpr_write_b32 a78, v50
  v_accvgpr_write_b32 a79, v51
  v_accvgpr_read_b32 v50, a80
  v_accvgpr_read_b32 v51, a81
  v_mul_f32 v50, v50, v49
  v_mul_f32 v51, v51, v49
  v_accvgpr_write_b32 a80, v50
  v_accvgpr_write_b32 a81, v51
  v_accvgpr_read_b32 v50, a82
  v_accvgpr_read_b32 v51, a83
  v_mul_f32 v50, v50, v49
  v_mul_f32 v51, v51, v49
  v_accvgpr_write_b32 a82, v50
  v_accvgpr_write_b32 a83, v51
  v_accvgpr_read_b32 v50, a84
  v_accvgpr_read_b32 v51, a85
  v_mul_f32 v50, v50, v49
  v_mul_f32 v51, v51, v49
  v_accvgpr_write_b32 a84, v50
  v_accvgpr_write_b32 a85, v51
  v_accvgpr_read_b32 v50, a86
  v_accvgpr_read_b32 v51, a87
  v_mul_f32 v50, v50, v49
  v_mul_f32 v51, v51, v49
  v_accvgpr_write_b32 a86, v50
  v_accvgpr_write_b32 a87, v51
  v_accvgpr_read_b32 v50, a88
  v_accvgpr_read_b32 v51, a89
  v_mul_f32 v50, v50, v49
  v_mul_f32 v51, v51, v49
  v_accvgpr_write_b32 a88, v50
  v_accvgpr_write_b32 a89, v51
  v_accvgpr_read_b32 v50, a90
  v_accvgpr_read_b32 v51, a91
  v_mul_f32 v50, v50, v49
  v_mul_f32 v51, v51, v49
  v_accvgpr_write_b32 a90, v50
  v_accvgpr_write_b32 a91, v51
  v_accvgpr_read_b32 v50, a92
  v_accvgpr_read_b32 v51, a93
  v_mul_f32 v50, v50, v49
  v_mul_f32 v51, v51, v49
  v_accvgpr_write_b32 a92, v50
  v_accvgpr_write_b32 a93, v51
  v_accvgpr_read_b32 v50, a94
  v_accvgpr_read_b32 v51, a95
  v_mul_f32 v50, v50, v49
  v_mul_f32 v51, v51, v49
  v_accvgpr_write_b32 a94, v50
  v_accvgpr_write_b32 a95, v51
  s_nop 2
  s_branch fa_kernel_back46
fa_kernel_rare47:
  s_nop 7
  v_mov_b32 v49, v48
  s_nop 1
  v_permlane16_swap_b32 v48, v49
  s_nop 1
  v_max_f32 v48, v48, v49
  v_mov_b32 v49, v48
  s_nop 1
  v_permlane32_swap_b32 v48, v49
  s_nop 1
  v_max_f32 v48, v48, v49
  s_ashr_i32 s59, s37, 31
  s_and_b32 s59, s59, 0xff800000
  s_mov_b32 s37, 0x41000000
  v_max_f32 v48, s59, v48
  v_sub_f32 v112, v112, v48
  v_sub_f32 v113, v113, v48
  v_sub_f32 v114, v114, v48
  v_sub_f32 v115, v115, v48
  v_sub_f32 v116, v116, v48
  v_sub_f32 v117, v117, v48
  v_sub_f32 v118, v118, v48
  v_sub_f32 v119, v119, v48
  v_sub_f32 v68, v68, v48
  v_sub_f32 v69, v69, v48
  v_sub_f32 v70, v70, v48
  v_sub_f32 v71, v71, v48
  s_cmp_lg_u32 s59, 0
  s_cbranch_scc1 fa_kernel_back47
  v_sub_f32 v49, 0, v48
  v_exp_f32 v49, v49
  s_nop 1
  v_mul_f32 v88, v88, v49
  v_mul_f32 v89, v89, v49
  v_mul_f32 v90, v90, v49
  v_mul_f32 v91, v91, v49
  v_accvgpr_read_b32 v50, a96
  v_accvgpr_read_b32 v51, a97
  v_mul_f32 v50, v50, v49
  v_mul_f32 v51, v51, v49
  v_accvgpr_write_b32 a96, v50
  v_accvgpr_write_b32 a97, v51
  v_accvgpr_read_b32 v50, a98
  v_accvgpr_read_b32 v51, a99
  v_mul_f32 v50, v50, v49
  v_mul_f32 v51, v51, v49
  v_accvgpr_write_b32 a98, v50
  v_accvgpr_write_b32 a99, v51
  v_accvgpr_read_b32 v50, a100
  v_accvgpr_read_b32 v51, a101
  v_mul_f32 v50, v50, v49
  v_mul_f32 v51, v51, v49
  v_accvgpr_write_b32 a100, v50
  v_accvgpr_write_b32 a101, v51
  v_accvgpr_read_b32 v50, a102
  v_accvgpr_read_b32 v51, a103
  v_mul_f32 v50, v50, v49
  v_mul_f32 v51, v51, v49
  v_accvgpr_write_b32 a102, v50
  v_accvgpr_write_b32 a103, v51
  v_accvgpr_read_b32 v50, a104
  v_accvgpr_read_b32 v51, a105
  v_mul_f32 v50, v50, v49
  v_mul_f32 v51, v51, v49
  v_accvgpr_write_b32 a104, v50
  v_accvgpr_write_b32 a105, v51
  v_accvgpr_read_b32 v50, a106
  v_accvgpr_read_b32 v51, a107
  v_mul_f32 v50, v50, v49
  v_mul_f32 v51, v51, v49
  v_accvgpr_write_b32 a106, v50
  v_accvgpr_write_b32 a107, v51
  v_accvgpr_read_b32 v50, a108
  v_accvgpr_read_b32 v51, a109
  v_mul_f32 v50, v50, v49
  v_mul_f32 v51, v51, v49
  v_accvgpr_write_b32 a108, v50
  v_accvgpr_write_b32 a109, v51
  v_accvgpr_read_b32 v50, a110
  v_accvgpr_read_b32 v51, a111
  v_mul_f32 v50, v50, v49
  v_mul_f32 v51, v51, v49
  v_accvgpr_write_b32 a110, v50
  v_accvgpr_write_b32 a111, v51
  v_accvgpr_read_b32 v50, a112
  v_accvgpr_read_b32 v51, a113
  v_mul_f32 v50, v50, v49
  v_mul_f32 v51, v51, v49
  v_accvgpr_write_b32 a112, v50
  v_accvgpr_write_b32 a113, v51
  v_accvgpr_read_b32 v50, a114
  v_accvgpr_read_b32 v51, a115
  v_mul_f32 v50, v50, v49
  v_mul_f32 v51, v51, v49
  v_accvgpr_write_b32 a114, v50
  v_accvgpr_write_b32 a115, v51
  v_accvgpr_read_b32 v50, a116
  v_accvgpr_read_b32 v51, a117
  v_mul_f32 v50, v50, v49
  v_mul_f32 v51, v51, v49
  v_accvgpr_write_b32 a116, v50
  v_accvgpr_write_b32 a117, v51
  v_accvgpr_read_b32 v50, a118
  v_accvgpr_read_b32 v51, a119
  v_mul_f32 v50, v50, v49
  v_mul_f32 v51, v51, v49
  v_accvgpr_write_b32 a118, v50
  v_accvgpr_write_b32 a119, v51
  v_accvgpr_read_b32 v50, a120
  v_accvgpr_read_b32 v51, a121
  v_mul_f32 v50, v50, v49
  v_mul_f32 v51, v51, v49
  v_accvgpr_write_b32 a120, v50
  v_accvgpr_write_b32 a121, v51
  v_accvgpr_read_b32 v50, a122
  v_accvgpr_read_b32 v51, a123
  v_mul_f32 v50, v50, v49
  v_mul_f32 v51, v51, v49
  v_accvgpr_write_b32 a122, v50
  v_accvgpr_write_b32 a123, v51
  v_accvgpr_read_b32 v50, a124
  v_accvgpr_read_b32 v51, a125
  v_mul_f32 v50, v50, v49
  v_mul_f32 v51, v51, v49
  v_accvgpr_write_b32 a124, v50
  v_accvgpr_write_b32 a125, v51
  v_accvgpr_read_b32 v50, a126
  v_accvgpr_read_b32 v51, a127
  v_mul_f32 v50, v50, v49
  v_mul_f32 v51, v51, v49
  v_accvgpr_write_b32 a126, v50
  v_accvgpr_write_b32 a127, v51
  s_nop 2
  s_branch fa_kernel_back47
fa_kernel_rare48:
  s_nop 7
  v_mov_b32 v49, v48
  s_nop 1
  v_permlane16_swap_b32 v48, v49
  s_nop 1
  v_max_f32 v48, v48, v49
  v_mov_b32 v49, v48
  s_nop 1
  v_permlane32_swap_b32 v48, v49
  s_nop 1
  v_max_f32 v48, v48, v49
  s_ashr_i32 s59, s34, 31
  s_and_b32 s59, s59, 0xff800000
  s_mov_b32 s34, 0x41000000
  v_max_f32 v48, s59, v48
  v_sub_f32 v96, v96, v48
  v_sub_f32 v97, v97, v48
  v_sub_f32 v98, v98, v48
  v_sub_f32 v99, v99, v48
  v_sub_f32 v100, v100, v48
  v_sub_f32 v101, v101, v48
  v_sub_f32 v102, v102, v48
  v_sub_f32 v103, v103, v48
  v_sub_f32 v56, v56, v48
  v_sub_f32 v57, v57, v48
  v_sub_f32 v58, v58, v48
  v_sub_f32 v59, v59, v48
  s_cmp_lg_u32 s59, 0
  s_cbranch_scc1 fa_kernel_back48
  v_sub_f32 v49, 0, v48
  v_exp_f32 v49, v49
  s_nop 1
  v_mul_f32 v76, v76, v49
  v_mul_f32 v77, v77, v49
  v_mul_f32 v78, v78, v49
  v_mul_f32 v79, v79, v49
  v_accvgpr_read_b32 v50, a0
  v_accvgpr_read_b32 v51, a1
  v_mul_f32 v50, v50, v49
  v_mul_f32 v51, v51, v49
  v_accvgpr_write_b32 a0, v50
  v_accvgpr_write_b32 a1, v51
  v_accvgpr_read_b32 v50, a2
  v_accvgpr_read_b32 v51, a3
  v_mul_f32 v50, v50, v49
  v_mul_f32 v51, v51, v49
  v_accvgpr_write_b32 a2, v50
  v_accvgpr_write_b32 a3, v51
  v_accvgpr_read_b32 v50, a4
  v_accvgpr_read_b32 v51, a5
  v_mul_f32 v50, v50, v49
  v_mul_f32 v51, v51, v49
  v_accvgpr_write_b32 a4, v50
  v_accvgpr_write_b32 a5, v51
  v_accvgpr_read_b32 v50, a6
  v_accvgpr_read_b32 v51, a7
  v_mul_f32 v50, v50, v49
  v_mul_f32 v51, v51, v49
  v_accvgpr_write_b32 a6, v50
  v_accvgpr_write_b32 a7, v51
  v_accvgpr_read_b32 v50, a8
  v_accvgpr_read_b32 v51, a9
  v_mul_f32 v50, v50, v49
  v_mul_f32 v51, v51, v49
  v_accvgpr_write_b32 a8, v50
  v_accvgpr_write_b32 a9, v51
  v_accvgpr_read_b32 v50, a10
  v_accvgpr_read_b32 v51, a11
  v_mul_f32 v50, v50, v49
  v_mul_f32 v51, v51, v49
  v_accvgpr_write_b32 a10, v50
  v_accvgpr_write_b32 a11, v51
  v_accvgpr_read_b32 v50, a12
  v_accvgpr_read_b32 v51, a13
  v_mul_f32 v50, v50, v49
  v_mul_f32 v51, v51, v49
  v_accvgpr_write_b32 a12, v50
  v_accvgpr_write_b32 a13, v51
  v_accvgpr_read_b32 v50, a14
  v_accvgpr_read_b32 v51, a15
  v_mul_f32 v50, v50, v49
  v_mul_f32 v51, v51, v49
  v_accvgpr_write_b32 a14, v50
  v_accvgpr_write_b32 a15, v51
  v_accvgpr_read_b32 v50, a16
  v_accvgpr_read_b32 v51, a17
  v_mul_f32 v50, v50, v49
  v_mul_f32 v51, v51, v49
  v_accvgpr_write_b32 a16, v50
  v_accvgpr_write_b32 a17, v51
  v_accvgpr_read_b32 v50, a18
  v_accvgpr_read_b32 v51, a19
  v_mul_f32 v50, v50, v49
  v_mul_f32 v51, v51, v49
  v_accvgpr_write_b32 a18, v50
  v_accvgpr_write_b32 a19, v51
  v_accvgpr_read_b32 v50, a20
  v_accvgpr_read_b32 v51, a21
  v_mul_f32 v50, v50, v49
  v_mul_f32 v51, v51, v49
  v_accvgpr_write_b32 a20, v50
  v_accvgpr_write_b32 a21, v51
  v_accvgpr_read_b32 v50, a22
  v_accvgpr_read_b32 v51, a23
  v_mul_f32 v50, v50, v49
  v_mul_f32 v51, v51, v49
  v_accvgpr_write_b32 a22, v50
  v_accvgpr_write_b32 a23, v51
  v_accvgpr_read_b32 v50, a24
  v_accvgpr_read_b32 v51, a25
  v_mul_f32 v50, v50, v49
  v_mul_f32 v51, v51, v49
  v_accvgpr_write_b32 a24, v50
  v_accvgpr_write_b32 a25, v51
  v_accvgpr_read_b32 v50, a26
  v_accvgpr_read_b32 v51, a27
  v_mul_f32 v50, v50, v49
  v_mul_f32 v51, v51, v49
  v_accvgpr_write_b32 a26, v50
  v_accvgpr_write_b32 a27, v51
  v_accvgpr_read_b32 v50, a28
  v_accvgpr_read_b32 v51, a29
  v_mul_f32 v50, v50, v49
  v_mul_f32 v51, v51, v49
  v_accvgpr_write_b32 a28, v50
  v_accvgpr_write_b32 a29, v51
  v_accvgpr_read_b32 v50, a30
  v_accvgpr_read_b32 v51, a31
  v_mul_f32 v50, v50, v49
  v_mul_f32 v51, v51, v49
  v_accvgpr_write_b32 a30, v50
  v_accvgpr_write_b32 a31, v51
  s_nop 2
  s_branch fa_kernel_back48
fa_kernel_rare49:
  s_nop 7
  v_mov_b32 v49, v48
  s_nop 1
  v_permlane16_swap_b32 v48, v49
  s_nop 1
  v_max_f32 v48, v48, v49
  v_mov_b32 v49, v48
  s_nop 1
  v_permlane32_swap_b32 v48, v49
  s_nop 1
  v_max_f32 v48, v48, v49
  s_ashr_i32 s59, s35, 31
  s_and_b32 s59, s59, 0xff800000
  s_mov_b32 s35, 0x41000000
  v_max_f32 v48, s59, v48
  v_sub_f32 v104, v104, v48
  v_sub_f32 v105, v105, v48
  v_sub_f32 v106, v106, v48
  v_sub_f32 v107, v107, v48
  v_sub_f32 v108, v108, v48
  v_sub_f32 v109, v109, v48
  v_sub_f32 v110, v110, v48
  v_sub_f32 v111, v111, v48
  v_sub_f32 v60, v60, v48
  v_sub_f32 v61, v61, v48
  v_sub_f32 v62, v62, v48
  v_sub_f32 v63, v63, v48
  s_cmp_lg_u32 s59, 0
  s_cbranch_scc1 fa_kernel_back49
  v_sub_f32 v49, 0, v48
  v_exp_f32 v49, v49
  s_nop 1
  v_mul_f32 v80, v80, v49
  v_mul_f32 v81, v81, v49
  v_mul_f32 v82, v82, v49
  v_mul_f32 v83, v83, v49
  v_accvgpr_read_b32 v50, a32
  v_accvgpr_read_b32 v51, a33
  v_mul_f32 v50, v50, v49
  v_mul_f32 v51, v51, v49
  v_accvgpr_write_b32 a32, v50
  v_accvgpr_write_b32 a33, v51
  v_accvgpr_read_b32 v50, a34
  v_accvgpr_read_b32 v51, a35
  v_mul_f32 v50, v50, v49
  v_mul_f32 v51, v51, v49
  v_accvgpr_write_b32 a34, v50
  v_accvgpr_write_b32 a35, v51
  v_accvgpr_read_b32 v50, a36
  v_accvgpr_read_b32 v51, a37
  v_mul_f32 v50, v50, v49
  v_mul_f32 v51, v51, v49
  v_accvgpr_write_b32 a36, v50
  v_accvgpr_write_b32 a37, v51
  v_accvgpr_read_b32 v50, a38
  v_accvgpr_read_b32 v51, a39
  v_mul_f32 v50, v50, v49
  v_mul_f32 v51, v51, v49
  v_accvgpr_write_b32 a38, v50
  v_accvgpr_write_b32 a39, v51
  v_accvgpr_read_b32 v50, a40
  v_accvgpr_read_b32 v51, a41
  v_mul_f32 v50, v50, v49
  v_mul_f32 v51, v51, v49
  v_accvgpr_write_b32 a40, v50
  v_accvgpr_write_b32 a41, v51
  v_accvgpr_read_b32 v50, a42
  v_accvgpr_read_b32 v51, a43
  v_mul_f32 v50, v50, v49
  v_mul_f32 v51, v51, v49
  v_accvgpr_write_b32 a42, v50
  v_accvgpr_write_b32 a43, v51
  v_accvgpr_read_b32 v50, a44
  v_accvgpr_read_b32 v51, a45
  v_mul_f32 v50, v50, v49
  v_mul_f32 v51, v51, v49
  v_accvgpr_write_b32 a44, v50
  v_accvgpr_write_b32 a45, v51
  v_accvgpr_read_b32 v50, a46
  v_accvgpr_read_b32 v51, a47
  v_mul_f32 v50, v50, v49
  v_mul_f32 v51, v51, v49
  v_accvgpr_write_b32 a46, v50
  v_accvgpr_write_b32 a47, v51
  v_accvgpr_read_b32 v50, a48
  v_accvgpr_read_b32 v51, a49
  v_mul_f32 v50, v50, v49
  v_mul_f32 v51, v51, v49
  v_accvgpr_write_b32 a48, v50
  v_accvgpr_write_b32 a49, v51
  v_accvgpr_read_b32 v50, a50
  v_accvgpr_read_b32 v51, a51
  v_mul_f32 v50, v50, v49
  v_mul_f32 v51, v51, v49
  v_accvgpr_write_b32 a50, v50
  v_accvgpr_write_b32 a51, v51
  v_accvgpr_read_b32 v50, a52
  v_accvgpr_read_b32 v51, a53
  v_mul_f32 v50, v50, v49
  v_mul_f32 v51, v51, v49
  v_accvgpr_write_b32 a52, v50
  v_accvgpr_write_b32 a53, v51
  v_accvgpr_read_b32 v50, a54
  v_accvgpr_read_b32 v51, a55
  v_mul_f32 v50, v50, v49
  v_mul_f32 v51, v51, v49
  v_accvgpr_write_b32 a54, v50
  v_accvgpr_write_b32 a55, v51
  v_accvgpr_read_b32 v50, a56
  v_accvgpr_read_b32 v51, a57
  v_mul_f32 v50, v50, v49
  v_mul_f32 v51, v51, v49
  v_accvgpr_write_b32 a56, v50
  v_accvgpr_write_b32 a57, v51
  v_accvgpr_read_b32 v50, a58
  v_accvgpr_read_b32 v51, a59
  v_mul_f32 v50, v50, v49
  v_mul_f32 v51, v51, v49
  v_accvgpr_write_b32 a58, v50
  v_accvgpr_write_b32 a59, v51
  v_accvgpr_read_b32 v50, a60
  v_accvgpr_read_b32 v51, a61
  v_mul_f32 v50, v50, v49
  v_mul_f32 v51, v51, v49
  v_accvgpr_write_b32 a60, v50
  v_accvgpr_write_b32 a61, v51
  v_accvgpr_read_b32 v50, a62
  v_accvgpr_read_b32 v51, a63
  v_mul_f32 v50, v50, v49
  v_mul_f32 v51, v51, v49
  v_accvgpr_write_b32 a62, v50
  v_accvgpr_write_b32 a63, v51
  s_nop 2
  s_branch fa_kernel_back49
fa_kernel_rare50:
  s_nop 7
  v_mov_b32 v49, v48
  s_nop 1
  v_permlane16_swap_b32 v48, v49
  s_nop 1
  v_max_f32 v48, v48, v49
  v_mov_b32 v49, v48
  s_nop 1
  v_permlane32_swap_b32 v48, v49
  s_nop 1
  v_max_f32 v48, v48, v49
  s_ashr_i32 s59, s36, 31
  s_and_b32 s59, s59, 0xff800000
  s_mov_b32 s36, 0x41000000
  v_max_f32 v48, s59, v48
  v_sub_f32 v112, v112, v48
  v_sub_f32 v113, v113, v48
  v_sub_f32 v114, v114, v48
  v_sub_f32 v115, v115, v48
  v_sub_f32 v116, v116, v48
  v_sub_f32 v117, v117, v48
  v_sub_f32 v118, v118, v48
  v_sub_f32 v119, v119, v48
  v_sub_f32 v64, v64, v48
  v_sub_f32 v65, v65, v48
  v_sub_f32 v66, v66, v48
  v_sub_f32 v67, v67, v48
  s_cmp_lg_u32 s59, 0
  s_cbranch_scc1 fa_kernel_back50
  v_sub_f32 v49, 0, v48
  v_exp_f32 v49, v49
  s_nop 1
  v_mul_f32 v84, v84, v49
  v_mul_f32 v85, v85, v49
  v_mul_f32 v86, v86, v49
  v_mul_f32 v87, v87, v49
  v_accvgpr_read_b32 v50, a64
  v_accvgpr_read_b32 v51, a65
  v_mul_f32 v50, v50, v49
  v_mul_f32 v51, v51, v49
  v_accvgpr_write_b32 a64, v50
  v_accvgpr_write_b32 a65, v51
  v_accvgpr_read_b32 v50, a66
  v_accvgpr_read_b32 v51, a67
  v_mul_f32 v50, v50, v49
  v_mul_f32 v51, v51, v49
  v_accvgpr_write_b32 a66, v50
  v_accvgpr_write_b32 a67, v51
  v_accvgpr_read_b32 v50, a68
  v_accvgpr_read_b32 v51, a69
  v_mul_f32 v50, v50, v49
  v_mul_f32 v51, v51, v49
  v_accvgpr_write_b32 a68, v50
  v_accvgpr_write_b32 a69, v51
  v_accvgpr_read_b32 v50, a70
  v_accvgpr_read_b32 v51, a71
  v_mul_f32 v50, v50, v49
  v_mul_f32 v51, v51, v49
  v_accvgpr_write_b32 a70, v50
  v_accvgpr_write_b32 a71, v51
  v_accvgpr_read_b32 v50, a72
  v_accvgpr_read_b32 v51, a73
  v_mul_f32 v50, v50, v49
  v_mul_f32 v51, v51, v49
  v_accvgpr_write_b32 a72, v50
  v_accvgpr_write_b32 a73, v51
  v_accvgpr_read_b32 v50, a74
  v_accvgpr_read_b32 v51, a75
  v_mul_f32 v50, v50, v49
  v_mul_f32 v51, v51, v49
  v_accvgpr_write_b32 a74, v50
  v_accvgpr_write_b32 a75, v51
  v_accvgpr_read_b32 v50, a76
  v_accvgpr_read_b32 v51, a77
  v_mul_f32 v50, v50, v49
  v_mul_f32 v51, v51, v49
  v_accvgpr_write_b32 a76, v50
  v_accvgpr_write_b32 a77, v51
  v_accvgpr_read_b32 v50, a78
  v_accvgpr_read_b32 v51, a79
  v_mul_f32 v50, v50, v49
  v_mul_f32 v51, v51, v49
  v_accvgpr_write_b32 a78, v50
  v_accvgpr_write_b32 a79, v51
  v_accvgpr_read_b32 v50, a80
  v_accvgpr_read_b32 v51, a81
  v_mul_f32 v50, v50, v49
  v_mul_f32 v51, v51, v49
  v_accvgpr_write_b32 a80, v50
  v_accvgpr_write_b32 a81, v51
  v_accvgpr_read_b32 v50, a82
  v_accvgpr_read_b32 v51, a83
  v_mul_f32 v50, v50, v49
  v_mul_f32 v51, v51, v49
  v_accvgpr_write_b32 a82, v50
  v_accvgpr_write_b32 a83, v51
  v_accvgpr_read_b32 v50, a84
  v_accvgpr_read_b32 v51, a85
  v_mul_f32 v50, v50, v49
  v_mul_f32 v51, v51, v49
  v_accvgpr_write_b32 a84, v50
  v_accvgpr_write_b32 a85, v51
  v_accvgpr_read_b32 v50, a86
  v_accvgpr_read_b32 v51, a87
  v_mul_f32 v50, v50, v49
  v_mul_f32 v51, v51, v49
  v_accvgpr_write_b32 a86, v50
  v_accvgpr_write_b32 a87, v51
  v_accvgpr_read_b32 v50, a88
  v_accvgpr_read_b32 v51, a89
  v_mul_f32 v50, v50, v49
  v_mul_f32 v51, v51, v49
  v_accvgpr_write_b32 a88, v50
  v_accvgpr_write_b32 a89, v51
  v_accvgpr_read_b32 v50, a90
  v_accvgpr_read_b32 v51, a91
  v_mul_f32 v50, v50, v49
  v_mul_f32 v51, v51, v49
  v_accvgpr_write_b32 a90, v50
  v_accvgpr_write_b32 a91, v51
  v_accvgpr_read_b32 v50, a92
  v_accvgpr_read_b32 v51, a93
  v_mul_f32 v50, v50, v49
  v_mul_f32 v51, v51, v49
  v_accvgpr_write_b32 a92, v50
  v_accvgpr_write_b32 a93, v51
  v_accvgpr_read_b32 v50, a94
  v_accvgpr_read_b32 v51, a95
  v_mul_f32 v50, v50, v49
  v_mul_f32 v51, v51, v49
  v_accvgpr_write_b32 a94, v50
  v_accvgpr_write_b32 a95, v51
  s_nop 2
  s_branch fa_kernel_back50
fa_kernel_rare51:
  s_nop 7
  v_mov_b32 v49, v48
  s_nop 1
  v_permlane16_swap_b32 v48, v49
  s_nop 1
  v_max_f32 v48, v48, v49
  v_mov_b32 v49, v48
  s_nop 1
  v_permlane32_swap_b32 v48, v49
  s_nop 1
  v_max_f32 v48, v48, v49
  s_ashr_i32 s59, s37, 31
  s_and_b32 s59, s59, 0xff800000
  s_mov_b32 s37, 0x41000000
  v_max_f32 v48, s59, v48
  v_sub_f32 v96, v96, v48
  v_sub_f32 v97, v97, v48
  v_sub_f32 v98, v98, v48
  v_sub_f32 v99, v99, v48
  v_sub_f32 v100, v100, v48
  v_sub_f32 v101, v101, v48
  v_sub_f32 v102, v102, v48
  v_sub_f32 v103, v103, v48
  v_sub_f32 v68, v68, v48
  v_sub_f32 v69, v69, v48
  v_sub_f32 v70, v70, v48
  v_sub_f32 v71, v71, v48
  s_cmp_lg_u32 s59, 0
  s_cbranch_scc1 fa_kernel_back51
  v_sub_f32 v49, 0, v48
  v_exp_f32 v49, v49
  s_nop 1
  v_mul_f32 v88, v88, v49
  v_mul_f32 v89, v89, v49
  v_mul_f32 v90, v90, v49
  v_mul_f32 v91, v91, v49
  v_accvgpr_read_b32 v50, a96
  v_accvgpr_read_b32 v51, a97
  v_mul_f32 v50, v50, v49
  v_mul_f32 v51, v51, v49
  v_accvgpr_write_b32 a96, v50
  v_accvgpr_write_b32 a97, v51
  v_accvgpr_read_b32 v50, a98
  v_accvgpr_read_b32 v51, a99
  v_mul_f32 v50, v50, v49
  v_mul_f32 v51, v51, v49
  v_accvgpr_write_b32 a98, v50
  v_accvgpr_write_b32 a99, v51
  v_accvgpr_read_b32 v50, a100
  v_accvgpr_read_b32 v51, a101
  v_mul_f32 v50, v50, v49
  v_mul_f32 v51, v51, v49
  v_accvgpr_write_b32 a100, v50
  v_accvgpr_write_b32 a101, v51
  v_accvgpr_read_b32 v50, a102
  v_accvgpr_read_b32 v51, a103
  v_mul_f32 v50, v50, v49
  v_mul_f32 v51, v51, v49
  v_accvgpr_write_b32 a102, v50
  v_accvgpr_write_b32 a103, v51
  v_accvgpr_read_b32 v50, a104
  v_accvgpr_read_b32 v51, a105
  v_mul_f32 v50, v50, v49
  v_mul_f32 v51, v51, v49
  v_accvgpr_write_b32 a104, v50
  v_accvgpr_write_b32 a105, v51
  v_accvgpr_read_b32 v50, a106
  v_accvgpr_read_b32 v51, a107
  v_mul_f32 v50, v50, v49
  v_mul_f32 v51, v51, v49
  v_accvgpr_write_b32 a106, v50
  v_accvgpr_write_b32 a107, v51
  v_accvgpr_read_b32 v50, a108
  v_accvgpr_read_b32 v51, a109
  v_mul_f32 v50, v50, v49
  v_mul_f32 v51, v51, v49
  v_accvgpr_write_b32 a108, v50
  v_accvgpr_write_b32 a109, v51
  v_accvgpr_read_b32 v50, a110
  v_accvgpr_read_b32 v51, a111
  v_mul_f32 v50, v50, v49
  v_mul_f32 v51, v51, v49
  v_accvgpr_write_b32 a110, v50
  v_accvgpr_write_b32 a111, v51
  v_accvgpr_read_b32 v50, a112
  v_accvgpr_read_b32 v51, a113
  v_mul_f32 v50, v50, v49
  v_mul_f32 v51, v51, v49
  v_accvgpr_write_b32 a112, v50
  v_accvgpr_write_b32 a113, v51
  v_accvgpr_read_b32 v50, a114
  v_accvgpr_read_b32 v51, a115
  v_mul_f32 v50, v50, v49
  v_mul_f32 v51, v51, v49
  v_accvgpr_write_b32 a114, v50
  v_accvgpr_write_b32 a115, v51
  v_accvgpr_read_b32 v50, a116
  v_accvgpr_read_b32 v51, a117
  v_mul_f32 v50, v50, v49
  v_mul_f32 v51, v51, v49
  v_accvgpr_write_b32 a116, v50
  v_accvgpr_write_b32 a117, v51
  v_accvgpr_read_b32 v50, a118
  v_accvgpr_read_b32 v51, a119
  v_mul_f32 v50, v50, v49
  v_mul_f32 v51, v51, v49
  v_accvgpr_write_b32 a118, v50
  v_accvgpr_write_b32 a119, v51
  v_accvgpr_read_b32 v50, a120
  v_accvgpr_read_b32 v51, a121
  v_mul_f32 v50, v50, v49
  v_mul_f32 v51, v51, v49
  v_accvgpr_write_b32 a120, v50
  v_accvgpr_write_b32 a121, v51
  v_accvgpr_read_b32 v50, a122
  v_accvgpr_read_b32 v51, a123
  v_mul_f32 v50, v50, v49
  v_mul_f32 v51, v51, v49
  v_accvgpr_write_b32 a122, v50
  v_accvgpr_write_b32 a123, v51
  v_accvgpr_read_b32 v50, a124
  v_accvgpr_read_b32 v51, a125
  v_mul_f32 v50, v50, v49
  v_mul_f32 v51, v51, v49
  v_accvgpr_write_b32 a124, v50
  v_accvgpr_write_b32 a125, v51
  v_accvgpr_read_b32 v50, a126
  v_accvgpr_read_b32 v51, a127
  v_mul_f32 v50, v50, v49
  v_mul_f32 v51, v51, v49
  v_accvgpr_write_b32 a126, v50
  v_accvgpr_write_b32 a127, v51
  s_nop 2
  s_branch fa_kernel_back51
fa_kernel_rare52:
  s_nop 7
  v_mov_b32 v49, v48
  s_nop 1
  v_permlane16_swap_b32 v48, v49
  s_nop 1
  v_max_f32 v48, v48, v49
  v_mov_b32 v49, v48
  s_nop 1
  v_permlane32_swap_b32 v48, v49
  s_nop 1
  v_max_f32 v48, v48, v49
  s_ashr_i32 s59, s38, 31
  s_and_b32 s59, s59, 0xff800000
  s_mov_b32 s38, 0x41000000
  v_max_f32 v48, s59, v48
  v_sub_f32 v104, v104, v48
  v_sub_f32 v105, v105, v48
  v_sub_f32 v106, v106, v48
  v_sub_f32 v107, v107, v48
  v_sub_f32 v108, v108, v48
  v_sub_f32 v109, v109, v48
  v_sub_f32 v110, v110, v48
  v_sub_f32 v111, v111, v48
  v_sub_f32 v72, v72, v48
  v_sub_f32 v73, v73, v48
  v_sub_f32 v74, v74, v48
  v_sub_f32 v75, v75, v48
  s_cmp_lg_u32 s59, 0
  s_cbranch_scc1 fa_kernel_back52
  v_sub_f32 v49, 0, v48
  v_exp_f32 v49, v49
  s_nop 1
  v_mul_f32 v92, v92, v49
  v_mul_f32 v93, v93, v49
  v_mul_f32 v94, v94, v49
  v_mul_f32 v95, v95, v49
  v_accvgpr_read_b32 v50, a128
  v_accvgpr_read_b32 v51, a129
  v_mul_f32 v50, v50, v49
  v_mul_f32 v51, v51, v49
  v_accvgpr_write_b32 a128, v50
  v_accvgpr_write_b32 a129, v51
  v_accvgpr_read_b32 v50, a130
  v_accvgpr_read_b32 v51, a131
  v_mul_f32 v50, v50, v49
  v_mul_f32 v51, v51, v49
  v_accvgpr_write_b32 a130, v50
  v_accvgpr_write_b32 a131, v51
  v_accvgpr_read_b32 v50, a132
  v_accvgpr_read_b32 v51, a133
  v_mul_f32 v50, v50, v49
  v_mul_f32 v51, v51, v49
  v_accvgpr_write_b32 a132, v50
  v_accvgpr_write_b32 a133, v51
  v_accvgpr_read_b32 v50, a134
  v_accvgpr_read_b32 v51, a135
  v_mul_f32 v50, v50, v49
  v_mul_f32 v51, v51, v49
  v_accvgpr_write_b32 a134, v50
  v_accvgpr_write_b32 a135, v51
  v_accvgpr_read_b32 v50, a136
  v_accvgpr_read_b32 v51, a137
  v_mul_f32 v50, v50, v49
  v_mul_f32 v51, v51, v49
  v_accvgpr_write_b32 a136, v50
  v_accvgpr_write_b32 a137, v51
  v_accvgpr_read_b32 v50, a138
  v_accvgpr_read_b32 v51, a139
  v_mul_f32 v50, v50, v49
  v_mul_f32 v51, v51, v49
  v_accvgpr_write_b32 a138, v50
  v_accvgpr_write_b32 a139, v51
  v_accvgpr_read_b32 v50, a140
  v_accvgpr_read_b32 v51, a141
  v_mul_f32 v50, v50, v49
  v_mul_f32 v51, v51, v49
  v_accvgpr_write_b32 a140, v50
  v_accvgpr_write_b32 a141, v51
  v_accvgpr_read_b32 v50, a142
  v_accvgpr_read_b32 v51, a143
  v_mul_f32 v50, v50, v49
  v_mul_f32 v51, v51, v49
  v_accvgpr_write_b32 a142, v50
  v_accvgpr_write_b32 a143, v51
  v_accvgpr_read_b32 v50, a144
  v_accvgpr_read_b32 v51, a145
  v_mul_f32 v50, v50, v49
  v_mul_f32 v51, v51, v49
  v_accvgpr_write_b32 a144, v50
  v_accvgpr_write_b32 a145, v51
  v_accvgpr_read_b32 v50, a146
  v_accvgpr_read_b32 v51, a147
  v_mul_f32 v50, v50, v49
  v_mul_f32 v51, v51, v49
  v_accvgpr_write_b32 a146, v50
  v_accvgpr_write_b32 a147, v51
  v_accvgpr_read_b32 v50, a148
  v_accvgpr_read_b32 v51, a149
  v_mul_f32 v50, v50, v49
  v_mul_f32 v51, v51, v49
  v_accvgpr_write_b32 a148, v50
  v_accvgpr_write_b32 a149, v51
  v_accvgpr_read_b32 v50, a150
  v_accvgpr_read_b32 v51, a151
  v_mul_f32 v50, v50, v49
  v_mul_f32 v51, v51, v49
  v_accvgpr_write_b32 a150, v50
  v_accvgpr_write_b32 a151, v51
  v_accvgpr_read_b32 v50, a152
  v_accvgpr_read_b32 v51, a153
  v_mul_f32 v50, v50, v49
  v_mul_f32 v51, v51, v49
  v_accvgpr_write_b32 a152, v50
  v_accvgpr_write_b32 a153, v51
  v_accvgpr_read_b32 v50, a154
  v_accvgpr_read_b32 v51, a155
  v_mul_f32 v50, v50, v49
  v_mul_f32 v51, v51, v49
  v_accvgpr_write_b32 a154, v50
  v_accvgpr_write_b32 a155, v51
  v_accvgpr_read_b32 v50, a156
  v_accvgpr_read_b32 v51, a157
  v_mul_f32 v50, v50, v49
  v_mul_f32 v51, v51, v49
  v_accvgpr_write_b32 a156, v50
  v_accvgpr_write_b32 a157, v51
  v_accvgpr_read_b32 v50, a158
  v_accvgpr_read_b32 v51, a159
  v_mul_f32 v50, v50, v49
  v_mul_f32 v51, v51, v49
  v_accvgpr_write_b32 a158, v50
  v_accvgpr_write_b32 a159, v51
  s_nop 2
  s_branch fa_kernel_back52
fa_kernel_rare53:
  s_nop 7
  v_mov_b32 v49, v48
  s_nop 1
  v_permlane16_swap_b32 v48, v49
  s_nop 1
  v_max_f32 v48, v48, v49
  v_mov_b32 v49, v48
  s_nop 1
  v_permlane32_swap_b32 v48, v49
  s_nop 1
  v_max_f32 v48, v48, v49
  s_ashr_i32 s59, s34, 31
  s_and_b32 s59, s59, 0xff800000
  s_mov_b32 s34, 0x41000000
  v_max_f32 v48, s59, v48
  v_sub_f32 v112, v112, v48
  v_sub_f32 v113, v113, v48
  v_sub_f32 v114, v114, v48
  v_sub_f32 v115, v115, v48
  v_sub_f32 v116, v116, v48
  v_sub_f32 v117, v117, v48
  v_sub_f32 v118, v118, v48
  v_sub_f32 v119, v119, v48
  v_sub_f32 v56, v56, v48
  v_sub_f32 v57, v57, v48
  v_sub_f32 v58, v58, v48
  v_sub_f32 v59, v59, v48
  s_cmp_lg_u32 s59, 0
  s_cbranch_scc1 fa_kernel_back53
  v_sub_f32 v49, 0, v48
  v_exp_f32 v49, v49
  s_nop 1
  v_mul_f32 v76, v76, v49
  v_mul_f32 v77, v77, v49
  v_mul_f32 v78, v78, v49
  v_mul_f32 v79, v79, v49
  v_accvgpr_read_b32 v50, a0
  v_accvgpr_read_b32 v51, a1
  v_mul_f32 v50, v50, v49
  v_mul_f32 v51, v51, v49
  v_accvgpr_write_b32 a0, v50
  v_accvgpr_write_b32 a1, v51
  v_accvgpr_read_b32 v50, a2
  v_accvgpr_read_b32 v51, a3
  v_mul_f32 v50, v50, v49
  v_mul_f32 v51, v51, v49
  v_accvgpr_write_b32 a2, v50
  v_accvgpr_write_b32 a3, v51
  v_accvgpr_read_b32 v50, a4
  v_accvgpr_read_b32 v51, a5
  v_mul_f32 v50, v50, v49
  v_mul_f32 v51, v51, v49
  v_accvgpr_write_b32 a4, v50
  v_accvgpr_write_b32 a5, v51
  v_accvgpr_read_b32 v50, a6
  v_accvgpr_read_b32 v51, a7
  v_mul_f32 v50, v50, v49
  v_mul_f32 v51, v51, v49
  v_accvgpr_write_b32 a6, v50
  v_accvgpr_write_b32 a7, v51
  v_accvgpr_read_b32 v50, a8
  v_accvgpr_read_b32 v51, a9
  v_mul_f32 v50, v50, v49
  v_mul_f32 v51, v51, v49
  v_accvgpr_write_b32 a8, v50
  v_accvgpr_write_b32 a9, v51
  v_accvgpr_read_b32 v50, a10
  v_accvgpr_read_b32 v51, a11
  v_mul_f32 v50, v50, v49
  v_mul_f32 v51, v51, v49
  v_accvgpr_write_b32 a10, v50
  v_accvgpr_write_b32 a11, v51
  v_accvgpr_read_b32 v50, a12
  v_accvgpr_read_b32 v51, a13
  v_mul_f32 v50, v50, v49
  v_mul_f32 v51, v51, v49
  v_accvgpr_write_b32 a12, v50
  v_accvgpr_write_b32 a13, v51
  v_accvgpr_read_b32 v50, a14
  v_accvgpr_read_b32 v51, a15
  v_mul_f32 v50, v50, v49
  v_mul_f32 v51, v51, v49
  v_accvgpr_write_b32 a14, v50
  v_accvgpr_write_b32 a15, v51
  v_accvgpr_read_b32 v50, a16
  v_accvgpr_read_b32 v51, a17
  v_mul_f32 v50, v50, v49
  v_mul_f32 v51, v51, v49
  v_accvgpr_write_b32 a16, v50
  v_accvgpr_write_b32 a17, v51
  v_accvgpr_read_b32 v50, a18
  v_accvgpr_read_b32 v51, a19
  v_mul_f32 v50, v50, v49
  v_mul_f32 v51, v51, v49
  v_accvgpr_write_b32 a18, v50
  v_accvgpr_write_b32 a19, v51
  v_accvgpr_read_b32 v50, a20
  v_accvgpr_read_b32 v51, a21
  v_mul_f32 v50, v50, v49
  v_mul_f32 v51, v51, v49
  v_accvgpr_write_b32 a20, v50
  v_accvgpr_write_b32 a21, v51
  v_accvgpr_read_b32 v50, a22
  v_accvgpr_read_b32 v51, a23
  v_mul_f32 v50, v50, v49
  v_mul_f32 v51, v51, v49
  v_accvgpr_write_b32 a22, v50
  v_accvgpr_write_b32 a23, v51
  v_accvgpr_read_b32 v50, a24
  v_accvgpr_read_b32 v51, a25
  v_mul_f32 v50, v50, v49
  v_mul_f32 v51, v51, v49
  v_accvgpr_write_b32 a24, v50
  v_accvgpr_write_b32 a25, v51
  v_accvgpr_read_b32 v50, a26
  v_accvgpr_read_b32 v51, a27
  v_mul_f32 v50, v50, v49
  v_mul_f32 v51, v51, v49
  v_accvgpr_write_b32 a26, v50
  v_accvgpr_write_b32 a27, v51
  v_accvgpr_read_b32 v50, a28
  v_accvgpr_read_b32 v51, a29
  v_mul_f32 v50, v50, v49
  v_mul_f32 v51, v51, v49
  v_accvgpr_write_b32 a28, v50
  v_accvgpr_write_b32 a29, v51
  v_accvgpr_read_b32 v50, a30
  v_accvgpr_read_b32 v51, a31
  v_mul_f32 v50, v50, v49
  v_mul_f32 v51, v51, v49
  v_accvgpr_write_b32 a30, v50
  v_accvgpr_write_b32 a31, v51
  s_nop 2
  s_branch fa_kernel_back53
fa_kernel_rare54:
  s_nop 7
  v_mov_b32 v49, v48
  s_nop 1
  v_permlane16_swap_b32 v48, v49
  s_nop 1
  v_max_f32 v48, v48, v49
  v_mov_b32 v49, v48
  s_nop 1
  v_permlane32_swap_b32 v48, v49
  s_nop 1
  v_max_f32 v48, v48, v49
  s_ashr_i32 s59, s35, 31
  s_and_b32 s59, s59, 0xff800000
  s_mov_b32 s35, 0x41000000
  v_max_f32 v48, s59, v48
  v_sub_f32 v96, v96, v48
  v_sub_f32 v97, v97, v48
  v_sub_f32 v98, v98, v48
  v_sub_f32 v99, v99, v48
  v_sub_f32 v100, v100, v48
  v_sub_f32 v101, v101, v48
  v_sub_f32 v102, v102, v48
  v_sub_f32 v103, v103, v48
  v_sub_f32 v60, v60, v48
  v_sub_f32 v61, v61, v48
  v_sub_f32 v62, v62, v48
  v_sub_f32 v63, v63, v48
  s_cmp_lg_u32 s59, 0
  s_cbranch_scc1 fa_kernel_back54
  v_sub_f32 v49, 0, v48
  v_exp_f32 v49, v49
  s_nop 1
  v_mul_f32 v80, v80, v49
  v_mul_f32 v81, v81, v49
  v_mul_f32 v82, v82, v49
  v_mul_f32 v83, v83, v49
  v_accvgpr_read_b32 v50, a32
  v_accvgpr_read_b32 v51, a33
  v_mul_f32 v50, v50, v49
  v_mul_f32 v51, v51, v49
  v_accvgpr_write_b32 a32, v50
  v_accvgpr_write_b32 a33, v51
  v_accvgpr_read_b32 v50, a34
  v_accvgpr_read_b32 v51, a35
  v_mul_f32 v50, v50, v49
  v_mul_f32 v51, v51, v49
  v_accvgpr_write_b32 a34, v50
  v_accvgpr_write_b32 a35, v51
  v_accvgpr_read_b32 v50, a36
  v_accvgpr_read_b32 v51, a37
  v_mul_f32 v50, v50, v49
  v_mul_f32 v51, v51, v49
  v_accvgpr_write_b32 a36, v50
  v_accvgpr_write_b32 a37, v51
  v_accvgpr_read_b32 v50, a38
  v_accvgpr_read_b32 v51, a39
  v_mul_f32 v50, v50, v49
  v_mul_f32 v51, v51, v49
  v_accvgpr_write_b32 a38, v50
  v_accvgpr_write_b32 a39, v51
  v_accvgpr_read_b32 v50, a40
  v_accvgpr_read_b32 v51, a41
  v_mul_f32 v50, v50, v49
  v_mul_f32 v51, v51, v49
  v_accvgpr_write_b32 a40, v50
  v_accvgpr_write_b32 a41, v51
  v_accvgpr_read_b32 v50, a42
  v_accvgpr_read_b32 v51, a43
  v_mul_f32 v50, v50, v49
  v_mul_f32 v51, v51, v49
  v_accvgpr_write_b32 a42, v50
  v_accvgpr_write_b32 a43, v51
  v_accvgpr_read_b32 v50, a44
  v_accvgpr_read_b32 v51, a45
  v_mul_f32 v50, v50, v49
  v_mul_f32 v51, v51, v49
  v_accvgpr_write_b32 a44, v50
  v_accvgpr_write_b32 a45, v51
  v_accvgpr_read_b32 v50, a46
  v_accvgpr_read_b32 v51, a47
  v_mul_f32 v50, v50, v49
  v_mul_f32 v51, v51, v49
  v_accvgpr_write_b32 a46, v50
  v_accvgpr_write_b32 a47, v51
  v_accvgpr_read_b32 v50, a48
  v_accvgpr_read_b32 v51, a49
  v_mul_f32 v50, v50, v49
  v_mul_f32 v51, v51, v49
  v_accvgpr_write_b32 a48, v50
  v_accvgpr_write_b32 a49, v51
  v_accvgpr_read_b32 v50, a50
  v_accvgpr_read_b32 v51, a51
  v_mul_f32 v50, v50, v49
  v_mul_f32 v51, v51, v49
  v_accvgpr_write_b32 a50, v50
  v_accvgpr_write_b32 a51, v51
  v_accvgpr_read_b32 v50, a52
  v_accvgpr_read_b32 v51, a53
  v_mul_f32 v50, v50, v49
  v_mul_f32 v51, v51, v49
  v_accvgpr_write_b32 a52, v50
  v_accvgpr_write_b32 a53, v51
  v_accvgpr_read_b32 v50, a54
  v_accvgpr_read_b32 v51, a55
  v_mul_f32 v50, v50, v49
  v_mul_f32 v51, v51, v49
  v_accvgpr_write_b32 a54, v50
  v_accvgpr_write_b32 a55, v51
  v_accvgpr_read_b32 v50, a56
  v_accvgpr_read_b32 v51, a57
  v_mul_f32 v50, v50, v49
  v_mul_f32 v51, v51, v49
  v_accvgpr_write_b32 a56, v50
  v_accvgpr_write_b32 a57, v51
  v_accvgpr_read_b32 v50, a58
  v_accvgpr_read_b32 v51, a59
  v_mul_f32 v50, v50, v49
  v_mul_f32 v51, v51, v49
  v_accvgpr_write_b32 a58, v50
  v_accvgpr_write_b32 a59, v51
  v_accvgpr_read_b32 v50, a60
  v_accvgpr_read_b32 v51, a61
  v_mul_f32 v50, v50, v49
  v_mul_f32 v51, v51, v49
  v_accvgpr_write_b32 a60, v50
  v_accvgpr_write_b32 a61, v51
  v_accvgpr_read_b32 v50, a62
  v_accvgpr_read_b32 v51, a63
  v_mul_f32 v50, v50, v49
  v_mul_f32 v51, v51, v49
  v_accvgpr_write_b32 a62, v50
  v_accvgpr_write_b32 a63, v51
  s_nop 2
  s_branch fa_kernel_back54
fa_kernel_rare55:
  s_nop 7
  v_mov_b32 v49, v48
  s_nop 1
  v_permlane16_swap_b32 v48, v49
  s_nop 1
  v_max_f32 v48, v48, v49
  v_mov_b32 v49, v48
  s_nop 1
  v_permlane32_swap_b32 v48, v49
  s_nop 1
  v_max_f32 v48, v48, v49
  s_ashr_i32 s59, s36, 31
  s_and_b32 s59, s59, 0xff800000
  s_mov_b32 s36, 0x41000000
  v_max_f32 v48, s59, v48
  v_sub_f32 v104, v104, v48
  v_sub_f32 v105, v105, v48
  v_sub_f32 v106, v106, v48
  v_sub_f32 v107, v107, v48
  v_sub_f32 v108, v108, v48
  v_sub_f32 v109, v109, v48
  v_sub_f32 v110, v110, v48
  v_sub_f32 v111, v111, v48
  v_sub_f32 v64, v64, v48
  v_sub_f32 v65, v65, v48
  v_sub_f32 v66, v66, v48
  v_sub_f32 v67, v67, v48
  s_cmp_lg_u32 s59, 0
  s_cbranch_scc1 fa_kernel_back55
  v_sub_f32 v49, 0, v48
  v_exp_f32 v49, v49
  s_nop 1
  v_mul_f32 v84, v84, v49
  v_mul_f32 v85, v85, v49
  v_mul_f32 v86, v86, v49
  v_mul_f32 v87, v87, v49
  v_accvgpr_read_b32 v50, a64
  v_accvgpr_read_b32 v51, a65
  v_mul_f32 v50, v50, v49
  v_mul_f32 v51, v51, v49
  v_accvgpr_write_b32 a64, v50
  v_accvgpr_write_b32 a65, v51
  v_accvgpr_read_b32 v50, a66
  v_accvgpr_read_b32 v51, a67
  v_mul_f32 v50, v50, v49
  v_mul_f32 v51, v51, v49
  v_accvgpr_write_b32 a66, v50
  v_accvgpr_write_b32 a67, v51
  v_accvgpr_read_b32 v50, a68
  v_accvgpr_read_b32 v51, a69
  v_mul_f32 v50, v50, v49
  v_mul_f32 v51, v51, v49
  v_accvgpr_write_b32 a68, v50
  v_accvgpr_write_b32 a69, v51
  v_accvgpr_read_b32 v50, a70
  v_accvgpr_read_b32 v51, a71
  v_mul_f32 v50, v50, v49
  v_mul_f32 v51, v51, v49
  v_accvgpr_write_b32 a70, v50
  v_accvgpr_write_b32 a71, v51
  v_accvgpr_read_b32 v50, a72
  v_accvgpr_read_b32 v51, a73
  v_mul_f32 v50, v50, v49
  v_mul_f32 v51, v51, v49
  v_accvgpr_write_b32 a72, v50
  v_accvgpr_write_b32 a73, v51
  v_accvgpr_read_b32 v50, a74
  v_accvgpr_read_b32 v51, a75
  v_mul_f32 v50, v50, v49
  v_mul_f32 v51, v51, v49
  v_accvgpr_write_b32 a74, v50
  v_accvgpr_write_b32 a75, v51
  v_accvgpr_read_b32 v50, a76
  v_accvgpr_read_b32 v51, a77
  v_mul_f32 v50, v50, v49
  v_mul_f32 v51, v51, v49
  v_accvgpr_write_b32 a76, v50
  v_accvgpr_write_b32 a77, v51
  v_accvgpr_read_b32 v50, a78
  v_accvgpr_read_b32 v51, a79
  v_mul_f32 v50, v50, v49
  v_mul_f32 v51, v51, v49
  v_accvgpr_write_b32 a78, v50
  v_accvgpr_write_b32 a79, v51
  v_accvgpr_read_b32 v50, a80
  v_accvgpr_read_b32 v51, a81
  v_mul_f32 v50, v50, v49
  v_mul_f32 v51, v51, v49
  v_accvgpr_write_b32 a80, v50
  v_accvgpr_write_b32 a81, v51
  v_accvgpr_read_b32 v50, a82
  v_accvgpr_read_b32 v51, a83
  v_mul_f32 v50, v50, v49
  v_mul_f32 v51, v51, v49
  v_accvgpr_write_b32 a82, v50
  v_accvgpr_write_b32 a83, v51
  v_accvgpr_read_b32 v50, a84
  v_accvgpr_read_b32 v51, a85
  v_mul_f32 v50, v50, v49
  v_mul_f32 v51, v51, v49
  v_accvgpr_write_b32 a84, v50
  v_accvgpr_write_b32 a85, v51
  v_accvgpr_read_b32 v50, a86
  v_accvgpr_read_b32 v51, a87
  v_mul_f32 v50, v50, v49
  v_mul_f32 v51, v51, v49
  v_accvgpr_write_b32 a86, v50
  v_accvgpr_write_b32 a87, v51
  v_accvgpr_read_b32 v50, a88
  v_accvgpr_read_b32 v51, a89
  v_mul_f32 v50, v50, v49
  v_mul_f32 v51, v51, v49
  v_accvgpr_write_b32 a88, v50
  v_accvgpr_write_b32 a89, v51
  v_accvgpr_read_b32 v50, a90
  v_accvgpr_read_b32 v51, a91
  v_mul_f32 v50, v50, v49
  v_mul_f32 v51, v51, v49
  v_accvgpr_write_b32 a90, v50
  v_accvgpr_write_b32 a91, v51
  v_accvgpr_read_b32 v50, a92
  v_accvgpr_read_b32 v51, a93
  v_mul_f32 v50, v50, v49
  v_mul_f32 v51, v51, v49
  v_accvgpr_write_b32 a92, v50
  v_accvgpr_write_b32 a93, v51
  v_accvgpr_read_b32 v50, a94
  v_accvgpr_read_b32 v51, a95
  v_mul_f32 v50, v50, v49
  v_mul_f32 v51, v51, v49
  v_accvgpr_write_b32 a94, v50
  v_accvgpr_write_b32 a95, v51
  s_nop 2
  s_branch fa_kernel_back55
fa_kernel_rare56:
  s_nop 7
  v_mov_b32 v49, v48
  s_nop 1
  v_permlane16_swap_b32 v48, v49
  s_nop 1
  v_max_f32 v48, v48, v49
  v_mov_b32 v49, v48
  s_nop 1
  v_permlane32_swap_b32 v48, v49
  s_nop 1
  v_max_f32 v48, v48, v49
  s_ashr_i32 s59, s37, 31
  s_and_b32 s59, s59, 0xff800000
  s_mov_b32 s37, 0x41000000
  v_max_f32 v48, s59, v48
  v_sub_f32 v112, v112, v48
  v_sub_f32 v113, v113, v48
  v_sub_f32 v114, v114, v48
  v_sub_f32 v115, v115, v48
  v_sub_f32 v116, v116, v48
  v_sub_f32 v117, v117, v48
  v_sub_f32 v118, v118, v48
  v_sub_f32 v119, v119, v48
  v_sub_f32 v68, v68, v48
  v_sub_f32 v69, v69, v48
  v_sub_f32 v70, v70, v48
  v_sub_f32 v71, v71, v48
  s_cmp_lg_u32 s59, 0
  s_cbranch_scc1 fa_kernel_back56
  v_sub_f32 v49, 0, v48
  v_exp_f32 v49, v49
  s_nop 1
  v_mul_f32 v88, v88, v49
  v_mul_f32 v89, v89, v49
  v_mul_f32 v90, v90, v49
  v_mul_f32 v91, v91, v49
  v_accvgpr_read_b32 v50, a96
  v_accvgpr_read_b32 v51, a97
  v_mul_f32 v50, v50, v49
  v_mul_f32 v51, v51, v49
  v_accvgpr_write_b32 a96, v50
  v_accvgpr_write_b32 a97, v51
  v_accvgpr_read_b32 v50, a98
  v_accvgpr_read_b32 v51, a99
  v_mul_f32 v50, v50, v49
  v_mul_f32 v51, v51, v49
  v_accvgpr_write_b32 a98, v50
  v_accvgpr_write_b32 a99, v51
  v_accvgpr_read_b32 v50, a100
  v_accvgpr_read_b32 v51, a101
  v_mul_f32 v50, v50, v49
  v_mul_f32 v51, v51, v49
  v_accvgpr_write_b32 a100, v50
  v_accvgpr_write_b32 a101, v51
  v_accvgpr_read_b32 v50, a102
  v_accvgpr_read_b32 v51, a103
  v_mul_f32 v50, v50, v49
  v_mul_f32 v51, v51, v49
  v_accvgpr_write_b32 a102, v50
  v_accvgpr_write_b32 a103, v51
  v_accvgpr_read_b32 v50, a104
  v_accvgpr_read_b32 v51, a105
  v_mul_f32 v50, v50, v49
  v_mul_f32 v51, v51, v49
  v_accvgpr_write_b32 a104, v50
  v_accvgpr_write_b32 a105, v51
  v_accvgpr_read_b32 v50, a106
  v_accvgpr_read_b32 v51, a107
  v_mul_f32 v50, v50, v49
  v_mul_f32 v51, v51, v49
  v_accvgpr_write_b32 a106, v50
  v_accvgpr_write_b32 a107, v51
  v_accvgpr_read_b32 v50, a108
  v_accvgpr_read_b32 v51, a109
  v_mul_f32 v50, v50, v49
  v_mul_f32 v51, v51, v49
  v_accvgpr_write_b32 a108, v50
  v_accvgpr_write_b32 a109, v51
  v_accvgpr_read_b32 v50, a110
  v_accvgpr_read_b32 v51, a111
  v_mul_f32 v50, v50, v49
  v_mul_f32 v51, v51, v49
  v_accvgpr_write_b32 a110, v50
  v_accvgpr_write_b32 a111, v51
  v_accvgpr_read_b32 v50, a112
  v_accvgpr_read_b32 v51, a113
  v_mul_f32 v50, v50, v49
  v_mul_f32 v51, v51, v49
  v_accvgpr_write_b32 a112, v50
  v_accvgpr_write_b32 a113, v51
  v_accvgpr_read_b32 v50, a114
  v_accvgpr_read_b32 v51, a115
  v_mul_f32 v50, v50, v49
  v_mul_f32 v51, v51, v49
  v_accvgpr_write_b32 a114, v50
  v_accvgpr_write_b32 a115, v51
  v_accvgpr_read_b32 v50, a116
  v_accvgpr_read_b32 v51, a117
  v_mul_f32 v50, v50, v49
  v_mul_f32 v51, v51, v49
  v_accvgpr_write_b32 a116, v50
  v_accvgpr_write_b32 a117, v51
  v_accvgpr_read_b32 v50, a118
  v_accvgpr_read_b32 v51, a119
  v_mul_f32 v50, v50, v49
  v_mul_f32 v51, v51, v49
  v_accvgpr_write_b32 a118, v50
  v_accvgpr_write_b32 a119, v51
  v_accvgpr_read_b32 v50, a120
  v_accvgpr_read_b32 v51, a121
  v_mul_f32 v50, v50, v49
  v_mul_f32 v51, v51, v49
  v_accvgpr_write_b32 a120, v50
  v_accvgpr_write_b32 a121, v51
  v_accvgpr_read_b32 v50, a122
  v_accvgpr_read_b32 v51, a123
  v_mul_f32 v50, v50, v49
  v_mul_f32 v51, v51, v49
  v_accvgpr_write_b32 a122, v50
  v_accvgpr_write_b32 a123, v51
  v_accvgpr_read_b32 v50, a124
  v_accvgpr_read_b32 v51, a125
  v_mul_f32 v50, v50, v49
  v_mul_f32 v51, v51, v49
  v_accvgpr_write_b32 a124, v50
  v_accvgpr_write_b32 a125, v51
  v_accvgpr_read_b32 v50, a126
  v_accvgpr_read_b32 v51, a127
  v_mul_f32 v50, v50, v49
  v_mul_f32 v51, v51, v49
  v_accvgpr_write_b32 a126, v50
  v_accvgpr_write_b32 a127, v51
  s_nop 2
  s_branch fa_kernel_back56
fa_kernel_rare57:
  s_nop 7
  v_mov_b32 v49, v48
  s_nop 1
  v_permlane16_swap_b32 v48, v49
  s_nop 1
  v_max_f32 v48, v48, v49
  v_mov_b32 v49, v48
  s_nop 1
  v_permlane32_swap_b32 v48, v49
  s_nop 1
  v_max_f32 v48, v48, v49
  s_ashr_i32 s59, s34, 31
  s_and_b32 s59, s59, 0xff800000
  s_mov_b32 s34, 0x41000000
  v_max_f32 v48, s59, v48
  v_sub_f32 v96, v96, v48
  v_sub_f32 v97, v97, v48
  v_sub_f32 v98, v98, v48
  v_sub_f32 v99, v99, v48
  v_sub_f32 v100, v100, v48
  v_sub_f32 v101, v101, v48
  v_sub_f32 v102, v102, v48
  v_sub_f32 v103, v103, v48
  v_sub_f32 v56, v56, v48
  v_sub_f32 v57, v57, v48
  v_sub_f32 v58, v58, v48
  v_sub_f32 v59, v59, v48
  s_cmp_lg_u32 s59, 0
  s_cbranch_scc1 fa_kernel_back57
  v_sub_f32 v49, 0, v48
  v_exp_f32 v49, v49
  s_nop 1
  v_mul_f32 v76, v76, v49
  v_mul_f32 v77, v77, v49
  v_mul_f32 v78, v78, v49
  v_mul_f32 v79, v79, v49
  v_accvgpr_read_b32 v50, a0
  v_accvgpr_read_b32 v51, a1
  v_mul_f32 v50, v50, v49
  v_mul_f32 v51, v51, v49
  v_accvgpr_write_b32 a0, v50
  v_accvgpr_write_b32 a1, v51
  v_accvgpr_read_b32 v50, a2
  v_accvgpr_read_b32 v51, a3
  v_mul_f32 v50, v50, v49
  v_mul_f32 v51, v51, v49
  v_accvgpr_write_b32 a2, v50
  v_accvgpr_write_b32 a3, v51
  v_accvgpr_read_b32 v50, a4
  v_accvgpr_read_b32 v51, a5
  v_mul_f32 v50, v50, v49
  v_mul_f32 v51, v51, v49
  v_accvgpr_write_b32 a4, v50
  v_accvgpr_write_b32 a5, v51
  v_accvgpr_read_b32 v50, a6
  v_accvgpr_read_b32 v51, a7
  v_mul_f32 v50, v50, v49
  v_mul_f32 v51, v51, v49
  v_accvgpr_write_b32 a6, v50
  v_accvgpr_write_b32 a7, v51
  v_accvgpr_read_b32 v50, a8
  v_accvgpr_read_b32 v51, a9
  v_mul_f32 v50, v50, v49
  v_mul_f32 v51, v51, v49
  v_accvgpr_write_b32 a8, v50
  v_accvgpr_write_b32 a9, v51
  v_accvgpr_read_b32 v50, a10
  v_accvgpr_read_b32 v51, a11
  v_mul_f32 v50, v50, v49
  v_mul_f32 v51, v51, v49
  v_accvgpr_write_b32 a10, v50
  v_accvgpr_write_b32 a11, v51
  v_accvgpr_read_b32 v50, a12
  v_accvgpr_read_b32 v51, a13
  v_mul_f32 v50, v50, v49
  v_mul_f32 v51, v51, v49
  v_accvgpr_write_b32 a12, v50
  v_accvgpr_write_b32 a13, v51
  v_accvgpr_read_b32 v50, a14
  v_accvgpr_read_b32 v51, a15
  v_mul_f32 v50, v50, v49
  v_mul_f32 v51, v51, v49
  v_accvgpr_write_b32 a14, v50
  v_accvgpr_write_b32 a15, v51
  v_accvgpr_read_b32 v50, a16
  v_accvgpr_read_b32 v51, a17
  v_mul_f32 v50, v50, v49
  v_mul_f32 v51, v51, v49
  v_accvgpr_write_b32 a16, v50
  v_accvgpr_write_b32 a17, v51
  v_accvgpr_read_b32 v50, a18
  v_accvgpr_read_b32 v51, a19
  v_mul_f32 v50, v50, v49
  v_mul_f32 v51, v51, v49
  v_accvgpr_write_b32 a18, v50
  v_accvgpr_write_b32 a19, v51
  v_accvgpr_read_b32 v50, a20
  v_accvgpr_read_b32 v51, a21
  v_mul_f32 v50, v50, v49
  v_mul_f32 v51, v51, v49
  v_accvgpr_write_b32 a20, v50
  v_accvgpr_write_b32 a21, v51
  v_accvgpr_read_b32 v50, a22
  v_accvgpr_read_b32 v51, a23
  v_mul_f32 v50, v50, v49
  v_mul_f32 v51, v51, v49
  v_accvgpr_write_b32 a22, v50
  v_accvgpr_write_b32 a23, v51
  v_accvgpr_read_b32 v50, a24
  v_accvgpr_read_b32 v51, a25
  v_mul_f32 v50, v50, v49
  v_mul_f32 v51, v51, v49
  v_accvgpr_write_b32 a24, v50
  v_accvgpr_write_b32 a25, v51
  v_accvgpr_read_b32 v50, a26
  v_accvgpr_read_b32 v51, a27
  v_mul_f32 v50, v50, v49
  v_mul_f32 v51, v51, v49
  v_accvgpr_write_b32 a26, v50
  v_accvgpr_write_b32 a27, v51
  v_accvgpr_read_b32 v50, a28
  v_accvgpr_read_b32 v51, a29
  v_mul_f32 v50, v50, v49
  v_mul_f32 v51, v51, v49
  v_accvgpr_write_b32 a28, v50
  v_accvgpr_write_b32 a29, v51
  v_accvgpr_read_b32 v50, a30
  v_accvgpr_read_b32 v51, a31
  v_mul_f32 v50, v50, v49
  v_mul_f32 v51, v51, v49
  v_accvgpr_write_b32 a30, v50
  v_accvgpr_write_b32 a31, v51
  s_nop 2
  s_branch fa_kernel_back57
fa_kernel_rare58:
  s_nop 7
  v_mov_b32 v49, v48
  s_nop 1
  v_permlane16_swap_b32 v48, v49
  s_nop 1
  v_max_f32 v48, v48, v49
  v_mov_b32 v49, v48
  s_nop 1
  v_permlane32_swap_b32 v48, v49
  s_nop 1
  v_max_f32 v48, v48, v49
  s_ashr_i32 s59, s35, 31
  s_and_b32 s59, s59, 0xff800000
  s_mov_b32 s35, 0x41000000
  v_max_f32 v48, s59, v48
  v_sub_f32 v104, v104, v48
  v_sub_f32 v105, v105, v48
  v_sub_f32 v106, v106, v48
  v_sub_f32 v107, v107, v48
  v_sub_f32 v108, v108, v48
  v_sub_f32 v109, v109, v48
  v_sub_f32 v110, v110, v48
  v_sub_f32 v111, v111, v48
  v_sub_f32 v60, v60, v48
  v_sub_f32 v61, v61, v48
  v_sub_f32 v62, v62, v48
  v_sub_f32 v63, v63, v48
  s_cmp_lg_u32 s59, 0
  s_cbranch_scc1 fa_kernel_back58
  v_sub_f32 v49, 0, v48
  v_exp_f32 v49, v49
  s_nop 1
  v_mul_f32 v80, v80, v49
  v_mul_f32 v81, v81, v49
  v_mul_f32 v82, v82, v49
  v_mul_f32 v83, v83, v49
  v_accvgpr_read_b32 v50, a32
  v_accvgpr_read_b32 v51, a33
  v_mul_f32 v50, v50, v49
  v_mul_f32 v51, v51, v49
  v_accvgpr_write_b32 a32, v50
  v_accvgpr_write_b32 a33, v51
  v_accvgpr_read_b32 v50, a34
  v_accvgpr_read_b32 v51, a35
  v_mul_f32 v50, v50, v49
  v_mul_f32 v51, v51, v49
  v_accvgpr_write_b32 a34, v50
  v_accvgpr_write_b32 a35, v51
  v_accvgpr_read_b32 v50, a36
  v_accvgpr_read_b32 v51, a37
  v_mul_f32 v50, v50, v49
  v_mul_f32 v51, v51, v49
  v_accvgpr_write_b32 a36, v50
  v_accvgpr_write_b32 a37, v51
  v_accvgpr_read_b32 v50, a38
  v_accvgpr_read_b32 v51, a39
  v_mul_f32 v50, v50, v49
  v_mul_f32 v51, v51, v49
  v_accvgpr_write_b32 a38, v50
  v_accvgpr_write_b32 a39, v51
  v_accvgpr_read_b32 v50, a40
  v_accvgpr_read_b32 v51, a41
  v_mul_f32 v50, v50, v49
  v_mul_f32 v51, v51, v49
  v_accvgpr_write_b32 a40, v50
  v_accvgpr_write_b32 a41, v51
  v_accvgpr_read_b32 v50, a42
  v_accvgpr_read_b32 v51, a43
  v_mul_f32 v50, v50, v49
  v_mul_f32 v51, v51, v49
  v_accvgpr_write_b32 a42, v50
  v_accvgpr_write_b32 a43, v51
  v_accvgpr_read_b32 v50, a44
  v_accvgpr_read_b32 v51, a45
  v_mul_f32 v50, v50, v49
  v_mul_f32 v51, v51, v49
  v_accvgpr_write_b32 a44, v50
  v_accvgpr_write_b32 a45, v51
  v_accvgpr_read_b32 v50, a46
  v_accvgpr_read_b32 v51, a47
  v_mul_f32 v50, v50, v49
  v_mul_f32 v51, v51, v49
  v_accvgpr_write_b32 a46, v50
  v_accvgpr_write_b32 a47, v51
  v_accvgpr_read_b32 v50, a48
  v_accvgpr_read_b32 v51, a49
  v_mul_f32 v50, v50, v49
  v_mul_f32 v51, v51, v49
  v_accvgpr_write_b32 a48, v50
  v_accvgpr_write_b32 a49, v51
  v_accvgpr_read_b32 v50, a50
  v_accvgpr_read_b32 v51, a51
  v_mul_f32 v50, v50, v49
  v_mul_f32 v51, v51, v49
  v_accvgpr_write_b32 a50, v50
  v_accvgpr_write_b32 a51, v51
  v_accvgpr_read_b32 v50, a52
  v_accvgpr_read_b32 v51, a53
  v_mul_f32 v50, v50, v49
  v_mul_f32 v51, v51, v49
  v_accvgpr_write_b32 a52, v50
  v_accvgpr_write_b32 a53, v51
  v_accvgpr_read_b32 v50, a54
  v_accvgpr_read_b32 v51, a55
  v_mul_f32 v50, v50, v49
  v_mul_f32 v51, v51, v49
  v_accvgpr_write_b32 a54, v50
  v_accvgpr_write_b32 a55, v51
  v_accvgpr_read_b32 v50, a56
  v_accvgpr_read_b32 v51, a57
  v_mul_f32 v50, v50, v49
  v_mul_f32 v51, v51, v49
  v_accvgpr_write_b32 a56, v50
  v_accvgpr_write_b32 a57, v51
  v_accvgpr_read_b32 v50, a58
  v_accvgpr_read_b32 v51, a59
  v_mul_f32 v50, v50, v49
  v_mul_f32 v51, v51, v49
  v_accvgpr_write_b32 a58, v50
  v_accvgpr_write_b32 a59, v51
  v_accvgpr_read_b32 v50, a60
  v_accvgpr_read_b32 v51, a61
  v_mul_f32 v50, v50, v49
  v_mul_f32 v51, v51, v49
  v_accvgpr_write_b32 a60, v50
  v_accvgpr_write_b32 a61, v51
  v_accvgpr_read_b32 v50, a62
  v_accvgpr_read_b32 v51, a63
  v_mul_f32 v50, v50, v49
  v_mul_f32 v51, v51, v49
  v_accvgpr_write_b32 a62, v50
  v_accvgpr_write_b32 a63, v51
  s_nop 2
  s_branch fa_kernel_back58
fa_kernel_rare59:
  s_nop 7
  v_mov_b32 v49, v48
  s_nop 1
  v_permlane16_swap_b32 v48, v49
  s_nop 1
  v_max_f32 v48, v48, v49
  v_mov_b32 v49, v48
  s_nop 1
  v_permlane32_swap_b32 v48, v49
  s_nop 1
  v_max_f32 v48, v48, v49
  s_ashr_i32 s59, s36, 31
  s_and_b32 s59, s59, 0xff800000
  s_mov_b32 s36, 0x41000000
  v_max_f32 v48, s59, v48
  v_sub_f32 v112, v112, v48
  v_sub_f32 v113, v113, v48
  v_sub_f32 v114, v114, v48
  v_sub_f32 v115, v115, v48
  v_sub_f32 v116, v116, v48
  v_sub_f32 v117, v117, v48
  v_sub_f32 v118, v118, v48
  v_sub_f32 v119, v119, v48
  v_sub_f32 v64, v64, v48
  v_sub_f32 v65, v65, v48
  v_sub_f32 v66, v66, v48
  v_sub_f32 v67, v67, v48
  s_cmp_lg_u32 s59, 0
  s_cbranch_scc1 fa_kernel_back59
  v_sub_f32 v49, 0, v48
  v_exp_f32 v49, v49
  s_nop 1
  v_mul_f32 v84, v84, v49
  v_mul_f32 v85, v85, v49
  v_mul_f32 v86, v86, v49
  v_mul_f32 v87, v87, v49
  v_accvgpr_read_b32 v50, a64
  v_accvgpr_read_b32 v51, a65
  v_mul_f32 v50, v50, v49
  v_mul_f32 v51, v51, v49
  v_accvgpr_write_b32 a64, v50
  v_accvgpr_write_b32 a65, v51
  v_accvgpr_read_b32 v50, a66
  v_accvgpr_read_b32 v51, a67
  v_mul_f32 v50, v50, v49
  v_mul_f32 v51, v51, v49
  v_accvgpr_write_b32 a66, v50
  v_accvgpr_write_b32 a67, v51
  v_accvgpr_read_b32 v50, a68
  v_accvgpr_read_b32 v51, a69
  v_mul_f32 v50, v50, v49
  v_mul_f32 v51, v51, v49
  v_accvgpr_write_b32 a68, v50
  v_accvgpr_write_b32 a69, v51
  v_accvgpr_read_b32 v50, a70
  v_accvgpr_read_b32 v51, a71
  v_mul_f32 v50, v50, v49
  v_mul_f32 v51, v51, v49
  v_accvgpr_write_b32 a70, v50
  v_accvgpr_write_b32 a71, v51
  v_accvgpr_read_b32 v50, a72
  v_accvgpr_read_b32 v51, a73
  v_mul_f32 v50, v50, v49
  v_mul_f32 v51, v51, v49
  v_accvgpr_write_b32 a72, v50
  v_accvgpr_write_b32 a73, v51
  v_accvgpr_read_b32 v50, a74
  v_accvgpr_read_b32 v51, a75
  v_mul_f32 v50, v50, v49
  v_mul_f32 v51, v51, v49
  v_accvgpr_write_b32 a74, v50
  v_accvgpr_write_b32 a75, v51
  v_accvgpr_read_b32 v50, a76
  v_accvgpr_read_b32 v51, a77
  v_mul_f32 v50, v50, v49
  v_mul_f32 v51, v51, v49
  v_accvgpr_write_b32 a76, v50
  v_accvgpr_write_b32 a77, v51
  v_accvgpr_read_b32 v50, a78
  v_accvgpr_read_b32 v51, a79
  v_mul_f32 v50, v50, v49
  v_mul_f32 v51, v51, v49
  v_accvgpr_write_b32 a78, v50
  v_accvgpr_write_b32 a79, v51
  v_accvgpr_read_b32 v50, a80
  v_accvgpr_read_b32 v51, a81
  v_mul_f32 v50, v50, v49
  v_mul_f32 v51, v51, v49
  v_accvgpr_write_b32 a80, v50
  v_accvgpr_write_b32 a81, v51
  v_accvgpr_read_b32 v50, a82
  v_accvgpr_read_b32 v51, a83
  v_mul_f32 v50, v50, v49
  v_mul_f32 v51, v51, v49
  v_accvgpr_write_b32 a82, v50
  v_accvgpr_write_b32 a83, v51
  v_accvgpr_read_b32 v50, a84
  v_accvgpr_read_b32 v51, a85
  v_mul_f32 v50, v50, v49
  v_mul_f32 v51, v51, v49
  v_accvgpr_write_b32 a84, v50
  v_accvgpr_write_b32 a85, v51
  v_accvgpr_read_b32 v50, a86
  v_accvgpr_read_b32 v51, a87
  v_mul_f32 v50, v50, v49
  v_mul_f32 v51, v51, v49
  v_accvgpr_write_b32 a86, v50
  v_accvgpr_write_b32 a87, v51
  v_accvgpr_read_b32 v50, a88
  v_accvgpr_read_b32 v51, a89
  v_mul_f32 v50, v50, v49
  v_mul_f32 v51, v51, v49
  v_accvgpr_write_b32 a88, v50
  v_accvgpr_write_b32 a89, v51
  v_accvgpr_read_b32 v50, a90
  v_accvgpr_read_b32 v51, a91
  v_mul_f32 v50, v50, v49
  v_mul_f32 v51, v51, v49
  v_accvgpr_write_b32 a90, v50
  v_accvgpr_write_b32 a91, v51
  v_accvgpr_read_b32 v50, a92
  v_accvgpr_read_b32 v51, a93
  v_mul_f32 v50, v50, v49
  v_mul_f32 v51, v51, v49
  v_accvgpr_write_b32 a92, v50
  v_accvgpr_write_b32 a93, v51
  v_accvgpr_read_b32 v50, a94
  v_accvgpr_read_b32 v51, a95
  v_mul_f32 v50, v50, v49
  v_mul_f32 v51, v51, v49
  v_accvgpr_write_b32 a94, v50
  v_accvgpr_write_b32 a95, v51
  s_nop 2
  s_branch fa_kernel_back59
fa_kernel_rare60:
  s_nop 7
  v_mov_b32 v49, v48
  s_nop 1
  v_permlane16_swap_b32 v48, v49
  s_nop 1
  v_max_f32 v48, v48, v49
  v_mov_b32 v49, v48
  s_nop 1
  v_permlane32_swap_b32 v48, v49
  s_nop 1
  v_max_f32 v48, v48, v49
  s_ashr_i32 s59, s37, 31
  s_and_b32 s59, s59, 0xff800000
  s_mov_b32 s37, 0x41000000
  v_max_f32 v48, s59, v48
  v_sub_f32 v96, v96, v48
  v_sub_f32 v97, v97, v48
  v_sub_f32 v98, v98, v48
  v_sub_f32 v99, v99, v48
  v_sub_f32 v100, v100, v48
  v_sub_f32 v101, v101, v48
  v_sub_f32 v102, v102, v48
  v_sub_f32 v103, v103, v48
  v_sub_f32 v68, v68, v48
  v_sub_f32 v69, v69, v48
  v_sub_f32 v70, v70, v48
  v_sub_f32 v71, v71, v48
  s_cmp_lg_u32 s59, 0
  s_cbranch_scc1 fa_kernel_back60
  v_sub_f32 v49, 0, v48
  v_exp_f32 v49, v49
  s_nop 1
  v_mul_f32 v88, v88, v49
  v_mul_f32 v89, v89, v49
  v_mul_f32 v90, v90, v49
  v_mul_f32 v91, v91, v49
  v_accvgpr_read_b32 v50, a96
  v_accvgpr_read_b32 v51, a97
  v_mul_f32 v50, v50, v49
  v_mul_f32 v51, v51, v49
  v_accvgpr_write_b32 a96, v50
  v_accvgpr_write_b32 a97, v51
  v_accvgpr_read_b32 v50, a98
  v_accvgpr_read_b32 v51, a99
  v_mul_f32 v50, v50, v49
  v_mul_f32 v51, v51, v49
  v_accvgpr_write_b32 a98, v50
  v_accvgpr_write_b32 a99, v51
  v_accvgpr_read_b32 v50, a100
  v_accvgpr_read_b32 v51, a101
  v_mul_f32 v50, v50, v49
  v_mul_f32 v51, v51, v49
  v_accvgpr_write_b32 a100, v50
  v_accvgpr_write_b32 a101, v51
  v_accvgpr_read_b32 v50, a102
  v_accvgpr_read_b32 v51, a103
  v_mul_f32 v50, v50, v49
  v_mul_f32 v51, v51, v49
  v_accvgpr_write_b32 a102, v50
  v_accvgpr_write_b32 a103, v51
  v_accvgpr_read_b32 v50, a104
  v_accvgpr_read_b32 v51, a105
  v_mul_f32 v50, v50, v49
  v_mul_f32 v51, v51, v49
  v_accvgpr_write_b32 a104, v50
  v_accvgpr_write_b32 a105, v51
  v_accvgpr_read_b32 v50, a106
  v_accvgpr_read_b32 v51, a107
  v_mul_f32 v50, v50, v49
  v_mul_f32 v51, v51, v49
  v_accvgpr_write_b32 a106, v50
  v_accvgpr_write_b32 a107, v51
  v_accvgpr_read_b32 v50, a108
  v_accvgpr_read_b32 v51, a109
  v_mul_f32 v50, v50, v49
  v_mul_f32 v51, v51, v49
  v_accvgpr_write_b32 a108, v50
  v_accvgpr_write_b32 a109, v51
  v_accvgpr_read_b32 v50, a110
  v_accvgpr_read_b32 v51, a111
  v_mul_f32 v50, v50, v49
  v_mul_f32 v51, v51, v49
  v_accvgpr_write_b32 a110, v50
  v_accvgpr_write_b32 a111, v51
  v_accvgpr_read_b32 v50, a112
  v_accvgpr_read_b32 v51, a113
  v_mul_f32 v50, v50, v49
  v_mul_f32 v51, v51, v49
  v_accvgpr_write_b32 a112, v50
  v_accvgpr_write_b32 a113, v51
  v_accvgpr_read_b32 v50, a114
  v_accvgpr_read_b32 v51, a115
  v_mul_f32 v50, v50, v49
  v_mul_f32 v51, v51, v49
  v_accvgpr_write_b32 a114, v50
  v_accvgpr_write_b32 a115, v51
  v_accvgpr_read_b32 v50, a116
  v_accvgpr_read_b32 v51, a117
  v_mul_f32 v50, v50, v49
  v_mul_f32 v51, v51, v49
  v_accvgpr_write_b32 a116, v50
  v_accvgpr_write_b32 a117, v51
  v_accvgpr_read_b32 v50, a118
  v_accvgpr_read_b32 v51, a119
  v_mul_f32 v50, v50, v49
  v_mul_f32 v51, v51, v49
  v_accvgpr_write_b32 a118, v50
  v_accvgpr_write_b32 a119, v51
  v_accvgpr_read_b32 v50, a120
  v_accvgpr_read_b32 v51, a121
  v_mul_f32 v50, v50, v49
  v_mul_f32 v51, v51, v49
  v_accvgpr_write_b32 a120, v50
  v_accvgpr_write_b32 a121, v51
  v_accvgpr_read_b32 v50, a122
  v_accvgpr_read_b32 v51, a123
  v_mul_f32 v50, v50, v49
  v_mul_f32 v51, v51, v49
  v_accvgpr_write_b32 a122, v50
  v_accvgpr_write_b32 a123, v51
  v_accvgpr_read_b32 v50, a124
  v_accvgpr_read_b32 v51, a125
  v_mul_f32 v50, v50, v49
  v_mul_f32 v51, v51, v49
  v_accvgpr_write_b32 a124, v50
  v_accvgpr_write_b32 a125, v51
  v_accvgpr_read_b32 v50, a126
  v_accvgpr_read_b32 v51, a127
  v_mul_f32 v50, v50, v49
  v_mul_f32 v51, v51, v49
  v_accvgpr_write_b32 a126, v50
  v_accvgpr_write_b32 a127, v51
  s_nop 2
  s_branch fa_kernel_back60
fa_kernel_rare61:
  s_nop 7
  v_mov_b32 v49, v48
  s_nop 1
  v_permlane16_swap_b32 v48, v49
  s_nop 1
  v_max_f32 v48, v48, v49
  v_mov_b32 v49, v48
  s_nop 1
  v_permlane32_swap_b32 v48, v49
  s_nop 1
  v_max_f32 v48, v48, v49
  s_ashr_i32 s59, s34, 31
  s_and_b32 s59, s59, 0xff800000
  s_mov_b32 s34, 0x41000000
  v_max_f32 v48, s59, v48
  v_sub_f32 v104, v104, v48
  v_sub_f32 v105, v105, v48
  v_sub_f32 v106, v106, v48
  v_sub_f32 v107, v107, v48
  v_sub_f32 v108, v108, v48
  v_sub_f32 v109, v109, v48
  v_sub_f32 v110, v110, v48
  v_sub_f32 v111, v111, v48
  v_sub_f32 v56, v56, v48
  v_sub_f32 v57, v57, v48
  v_sub_f32 v58, v58, v48
  v_sub_f32 v59, v59, v48
  s_cmp_lg_u32 s59, 0
  s_cbranch_scc1 fa_kernel_back61
  v_sub_f32 v49, 0, v48
  v_exp_f32 v49, v49
  s_nop 1
  v_mul_f32 v76, v76, v49
  v_mul_f32 v77, v77, v49
  v_mul_f32 v78, v78, v49
  v_mul_f32 v79, v79, v49
  v_accvgpr_read_b32 v50, a0
  v_accvgpr_read_b32 v51, a1
  v_mul_f32 v50, v50, v49
  v_mul_f32 v51, v51, v49
  v_accvgpr_write_b32 a0, v50
  v_accvgpr_write_b32 a1, v51
  v_accvgpr_read_b32 v50, a2
  v_accvgpr_read_b32 v51, a3
  v_mul_f32 v50, v50, v49
  v_mul_f32 v51, v51, v49
  v_accvgpr_write_b32 a2, v50
  v_accvgpr_write_b32 a3, v51
  v_accvgpr_read_b32 v50, a4
  v_accvgpr_read_b32 v51, a5
  v_mul_f32 v50, v50, v49
  v_mul_f32 v51, v51, v49
  v_accvgpr_write_b32 a4, v50
  v_accvgpr_write_b32 a5, v51
  v_accvgpr_read_b32 v50, a6
  v_accvgpr_read_b32 v51, a7
  v_mul_f32 v50, v50, v49
  v_mul_f32 v51, v51, v49
  v_accvgpr_write_b32 a6, v50
  v_accvgpr_write_b32 a7, v51
  v_accvgpr_read_b32 v50, a8
  v_accvgpr_read_b32 v51, a9
  v_mul_f32 v50, v50, v49
  v_mul_f32 v51, v51, v49
  v_accvgpr_write_b32 a8, v50
  v_accvgpr_write_b32 a9, v51
  v_accvgpr_read_b32 v50, a10
  v_accvgpr_read_b32 v51, a11
  v_mul_f32 v50, v50, v49
  v_mul_f32 v51, v51, v49
  v_accvgpr_write_b32 a10, v50
  v_accvgpr_write_b32 a11, v51
  v_accvgpr_read_b32 v50, a12
  v_accvgpr_read_b32 v51, a13
  v_mul_f32 v50, v50, v49
  v_mul_f32 v51, v51, v49
  v_accvgpr_write_b32 a12, v50
  v_accvgpr_write_b32 a13, v51
  v_accvgpr_read_b32 v50, a14
  v_accvgpr_read_b32 v51, a15
  v_mul_f32 v50, v50, v49
  v_mul_f32 v51, v51, v49
  v_accvgpr_write_b32 a14, v50
  v_accvgpr_write_b32 a15, v51
  v_accvgpr_read_b32 v50, a16
  v_accvgpr_read_b32 v51, a17
  v_mul_f32 v50, v50, v49
  v_mul_f32 v51, v51, v49
  v_accvgpr_write_b32 a16, v50
  v_accvgpr_write_b32 a17, v51
  v_accvgpr_read_b32 v50, a18
  v_accvgpr_read_b32 v51, a19
  v_mul_f32 v50, v50, v49
  v_mul_f32 v51, v51, v49
  v_accvgpr_write_b32 a18, v50
  v_accvgpr_write_b32 a19, v51
  v_accvgpr_read_b32 v50, a20
  v_accvgpr_read_b32 v51, a21
  v_mul_f32 v50, v50, v49
  v_mul_f32 v51, v51, v49
  v_accvgpr_write_b32 a20, v50
  v_accvgpr_write_b32 a21, v51
  v_accvgpr_read_b32 v50, a22
  v_accvgpr_read_b32 v51, a23
  v_mul_f32 v50, v50, v49
  v_mul_f32 v51, v51, v49
  v_accvgpr_write_b32 a22, v50
  v_accvgpr_write_b32 a23, v51
  v_accvgpr_read_b32 v50, a24
  v_accvgpr_read_b32 v51, a25
  v_mul_f32 v50, v50, v49
  v_mul_f32 v51, v51, v49
  v_accvgpr_write_b32 a24, v50
  v_accvgpr_write_b32 a25, v51
  v_accvgpr_read_b32 v50, a26
  v_accvgpr_read_b32 v51, a27
  v_mul_f32 v50, v50, v49
  v_mul_f32 v51, v51, v49
  v_accvgpr_write_b32 a26, v50
  v_accvgpr_write_b32 a27, v51
  v_accvgpr_read_b32 v50, a28
  v_accvgpr_read_b32 v51, a29
  v_mul_f32 v50, v50, v49
  v_mul_f32 v51, v51, v49
  v_accvgpr_write_b32 a28, v50
  v_accvgpr_write_b32 a29, v51
  v_accvgpr_read_b32 v50, a30
  v_accvgpr_read_b32 v51, a31
  v_mul_f32 v50, v50, v49
  v_mul_f32 v51, v51, v49
  v_accvgpr_write_b32 a30, v50
  v_accvgpr_write_b32 a31, v51
  s_nop 2
  s_branch fa_kernel_back61
fa_kernel_rare62:
  s_nop 7
  v_mov_b32 v49, v48
  s_nop 1
  v_permlane16_swap_b32 v48, v49
  s_nop 1
  v_max_f32 v48, v48, v49
  v_mov_b32 v49, v48
  s_nop 1
  v_permlane32_swap_b32 v48, v49
  s_nop 1
  v_max_f32 v48, v48, v49
  s_ashr_i32 s59, s35, 31
  s_and_b32 s59, s59, 0xff800000
  s_mov_b32 s35, 0x41000000
  v_max_f32 v48, s59, v48
  v_sub_f32 v112, v112, v48
  v_sub_f32 v113, v113, v48
  v_sub_f32 v114, v114, v48
  v_sub_f32 v115, v115, v48
  v_sub_f32 v116, v116, v48
  v_sub_f32 v117, v117, v48
  v_sub_f32 v118, v118, v48
  v_sub_f32 v119, v119, v48
  v_sub_f32 v60, v60, v48
  v_sub_f32 v61, v61, v48
  v_sub_f32 v62, v62, v48
  v_sub_f32 v63, v63, v48
  s_cmp_lg_u32 s59, 0
  s_cbranch_scc1 fa_kernel_back62
  v_sub_f32 v49, 0, v48
  v_exp_f32 v49, v49
  s_nop 1
  v_mul_f32 v80, v80, v49
  v_mul_f32 v81, v81, v49
  v_mul_f32 v82, v82, v49
  v_mul_f32 v83, v83, v49
  v_accvgpr_read_b32 v50, a32
  v_accvgpr_read_b32 v51, a33
  v_mul_f32 v50, v50, v49
  v_mul_f32 v51, v51, v49
  v_accvgpr_write_b32 a32, v50
  v_accvgpr_write_b32 a33, v51
  v_accvgpr_read_b32 v50, a34
  v_accvgpr_read_b32 v51, a35
  v_mul_f32 v50, v50, v49
  v_mul_f32 v51, v51, v49
  v_accvgpr_write_b32 a34, v50
  v_accvgpr_write_b32 a35, v51
  v_accvgpr_read_b32 v50, a36
  v_accvgpr_read_b32 v51, a37
  v_mul_f32 v50, v50, v49
  v_mul_f32 v51, v51, v49
  v_accvgpr_write_b32 a36, v50
  v_accvgpr_write_b32 a37, v51
  v_accvgpr_read_b32 v50, a38
  v_accvgpr_read_b32 v51, a39
  v_mul_f32 v50, v50, v49
  v_mul_f32 v51, v51, v49
  v_accvgpr_write_b32 a38, v50
  v_accvgpr_write_b32 a39, v51
  v_accvgpr_read_b32 v50, a40
  v_accvgpr_read_b32 v51, a41
  v_mul_f32 v50, v50, v49
  v_mul_f32 v51, v51, v49
  v_accvgpr_write_b32 a40, v50
  v_accvgpr_write_b32 a41, v51
  v_accvgpr_read_b32 v50, a42
  v_accvgpr_read_b32 v51, a43
  v_mul_f32 v50, v50, v49
  v_mul_f32 v51, v51, v49
  v_accvgpr_write_b32 a42, v50
  v_accvgpr_write_b32 a43, v51
  v_accvgpr_read_b32 v50, a44
  v_accvgpr_read_b32 v51, a45
  v_mul_f32 v50, v50, v49
  v_mul_f32 v51, v51, v49
  v_accvgpr_write_b32 a44, v50
  v_accvgpr_write_b32 a45, v51
  v_accvgpr_read_b32 v50, a46
  v_accvgpr_read_b32 v51, a47
  v_mul_f32 v50, v50, v49
  v_mul_f32 v51, v51, v49
  v_accvgpr_write_b32 a46, v50
  v_accvgpr_write_b32 a47, v51
  v_accvgpr_read_b32 v50, a48
  v_accvgpr_read_b32 v51, a49
  v_mul_f32 v50, v50, v49
  v_mul_f32 v51, v51, v49
  v_accvgpr_write_b32 a48, v50
  v_accvgpr_write_b32 a49, v51
  v_accvgpr_read_b32 v50, a50
  v_accvgpr_read_b32 v51, a51
  v_mul_f32 v50, v50, v49
  v_mul_f32 v51, v51, v49
  v_accvgpr_write_b32 a50, v50
  v_accvgpr_write_b32 a51, v51
  v_accvgpr_read_b32 v50, a52
  v_accvgpr_read_b32 v51, a53
  v_mul_f32 v50, v50, v49
  v_mul_f32 v51, v51, v49
  v_accvgpr_write_b32 a52, v50
  v_accvgpr_write_b32 a53, v51
  v_accvgpr_read_b32 v50, a54
  v_accvgpr_read_b32 v51, a55
  v_mul_f32 v50, v50, v49
  v_mul_f32 v51, v51, v49
  v_accvgpr_write_b32 a54, v50
  v_accvgpr_write_b32 a55, v51
  v_accvgpr_read_b32 v50, a56
  v_accvgpr_read_b32 v51, a57
  v_mul_f32 v50, v50, v49
  v_mul_f32 v51, v51, v49
  v_accvgpr_write_b32 a56, v50
  v_accvgpr_write_b32 a57, v51
  v_accvgpr_read_b32 v50, a58
  v_accvgpr_read_b32 v51, a59
  v_mul_f32 v50, v50, v49
  v_mul_f32 v51, v51, v49
  v_accvgpr_write_b32 a58, v50
  v_accvgpr_write_b32 a59, v51
  v_accvgpr_read_b32 v50, a60
  v_accvgpr_read_b32 v51, a61
  v_mul_f32 v50, v50, v49
  v_mul_f32 v51, v51, v49
  v_accvgpr_write_b32 a60, v50
  v_accvgpr_write_b32 a61, v51
  v_accvgpr_read_b32 v50, a62
  v_accvgpr_read_b32 v51, a63
  v_mul_f32 v50, v50, v49
  v_mul_f32 v51, v51, v49
  v_accvgpr_write_b32 a62, v50
  v_accvgpr_write_b32 a63, v51
  s_nop 2
  s_branch fa_kernel_back62
fa_kernel_rare63:
  s_nop 7
  v_mov_b32 v49, v48
  s_nop 1
  v_permlane16_swap_b32 v48, v49
  s_nop 1
  v_max_f32 v48, v48, v49
  v_mov_b32 v49, v48
  s_nop 1
  v_permlane32_swap_b32 v48, v49
  s_nop 1
  v_max_f32 v48, v48, v49
  s_ashr_i32 s59, s36, 31
  s_and_b32 s59, s59, 0xff800000
  s_mov_b32 s36, 0x41000000
  v_max_f32 v48, s59, v48
  v_sub_f32 v96, v96, v48
  v_sub_f32 v97, v97, v48
  v_sub_f32 v98, v98, v48
  v_sub_f32 v99, v99, v48
  v_sub_f32 v100, v100, v48
  v_sub_f32 v101, v101, v48
  v_sub_f32 v102, v102, v48
  v_sub_f32 v103, v103, v48
  v_sub_f32 v64, v64, v48
  v_sub_f32 v65, v65, v48
  v_sub_f32 v66, v66, v48
  v_sub_f32 v67, v67, v48
  s_cmp_lg_u32 s59, 0
  s_cbranch_scc1 fa_kernel_back63
  v_sub_f32 v49, 0, v48
  v_exp_f32 v49, v49
  s_nop 1
  v_mul_f32 v84, v84, v49
  v_mul_f32 v85, v85, v49
  v_mul_f32 v86, v86, v49
  v_mul_f32 v87, v87, v49
  v_accvgpr_read_b32 v50, a64
  v_accvgpr_read_b32 v51, a65
  v_mul_f32 v50, v50, v49
  v_mul_f32 v51, v51, v49
  v_accvgpr_write_b32 a64, v50
  v_accvgpr_write_b32 a65, v51
  v_accvgpr_read_b32 v50, a66
  v_accvgpr_read_b32 v51, a67
  v_mul_f32 v50, v50, v49
  v_mul_f32 v51, v51, v49
  v_accvgpr_write_b32 a66, v50
  v_accvgpr_write_b32 a67, v51
  v_accvgpr_read_b32 v50, a68
  v_accvgpr_read_b32 v51, a69
  v_mul_f32 v50, v50, v49
  v_mul_f32 v51, v51, v49
  v_accvgpr_write_b32 a68, v50
  v_accvgpr_write_b32 a69, v51
  v_accvgpr_read_b32 v50, a70
  v_accvgpr_read_b32 v51, a71
  v_mul_f32 v50, v50, v49
  v_mul_f32 v51, v51, v49
  v_accvgpr_write_b32 a70, v50
  v_accvgpr_write_b32 a71, v51
  v_accvgpr_read_b32 v50, a72
  v_accvgpr_read_b32 v51, a73
  v_mul_f32 v50, v50, v49
  v_mul_f32 v51, v51, v49
  v_accvgpr_write_b32 a72, v50
  v_accvgpr_write_b32 a73, v51
  v_accvgpr_read_b32 v50, a74
  v_accvgpr_read_b32 v51, a75
  v_mul_f32 v50, v50, v49
  v_mul_f32 v51, v51, v49
  v_accvgpr_write_b32 a74, v50
  v_accvgpr_write_b32 a75, v51
  v_accvgpr_read_b32 v50, a76
  v_accvgpr_read_b32 v51, a77
  v_mul_f32 v50, v50, v49
  v_mul_f32 v51, v51, v49
  v_accvgpr_write_b32 a76, v50
  v_accvgpr_write_b32 a77, v51
  v_accvgpr_read_b32 v50, a78
  v_accvgpr_read_b32 v51, a79
  v_mul_f32 v50, v50, v49
  v_mul_f32 v51, v51, v49
  v_accvgpr_write_b32 a78, v50
  v_accvgpr_write_b32 a79, v51
  v_accvgpr_read_b32 v50, a80
  v_accvgpr_read_b32 v51, a81
  v_mul_f32 v50, v50, v49
  v_mul_f32 v51, v51, v49
  v_accvgpr_write_b32 a80, v50
  v_accvgpr_write_b32 a81, v51
  v_accvgpr_read_b32 v50, a82
  v_accvgpr_read_b32 v51, a83
  v_mul_f32 v50, v50, v49
  v_mul_f32 v51, v51, v49
  v_accvgpr_write_b32 a82, v50
  v_accvgpr_write_b32 a83, v51
  v_accvgpr_read_b32 v50, a84
  v_accvgpr_read_b32 v51, a85
  v_mul_f32 v50, v50, v49
  v_mul_f32 v51, v51, v49
  v_accvgpr_write_b32 a84, v50
  v_accvgpr_write_b32 a85, v51
  v_accvgpr_read_b32 v50, a86
  v_accvgpr_read_b32 v51, a87
  v_mul_f32 v50, v50, v49
  v_mul_f32 v51, v51, v49
  v_accvgpr_write_b32 a86, v50
  v_accvgpr_write_b32 a87, v51
  v_accvgpr_read_b32 v50, a88
  v_accvgpr_read_b32 v51, a89
  v_mul_f32 v50, v50, v49
  v_mul_f32 v51, v51, v49
  v_accvgpr_write_b32 a88, v50
  v_accvgpr_write_b32 a89, v51
  v_accvgpr_read_b32 v50, a90
  v_accvgpr_read_b32 v51, a91
  v_mul_f32 v50, v50, v49
  v_mul_f32 v51, v51, v49
  v_accvgpr_write_b32 a90, v50
  v_accvgpr_write_b32 a91, v51
  v_accvgpr_read_b32 v50, a92
  v_accvgpr_read_b32 v51, a93
  v_mul_f32 v50, v50, v49
  v_mul_f32 v51, v51, v49
  v_accvgpr_write_b32 a92, v50
  v_accvgpr_write_b32 a93, v51
  v_accvgpr_read_b32 v50, a94
  v_accvgpr_read_b32 v51, a95
  v_mul_f32 v50, v50, v49
  v_mul_f32 v51, v51, v49
  v_accvgpr_write_b32 a94, v50
  v_accvgpr_write_b32 a95, v51
  s_nop 2
  s_branch fa_kernel_back63
fa_kernel_rare64:
  s_nop 7
  v_mov_b32 v49, v48
  s_nop 1
  v_permlane16_swap_b32 v48, v49
  s_nop 1
  v_max_f32 v48, v48, v49
  v_mov_b32 v49, v48
  s_nop 1
  v_permlane32_swap_b32 v48, v49
  s_nop 1
  v_max_f32 v48, v48, v49
  s_ashr_i32 s59, s37, 31
  s_and_b32 s59, s59, 0xff800000
  s_mov_b32 s37, 0x41000000
  v_max_f32 v48, s59, v48
  v_sub_f32 v104, v104, v48
  v_sub_f32 v105, v105, v48
  v_sub_f32 v106, v106, v48
  v_sub_f32 v107, v107, v48
  v_sub_f32 v108, v108, v48
  v_sub_f32 v109, v109, v48
  v_sub_f32 v110, v110, v48
  v_sub_f32 v111, v111, v48
  v_sub_f32 v68, v68, v48
  v_sub_f32 v69, v69, v48
  v_sub_f32 v70, v70, v48
  v_sub_f32 v71, v71, v48
  s_cmp_lg_u32 s59, 0
  s_cbranch_scc1 fa_kernel_back64
  v_sub_f32 v49, 0, v48
  v_exp_f32 v49, v49
  s_nop 1
  v_mul_f32 v88, v88, v49
  v_mul_f32 v89, v89, v49
  v_mul_f32 v90, v90, v49
  v_mul_f32 v91, v91, v49
  v_accvgpr_read_b32 v50, a96
  v_accvgpr_read_b32 v51, a97
  v_mul_f32 v50, v50, v49
  v_mul_f32 v51, v51, v49
  v_accvgpr_write_b32 a96, v50
  v_accvgpr_write_b32 a97, v51
  v_accvgpr_read_b32 v50, a98
  v_accvgpr_read_b32 v51, a99
  v_mul_f32 v50, v50, v49
  v_mul_f32 v51, v51, v49
  v_accvgpr_write_b32 a98, v50
  v_accvgpr_write_b32 a99, v51
  v_accvgpr_read_b32 v50, a100
  v_accvgpr_read_b32 v51, a101
  v_mul_f32 v50, v50, v49
  v_mul_f32 v51, v51, v49
  v_accvgpr_write_b32 a100, v50
  v_accvgpr_write_b32 a101, v51
  v_accvgpr_read_b32 v50, a102
  v_accvgpr_read_b32 v51, a103
  v_mul_f32 v50, v50, v49
  v_mul_f32 v51, v51, v49
  v_accvgpr_write_b32 a102, v50
  v_accvgpr_write_b32 a103, v51
  v_accvgpr_read_b32 v50, a104
  v_accvgpr_read_b32 v51, a105
  v_mul_f32 v50, v50, v49
  v_mul_f32 v51, v51, v49
  v_accvgpr_write_b32 a104, v50
  v_accvgpr_write_b32 a105, v51
  v_accvgpr_read_b32 v50, a106
  v_accvgpr_read_b32 v51, a107
  v_mul_f32 v50, v50, v49
  v_mul_f32 v51, v51, v49
  v_accvgpr_write_b32 a106, v50
  v_accvgpr_write_b32 a107, v51
  v_accvgpr_read_b32 v50, a108
  v_accvgpr_read_b32 v51, a109
  v_mul_f32 v50, v50, v49
  v_mul_f32 v51, v51, v49
  v_accvgpr_write_b32 a108, v50
  v_accvgpr_write_b32 a109, v51
  v_accvgpr_read_b32 v50, a110
  v_accvgpr_read_b32 v51, a111
  v_mul_f32 v50, v50, v49
  v_mul_f32 v51, v51, v49
  v_accvgpr_write_b32 a110, v50
  v_accvgpr_write_b32 a111, v51
  v_accvgpr_read_b32 v50, a112
  v_accvgpr_read_b32 v51, a113
  v_mul_f32 v50, v50, v49
  v_mul_f32 v51, v51, v49
  v_accvgpr_write_b32 a112, v50
  v_accvgpr_write_b32 a113, v51
  v_accvgpr_read_b32 v50, a114
  v_accvgpr_read_b32 v51, a115
  v_mul_f32 v50, v50, v49
  v_mul_f32 v51, v51, v49
  v_accvgpr_write_b32 a114, v50
  v_accvgpr_write_b32 a115, v51
  v_accvgpr_read_b32 v50, a116
  v_accvgpr_read_b32 v51, a117
  v_mul_f32 v50, v50, v49
  v_mul_f32 v51, v51, v49
  v_accvgpr_write_b32 a116, v50
  v_accvgpr_write_b32 a117, v51
  v_accvgpr_read_b32 v50, a118
  v_accvgpr_read_b32 v51, a119
  v_mul_f32 v50, v50, v49
  v_mul_f32 v51, v51, v49
  v_accvgpr_write_b32 a118, v50
  v_accvgpr_write_b32 a119, v51
  v_accvgpr_read_b32 v50, a120
  v_accvgpr_read_b32 v51, a121
  v_mul_f32 v50, v50, v49
  v_mul_f32 v51, v51, v49
  v_accvgpr_write_b32 a120, v50
  v_accvgpr_write_b32 a121, v51
  v_accvgpr_read_b32 v50, a122
  v_accvgpr_read_b32 v51, a123
  v_mul_f32 v50, v50, v49
  v_mul_f32 v51, v51, v49
  v_accvgpr_write_b32 a122, v50
  v_accvgpr_write_b32 a123, v51
  v_accvgpr_read_b32 v50, a124
  v_accvgpr_read_b32 v51, a125
  v_mul_f32 v50, v50, v49
  v_mul_f32 v51, v51, v49
  v_accvgpr_write_b32 a124, v50
  v_accvgpr_write_b32 a125, v51
  v_accvgpr_read_b32 v50, a126
  v_accvgpr_read_b32 v51, a127
  v_mul_f32 v50, v50, v49
  v_mul_f32 v51, v51, v49
  v_accvgpr_write_b32 a126, v50
  v_accvgpr_write_b32 a127, v51
  s_nop 2
  s_branch fa_kernel_back64
fa_kernel_rare65:
  s_nop 7
  v_mov_b32 v49, v48
  s_nop 1
  v_permlane16_swap_b32 v48, v49
  s_nop 1
  v_max_f32 v48, v48, v49
  v_mov_b32 v49, v48
  s_nop 1
  v_permlane32_swap_b32 v48, v49
  s_nop 1
  v_max_f32 v48, v48, v49
  s_ashr_i32 s59, s38, 31
  s_and_b32 s59, s59, 0xff800000
  s_mov_b32 s38, 0x41000000
  v_max_f32 v48, s59, v48
  v_sub_f32 v112, v112, v48
  v_sub_f32 v113, v113, v48
  v_sub_f32 v114, v114, v48
  v_sub_f32 v115, v115, v48
  v_sub_f32 v116, v116, v48
  v_sub_f32 v117, v117, v48
  v_sub_f32 v118, v118, v48
  v_sub_f32 v119, v119, v48
  v_sub_f32 v72, v72, v48
  v_sub_f32 v73, v73, v48
  v_sub_f32 v74, v74, v48
  v_sub_f32 v75, v75, v48
  s_cmp_lg_u32 s59, 0
  s_cbranch_scc1 fa_kernel_back65
  v_sub_f32 v49, 0, v48
  v_exp_f32 v49, v49
  s_nop 1
  v_mul_f32 v92, v92, v49
  v_mul_f32 v93, v93, v49
  v_mul_f32 v94, v94, v49
  v_mul_f32 v95, v95, v49
  v_accvgpr_read_b32 v50, a128
  v_accvgpr_read_b32 v51, a129
  v_mul_f32 v50, v50, v49
  v_mul_f32 v51, v51, v49
  v_accvgpr_write_b32 a128, v50
  v_accvgpr_write_b32 a129, v51
  v_accvgpr_read_b32 v50, a130
  v_accvgpr_read_b32 v51, a131
  v_mul_f32 v50, v50, v49
  v_mul_f32 v51, v51, v49
  v_accvgpr_write_b32 a130, v50
  v_accvgpr_write_b32 a131, v51
  v_accvgpr_read_b32 v50, a132
  v_accvgpr_read_b32 v51, a133
  v_mul_f32 v50, v50, v49
  v_mul_f32 v51, v51, v49
  v_accvgpr_write_b32 a132, v50
  v_accvgpr_write_b32 a133, v51
  v_accvgpr_read_b32 v50, a134
  v_accvgpr_read_b32 v51, a135
  v_mul_f32 v50, v50, v49
  v_mul_f32 v51, v51, v49
  v_accvgpr_write_b32 a134, v50
  v_accvgpr_write_b32 a135, v51
  v_accvgpr_read_b32 v50, a136
  v_accvgpr_read_b32 v51, a137
  v_mul_f32 v50, v50, v49
  v_mul_f32 v51, v51, v49
  v_accvgpr_write_b32 a136, v50
  v_accvgpr_write_b32 a137, v51
  v_accvgpr_read_b32 v50, a138
  v_accvgpr_read_b32 v51, a139
  v_mul_f32 v50, v50, v49
  v_mul_f32 v51, v51, v49
  v_accvgpr_write_b32 a138, v50
  v_accvgpr_write_b32 a139, v51
  v_accvgpr_read_b32 v50, a140
  v_accvgpr_read_b32 v51, a141
  v_mul_f32 v50, v50, v49
  v_mul_f32 v51, v51, v49
  v_accvgpr_write_b32 a140, v50
  v_accvgpr_write_b32 a141, v51
  v_accvgpr_read_b32 v50, a142
  v_accvgpr_read_b32 v51, a143
  v_mul_f32 v50, v50, v49
  v_mul_f32 v51, v51, v49
  v_accvgpr_write_b32 a142, v50
  v_accvgpr_write_b32 a143, v51
  v_accvgpr_read_b32 v50, a144
  v_accvgpr_read_b32 v51, a145
  v_mul_f32 v50, v50, v49
  v_mul_f32 v51, v51, v49
  v_accvgpr_write_b32 a144, v50
  v_accvgpr_write_b32 a145, v51
  v_accvgpr_read_b32 v50, a146
  v_accvgpr_read_b32 v51, a147
  v_mul_f32 v50, v50, v49
  v_mul_f32 v51, v51, v49
  v_accvgpr_write_b32 a146, v50
  v_accvgpr_write_b32 a147, v51
  v_accvgpr_read_b32 v50, a148
  v_accvgpr_read_b32 v51, a149
  v_mul_f32 v50, v50, v49
  v_mul_f32 v51, v51, v49
  v_accvgpr_write_b32 a148, v50
  v_accvgpr_write_b32 a149, v51
  v_accvgpr_read_b32 v50, a150
  v_accvgpr_read_b32 v51, a151
  v_mul_f32 v50, v50, v49
  v_mul_f32 v51, v51, v49
  v_accvgpr_write_b32 a150, v50
  v_accvgpr_write_b32 a151, v51
  v_accvgpr_read_b32 v50, a152
  v_accvgpr_read_b32 v51, a153
  v_mul_f32 v50, v50, v49
  v_mul_f32 v51, v51, v49
  v_accvgpr_write_b32 a152, v50
  v_accvgpr_write_b32 a153, v51
  v_accvgpr_read_b32 v50, a154
  v_accvgpr_read_b32 v51, a155
  v_mul_f32 v50, v50, v49
  v_mul_f32 v51, v51, v49
  v_accvgpr_write_b32 a154, v50
  v_accvgpr_write_b32 a155, v51
  v_accvgpr_read_b32 v50, a156
  v_accvgpr_read_b32 v51, a157
  v_mul_f32 v50, v50, v49
  v_mul_f32 v51, v51, v49
  v_accvgpr_write_b32 a156, v50
  v_accvgpr_write_b32 a157, v51
  v_accvgpr_read_b32 v50, a158
  v_accvgpr_read_b32 v51, a159
  v_mul_f32 v50, v50, v49
  v_mul_f32 v51, v51, v49
  v_accvgpr_write_b32 a158, v50
  v_accvgpr_write_b32 a159, v51
  s_nop 2
  s_branch fa_kernel_back65
fa_kernel_rare66:
  s_nop 7
  v_mov_b32 v49, v48
  s_nop 1
  v_permlane16_swap_b32 v48, v49
  s_nop 1
  v_max_f32 v48, v48, v49
  v_mov_b32 v49, v48
  s_nop 1
  v_permlane32_swap_b32 v48, v49
  s_nop 1
  v_max_f32 v48, v48, v49
  s_ashr_i32 s59, s34, 31
  s_and_b32 s59, s59, 0xff800000
  s_mov_b32 s34, 0x41000000
  v_max_f32 v48, s59, v48
  v_sub_f32 v96, v96, v48
  v_sub_f32 v97, v97, v48
  v_sub_f32 v98, v98, v48
  v_sub_f32 v99, v99, v48
  v_sub_f32 v100, v100, v48
  v_sub_f32 v101, v101, v48
  v_sub_f32 v102, v102, v48
  v_sub_f32 v103, v103, v48
  v_sub_f32 v56, v56, v48
  v_sub_f32 v57, v57, v48
  v_sub_f32 v58, v58, v48
  v_sub_f32 v59, v59, v48
  s_cmp_lg_u32 s59, 0
  s_cbranch_scc1 fa_kernel_back66
  v_sub_f32 v49, 0, v48
  v_exp_f32 v49, v49
  s_nop 1
  v_mul_f32 v76, v76, v49
  v_mul_f32 v77, v77, v49
  v_mul_f32 v78, v78, v49
  v_mul_f32 v79, v79, v49
  v_accvgpr_read_b32 v50, a0
  v_accvgpr_read_b32 v51, a1
  v_mul_f32 v50, v50, v49
  v_mul_f32 v51, v51, v49
  v_accvgpr_write_b32 a0, v50
  v_accvgpr_write_b32 a1, v51
  v_accvgpr_read_b32 v50, a2
  v_accvgpr_read_b32 v51, a3
  v_mul_f32 v50, v50, v49
  v_mul_f32 v51, v51, v49
  v_accvgpr_write_b32 a2, v50
  v_accvgpr_write_b32 a3, v51
  v_accvgpr_read_b32 v50, a4
  v_accvgpr_read_b32 v51, a5
  v_mul_f32 v50, v50, v49
  v_mul_f32 v51, v51, v49
  v_accvgpr_write_b32 a4, v50
  v_accvgpr_write_b32 a5, v51
  v_accvgpr_read_b32 v50, a6
  v_accvgpr_read_b32 v51, a7
  v_mul_f32 v50, v50, v49
  v_mul_f32 v51, v51, v49
  v_accvgpr_write_b32 a6, v50
  v_accvgpr_write_b32 a7, v51
  v_accvgpr_read_b32 v50, a8
  v_accvgpr_read_b32 v51, a9
  v_mul_f32 v50, v50, v49
  v_mul_f32 v51, v51, v49
  v_accvgpr_write_b32 a8, v50
  v_accvgpr_write_b32 a9, v51
  v_accvgpr_read_b32 v50, a10
  v_accvgpr_read_b32 v51, a11
  v_mul_f32 v50, v50, v49
  v_mul_f32 v51, v51, v49
  v_accvgpr_write_b32 a10, v50
  v_accvgpr_write_b32 a11, v51
  v_accvgpr_read_b32 v50, a12
  v_accvgpr_read_b32 v51, a13
  v_mul_f32 v50, v50, v49
  v_mul_f32 v51, v51, v49
  v_accvgpr_write_b32 a12, v50
  v_accvgpr_write_b32 a13, v51
  v_accvgpr_read_b32 v50, a14
  v_accvgpr_read_b32 v51, a15
  v_mul_f32 v50, v50, v49
  v_mul_f32 v51, v51, v49
  v_accvgpr_write_b32 a14, v50
  v_accvgpr_write_b32 a15, v51
  v_accvgpr_read_b32 v50, a16
  v_accvgpr_read_b32 v51, a17
  v_mul_f32 v50, v50, v49
  v_mul_f32 v51, v51, v49
  v_accvgpr_write_b32 a16, v50
  v_accvgpr_write_b32 a17, v51
  v_accvgpr_read_b32 v50, a18
  v_accvgpr_read_b32 v51, a19
  v_mul_f32 v50, v50, v49
  v_mul_f32 v51, v51, v49
  v_accvgpr_write_b32 a18, v50
  v_accvgpr_write_b32 a19, v51
  v_accvgpr_read_b32 v50, a20
  v_accvgpr_read_b32 v51, a21
  v_mul_f32 v50, v50, v49
  v_mul_f32 v51, v51, v49
  v_accvgpr_write_b32 a20, v50
  v_accvgpr_write_b32 a21, v51
  v_accvgpr_read_b32 v50, a22
  v_accvgpr_read_b32 v51, a23
  v_mul_f32 v50, v50, v49
  v_mul_f32 v51, v51, v49
  v_accvgpr_write_b32 a22, v50
  v_accvgpr_write_b32 a23, v51
  v_accvgpr_read_b32 v50, a24
  v_accvgpr_read_b32 v51, a25
  v_mul_f32 v50, v50, v49
  v_mul_f32 v51, v51, v49
  v_accvgpr_write_b32 a24, v50
  v_accvgpr_write_b32 a25, v51
  v_accvgpr_read_b32 v50, a26
  v_accvgpr_read_b32 v51, a27
  v_mul_f32 v50, v50, v49
  v_mul_f32 v51, v51, v49
  v_accvgpr_write_b32 a26, v50
  v_accvgpr_write_b32 a27, v51
  v_accvgpr_read_b32 v50, a28
  v_accvgpr_read_b32 v51, a29
  v_mul_f32 v50, v50, v49
  v_mul_f32 v51, v51, v49
  v_accvgpr_write_b32 a28, v50
  v_accvgpr_write_b32 a29, v51
  v_accvgpr_read_b32 v50, a30
  v_accvgpr_read_b32 v51, a31
  v_mul_f32 v50, v50, v49
  v_mul_f32 v51, v51, v49
  v_accvgpr_write_b32 a30, v50
  v_accvgpr_write_b32 a31, v51
  s_nop 2
  s_branch fa_kernel_back66
fa_kernel_rare67:
  s_nop 7
  v_mov_b32 v49, v48
  s_nop 1
  v_permlane16_swap_b32 v48, v49
  s_nop 1
  v_max_f32 v48, v48, v49
  v_mov_b32 v49, v48
  s_nop 1
  v_permlane32_swap_b32 v48, v49
  s_nop 1
  v_max_f32 v48, v48, v49
  s_ashr_i32 s59, s35, 31
  s_and_b32 s59, s59, 0xff800000
  s_mov_b32 s35, 0x41000000
  v_max_f32 v48, s59, v48
  v_sub_f32 v104, v104, v48
  v_sub_f32 v105, v105, v48
  v_sub_f32 v106, v106, v48
  v_sub_f32 v107, v107, v48
  v_sub_f32 v108, v108, v48
  v_sub_f32 v109, v109, v48
  v_sub_f32 v110, v110, v48
  v_sub_f32 v111, v111, v48
  v_sub_f32 v60, v60, v48
  v_sub_f32 v61, v61, v48
  v_sub_f32 v62, v62, v48
  v_sub_f32 v63, v63, v48
  s_cmp_lg_u32 s59, 0
  s_cbranch_scc1 fa_kernel_back67
  v_sub_f32 v49, 0, v48
  v_exp_f32 v49, v49
  s_nop 1
  v_mul_f32 v80, v80, v49
  v_mul_f32 v81, v81, v49
  v_mul_f32 v82, v82, v49
  v_mul_f32 v83, v83, v49
  v_accvgpr_read_b32 v50, a32
  v_accvgpr_read_b32 v51, a33
  v_mul_f32 v50, v50, v49
  v_mul_f32 v51, v51, v49
  v_accvgpr_write_b32 a32, v50
  v_accvgpr_write_b32 a33, v51
  v_accvgpr_read_b32 v50, a34
  v_accvgpr_read_b32 v51, a35
  v_mul_f32 v50, v50, v49
  v_mul_f32 v51, v51, v49
  v_accvgpr_write_b32 a34, v50
  v_accvgpr_write_b32 a35, v51
  v_accvgpr_read_b32 v50, a36
  v_accvgpr_read_b32 v51, a37
  v_mul_f32 v50, v50, v49
  v_mul_f32 v51, v51, v49
  v_accvgpr_write_b32 a36, v50
  v_accvgpr_write_b32 a37, v51
  v_accvgpr_read_b32 v50, a38
  v_accvgpr_read_b32 v51, a39
  v_mul_f32 v50, v50, v49
  v_mul_f32 v51, v51, v49
  v_accvgpr_write_b32 a38, v50
  v_accvgpr_write_b32 a39, v51
  v_accvgpr_read_b32 v50, a40
  v_accvgpr_read_b32 v51, a41
  v_mul_f32 v50, v50, v49
  v_mul_f32 v51, v51, v49
  v_accvgpr_write_b32 a40, v50
  v_accvgpr_write_b32 a41, v51
  v_accvgpr_read_b32 v50, a42
  v_accvgpr_read_b32 v51, a43
  v_mul_f32 v50, v50, v49
  v_mul_f32 v51, v51, v49
  v_accvgpr_write_b32 a42, v50
  v_accvgpr_write_b32 a43, v51
  v_accvgpr_read_b32 v50, a44
  v_accvgpr_read_b32 v51, a45
  v_mul_f32 v50, v50, v49
  v_mul_f32 v51, v51, v49
  v_accvgpr_write_b32 a44, v50
  v_accvgpr_write_b32 a45, v51
  v_accvgpr_read_b32 v50, a46
  v_accvgpr_read_b32 v51, a47
  v_mul_f32 v50, v50, v49
  v_mul_f32 v51, v51, v49
  v_accvgpr_write_b32 a46, v50
  v_accvgpr_write_b32 a47, v51
  v_accvgpr_read_b32 v50, a48
  v_accvgpr_read_b32 v51, a49
  v_mul_f32 v50, v50, v49
  v_mul_f32 v51, v51, v49
  v_accvgpr_write_b32 a48, v50
  v_accvgpr_write_b32 a49, v51
  v_accvgpr_read_b32 v50, a50
  v_accvgpr_read_b32 v51, a51
  v_mul_f32 v50, v50, v49
  v_mul_f32 v51, v51, v49
  v_accvgpr_write_b32 a50, v50
  v_accvgpr_write_b32 a51, v51
  v_accvgpr_read_b32 v50, a52
  v_accvgpr_read_b32 v51, a53
  v_mul_f32 v50, v50, v49
  v_mul_f32 v51, v51, v49
  v_accvgpr_write_b32 a52, v50
  v_accvgpr_write_b32 a53, v51
  v_accvgpr_read_b32 v50, a54
  v_accvgpr_read_b32 v51, a55
  v_mul_f32 v50, v50, v49
  v_mul_f32 v51, v51, v49
  v_accvgpr_write_b32 a54, v50
  v_accvgpr_write_b32 a55, v51
  v_accvgpr_read_b32 v50, a56
  v_accvgpr_read_b32 v51, a57
  v_mul_f32 v50, v50, v49
  v_mul_f32 v51, v51, v49
  v_accvgpr_write_b32 a56, v50
  v_accvgpr_write_b32 a57, v51
  v_accvgpr_read_b32 v50, a58
  v_accvgpr_read_b32 v51, a59
  v_mul_f32 v50, v50, v49
  v_mul_f32 v51, v51, v49
  v_accvgpr_write_b32 a58, v50
  v_accvgpr_write_b32 a59, v51
  v_accvgpr_read_b32 v50, a60
  v_accvgpr_read_b32 v51, a61
  v_mul_f32 v50, v50, v49
  v_mul_f32 v51, v51, v49
  v_accvgpr_write_b32 a60, v50
  v_accvgpr_write_b32 a61, v51
  v_accvgpr_read_b32 v50, a62
  v_accvgpr_read_b32 v51, a63
  v_mul_f32 v50, v50, v49
  v_mul_f32 v51, v51, v49
  v_accvgpr_write_b32 a62, v50
  v_accvgpr_write_b32 a63, v51
  s_nop 2
  s_branch fa_kernel_back67
fa_kernel_rare68:
  s_nop 7
  v_mov_b32 v49, v48
  s_nop 1
  v_permlane16_swap_b32 v48, v49
  s_nop 1
  v_max_f32 v48, v48, v49
  v_mov_b32 v49, v48
  s_nop 1
  v_permlane32_swap_b32 v48, v49
  s_nop 1
  v_max_f32 v48, v48, v49
  s_ashr_i32 s59, s36, 31
  s_and_b32 s59, s59, 0xff800000
  s_mov_b32 s36, 0x41000000
  v_max_f32 v48, s59, v48
  v_sub_f32 v112, v112, v48
  v_sub_f32 v113, v113, v48
  v_sub_f32 v114, v114, v48
  v_sub_f32 v115, v115, v48
  v_sub_f32 v116, v116, v48
  v_sub_f32 v117, v117, v48
  v_sub_f32 v118, v118, v48
  v_sub_f32 v119, v119, v48
  v_sub_f32 v64, v64, v48
  v_sub_f32 v65, v65, v48
  v_sub_f32 v66, v66, v48
  v_sub_f32 v67, v67, v48
  s_cmp_lg_u32 s59, 0
  s_cbranch_scc1 fa_kernel_back68
  v_sub_f32 v49, 0, v48
  v_exp_f32 v49, v49
  s_nop 1
  v_mul_f32 v84, v84, v49
  v_mul_f32 v85, v85, v49
  v_mul_f32 v86, v86, v49
  v_mul_f32 v87, v87, v49
  v_accvgpr_read_b32 v50, a64
  v_accvgpr_read_b32 v51, a65
  v_mul_f32 v50, v50, v49
  v_mul_f32 v51, v51, v49
  v_accvgpr_write_b32 a64, v50
  v_accvgpr_write_b32 a65, v51
  v_accvgpr_read_b32 v50, a66
  v_accvgpr_read_b32 v51, a67
  v_mul_f32 v50, v50, v49
  v_mul_f32 v51, v51, v49
  v_accvgpr_write_b32 a66, v50
  v_accvgpr_write_b32 a67, v51
  v_accvgpr_read_b32 v50, a68
  v_accvgpr_read_b32 v51, a69
  v_mul_f32 v50, v50, v49
  v_mul_f32 v51, v51, v49
  v_accvgpr_write_b32 a68, v50
  v_accvgpr_write_b32 a69, v51
  v_accvgpr_read_b32 v50, a70
  v_accvgpr_read_b32 v51, a71
  v_mul_f32 v50, v50, v49
  v_mul_f32 v51, v51, v49
  v_accvgpr_write_b32 a70, v50
  v_accvgpr_write_b32 a71, v51
  v_accvgpr_read_b32 v50, a72
  v_accvgpr_read_b32 v51, a73
  v_mul_f32 v50, v50, v49
  v_mul_f32 v51, v51, v49
  v_accvgpr_write_b32 a72, v50
  v_accvgpr_write_b32 a73, v51
  v_accvgpr_read_b32 v50, a74
  v_accvgpr_read_b32 v51, a75
  v_mul_f32 v50, v50, v49
  v_mul_f32 v51, v51, v49
  v_accvgpr_write_b32 a74, v50
  v_accvgpr_write_b32 a75, v51
  v_accvgpr_read_b32 v50, a76
  v_accvgpr_read_b32 v51, a77
  v_mul_f32 v50, v50, v49
  v_mul_f32 v51, v51, v49
  v_accvgpr_write_b32 a76, v50
  v_accvgpr_write_b32 a77, v51
  v_accvgpr_read_b32 v50, a78
  v_accvgpr_read_b32 v51, a79
  v_mul_f32 v50, v50, v49
  v_mul_f32 v51, v51, v49
  v_accvgpr_write_b32 a78, v50
  v_accvgpr_write_b32 a79, v51
  v_accvgpr_read_b32 v50, a80
  v_accvgpr_read_b32 v51, a81
  v_mul_f32 v50, v50, v49
  v_mul_f32 v51, v51, v49
  v_accvgpr_write_b32 a80, v50
  v_accvgpr_write_b32 a81, v51
  v_accvgpr_read_b32 v50, a82
  v_accvgpr_read_b32 v51, a83
  v_mul_f32 v50, v50, v49
  v_mul_f32 v51, v51, v49
  v_accvgpr_write_b32 a82, v50
  v_accvgpr_write_b32 a83, v51
  v_accvgpr_read_b32 v50, a84
  v_accvgpr_read_b32 v51, a85
  v_mul_f32 v50, v50, v49
  v_mul_f32 v51, v51, v49
  v_accvgpr_write_b32 a84, v50
  v_accvgpr_write_b32 a85, v51
  v_accvgpr_read_b32 v50, a86
  v_accvgpr_read_b32 v51, a87
  v_mul_f32 v50, v50, v49
  v_mul_f32 v51, v51, v49
  v_accvgpr_write_b32 a86, v50
  v_accvgpr_write_b32 a87, v51
  v_accvgpr_read_b32 v50, a88
  v_accvgpr_read_b32 v51, a89
  v_mul_f32 v50, v50, v49
  v_mul_f32 v51, v51, v49
  v_accvgpr_write_b32 a88, v50
  v_accvgpr_write_b32 a89, v51
  v_accvgpr_read_b32 v50, a90
  v_accvgpr_read_b32 v51, a91
  v_mul_f32 v50, v50, v49
  v_mul_f32 v51, v51, v49
  v_accvgpr_write_b32 a90, v50
  v_accvgpr_write_b32 a91, v51
  v_accvgpr_read_b32 v50, a92
  v_accvgpr_read_b32 v51, a93
  v_mul_f32 v50, v50, v49
  v_mul_f32 v51, v51, v49
  v_accvgpr_write_b32 a92, v50
  v_accvgpr_write_b32 a93, v51
  v_accvgpr_read_b32 v50, a94
  v_accvgpr_read_b32 v51, a95
  v_mul_f32 v50, v50, v49
  v_mul_f32 v51, v51, v49
  v_accvgpr_write_b32 a94, v50
  v_accvgpr_write_b32 a95, v51
  s_nop 2
  s_branch fa_kernel_back68
fa_kernel_rare69:
  s_nop 7
  v_mov_b32 v49, v48
  s_nop 1
  v_permlane16_swap_b32 v48, v49
  s_nop 1
  v_max_f32 v48, v48, v49
  v_mov_b32 v49, v48
  s_nop 1
  v_permlane32_swap_b32 v48, v49
  s_nop 1
  v_max_f32 v48, v48, v49
  s_ashr_i32 s59, s37, 31
  s_and_b32 s59, s59, 0xff800000
  s_mov_b32 s37, 0x41000000
  v_max_f32 v48, s59, v48
  v_sub_f32 v96, v96, v48
  v_sub_f32 v97, v97, v48
  v_sub_f32 v98, v98, v48
  v_sub_f32 v99, v99, v48
  v_sub_f32 v100, v100, v48
  v_sub_f32 v101, v101, v48
  v_sub_f32 v102, v102, v48
  v_sub_f32 v103, v103, v48
  v_sub_f32 v68, v68, v48
  v_sub_f32 v69, v69, v48
  v_sub_f32 v70, v70, v48
  v_sub_f32 v71, v71, v48
  s_cmp_lg_u32 s59, 0
  s_cbranch_scc1 fa_kernel_back69
  v_sub_f32 v49, 0, v48
  v_exp_f32 v49, v49
  s_nop 1
  v_mul_f32 v88, v88, v49
  v_mul_f32 v89, v89, v49
  v_mul_f32 v90, v90, v49
  v_mul_f32 v91, v91, v49
  v_accvgpr_read_b32 v50, a96
  v_accvgpr_read_b32 v51, a97
  v_mul_f32 v50, v50, v49
  v_mul_f32 v51, v51, v49
  v_accvgpr_write_b32 a96, v50
  v_accvgpr_write_b32 a97, v51
  v_accvgpr_read_b32 v50, a98
  v_accvgpr_read_b32 v51, a99
  v_mul_f32 v50, v50, v49
  v_mul_f32 v51, v51, v49
  v_accvgpr_write_b32 a98, v50
  v_accvgpr_write_b32 a99, v51
  v_accvgpr_read_b32 v50, a100
  v_accvgpr_read_b32 v51, a101
  v_mul_f32 v50, v50, v49
  v_mul_f32 v51, v51, v49
  v_accvgpr_write_b32 a100, v50
  v_accvgpr_write_b32 a101, v51
  v_accvgpr_read_b32 v50, a102
  v_accvgpr_read_b32 v51, a103
  v_mul_f32 v50, v50, v49
  v_mul_f32 v51, v51, v49
  v_accvgpr_write_b32 a102, v50
  v_accvgpr_write_b32 a103, v51
  v_accvgpr_read_b32 v50, a104
  v_accvgpr_read_b32 v51, a105
  v_mul_f32 v50, v50, v49
  v_mul_f32 v51, v51, v49
  v_accvgpr_write_b32 a104, v50
  v_accvgpr_write_b32 a105, v51
  v_accvgpr_read_b32 v50, a106
  v_accvgpr_read_b32 v51, a107
  v_mul_f32 v50, v50, v49
  v_mul_f32 v51, v51, v49
  v_accvgpr_write_b32 a106, v50
  v_accvgpr_write_b32 a107, v51
  v_accvgpr_read_b32 v50, a108
  v_accvgpr_read_b32 v51, a109
  v_mul_f32 v50, v50, v49
  v_mul_f32 v51, v51, v49
  v_accvgpr_write_b32 a108, v50
  v_accvgpr_write_b32 a109, v51
  v_accvgpr_read_b32 v50, a110
  v_accvgpr_read_b32 v51, a111
  v_mul_f32 v50, v50, v49
  v_mul_f32 v51, v51, v49
  v_accvgpr_write_b32 a110, v50
  v_accvgpr_write_b32 a111, v51
  v_accvgpr_read_b32 v50, a112
  v_accvgpr_read_b32 v51, a113
  v_mul_f32 v50, v50, v49
  v_mul_f32 v51, v51, v49
  v_accvgpr_write_b32 a112, v50
  v_accvgpr_write_b32 a113, v51
  v_accvgpr_read_b32 v50, a114
  v_accvgpr_read_b32 v51, a115
  v_mul_f32 v50, v50, v49
  v_mul_f32 v51, v51, v49
  v_accvgpr_write_b32 a114, v50
  v_accvgpr_write_b32 a115, v51
  v_accvgpr_read_b32 v50, a116
  v_accvgpr_read_b32 v51, a117
  v_mul_f32 v50, v50, v49
  v_mul_f32 v51, v51, v49
  v_accvgpr_write_b32 a116, v50
  v_accvgpr_write_b32 a117, v51
  v_accvgpr_read_b32 v50, a118
  v_accvgpr_read_b32 v51, a119
  v_mul_f32 v50, v50, v49
  v_mul_f32 v51, v51, v49
  v_accvgpr_write_b32 a118, v50
  v_accvgpr_write_b32 a119, v51
  v_accvgpr_read_b32 v50, a120
  v_accvgpr_read_b32 v51, a121
  v_mul_f32 v50, v50, v49
  v_mul_f32 v51, v51, v49
  v_accvgpr_write_b32 a120, v50
  v_accvgpr_write_b32 a121, v51
  v_accvgpr_read_b32 v50, a122
  v_accvgpr_read_b32 v51, a123
  v_mul_f32 v50, v50, v49
  v_mul_f32 v51, v51, v49
  v_accvgpr_write_b32 a122, v50
  v_accvgpr_write_b32 a123, v51
  v_accvgpr_read_b32 v50, a124
  v_accvgpr_read_b32 v51, a125
  v_mul_f32 v50, v50, v49
  v_mul_f32 v51, v51, v49
  v_accvgpr_write_b32 a124, v50
  v_accvgpr_write_b32 a125, v51
  v_accvgpr_read_b32 v50, a126
  v_accvgpr_read_b32 v51, a127
  v_mul_f32 v50, v50, v49
  v_mul_f32 v51, v51, v49
  v_accvgpr_write_b32 a126, v50
  v_accvgpr_write_b32 a127, v51
  s_nop 2
  s_branch fa_kernel_back69
fa_kernel_rare70:
  s_nop 7
  v_mov_b32 v49, v48
  s_nop 1
  v_permlane16_swap_b32 v48, v49
  s_nop 1
  v_max_f32 v48, v48, v49
  v_mov_b32 v49, v48
  s_nop 1
  v_permlane32_swap_b32 v48, v49
  s_nop 1
  v_max_f32 v48, v48, v49
  s_ashr_i32 s59, s34, 31
  s_and_b32 s59, s59, 0xff800000
  s_mov_b32 s34, 0x41000000
  v_max_f32 v48, s59, v48
  v_sub_f32 v104, v104, v48
  v_sub_f32 v105, v105, v48
  v_sub_f32 v106, v106, v48
  v_sub_f32 v107, v107, v48
  v_sub_f32 v108, v108, v48
  v_sub_f32 v109, v109, v48
  v_sub_f32 v110, v110, v48
  v_sub_f32 v111, v111, v48
  v_sub_f32 v56, v56, v48
  v_sub_f32 v57, v57, v48
  v_sub_f32 v58, v58, v48
  v_sub_f32 v59, v59, v48
  s_cmp_lg_u32 s59, 0
  s_cbranch_scc1 fa_kernel_back70
  v_sub_f32 v49, 0, v48
  v_exp_f32 v49, v49
  s_nop 1
  v_mul_f32 v76, v76, v49
  v_mul_f32 v77, v77, v49
  v_mul_f32 v78, v78, v49
  v_mul_f32 v79, v79, v49
  v_accvgpr_read_b32 v50, a0
  v_accvgpr_read_b32 v51, a1
  v_mul_f32 v50, v50, v49
  v_mul_f32 v51, v51, v49
  v_accvgpr_write_b32 a0, v50
  v_accvgpr_write_b32 a1, v51
  v_accvgpr_read_b32 v50, a2
  v_accvgpr_read_b32 v51, a3
  v_mul_f32 v50, v50, v49
  v_mul_f32 v51, v51, v49
  v_accvgpr_write_b32 a2, v50
  v_accvgpr_write_b32 a3, v51
  v_accvgpr_read_b32 v50, a4
  v_accvgpr_read_b32 v51, a5
  v_mul_f32 v50, v50, v49
  v_mul_f32 v51, v51, v49
  v_accvgpr_write_b32 a4, v50
  v_accvgpr_write_b32 a5, v51
  v_accvgpr_read_b32 v50, a6
  v_accvgpr_read_b32 v51, a7
  v_mul_f32 v50, v50, v49
  v_mul_f32 v51, v51, v49
  v_accvgpr_write_b32 a6, v50
  v_accvgpr_write_b32 a7, v51
  v_accvgpr_read_b32 v50, a8
  v_accvgpr_read_b32 v51, a9
  v_mul_f32 v50, v50, v49
  v_mul_f32 v51, v51, v49
  v_accvgpr_write_b32 a8, v50
  v_accvgpr_write_b32 a9, v51
  v_accvgpr_read_b32 v50, a10
  v_accvgpr_read_b32 v51, a11
  v_mul_f32 v50, v50, v49
  v_mul_f32 v51, v51, v49
  v_accvgpr_write_b32 a10, v50
  v_accvgpr_write_b32 a11, v51
  v_accvgpr_read_b32 v50, a12
  v_accvgpr_read_b32 v51, a13
  v_mul_f32 v50, v50, v49
  v_mul_f32 v51, v51, v49
  v_accvgpr_write_b32 a12, v50
  v_accvgpr_write_b32 a13, v51
  v_accvgpr_read_b32 v50, a14
  v_accvgpr_read_b32 v51, a15
  v_mul_f32 v50, v50, v49
  v_mul_f32 v51, v51, v49
  v_accvgpr_write_b32 a14, v50
  v_accvgpr_write_b32 a15, v51
  v_accvgpr_read_b32 v50, a16
  v_accvgpr_read_b32 v51, a17
  v_mul_f32 v50, v50, v49
  v_mul_f32 v51, v51, v49
  v_accvgpr_write_b32 a16, v50
  v_accvgpr_write_b32 a17, v51
  v_accvgpr_read_b32 v50, a18
  v_accvgpr_read_b32 v51, a19
  v_mul_f32 v50, v50, v49
  v_mul_f32 v51, v51, v49
  v_accvgpr_write_b32 a18, v50
  v_accvgpr_write_b32 a19, v51
  v_accvgpr_read_b32 v50, a20
  v_accvgpr_read_b32 v51, a21
  v_mul_f32 v50, v50, v49
  v_mul_f32 v51, v51, v49
  v_accvgpr_write_b32 a20, v50
  v_accvgpr_write_b32 a21, v51
  v_accvgpr_read_b32 v50, a22
  v_accvgpr_read_b32 v51, a23
  v_mul_f32 v50, v50, v49
  v_mul_f32 v51, v51, v49
  v_accvgpr_write_b32 a22, v50
  v_accvgpr_write_b32 a23, v51
  v_accvgpr_read_b32 v50, a24
  v_accvgpr_read_b32 v51, a25
  v_mul_f32 v50, v50, v49
  v_mul_f32 v51, v51, v49
  v_accvgpr_write_b32 a24, v50
  v_accvgpr_write_b32 a25, v51
  v_accvgpr_read_b32 v50, a26
  v_accvgpr_read_b32 v51, a27
  v_mul_f32 v50, v50, v49
  v_mul_f32 v51, v51, v49
  v_accvgpr_write_b32 a26, v50
  v_accvgpr_write_b32 a27, v51
  v_accvgpr_read_b32 v50, a28
  v_accvgpr_read_b32 v51, a29
  v_mul_f32 v50, v50, v49
  v_mul_f32 v51, v51, v49
  v_accvgpr_write_b32 a28, v50
  v_accvgpr_write_b32 a29, v51
  v_accvgpr_read_b32 v50, a30
  v_accvgpr_read_b32 v51, a31
  v_mul_f32 v50, v50, v49
  v_mul_f32 v51, v51, v49
  v_accvgpr_write_b32 a30, v50
  v_accvgpr_write_b32 a31, v51
  s_nop 2
  s_branch fa_kernel_back70
fa_kernel_rare71:
  s_nop 7
  v_mov_b32 v49, v48
  s_nop 1
  v_permlane16_swap_b32 v48, v49
  s_nop 1
  v_max_f32 v48, v48, v49
  v_mov_b32 v49, v48
  s_nop 1
  v_permlane32_swap_b32 v48, v49
  s_nop 1
  v_max_f32 v48, v48, v49
  s_ashr_i32 s59, s35, 31
  s_and_b32 s59, s59, 0xff800000
  s_mov_b32 s35, 0x41000000
  v_max_f32 v48, s59, v48
  v_sub_f32 v112, v112, v48
  v_sub_f32 v113, v113, v48
  v_sub_f32 v114, v114, v48
  v_sub_f32 v115, v115, v48
  v_sub_f32 v116, v116, v48
  v_sub_f32 v117, v117, v48
  v_sub_f32 v118, v118, v48
  v_sub_f32 v119, v119, v48
  v_sub_f32 v60, v60, v48
  v_sub_f32 v61, v61, v48
  v_sub_f32 v62, v62, v48
  v_sub_f32 v63, v63, v48
  s_cmp_lg_u32 s59, 0
  s_cbranch_scc1 fa_kernel_back71
  v_sub_f32 v49, 0, v48
  v_exp_f32 v49, v49
  s_nop 1
  v_mul_f32 v80, v80, v49
  v_mul_f32 v81, v81, v49
  v_mul_f32 v82, v82, v49
  v_mul_f32 v83, v83, v49
  v_accvgpr_read_b32 v50, a32
  v_accvgpr_read_b32 v51, a33
  v_mul_f32 v50, v50, v49
  v_mul_f32 v51, v51, v49
  v_accvgpr_write_b32 a32, v50
  v_accvgpr_write_b32 a33, v51
  v_accvgpr_read_b32 v50, a34
  v_accvgpr_read_b32 v51, a35
  v_mul_f32 v50, v50, v49
  v_mul_f32 v51, v51, v49
  v_accvgpr_write_b32 a34, v50
  v_accvgpr_write_b32 a35, v51
  v_accvgpr_read_b32 v50, a36
  v_accvgpr_read_b32 v51, a37
  v_mul_f32 v50, v50, v49
  v_mul_f32 v51, v51, v49
  v_accvgpr_write_b32 a36, v50
  v_accvgpr_write_b32 a37, v51
  v_accvgpr_read_b32 v50, a38
  v_accvgpr_read_b32 v51, a39
  v_mul_f32 v50, v50, v49
  v_mul_f32 v51, v51, v49
  v_accvgpr_write_b32 a38, v50
  v_accvgpr_write_b32 a39, v51
  v_accvgpr_read_b32 v50, a40
  v_accvgpr_read_b32 v51, a41
  v_mul_f32 v50, v50, v49
  v_mul_f32 v51, v51, v49
  v_accvgpr_write_b32 a40, v50
  v_accvgpr_write_b32 a41, v51
  v_accvgpr_read_b32 v50, a42
  v_accvgpr_read_b32 v51, a43
  v_mul_f32 v50, v50, v49
  v_mul_f32 v51, v51, v49
  v_accvgpr_write_b32 a42, v50
  v_accvgpr_write_b32 a43, v51
  v_accvgpr_read_b32 v50, a44
  v_accvgpr_read_b32 v51, a45
  v_mul_f32 v50, v50, v49
  v_mul_f32 v51, v51, v49
  v_accvgpr_write_b32 a44, v50
  v_accvgpr_write_b32 a45, v51
  v_accvgpr_read_b32 v50, a46
  v_accvgpr_read_b32 v51, a47
  v_mul_f32 v50, v50, v49
  v_mul_f32 v51, v51, v49
  v_accvgpr_write_b32 a46, v50
  v_accvgpr_write_b32 a47, v51
  v_accvgpr_read_b32 v50, a48
  v_accvgpr_read_b32 v51, a49
  v_mul_f32 v50, v50, v49
  v_mul_f32 v51, v51, v49
  v_accvgpr_write_b32 a48, v50
  v_accvgpr_write_b32 a49, v51
  v_accvgpr_read_b32 v50, a50
  v_accvgpr_read_b32 v51, a51
  v_mul_f32 v50, v50, v49
  v_mul_f32 v51, v51, v49
  v_accvgpr_write_b32 a50, v50
  v_accvgpr_write_b32 a51, v51
  v_accvgpr_read_b32 v50, a52
  v_accvgpr_read_b32 v51, a53
  v_mul_f32 v50, v50, v49
  v_mul_f32 v51, v51, v49
  v_accvgpr_write_b32 a52, v50
  v_accvgpr_write_b32 a53, v51
  v_accvgpr_read_b32 v50, a54
  v_accvgpr_read_b32 v51, a55
  v_mul_f32 v50, v50, v49
  v_mul_f32 v51, v51, v49
  v_accvgpr_write_b32 a54, v50
  v_accvgpr_write_b32 a55, v51
  v_accvgpr_read_b32 v50, a56
  v_accvgpr_read_b32 v51, a57
  v_mul_f32 v50, v50, v49
  v_mul_f32 v51, v51, v49
  v_accvgpr_write_b32 a56, v50
  v_accvgpr_write_b32 a57, v51
  v_accvgpr_read_b32 v50, a58
  v_accvgpr_read_b32 v51, a59
  v_mul_f32 v50, v50, v49
  v_mul_f32 v51, v51, v49
  v_accvgpr_write_b32 a58, v50
  v_accvgpr_write_b32 a59, v51
  v_accvgpr_read_b32 v50, a60
  v_accvgpr_read_b32 v51, a61
  v_mul_f32 v50, v50, v49
  v_mul_f32 v51, v51, v49
  v_accvgpr_write_b32 a60, v50
  v_accvgpr_write_b32 a61, v51
  v_accvgpr_read_b32 v50, a62
  v_accvgpr_read_b32 v51, a63
  v_mul_f32 v50, v50, v49
  v_mul_f32 v51, v51, v49
  v_accvgpr_write_b32 a62, v50
  v_accvgpr_write_b32 a63, v51
  s_nop 2
  s_branch fa_kernel_back71
fa_kernel_rare72:
  s_nop 7
  v_mov_b32 v49, v48
  s_nop 1
  v_permlane16_swap_b32 v48, v49
  s_nop 1
  v_max_f32 v48, v48, v49
  v_mov_b32 v49, v48
  s_nop 1
  v_permlane32_swap_b32 v48, v49
  s_nop 1
  v_max_f32 v48, v48, v49
  s_ashr_i32 s59, s36, 31
  s_and_b32 s59, s59, 0xff800000
  s_mov_b32 s36, 0x41000000
  v_max_f32 v48, s59, v48
  v_sub_f32 v96, v96, v48
  v_sub_f32 v97, v97, v48
  v_sub_f32 v98, v98, v48
  v_sub_f32 v99, v99, v48
  v_sub_f32 v100, v100, v48
  v_sub_f32 v101, v101, v48
  v_sub_f32 v102, v102, v48
  v_sub_f32 v103, v103, v48
  v_sub_f32 v64, v64, v48
  v_sub_f32 v65, v65, v48
  v_sub_f32 v66, v66, v48
  v_sub_f32 v67, v67, v48
  s_cmp_lg_u32 s59, 0
  s_cbranch_scc1 fa_kernel_back72
  v_sub_f32 v49, 0, v48
  v_exp_f32 v49, v49
  s_nop 1
  v_mul_f32 v84, v84, v49
  v_mul_f32 v85, v85, v49
  v_mul_f32 v86, v86, v49
  v_mul_f32 v87, v87, v49
  v_accvgpr_read_b32 v50, a64
  v_accvgpr_read_b32 v51, a65
  v_mul_f32 v50, v50, v49
  v_mul_f32 v51, v51, v49
  v_accvgpr_write_b32 a64, v50
  v_accvgpr_write_b32 a65, v51
  v_accvgpr_read_b32 v50, a66
  v_accvgpr_read_b32 v51, a67
  v_mul_f32 v50, v50, v49
  v_mul_f32 v51, v51, v49
  v_accvgpr_write_b32 a66, v50
  v_accvgpr_write_b32 a67, v51
  v_accvgpr_read_b32 v50, a68
  v_accvgpr_read_b32 v51, a69
  v_mul_f32 v50, v50, v49
  v_mul_f32 v51, v51, v49
  v_accvgpr_write_b32 a68, v50
  v_accvgpr_write_b32 a69, v51
  v_accvgpr_read_b32 v50, a70
  v_accvgpr_read_b32 v51, a71
  v_mul_f32 v50, v50, v49
  v_mul_f32 v51, v51, v49
  v_accvgpr_write_b32 a70, v50
  v_accvgpr_write_b32 a71, v51
  v_accvgpr_read_b32 v50, a72
  v_accvgpr_read_b32 v51, a73
  v_mul_f32 v50, v50, v49
  v_mul_f32 v51, v51, v49
  v_accvgpr_write_b32 a72, v50
  v_accvgpr_write_b32 a73, v51
  v_accvgpr_read_b32 v50, a74
  v_accvgpr_read_b32 v51, a75
  v_mul_f32 v50, v50, v49
  v_mul_f32 v51, v51, v49
  v_accvgpr_write_b32 a74, v50
  v_accvgpr_write_b32 a75, v51
  v_accvgpr_read_b32 v50, a76
  v_accvgpr_read_b32 v51, a77
  v_mul_f32 v50, v50, v49
  v_mul_f32 v51, v51, v49
  v_accvgpr_write_b32 a76, v50
  v_accvgpr_write_b32 a77, v51
  v_accvgpr_read_b32 v50, a78
  v_accvgpr_read_b32 v51, a79
  v_mul_f32 v50, v50, v49
  v_mul_f32 v51, v51, v49
  v_accvgpr_write_b32 a78, v50
  v_accvgpr_write_b32 a79, v51
  v_accvgpr_read_b32 v50, a80
  v_accvgpr_read_b32 v51, a81
  v_mul_f32 v50, v50, v49
  v_mul_f32 v51, v51, v49
  v_accvgpr_write_b32 a80, v50
  v_accvgpr_write_b32 a81, v51
  v_accvgpr_read_b32 v50, a82
  v_accvgpr_read_b32 v51, a83
  v_mul_f32 v50, v50, v49
  v_mul_f32 v51, v51, v49
  v_accvgpr_write_b32 a82, v50
  v_accvgpr_write_b32 a83, v51
  v_accvgpr_read_b32 v50, a84
  v_accvgpr_read_b32 v51, a85
  v_mul_f32 v50, v50, v49
  v_mul_f32 v51, v51, v49
  v_accvgpr_write_b32 a84, v50
  v_accvgpr_write_b32 a85, v51
  v_accvgpr_read_b32 v50, a86
  v_accvgpr_read_b32 v51, a87
  v_mul_f32 v50, v50, v49
  v_mul_f32 v51, v51, v49
  v_accvgpr_write_b32 a86, v50
  v_accvgpr_write_b32 a87, v51
  v_accvgpr_read_b32 v50, a88
  v_accvgpr_read_b32 v51, a89
  v_mul_f32 v50, v50, v49
  v_mul_f32 v51, v51, v49
  v_accvgpr_write_b32 a88, v50
  v_accvgpr_write_b32 a89, v51
  v_accvgpr_read_b32 v50, a90
  v_accvgpr_read_b32 v51, a91
  v_mul_f32 v50, v50, v49
  v_mul_f32 v51, v51, v49
  v_accvgpr_write_b32 a90, v50
  v_accvgpr_write_b32 a91, v51
  v_accvgpr_read_b32 v50, a92
  v_accvgpr_read_b32 v51, a93
  v_mul_f32 v50, v50, v49
  v_mul_f32 v51, v51, v49
  v_accvgpr_write_b32 a92, v50
  v_accvgpr_write_b32 a93, v51
  v_accvgpr_read_b32 v50, a94
  v_accvgpr_read_b32 v51, a95
  v_mul_f32 v50, v50, v49
  v_mul_f32 v51, v51, v49
  v_accvgpr_write_b32 a94, v50
  v_accvgpr_write_b32 a95, v51
  s_nop 2
  s_branch fa_kernel_back72
fa_kernel_rare73:
  s_nop 7
  v_mov_b32 v49, v48
  s_nop 1
  v_permlane16_swap_b32 v48, v49
  s_nop 1
  v_max_f32 v48, v48, v49
  v_mov_b32 v49, v48
  s_nop 1
  v_permlane32_swap_b32 v48, v49
  s_nop 1
  v_max_f32 v48, v48, v49
  s_ashr_i32 s59, s37, 31
  s_and_b32 s59, s59, 0xff800000
  s_mov_b32 s37, 0x41000000
  v_max_f32 v48, s59, v48
  v_sub_f32 v104, v104, v48
  v_sub_f32 v105, v105, v48
  v_sub_f32 v106, v106, v48
  v_sub_f32 v107, v107, v48
  v_sub_f32 v108, v108, v48
  v_sub_f32 v109, v109, v48
  v_sub_f32 v110, v110, v48
  v_sub_f32 v111, v111, v48
  v_sub_f32 v68, v68, v48
  v_sub_f32 v69, v69, v48
  v_sub_f32 v70, v70, v48
  v_sub_f32 v71, v71, v48
  s_cmp_lg_u32 s59, 0
  s_cbranch_scc1 fa_kernel_back73
  v_sub_f32 v49, 0, v48
  v_exp_f32 v49, v49
  s_nop 1
  v_mul_f32 v88, v88, v49
  v_mul_f32 v89, v89, v49
  v_mul_f32 v90, v90, v49
  v_mul_f32 v91, v91, v49
  v_accvgpr_read_b32 v50, a96
  v_accvgpr_read_b32 v51, a97
  v_mul_f32 v50, v50, v49
  v_mul_f32 v51, v51, v49
  v_accvgpr_write_b32 a96, v50
  v_accvgpr_write_b32 a97, v51
  v_accvgpr_read_b32 v50, a98
  v_accvgpr_read_b32 v51, a99
  v_mul_f32 v50, v50, v49
  v_mul_f32 v51, v51, v49
  v_accvgpr_write_b32 a98, v50
  v_accvgpr_write_b32 a99, v51
  v_accvgpr_read_b32 v50, a100
  v_accvgpr_read_b32 v51, a101
  v_mul_f32 v50, v50, v49
  v_mul_f32 v51, v51, v49
  v_accvgpr_write_b32 a100, v50
  v_accvgpr_write_b32 a101, v51
  v_accvgpr_read_b32 v50, a102
  v_accvgpr_read_b32 v51, a103
  v_mul_f32 v50, v50, v49
  v_mul_f32 v51, v51, v49
  v_accvgpr_write_b32 a102, v50
  v_accvgpr_write_b32 a103, v51
  v_accvgpr_read_b32 v50, a104
  v_accvgpr_read_b32 v51, a105
  v_mul_f32 v50, v50, v49
  v_mul_f32 v51, v51, v49
  v_accvgpr_write_b32 a104, v50
  v_accvgpr_write_b32 a105, v51
  v_accvgpr_read_b32 v50, a106
  v_accvgpr_read_b32 v51, a107
  v_mul_f32 v50, v50, v49
  v_mul_f32 v51, v51, v49
  v_accvgpr_write_b32 a106, v50
  v_accvgpr_write_b32 a107, v51
  v_accvgpr_read_b32 v50, a108
  v_accvgpr_read_b32 v51, a109
  v_mul_f32 v50, v50, v49
  v_mul_f32 v51, v51, v49
  v_accvgpr_write_b32 a108, v50
  v_accvgpr_write_b32 a109, v51
  v_accvgpr_read_b32 v50, a110
  v_accvgpr_read_b32 v51, a111
  v_mul_f32 v50, v50, v49
  v_mul_f32 v51, v51, v49
  v_accvgpr_write_b32 a110, v50
  v_accvgpr_write_b32 a111, v51
  v_accvgpr_read_b32 v50, a112
  v_accvgpr_read_b32 v51, a113
  v_mul_f32 v50, v50, v49
  v_mul_f32 v51, v51, v49
  v_accvgpr_write_b32 a112, v50
  v_accvgpr_write_b32 a113, v51
  v_accvgpr_read_b32 v50, a114
  v_accvgpr_read_b32 v51, a115
  v_mul_f32 v50, v50, v49
  v_mul_f32 v51, v51, v49
  v_accvgpr_write_b32 a114, v50
  v_accvgpr_write_b32 a115, v51
  v_accvgpr_read_b32 v50, a116
  v_accvgpr_read_b32 v51, a117
  v_mul_f32 v50, v50, v49
  v_mul_f32 v51, v51, v49
  v_accvgpr_write_b32 a116, v50
  v_accvgpr_write_b32 a117, v51
  v_accvgpr_read_b32 v50, a118
  v_accvgpr_read_b32 v51, a119
  v_mul_f32 v50, v50, v49
  v_mul_f32 v51, v51, v49
  v_accvgpr_write_b32 a118, v50
  v_accvgpr_write_b32 a119, v51
  v_accvgpr_read_b32 v50, a120
  v_accvgpr_read_b32 v51, a121
  v_mul_f32 v50, v50, v49
  v_mul_f32 v51, v51, v49
  v_accvgpr_write_b32 a120, v50
  v_accvgpr_write_b32 a121, v51
  v_accvgpr_read_b32 v50, a122
  v_accvgpr_read_b32 v51, a123
  v_mul_f32 v50, v50, v49
  v_mul_f32 v51, v51, v49
  v_accvgpr_write_b32 a122, v50
  v_accvgpr_write_b32 a123, v51
  v_accvgpr_read_b32 v50, a124
  v_accvgpr_read_b32 v51, a125
  v_mul_f32 v50, v50, v49
  v_mul_f32 v51, v51, v49
  v_accvgpr_write_b32 a124, v50
  v_accvgpr_write_b32 a125, v51
  v_accvgpr_read_b32 v50, a126
  v_accvgpr_read_b32 v51, a127
  v_mul_f32 v50, v50, v49
  v_mul_f32 v51, v51, v49
  v_accvgpr_write_b32 a126, v50
  v_accvgpr_write_b32 a127, v51
  s_nop 2
  s_branch fa_kernel_back73
fa_kernel_rare74:
  s_nop 7
  v_mov_b32 v49, v48
  s_nop 1
  v_permlane16_swap_b32 v48, v49
  s_nop 1
  v_max_f32 v48, v48, v49
  v_mov_b32 v49, v48
  s_nop 1
  v_permlane32_swap_b32 v48, v49
  s_nop 1
  v_max_f32 v48, v48, v49
  s_ashr_i32 s59, s38, 31
  s_and_b32 s59, s59, 0xff800000
  s_mov_b32 s38, 0x41000000
  v_max_f32 v48, s59, v48
  v_sub_f32 v112, v112, v48
  v_sub_f32 v113, v113, v48
  v_sub_f32 v114, v114, v48
  v_sub_f32 v115, v115, v48
  v_sub_f32 v116, v116, v48
  v_sub_f32 v117, v117, v48
  v_sub_f32 v118, v118, v48
  v_sub_f32 v119, v119, v48
  v_sub_f32 v72, v72, v48
  v_sub_f32 v73, v73, v48
  v_sub_f32 v74, v74, v48
  v_sub_f32 v75, v75, v48
  s_cmp_lg_u32 s59, 0
  s_cbranch_scc1 fa_kernel_back74
  v_sub_f32 v49, 0, v48
  v_exp_f32 v49, v49
  s_nop 1
  v_mul_f32 v92, v92, v49
  v_mul_f32 v93, v93, v49
  v_mul_f32 v94, v94, v49
  v_mul_f32 v95, v95, v49
  v_accvgpr_read_b32 v50, a128
  v_accvgpr_read_b32 v51, a129
  v_mul_f32 v50, v50, v49
  v_mul_f32 v51, v51, v49
  v_accvgpr_write_b32 a128, v50
  v_accvgpr_write_b32 a129, v51
  v_accvgpr_read_b32 v50, a130
  v_accvgpr_read_b32 v51, a131
  v_mul_f32 v50, v50, v49
  v_mul_f32 v51, v51, v49
  v_accvgpr_write_b32 a130, v50
  v_accvgpr_write_b32 a131, v51
  v_accvgpr_read_b32 v50, a132
  v_accvgpr_read_b32 v51, a133
  v_mul_f32 v50, v50, v49
  v_mul_f32 v51, v51, v49
  v_accvgpr_write_b32 a132, v50
  v_accvgpr_write_b32 a133, v51
  v_accvgpr_read_b32 v50, a134
  v_accvgpr_read_b32 v51, a135
  v_mul_f32 v50, v50, v49
  v_mul_f32 v51, v51, v49
  v_accvgpr_write_b32 a134, v50
  v_accvgpr_write_b32 a135, v51
  v_accvgpr_read_b32 v50, a136
  v_accvgpr_read_b32 v51, a137
  v_mul_f32 v50, v50, v49
  v_mul_f32 v51, v51, v49
  v_accvgpr_write_b32 a136, v50
  v_accvgpr_write_b32 a137, v51
  v_accvgpr_read_b32 v50, a138
  v_accvgpr_read_b32 v51, a139
  v_mul_f32 v50, v50, v49
  v_mul_f32 v51, v51, v49
  v_accvgpr_write_b32 a138, v50
  v_accvgpr_write_b32 a139, v51
  v_accvgpr_read_b32 v50, a140
  v_accvgpr_read_b32 v51, a141
  v_mul_f32 v50, v50, v49
  v_mul_f32 v51, v51, v49
  v_accvgpr_write_b32 a140, v50
  v_accvgpr_write_b32 a141, v51
  v_accvgpr_read_b32 v50, a142
  v_accvgpr_read_b32 v51, a143
  v_mul_f32 v50, v50, v49
  v_mul_f32 v51, v51, v49
  v_accvgpr_write_b32 a142, v50
  v_accvgpr_write_b32 a143, v51
  v_accvgpr_read_b32 v50, a144
  v_accvgpr_read_b32 v51, a145
  v_mul_f32 v50, v50, v49
  v_mul_f32 v51, v51, v49
  v_accvgpr_write_b32 a144, v50
  v_accvgpr_write_b32 a145, v51
  v_accvgpr_read_b32 v50, a146
  v_accvgpr_read_b32 v51, a147
  v_mul_f32 v50, v50, v49
  v_mul_f32 v51, v51, v49
  v_accvgpr_write_b32 a146, v50
  v_accvgpr_write_b32 a147, v51
  v_accvgpr_read_b32 v50, a148
  v_accvgpr_read_b32 v51, a149
  v_mul_f32 v50, v50, v49
  v_mul_f32 v51, v51, v49
  v_accvgpr_write_b32 a148, v50
  v_accvgpr_write_b32 a149, v51
  v_accvgpr_read_b32 v50, a150
  v_accvgpr_read_b32 v51, a151
  v_mul_f32 v50, v50, v49
  v_mul_f32 v51, v51, v49
  v_accvgpr_write_b32 a150, v50
  v_accvgpr_write_b32 a151, v51
  v_accvgpr_read_b32 v50, a152
  v_accvgpr_read_b32 v51, a153
  v_mul_f32 v50, v50, v49
  v_mul_f32 v51, v51, v49
  v_accvgpr_write_b32 a152, v50
  v_accvgpr_write_b32 a153, v51
  v_accvgpr_read_b32 v50, a154
  v_accvgpr_read_b32 v51, a155
  v_mul_f32 v50, v50, v49
  v_mul_f32 v51, v51, v49
  v_accvgpr_write_b32 a154, v50
  v_accvgpr_write_b32 a155, v51
  v_accvgpr_read_b32 v50, a156
  v_accvgpr_read_b32 v51, a157
  v_mul_f32 v50, v50, v49
  v_mul_f32 v51, v51, v49
  v_accvgpr_write_b32 a156, v50
  v_accvgpr_write_b32 a157, v51
  v_accvgpr_read_b32 v50, a158
  v_accvgpr_read_b32 v51, a159
  v_mul_f32 v50, v50, v49
  v_mul_f32 v51, v51, v49
  v_accvgpr_write_b32 a158, v50
  v_accvgpr_write_b32 a159, v51
  s_nop 2
  s_branch fa_kernel_back74
.section .rodata,"a"
.p2align 6
.amdhsa_kernel fa_kernel
  .amdhsa_next_free_vgpr 512
  .amdhsa_next_free_sgpr 102
  .amdhsa_accum_offset 256
  .amdhsa_group_segment_fixed_size 0
  .amdhsa_kernarg_size 104
  .amdhsa_user_sgpr_count 2
  .amdhsa_user_sgpr_kernarg_segment_ptr 1
  .amdhsa_system_sgpr_workgroup_id_x 1
.end_amdhsa_kernel
.text
.p2align 8
.globl oproj_kernel
.type oproj_kernel,@function
oproj_kernel:
  s_cmp_ge_u32 s2, 256
  s_cbranch_scc1 oproj_kernel_done
  s_load_dwordx2 s[4:5], s[0:1], 96
  s_load_dwordx2 s[6:7], s[0:1], 80
  s_load_dwordx2 s[8:9], s[0:1], 32
  s_load_dwordx2 s[10:11], s[0:1], 72
  v_lshrrev_b32 v1, 6, v0
  v_and_b32 v2, 63, v0
  v_readfirstlane_b32 s24, v1
  s_and_b32 s32, s2, 7
  s_lshr_b32 s33, s2, 3
  s_lshr_b32 s25, s32, 2
  s_and_b32 s28, s33, 1
  s_and_b32 s34, s32, 1
  s_lshl_b32 s34, s34, 2
  s_lshr_b32 s35, s33, 1
  s_and_b32 s35, s35, 3
  s_add_u32 s26, s34, s35
  s_lshr_b32 s34, s32, 1
  s_and_b32 s34, s34, 1
  s_lshl_b32 s34, s34, 2
  s_lshr_b32 s35, s33, 3
  s_add_u32 s27, s34, s35
  s_and_b32 s29, s24, 1
  s_lshr_b32 s30, s24, 1
  v_lshlrev_b32 v10, 4, v2
  v_add_u32 v11, 4096, v10
  v_add_u32 v12, 8192, v10
  v_lshrrev_b32 v3, 4, v2
  v_and_b32 v4, 15, v2
  v_lshlrev_b32 v5, 2, v3
  v_xor_b32 v4, v4, v5
  v_lshlrev_b32 v4, 4, v4
  v_lshlrev_b32 v5, 11, v3
  v_add_u32 v13, v5, v4
  v_xor_b32 v14, 0, v13
  v_add_u32 v14, 0, v14
  v_xor_b32 v15, 0, v13
  v_add_u32 v15, 8192, v15
  v_xor_b32 v16, 16, v13
  v_add_u32 v16, 16384, v16
  v_xor_b32 v17, 16, v13
  v_add_u32 v17, 24576, v17
  v_xor_b32 v18, 32, v13
  v_add_u32 v18, 32768, v18
  v_xor_b32 v19, 32, v13
  v_add_u32 v19, 40960, v19
  v_xor_b32 v20, 48, v13
  v_add_u32 v20, 49152, v20
  v_xor_b32 v21, 48, v13
  v_add_u32 v21, 57344, v21
  v_lshrrev_b32 v3, 2, v2
  v_and_b32 v3, 3, v3
  v_lshrrev_b32 v4, 4, v2
  v_and_b32 v5, 3, v2
  v_xor_b32 v5, v5, v4
  v_lshlrev_b32 v5, 4, v5
  v_lshlrev_b32 v6, 6, v3
  v_add_u32 v5, v5, v6
  v_lshlrev_b32 v6, 3, v4
  v_add_u32 v6, v6, v3
  v_lshlrev_b32 v6, 8, v6
  s_lshl_b32 s75, s24, 15
  v_add_u32 v6, s75, v6
  s_xor_b32 s32, s24, 0
  s_lshl_b32 s32, s32, 6
  v_xor_b32 v7, s32, v5
  v_add_u32 v22, v6, v7
  s_xor_b32 s32, s24, 1
  s_lshl_b32 s32, s32, 6
  v_xor_b32 v7, s32, v5
  v_add_u32 v23, v6, v7
  s_xor_b32 s32, s24, 2
  s_lshl_b32 s32, s32, 6
  v_xor_b32 v7, s32, v5
  v_add_u32 v24, v6, v7
  s_xor_b32 s32, s24, 3
  s_lshl_b32 s32, s32, 6
  v_xor_b32 v7, s32, v5
  v_add_u32 v25, v6, v7
  s_waitcnt lgkmcnt(0)
  s_add_u32 s52, s4, 50331648
  s_addc_u32 s53, s5, 0
  s_lshl_b32 s32, s25, 3
  s_add_u32 s32, s32, s26
  s_mul_i32 s32, s32, 1179648
  s_add_u32 s12, s4, s32
  s_addc_u32 s13, s5, 0
  s_and_b32 s13, s13, 0xffff
  s_mov_b32 s14, 1179648
  s_mov_b32 s15, 0x20000
  s_cmp_eq_u32 s25, 0
  s_cselect_b32 s16, s8, s10
  s_cselect_b32 s17, s9, s11
  s_lshl_b32 s32, s27, 8
  s_add_u32 s16, s16, s32
  s_addc_u32 s17, s17, 0
  s_and_b32 s17, s17, 0xffff
  s_sub_u32 s18, 8388608, s32
  s_mov_b32 s19, 0x20000
  s_lshl_b32 s32, s28, 4
  s_lshl_b32 s33, s24, 2
  s_add_u32 s32, s32, s33
  s_mul_i32 s36, s32, 36864
  s_add_u32 s38, s36, 147456
  s_lshl_b32 s37, s32, 18
  s_add_u32 s39, s37, 1048576
  s_cmp_lt_u32 s37, s39
  s_cselect_b32 s42, s37, 8388608
  s_add_u32 m0, s75, 0
  s_nop 0
  buffer_load_dwordx4 v14, s[16:19], s42 offen lds
  s_add_u32 m0, s75, 1024
  s_nop 0
  buffer_load_dwordx4 v15, s[16:19], s42 offen lds
  s_add_u32 m0, s75, 2048
  s_nop 0
  buffer_load_dwordx4 v16, s[16:19], s42 offen lds
  s_add_u32 m0, s75, 3072
  s_nop 0
  buffer_load_dwordx4 v17, s[16:19], s42 offen lds
  s_add_u32 m0, s75, 4096
  s_nop 0
  buffer_load_dwordx4 v18, s[16:19], s42 offen lds
  s_add_u32 m0, s75, 5120
  s_nop 0
  buffer_load_dwordx4 v19, s[16:19], s42 offen lds
  s_add_u32 m0, s75, 6144
  s_nop 0
  buffer_load_dwordx4 v20, s[16:19], s42 offen lds
  s_add_u32 m0, s75, 7168
  s_nop 0
  buffer_load_dwordx4 v21, s[16:19], s42 offen lds
  s_add_u32 s37, s37, 65536
  s_cmp_lt_u32 s36, s38
  s_cselect_b32 s41, s36, 1179648
  buffer_load_dwordx4 v[32:35], v10, s[12:15], s41 offen offset:0
  buffer_load_dwordx4 v[36:39], v10, s[12:15], s41 offen offset:1024
  buffer_load_dwordx4 v[40:43], v10, s[12:15], s41 offen offset:2048
  buffer_load_dwordx4 v[44:47], v10, s[12:15], s41 offen offset:3072
  buffer_load_dwordx4 v[48:51], v11, s[12:15], s41 offen offset:0
  buffer_load_dwordx4 v[52:55], v11, s[12:15], s41 offen offset:1024
  buffer_load_dwordx4 v[56:59], v11, s[12:15], s41 offen offset:2048
  buffer_load_dwordx4 v[60:63], v11, s[12:15], s41 offen offset:3072
  buffer_load_dwordx4 v[64:67], v12, s[12:15], s41 offen offset:0
  s_add_u32 s36, s36, 9216
  s_cmp_lt_u32 s37, s39
  s_cselect_b32 s42, s37, 8388608
  s_add_u32 m0, s75, 8192
  s_nop 0
  buffer_load_dwordx4 v14, s[16:19], s42 offen lds
  s_add_u32 m0, s75, 9216
  s_nop 0
  buffer_load_dwordx4 v15, s[16:19], s42 offen lds
  s_add_u32 m0, s75, 10240
  s_nop 0
  buffer_load_dwordx4 v16, s[16:19], s42 offen lds
  s_add_u32 m0, s75, 11264
  s_nop 0
  buffer_load_dwordx4 v17, s[16:19], s42 offen lds
  s_add_u32 m0, s75, 12288
  s_nop 0
  buffer_load_dwordx4 v18, s[16:19], s42 offen lds
  s_add_u32 m0, s75, 13312
  s_nop 0
  buffer_load_dwordx4 v19, s[16:19], s42 offen lds
  s_add_u32 m0, s75, 14336
  s_nop 0
  buffer_load_dwordx4 v20, s[16:19], s42 offen lds
  s_add_u32 m0, s75, 15360
  s_nop 0
  buffer_load_dwordx4 v21, s[16:19], s42 offen lds
  s_add_u32 s37, s37, 65536
  v_mov_b32 v4, 0
  v_mov_b32 v5, 0
  v_mov_b32 v6, 0
  v_mov_b32 v7, 0
  s_cmp_lt_u32 s36, s38
  s_cselect_b32 s41, s36, 1179648
  v_mfma_f32_16x16x32_bf16 a[0:3], v[4:7], v[4:7], 0
  v_mfma_f32_16x16x32_bf16 a[4:7], v[4:7], v[4:7], 0
  buffer_load_dwordx4 v[68:71], v10, s[12:15], s41 offen offset:0
  v_mfma_f32_16x16x32_bf16 a[8:11], v[4:7], v[4:7], 0
  v_mfma_f32_16x16x32_bf16 a[12:15], v[4:7], v[4:7], 0
  buffer_load_dwordx4 v[72:75], v10, s[12:15], s41 offen offset:1024
  v_mfma_f32_16x16x32_bf16 a[16:19], v[4:7], v[4:7], 0
  v_mfma_f32_16x16x32_bf16 a[20:23], v[4:7], v[4:7], 0
  buffer_load_dwordx4 v[76:79], v10, s[12:15], s41 offen offset:2048
  v_mfma_f32_16x16x32_bf16 a[24:27], v[4:7], v[4:7], 0
  v_mfma_f32_16x16x32_bf16 a[28:31], v[4:7], v[4:7], 0
  buffer_load_dwordx4 v[80:83], v10, s[12:15], s41 offen offset:3072
  v_mfma_f32_16x16x32_bf16 a[32:35], v[4:7], v[4:7], 0
  v_mfma_f32_16x16x32_bf16 a[36:39], v[4:7], v[4:7], 0
  buffer_load_dwordx4 v[84:87], v11, s[12:15], s41 offen offset:0
  v_mfma_f32_16x16x32_bf16 a[40:43], v[4:7], v[4:7], 0
  v_mfma_f32_16x16x32_bf16 a[44:47], v[4:7], v[4:7], 0
  buffer_load_dwordx4 v[88:91], v11, s[12:15], s41 offen offset:1024
  v_mfma_f32_16x16x32_bf16 a[48:51], v[4:7], v[4:7], 0
  v_mfma_f32_16x16x32_bf16 a[52:55], v[4:7], v[4:7], 0
  buffer_load_dwordx4 v[92:95], v11, s[12:15], s41 offen offset:2048
  v_mfma_f32_16x16x32_bf16 a[56:59], v[4:7], v[4:7], 0
  v_mfma_f32_16x16x32_bf16 a[60:63], v[4:7], v[4:7], 0
  buffer_load_dwordx4 v[96:99], v11, s[12:15], s41 offen offset:3072
  v_mfma_f32_16x16x32_bf16 a[64:67], v[4:7], v[4:7], 0
  v_mfma_f32_16x16x32_bf16 a[68:71], v[4:7], v[4:7], 0
  buffer_load_dwordx4 v[100:103], v12, s[12:15], s41 offen offset:0
  v_mfma_f32_16x16x32_bf16 a[72:75], v[4:7], v[4:7], 0
  v_mfma_f32_16x16x32_bf16 a[76:79], v[4:7], v[4:7], 0
  s_add_u32 s36, s36, 9216
  v_mfma_f32_16x16x32_bf16 a[80:83], v[4:7], v[4:7], 0
  v_mfma_f32_16x16x32_bf16 a[84:87], v[4:7], v[4:7], 0
  s_cmp_lt_u32 s37, s39
  s_cselect_b32 s42, s37, 8388608
  v_mfma_f32_16x16x32_bf16 a[88:91], v[4:7], v[4:7], 0
  v_mfma_f32_16x16x32_bf16 a[92:95], v[4:7], v[4:7], 0
  s_add_u32 m0, s75, 16384
  s_nop 0
  buffer_load_dwordx4 v14, s[16:19], s42 offen lds
  v_mfma_f32_16x16x32_bf16 a[96:99], v[4:7], v[4:7], 0
  v_mfma_f32_16x16x32_bf16 a[100:103], v[4:7], v[4:7], 0
  s_add_u32 m0, s75, 17408
  s_nop 0
  buffer_load_dwordx4 v15, s[16:19], s42 offen lds
  v_mfma_f32_16x16x32_bf16 a[104:107], v[4:7], v[4:7], 0
  v_mfma_f32_16x16x32_bf16 a[108:111], v[4:7], v[4:7], 0
  s_add_u32 m0, s75, 18432
  s_nop 0
  buffer_load_dwordx4 v16, s[16:19], s42 offen lds
  v_mfma_f32_16x16x32_bf16 a[112:115], v[4:7], v[4:7], 0
  v_mfma_f32_16x16x32_bf16 a[116:119], v[4:7], v[4:7], 0
  s_add_u32 m0, s75, 19456
  s_nop 0
  buffer_load_dwordx4 v17, s[16:19], s42 offen lds
  v_mfma_f32_16x16x32_bf16 a[120:123], v[4:7], v[4:7], 0
  v_mfma_f32_16x16x32_bf16 a[124:127], v[4:7], v[4:7], 0
  s_add_u32 m0, s75, 20480
  s_nop 0
  buffer_load_dwordx4 v18, s[16:19], s42 offen lds
  v_mfma_f32_16x16x32_bf16 a[128:131], v[4:7], v[4:7], 0
  v_mfma_f32_16x16x32_bf16 a[132:135], v[4:7], v[4:7], 0
  s_add_u32 m0, s75, 21504
  s_nop 0
  buffer_load_dwordx4 v19, s[16:19], s42 offen lds
  v_mfma_f32_16x16x32_bf16 a[136:139], v[4:7], v[4:7], 0
  v_mfma_f32_16x16x32_bf16 a[140:143], v[4:7], v[4:7], 0
  s_add_u32 m0, s75, 22528
  s_nop 0
  buffer_load_dwordx4 v20, s[16:19], s42 offen lds
  v_mfma_f32_16x16x32_bf16 a[144:147], v[4:7], v[4:7], 0
  v_mfma_f32_16x16x32_bf16 a[148:151], v[4:7], v[4:7], 0
  s_add_u32 m0, s75, 23552
  s_nop 0
  buffer_load_dwordx4 v21, s[16:19], s42 offen lds
  v_mfma_f32_16x16x32_bf16 a[152:155], v[4:7], v[4:7], 0
  v_mfma_f32_16x16x32_bf16 a[156:159], v[4:7], v[4:7], 0
  s_add_u32 s37, s37, 65536
  v_mfma_f32_16x16x32_bf16 a[160:163], v[4:7], v[4:7], 0
  v_mfma_f32_16x16x32_bf16 a[164:167], v[4:7], v[4:7], 0
  s_cmp_lt_u32 s36, s38
  s_cselect_b32 s41, s36, 1179648
  v_mfma_f32_16x16x32_bf16 a[168:171], v[4:7], v[4:7], 0
  v_mfma_f32_16x16x32_bf16 a[172:175], v[4:7], v[4:7], 0
  buffer_load_dwordx4 v[104:107], v10, s[12:15], s41 offen offset:0
  v_mfma_f32_16x16x32_bf16 a[176:179], v[4:7], v[4:7], 0
  v_mfma_f32_16x16x32_bf16 a[180:183], v[4:7], v[4:7], 0
  buffer_load_dwordx4 v[108:111], v10, s[12:15], s41 offen offset:1024
  v_mfma_f32_16x16x32_bf16 a[184:187], v[4:7], v[4:7], 0
  v_mfma_f32_16x16x32_bf16 a[188:191], v[4:7], v[4:7], 0
  buffer_load_dwordx4 v[112:115], v10, s[12:15], s41 offen offset:2048
  v_mfma_f32_16x16x32_bf16 a[192:195], v[4:7], v[4:7], 0
  v_mfma_f32_16x16x32_bf16 a[196:199], v[4:7], v[4:7], 0
  buffer_load_dwordx4 v[116:119], v10, s[12:15], s41 offen offset:3072
  v_mfma_f32_16x16x32_bf16 a[200:203], v[4:7], v[4:7], 0
  v_mfma_f32_16x16x32_bf16 a[204:207], v[4:7], v[4:7], 0
  buffer_load_dwordx4 v[120:123], v11, s[12:15], s41 offen offset:0
  v_mfma_f32_16x16x32_bf16 a[208:211], v[4:7], v[4:7], 0
  v_mfma_f32_16x16x32_bf16 a[212:215], v[4:7], v[4:7], 0
  buffer_load_dwordx4 v[124:127], v11, s[12:15], s41 offen offset:1024
  v_mfma_f32_16x16x32_bf16 a[216:219], v[4:7], v[4:7], 0
  v_mfma_f32_16x16x32_bf16 a[220:223], v[4:7], v[4:7], 0
  buffer_load_dwordx4 v[128:131], v11, s[12:15], s41 offen offset:2048
  v_mfma_f32_16x16x32_bf16 a[224:227], v[4:7], v[4:7], 0
  v_mfma_f32_16x16x32_bf16 a[228:231], v[4:7], v[4:7], 0
  buffer_load_dwordx4 v[132:135], v11, s[12:15], s41 offen offset:3072
  v_mfma_f32_16x16x32_bf16 a[232:235], v[4:7], v[4:7], 0
  v_mfma_f32_16x16x32_bf16 a[236:239], v[4:7], v[4:7], 0
  buffer_load_dwordx4 v[136:139], v12, s[12:15], s41 offen offset:0
  v_mfma_f32_16x16x32_bf16 a[240:243], v[4:7], v[4:7], 0
  v_mfma_f32_16x16x32_bf16 a[244:247], v[4:7], v[4:7], 0
  s_add_u32 s36, s36, 9216
  v_mfma_f32_16x16x32_bf16 a[248:251], v[4:7], v[4:7], 0
  v_mfma_f32_16x16x32_bf16 a[252:255], v[4:7], v[4:7], 0
  s_cmp_lt_u32 s37, s39
  s_cselect_b32 s42, s37, 8388608
  v_mfma_f32_16x16x32_bf16 v[200:203], v[4:7], v[4:7], 0
  v_mfma_f32_16x16x32_bf16 v[204:207], v[4:7], v[4:7], 0
  s_add_u32 m0, s75, 24576
  s_nop 0
  buffer_load_dwordx4 v14, s[16:19], s42 offen lds
  v_mfma_f32_16x16x32_bf16 v[208:211], v[4:7], v[4:7], 0
  v_mfma_f32_16x16x32_bf16 v[212:215], v[4:7], v[4:7], 0
  s_add_u32 m0, s75, 25600
  s_nop 0
  buffer_load_dwordx4 v15, s[16:19], s42 offen lds
  v_mfma_f32_16x16x32_bf16 v[216:219], v[4:7], v[4:7], 0
  v_mfma_f32_16x16x32_bf16 v[220:223], v[4:7], v[4:7], 0
  s_add_u32 m0, s75, 26624
  s_nop 0
  buffer_load_dwordx4 v16, s[16:19], s42 offen lds
  v_mfma_f32_16x16x32_bf16 v[224:227], v[4:7], v[4:7], 0
  v_mfma_f32_16x16x32_bf16 v[228:231], v[4:7], v[4:7], 0
  s_add_u32 m0, s75, 27648
  s_nop 0
  buffer_load_dwordx4 v17, s[16:19], s42 offen lds
  s_add_u32 m0, s75, 28672
  s_nop 0
  buffer_load_dwordx4 v18, s[16:19], s42 offen lds
  s_add_u32 m0, s75, 29696
  s_nop 0
  buffer_load_dwordx4 v19, s[16:19], s42 offen lds
  s_add_u32 m0, s75, 30720
  s_nop 0
  buffer_load_dwordx4 v20, s[16:19], s42 offen lds
  s_add_u32 m0, s75, 31744
  s_nop 0
  buffer_load_dwordx4 v21, s[16:19], s42 offen lds
  s_add_u32 s37, s37, 65536
  s_waitcnt vmcnt(51)
  ds_read_b64_tr_b16 v[176:177], v22 offset:0
  ds_read_b64_tr_b16 v[178:179], v22 offset:1024
  ds_read_b64_tr_b16 v[180:181], v22 offset:8
  ds_read_b64_tr_b16 v[182:183], v22 offset:1032
  ds_read_b64_tr_b16 v[184:185], v23 offset:0
  ds_read_b64_tr_b16 v[186:187], v23 offset:1024
  ds_read_b64_tr_b16 v[188:189], v23 offset:8
  ds_read_b64_tr_b16 v[190:191], v23 offset:1032
  ds_read_b64_tr_b16 v[192:193], v24 offset:0
  ds_read_b64_tr_b16 v[194:195], v24 offset:1024
  ds_read_b64_tr_b16 v[196:197], v24 offset:8
  ds_read_b64_tr_b16 v[198:199], v24 offset:1032
  ds_read_b64_tr_b16 v[232:233], v25 offset:0
  ds_read_b64_tr_b16 v[234:235], v25 offset:1024
  ds_read_b64_tr_b16 v[236:237], v25 offset:8
  s_waitcnt lgkmcnt(14)
  ds_read_b64_tr_b16 v[238:239], v25 offset:1032
  s_waitcnt lgkmcnt(0)
  s_mov_b32 s31, 4
oproj_kernel_loop:
  s_waitcnt vmcnt(34)
  v_mfma_f32_16x16x32_bf16 a[0:3], v[176:179], v[32:35], a[0:3]
  s_cmp_lt_u32 s36, s38
  s_cselect_b32 s41, s36, 1179648
  buffer_load_dwordx4 v[140:143], v10, s[12:15], s41 offen offset:0
  v_mfma_f32_16x16x32_bf16 a[32:35], v[176:179], v[36:39], a[32:35]
  v_mfma_f32_16x16x32_bf16 a[64:67], v[176:179], v[40:43], a[64:67]
  v_mfma_f32_16x16x32_bf16 a[96:99], v[176:179], v[44:47], a[96:99]
  buffer_load_dwordx4 v[144:147], v10, s[12:15], s41 offen offset:1024
  v_mfma_f32_16x16x32_bf16 a[128:131], v[176:179], v[48:51], a[128:131]
  v_mfma_f32_16x16x32_bf16 a[160:163], v[176:179], v[52:55], a[160:163]
  v_mfma_f32_16x16x32_bf16 a[192:195], v[176:179], v[56:59], a[192:195]
  s_waitcnt lgkmcnt(0)
  v_mfma_f32_16x16x32_bf16 a[224:227], v[176:179], v[60:63], a[224:227]
  buffer_load_dwordx4 v[148:151], v10, s[12:15], s41 offen offset:2048
  v_mfma_f32_16x16x32_bf16 v[200:203], v[176:179], v[64:67], v[200:203]
  ds_read_b64_tr_b16 v[176:177], v22 offset:8192
  v_mfma_f32_16x16x32_bf16 a[4:7], v[180:183], v[32:35], a[4:7]
  ds_read_b64_tr_b16 v[178:179], v22 offset:9216
  v_mfma_f32_16x16x32_bf16 a[36:39], v[180:183], v[36:39], a[36:39]
  v_mfma_f32_16x16x32_bf16 a[68:71], v[180:183], v[40:43], a[68:71]
  v_mfma_f32_16x16x32_bf16 a[100:103], v[180:183], v[44:47], a[100:103]
  buffer_load_dwordx4 v[152:155], v10, s[12:15], s41 offen offset:3072
  v_mfma_f32_16x16x32_bf16 a[132:135], v[180:183], v[48:51], a[132:135]
  v_mfma_f32_16x16x32_bf16 a[164:167], v[180:183], v[52:55], a[164:167]
  v_mfma_f32_16x16x32_bf16 a[196:199], v[180:183], v[56:59], a[196:199]
  buffer_load_dwordx4 v[156:159], v11, s[12:15], s41 offen offset:0
  v_mfma_f32_16x16x32_bf16 a[228:231], v[180:183], v[60:63], a[228:231]
  v_mfma_f32_16x16x32_bf16 v[204:207], v[180:183], v[64:67], v[204:207]
  ds_read_b64_tr_b16 v[180:181], v22 offset:8200
  v_mfma_f32_16x16x32_bf16 a[8:11], v[184:187], v[32:35], a[8:11]
  ds_read_b64_tr_b16 v[182:183], v22 offset:9224
  v_mfma_f32_16x16x32_bf16 a[40:43], v[184:187], v[36:39], a[40:43]
  v_mfma_f32_16x16x32_bf16 a[72:75], v[184:187], v[40:43], a[72:75]
  buffer_load_dwordx4 v[160:163], v11, s[12:15], s41 offen offset:1024
  v_mfma_f32_16x16x32_bf16 a[104:107], v[184:187], v[44:47], a[104:107]
  v_mfma_f32_16x16x32_bf16 a[136:139], v[184:187], v[48:51], a[136:139]
  v_mfma_f32_16x16x32_bf16 a[168:171], v[184:187], v[52:55], a[168:171]
  buffer_load_dwordx4 v[164:167], v11, s[12:15], s41 offen offset:2048
  v_mfma_f32_16x16x32_bf16 a[200:203], v[184:187], v[56:59], a[200:203]
  v_mfma_f32_16x16x32_bf16 a[232:235], v[184:187], v[60:63], a[232:235]
  v_mfma_f32_16x16x32_bf16 v[208:211], v[184:187], v[64:67], v[208:211]
  ds_read_b64_tr_b16 v[184:185], v23 offset:8192
  v_mfma_f32_16x16x32_bf16 a[12:15], v[188:191], v[32:35], a[12:15]
  ds_read_b64_tr_b16 v[186:187], v23 offset:9216
  v_mfma_f32_16x16x32_bf16 a[44:47], v[188:191], v[36:39], a[44:47]
  buffer_load_dwordx4 v[168:171], v11, s[12:15], s41 offen offset:3072
  v_mfma_f32_16x16x32_bf16 a[76:79], v[188:191], v[40:43], a[76:79]
  v_mfma_f32_16x16x32_bf16 a[108:111], v[188:191], v[44:47], a[108:111]
  v_mfma_f32_16x16x32_bf16 a[140:143], v[188:191], v[48:51], a[140:143]
  buffer_load_dwordx4 v[172:175], v12, s[12:15], s41 offen offset:0
  v_mfma_f32_16x16x32_bf16 a[172:175], v[188:191], v[52:55], a[172:175]
  v_mfma_f32_16x16x32_bf16 a[204:207], v[188:191], v[56:59], a[204:207]
  s_add_u32 m0, s75, 0
  v_mfma_f32_16x16x32_bf16 a[236:239], v[188:191], v[60:63], a[236:239]
  s_add_u32 s36, s36, 9216
  s_cmp_lt_u32 s37, s39
  s_cselect_b32 s42, s37, 8388608
  buffer_load_dwordx4 v14, s[16:19], s42 offen lds
  v_mfma_f32_16x16x32_bf16 v[212:215], v[188:191], v[64:67], v[212:215]
  ds_read_b64_tr_b16 v[188:189], v23 offset:8200
  v_mfma_f32_16x16x32_bf16 a[16:19], v[192:195], v[32:35], a[16:19]
  ds_read_b64_tr_b16 v[190:191], v23 offset:9224
  v_mfma_f32_16x16x32_bf16 a[48:51], v[192:195], v[36:39], a[48:51]
  v_mfma_f32_16x16x32_bf16 a[80:83], v[192:195], v[40:43], a[80:83]
  s_add_u32 m0, s75, 1024
  v_mfma_f32_16x16x32_bf16 a[112:115], v[192:195], v[44:47], a[112:115]
  buffer_load_dwordx4 v15, s[16:19], s42 offen lds
  v_mfma_f32_16x16x32_bf16 a[144:147], v[192:195], v[48:51], a[144:147]
  v_mfma_f32_16x16x32_bf16 a[176:179], v[192:195], v[52:55], a[176:179]
  s_add_u32 m0, s75, 2048
  v_mfma_f32_16x16x32_bf16 a[208:211], v[192:195], v[56:59], a[208:211]
  buffer_load_dwordx4 v16, s[16:19], s42 offen lds
  v_mfma_f32_16x16x32_bf16 a[240:243], v[192:195], v[60:63], a[240:243]
  v_mfma_f32_16x16x32_bf16 v[216:219], v[192:195], v[64:67], v[216:219]
  ds_read_b64_tr_b16 v[192:193], v24 offset:8192
  v_mfma_f32_16x16x32_bf16 a[20:23], v[196:199], v[32:35], a[20:23]
  ds_read_b64_tr_b16 v[194:195], v24 offset:9216
  v_mfma_f32_16x16x32_bf16 a[52:55], v[196:199], v[36:39], a[52:55]
  s_add_u32 m0, s75, 3072
  v_mfma_f32_16x16x32_bf16 a[84:87], v[196:199], v[40:43], a[84:87]
  buffer_load_dwordx4 v17, s[16:19], s42 offen lds
  v_mfma_f32_16x16x32_bf16 a[116:119], v[196:199], v[44:47], a[116:119]
  v_mfma_f32_16x16x32_bf16 a[148:151], v[196:199], v[48:51], a[148:151]
  s_add_u32 m0, s75, 4096
  v_mfma_f32_16x16x32_bf16 a[180:183], v[196:199], v[52:55], a[180:183]
  buffer_load_dwordx4 v18, s[16:19], s42 offen lds
  v_mfma_f32_16x16x32_bf16 a[212:215], v[196:199], v[56:59], a[212:215]
  v_mfma_f32_16x16x32_bf16 a[244:247], v[196:199], v[60:63], a[244:247]
  v_mfma_f32_16x16x32_bf16 v[220:223], v[196:199], v[64:67], v[220:223]
  ds_read_b64_tr_b16 v[196:197], v24 offset:8200
  v_mfma_f32_16x16x32_bf16 a[24:27], v[232:235], v[32:35], a[24:27]
  ds_read_b64_tr_b16 v[198:199], v24 offset:9224
  s_add_u32 m0, s75, 5120
  v_mfma_f32_16x16x32_bf16 a[56:59], v[232:235], v[36:39], a[56:59]
  buffer_load_dwordx4 v19, s[16:19], s42 offen lds
  v_mfma_f32_16x16x32_bf16 a[88:91], v[232:235], v[40:43], a[88:91]
  v_mfma_f32_16x16x32_bf16 a[120:123], v[232:235], v[44:47], a[120:123]
  s_add_u32 m0, s75, 6144
  v_mfma_f32_16x16x32_bf16 a[152:155], v[232:235], v[48:51], a[152:155]
  buffer_load_dwordx4 v20, s[16:19], s42 offen lds
  v_mfma_f32_16x16x32_bf16 a[184:187], v[232:235], v[52:55], a[184:187]
  v_mfma_f32_16x16x32_bf16 a[216:219], v[232:235], v[56:59], a[216:219]
  s_add_u32 m0, s75, 7168
  v_mfma_f32_16x16x32_bf16 a[248:251], v[232:235], v[60:63], a[248:251]
  buffer_load_dwordx4 v21, s[16:19], s42 offen lds
  v_mfma_f32_16x16x32_bf16 v[224:227], v[232:235], v[64:67], v[224:227]
  ds_read_b64_tr_b16 v[232:233], v25 offset:8192
  v_mfma_f32_16x16x32_bf16 a[28:31], v[236:239], v[32:35], a[28:31]
  ds_read_b64_tr_b16 v[234:235], v25 offset:9216
  v_mfma_f32_16x16x32_bf16 a[60:63], v[236:239], v[36:39], a[60:63]
  v_mfma_f32_16x16x32_bf16 a[92:95], v[236:239], v[40:43], a[92:95]
  v_mfma_f32_16x16x32_bf16 a[124:127], v[236:239], v[44:47], a[124:127]
  s_add_u32 s37, s37, 65536
  v_mfma_f32_16x16x32_bf16 a[156:159], v[236:239], v[48:51], a[156:159]
  v_mfma_f32_16x16x32_bf16 a[188:191], v[236:239], v[52:55], a[188:191]
  v_mfma_f32_16x16x32_bf16 a[220:223], v[236:239], v[56:59], a[220:223]
  v_mfma_f32_16x16x32_bf16 a[252:255], v[236:239], v[60:63], a[252:255]
  v_mfma_f32_16x16x32_bf16 v[228:231], v[236:239], v[64:67], v[228:231]
  ds_read_b64_tr_b16 v[236:237], v25 offset:8200
  s_waitcnt lgkmcnt(7)
  ds_read_b64_tr_b16 v[238:239], v25 offset:9224
  s_waitcnt vmcnt(34)
  v_mfma_f32_16x16x32_bf16 a[0:3], v[176:179], v[68:71], a[0:3]
  s_cmp_lt_u32 s36, s38
  s_cselect_b32 s41, s36, 1179648
  buffer_load_dwordx4 v[32:35], v10, s[12:15], s41 offen offset:0
  v_mfma_f32_16x16x32_bf16 a[32:35], v[176:179], v[72:75], a[32:35]
  v_mfma_f32_16x16x32_bf16 a[64:67], v[176:179], v[76:79], a[64:67]
  v_mfma_f32_16x16x32_bf16 a[96:99], v[176:179], v[80:83], a[96:99]
  buffer_load_dwordx4 v[36:39], v10, s[12:15], s41 offen offset:1024
  v_mfma_f32_16x16x32_bf16 a[128:131], v[176:179], v[84:87], a[128:131]
  v_mfma_f32_16x16x32_bf16 a[160:163], v[176:179], v[88:91], a[160:163]
  v_mfma_f32_16x16x32_bf16 a[192:195], v[176:179], v[92:95], a[192:195]
  s_waitcnt lgkmcnt(0)
  v_mfma_f32_16x16x32_bf16 a[224:227], v[176:179], v[96:99], a[224:227]
  buffer_load_dwordx4 v[40:43], v10, s[12:15], s41 offen offset:2048
  v_mfma_f32_16x16x32_bf16 v[200:203], v[176:179], v[100:103], v[200:203]
  ds_read_b64_tr_b16 v[176:177], v22 offset:16384
  v_mfma_f32_16x16x32_bf16 a[4:7], v[180:183], v[68:71], a[4:7]
  ds_read_b64_tr_b16 v[178:179], v22 offset:17408
  v_mfma_f32_16x16x32_bf16 a[36:39], v[180:183], v[72:75], a[36:39]
  v_mfma_f32_16x16x32_bf16 a[68:71], v[180:183], v[76:79], a[68:71]
  v_mfma_f32_16x16x32_bf16 a[100:103], v[180:183], v[80:83], a[100:103]
  buffer_load_dwordx4 v[44:47], v10, s[12:15], s41 offen offset:3072
  v_mfma_f32_16x16x32_bf16 a[132:135], v[180:183], v[84:87], a[132:135]
  v_mfma_f32_16x16x32_bf16 a[164:167], v[180:183], v[88:91], a[164:167]
  v_mfma_f32_16x16x32_bf16 a[196:199], v[180:183], v[92:95], a[196:199]
  buffer_load_dwordx4 v[48:51], v11, s[12:15], s41 offen offset:0
  v_mfma_f32_16x16x32_bf16 a[228:231], v[180:183], v[96:99], a[228:231]
  v_mfma_f32_16x16x32_bf16 v[204:207], v[180:183], v[100:103], v[204:207]
  ds_read_b64_tr_b16 v[180:181], v22 offset:16392
  v_mfma_f32_16x16x32_bf16 a[8:11], v[184:187], v[68:71], a[8:11]
  ds_read_b64_tr_b16 v[182:183], v22 offset:17416
  v_mfma_f32_16x16x32_bf16 a[40:43], v[184:187], v[72:75], a[40:43]
  v_mfma_f32_16x16x32_bf16 a[72:75], v[184:187], v[76:79], a[72:75]
  buffer_load_dwordx4 v[52:55], v11, s[12:15], s41 offen offset:1024
  v_mfma_f32_16x16x32_bf16 a[104:107], v[184:187], v[80:83], a[104:107]
  v_mfma_f32_16x16x32_bf16 a[136:139], v[184:187], v[84:87], a[136:139]
  v_mfma_f32_16x16x32_bf16 a[168:171], v[184:187], v[88:91], a[168:171]
  buffer_load_dwordx4 v[56:59], v11, s[12:15], s41 offen offset:2048
  v_mfma_f32_16x16x32_bf16 a[200:203], v[184:187], v[92:95], a[200:203]
  v_mfma_f32_16x16x32_bf16 a[232:235], v[184:187], v[96:99], a[232:235]
  v_mfma_f32_16x16x32_bf16 v[208:211], v[184:187], v[100:103], v[208:211]
  ds_read_b64_tr_b16 v[184:185], v23 offset:16384
  v_mfma_f32_16x16x32_bf16 a[12:15], v[188:191], v[68:71], a[12:15]
  ds_read_b64_tr_b16 v[186:187], v23 offset:17408
  v_mfma_f32_16x16x32_bf16 a[44:47], v[188:191], v[72:75], a[44:47]
  buffer_load_dwordx4 v[60:63], v11, s[12:15], s41 offen offset:3072
  v_mfma_f32_16x16x32_bf16 a[76:79], v[188:191], v[76:79], a[76:79]
  v_mfma_f32_16x16x32_bf16 a[108:111], v[188:191], v[80:83], a[108:111]
  v_mfma_f32_16x16x32_bf16 a[140:143], v[188:191], v[84:87], a[140:143]
  buffer_load_dwordx4 v[64:67], v12, s[12:15], s41 offen offset:0
  v_mfma_f32_16x16x32_bf16 a[172:175], v[188:191], v[88:91], a[172:175]
  v_mfma_f32_16x16x32_bf16 a[204:207], v[188:191], v[92:95], a[204:207]
  s_add_u32 m0, s75, 8192
  v_mfma_f32_16x16x32_bf16 a[236:239], v[188:191], v[96:99], a[236:239]
  s_add_u32 s36, s36, 9216
  s_cmp_lt_u32 s37, s39
  s_cselect_b32 s42, s37, 8388608
  buffer_load_dwordx4 v14, s[16:19], s42 offen lds
  v_mfma_f32_16x16x32_bf16 v[212:215], v[188:191], v[100:103], v[212:215]
  ds_read_b64_tr_b16 v[188:189], v23 offset:16392
  v_mfma_f32_16x16x32_bf16 a[16:19], v[192:195], v[68:71], a[16:19]
  ds_read_b64_tr_b16 v[190:191], v23 offset:17416
  v_mfma_f32_16x16x32_bf16 a[48:51], v[192:195], v[72:75], a[48:51]
  v_mfma_f32_16x16x32_bf16 a[80:83], v[192:195], v[76:79], a[80:83]
  s_add_u32 m0, s75, 9216
  v_mfma_f32_16x16x32_bf16 a[112:115], v[192:195], v[80:83], a[112:115]
  buffer_load_dwordx4 v15, s[16:19], s42 offen lds
  v_mfma_f32_16x16x32_bf16 a[144:147], v[192:195], v[84:87], a[144:147]
  v_mfma_f32_16x16x32_bf16 a[176:179], v[192:195], v[88:91], a[176:179]
  s_add_u32 m0, s75, 10240
  v_mfma_f32_16x16x32_bf16 a[208:211], v[192:195], v[92:95], a[208:211]
  buffer_load_dwordx4 v16, s[16:19], s42 offen lds
  v_mfma_f32_16x16x32_bf16 a[240:243], v[192:195], v[96:99], a[240:243]
  v_mfma_f32_16x16x32_bf16 v[216:219], v[192:195], v[100:103], v[216:219]
  ds_read_b64_tr_b16 v[192:193], v24 offset:16384
  v_mfma_f32_16x16x32_bf16 a[20:23], v[196:199], v[68:71], a[20:23]
  ds_read_b64_tr_b16 v[194:195], v24 offset:17408
  v_mfma_f32_16x16x32_bf16 a[52:55], v[196:199], v[72:75], a[52:55]
  s_add_u32 m0, s75, 11264
  v_mfma_f32_16x16x32_bf16 a[84:87], v[196:199], v[76:79], a[84:87]
  buffer_load_dwordx4 v17, s[16:19], s42 offen lds
  v_mfma_f32_16x16x32_bf16 a[116:119], v[196:199], v[80:83], a[116:119]
  v_mfma_f32_16x16x32_bf16 a[148:151], v[196:199], v[84:87], a[148:151]
  s_add_u32 m0, s75, 12288
  v_mfma_f32_16x16x32_bf16 a[180:183], v[196:199], v[88:91], a[180:183]
  buffer_load_dwordx4 v18, s[16:19], s42 offen lds
  v_mfma_f32_16x16x32_bf16 a[212:215], v[196:199], v[92:95], a[212:215]
  v_mfma_f32_16x16x32_bf16 a[244:247], v[196:199], v[96:99], a[244:247]
  v_mfma_f32_16x16x32_bf16 v[220:223], v[196:199], v[100:103], v[220:223]
  ds_read_b64_tr_b16 v[196:197], v24 offset:16392
  v_mfma_f32_16x16x32_bf16 a[24:27], v[232:235], v[68:71], a[24:27]
  ds_read_b64_tr_b16 v[198:199], v24 offset:17416
  s_add_u32 m0, s75, 13312
  v_mfma_f32_16x16x32_bf16 a[56:59], v[232:235], v[72:75], a[56:59]
  buffer_load_dwordx4 v19, s[16:19], s42 offen lds
  v_mfma_f32_16x16x32_bf16 a[88:91], v[232:235], v[76:79], a[88:91]
  v_mfma_f32_16x16x32_bf16 a[120:123], v[232:235], v[80:83], a[120:123]
  s_add_u32 m0, s75, 14336
  v_mfma_f32_16x16x32_bf16 a[152:155], v[232:235], v[84:87], a[152:155]
  buffer_load_dwordx4 v20, s[16:19], s42 offen lds
  v_mfma_f32_16x16x32_bf16 a[184:187], v[232:235], v[88:91], a[184:187]
  v_mfma_f32_16x16x32_bf16 a[216:219], v[232:235], v[92:95], a[216:219]
  s_add_u32 m0, s75, 15360
  v_mfma_f32_16x16x32_bf16 a[248:251], v[232:235], v[96:99], a[248:251]
  buffer_load_dwordx4 v21, s[16:19], s42 offen lds
  v_mfma_f32_16x16x32_bf16 v[224:227], v[232:235], v[100:103], v[224:227]
  ds_read_b64_tr_b16 v[232:233], v25 offset:16384
  v_mfma_f32_16x16x32_bf16 a[28:31], v[236:239], v[68:71], a[28:31]
  ds_read_b64_tr_b16 v[234:235], v25 offset:17408
  v_mfma_f32_16x16x32_bf16 a[60:63], v[236:239], v[72:75], a[60:63]
  v_mfma_f32_16x16x32_bf16 a[92:95], v[236:239], v[76:79], a[92:95]
  v_mfma_f32_16x16x32_bf16 a[124:127], v[236:239], v[80:83], a[124:127]
  s_add_u32 s37, s37, 65536
  v_mfma_f32_16x16x32_bf16 a[156:159], v[236:239], v[84:87], a[156:159]
  v_mfma_f32_16x16x32_bf16 a[188:191], v[236:239], v[88:91], a[188:191]
  v_mfma_f32_16x16x32_bf16 a[220:223], v[236:239], v[92:95], a[220:223]
  v_mfma_f32_16x16x32_bf16 a[252:255], v[236:239], v[96:99], a[252:255]
  v_mfma_f32_16x16x32_bf16 v[228:231], v[236:239], v[100:103], v[228:231]
  ds_read_b64_tr_b16 v[236:237], v25 offset:16392
  s_waitcnt lgkmcnt(7)
  ds_read_b64_tr_b16 v[238:239], v25 offset:17416
  s_waitcnt vmcnt(34)
  v_mfma_f32_16x16x32_bf16 a[0:3], v[176:179], v[104:107], a[0:3]
  s_cmp_lt_u32 s36, s38
  s_cselect_b32 s41, s36, 1179648
  buffer_load_dwordx4 v[68:71], v10, s[12:15], s41 offen offset:0
  v_mfma_f32_16x16x32_bf16 a[32:35], v[176:179], v[108:111], a[32:35]
  v_mfma_f32_16x16x32_bf16 a[64:67], v[176:179], v[112:115], a[64:67]
  v_mfma_f32_16x16x32_bf16 a[96:99], v[176:179], v[116:119], a[96:99]
  buffer_load_dwordx4 v[72:75], v10, s[12:15], s41 offen offset:1024
  v_mfma_f32_16x16x32_bf16 a[128:131], v[176:179], v[120:123], a[128:131]
  v_mfma_f32_16x16x32_bf16 a[160:163], v[176:179], v[124:127], a[160:163]
  v_mfma_f32_16x16x32_bf16 a[192:195], v[176:179], v[128:131], a[192:195]
  s_waitcnt lgkmcnt(0)
  v_mfma_f32_16x16x32_bf16 a[224:227], v[176:179], v[132:135], a[224:227]
  buffer_load_dwordx4 v[76:79], v10, s[12:15], s41 offen offset:2048
  v_mfma_f32_16x16x32_bf16 v[200:203], v[176:179], v[136:139], v[200:203]
  ds_read_b64_tr_b16 v[176:177], v22 offset:24576
  v_mfma_f32_16x16x32_bf16 a[4:7], v[180:183], v[104:107], a[4:7]
  ds_read_b64_tr_b16 v[178:179], v22 offset:25600
  v_mfma_f32_16x16x32_bf16 a[36:39], v[180:183], v[108:111], a[36:39]
  v_mfma_f32_16x16x32_bf16 a[68:71], v[180:183], v[112:115], a[68:71]
  v_mfma_f32_16x16x32_bf16 a[100:103], v[180:183], v[116:119], a[100:103]
  buffer_load_dwordx4 v[80:83], v10, s[12:15], s41 offen offset:3072
  v_mfma_f32_16x16x32_bf16 a[132:135], v[180:183], v[120:123], a[132:135]
  v_mfma_f32_16x16x32_bf16 a[164:167], v[180:183], v[124:127], a[164:167]
  v_mfma_f32_16x16x32_bf16 a[196:199], v[180:183], v[128:131], a[196:199]
  buffer_load_dwordx4 v[84:87], v11, s[12:15], s41 offen offset:0
  v_mfma_f32_16x16x32_bf16 a[228:231], v[180:183], v[132:135], a[228:231]
  v_mfma_f32_16x16x32_bf16 v[204:207], v[180:183], v[136:139], v[204:207]
  ds_read_b64_tr_b16 v[180:181], v22 offset:24584
  v_mfma_f32_16x16x32_bf16 a[8:11], v[184:187], v[104:107], a[8:11]
  ds_read_b64_tr_b16 v[182:183], v22 offset:25608
  v_mfma_f32_16x16x32_bf16 a[40:43], v[184:187], v[108:111], a[40:43]
  v_mfma_f32_16x16x32_bf16 a[72:75], v[184:187], v[112:115], a[72:75]
  buffer_load_dwordx4 v[88:91], v11, s[12:15], s41 offen offset:1024
  v_mfma_f32_16x16x32_bf16 a[104:107], v[184:187], v[116:119], a[104:107]
  v_mfma_f32_16x16x32_bf16 a[136:139], v[184:187], v[120:123], a[136:139]
  v_mfma_f32_16x16x32_bf16 a[168:171], v[184:187], v[124:127], a[168:171]
  buffer_load_dwordx4 v[92:95], v11, s[12:15], s41 offen offset:2048
  v_mfma_f32_16x16x32_bf16 a[200:203], v[184:187], v[128:131], a[200:203]
  v_mfma_f32_16x16x32_bf16 a[232:235], v[184:187], v[132:135], a[232:235]
  v_mfma_f32_16x16x32_bf16 v[208:211], v[184:187], v[136:139], v[208:211]
  ds_read_b64_tr_b16 v[184:185], v23 offset:24576
  v_mfma_f32_16x16x32_bf16 a[12:15], v[188:191], v[104:107], a[12:15]
  ds_read_b64_tr_b16 v[186:187], v23 offset:25600
  v_mfma_f32_16x16x32_bf16 a[44:47], v[188:191], v[108:111], a[44:47]
  buffer_load_dwordx4 v[96:99], v11, s[12:15], s41 offen offset:3072
  v_mfma_f32_16x16x32_bf16 a[76:79], v[188:191], v[112:115], a[76:79]
  v_mfma_f32_16x16x32_bf16 a[108:111], v[188:191], v[116:119], a[108:111]
  v_mfma_f32_16x16x32_bf16 a[140:143], v[188:191], v[120:123], a[140:143]
  buffer_load_dwordx4 v[100:103], v12, s[12:15], s41 offen offset:0
  v_mfma_f32_16x16x32_bf16 a[172:175], v[188:191], v[124:127], a[172:175]
  v_mfma_f32_16x16x32_bf16 a[204:207], v[188:191], v[128:131], a[204:207]
  s_add_u32 m0, s75, 16384
  v_mfma_f32_16x16x32_bf16 a[236:239], v[188:191], v[132:135], a[236:239]
  s_add_u32 s36, s36, 9216
  s_cmp_lt_u32 s37, s39
  s_cselect_b32 s42, s37, 8388608
  buffer_load_dwordx4 v14, s[16:19], s42 offen lds
  v_mfma_f32_16x16x32_bf16 v[212:215], v[188:191], v[136:139], v[212:215]
  ds_read_b64_tr_b16 v[188:189], v23 offset:24584
  v_mfma_f32_16x16x32_bf16 a[16:19], v[192:195], v[104:107], a[16:19]
  ds_read_b64_tr_b16 v[190:191], v23 offset:25608
  v_mfma_f32_16x16x32_bf16 a[48:51], v[192:195], v[108:111], a[48:51]
  v_mfma_f32_16x16x32_bf16 a[80:83], v[192:195], v[112:115], a[80:83]
  s_add_u32 m0, s75, 17408
  v_mfma_f32_16x16x32_bf16 a[112:115], v[192:195], v[116:119], a[112:115]
  buffer_load_dwordx4 v15, s[16:19], s42 offen lds
  v_mfma_f32_16x16x32_bf16 a[144:147], v[192:195], v[120:123], a[144:147]
  v_mfma_f32_16x16x32_bf16 a[176:179], v[192:195], v[124:127], a[176:179]
  s_add_u32 m0, s75, 18432
  v_mfma_f32_16x16x32_bf16 a[208:211], v[192:195], v[128:131], a[208:211]
  buffer_load_dwordx4 v16, s[16:19], s42 offen lds
  v_mfma_f32_16x16x32_bf16 a[240:243], v[192:195], v[132:135], a[240:243]
  v_mfma_f32_16x16x32_bf16 v[216:219], v[192:195], v[136:139], v[216:219]
  ds_read_b64_tr_b16 v[192:193], v24 offset:24576
  v_mfma_f32_16x16x32_bf16 a[20:23], v[196:199], v[104:107], a[20:23]
  ds_read_b64_tr_b16 v[194:195], v24 offset:25600
  v_mfma_f32_16x16x32_bf16 a[52:55], v[196:199], v[108:111], a[52:55]
  s_add_u32 m0, s75, 19456
  v_mfma_f32_16x16x32_bf16 a[84:87], v[196:199], v[112:115], a[84:87]
  buffer_load_dwordx4 v17, s[16:19], s42 offen lds
  v_mfma_f32_16x16x32_bf16 a[116:119], v[196:199], v[116:119], a[116:119]
  v_mfma_f32_16x16x32_bf16 a[148:151], v[196:199], v[120:123], a[148:151]
  s_add_u32 m0, s75, 20480
  v_mfma_f32_16x16x32_bf16 a[180:183], v[196:199], v[124:127], a[180:183]
  buffer_load_dwordx4 v18, s[16:19], s42 offen lds
  v_mfma_f32_16x16x32_bf16 a[212:215], v[196:199], v[128:131], a[212:215]
  v_mfma_f32_16x16x32_bf16 a[244:247], v[196:199], v[132:135], a[244:247]
  v_mfma_f32_16x16x32_bf16 v[220:223], v[196:199], v[136:139], v[220:223]
  ds_read_b64_tr_b16 v[196:197], v24 offset:24584
  v_mfma_f32_16x16x32_bf16 a[24:27], v[232:235], v[104:107], a[24:27]
  ds_read_b64_tr_b16 v[198:199], v24 offset:25608
  s_add_u32 m0, s75, 21504
  v_mfma_f32_16x16x32_bf16 a[56:59], v[232:235], v[108:111], a[56:59]
  buffer_load_dwordx4 v19, s[16:19], s42 offen lds
  v_mfma_f32_16x16x32_bf16 a[88:91], v[232:235], v[112:115], a[88:91]
  v_mfma_f32_16x16x32_bf16 a[120:123], v[232:235], v[116:119], a[120:123]
  s_add_u32 m0, s75, 22528
  v_mfma_f32_16x16x32_bf16 a[152:155], v[232:235], v[120:123], a[152:155]
  buffer_load_dwordx4 v20, s[16:19], s42 offen lds
  v_mfma_f32_16x16x32_bf16 a[184:187], v[232:235], v[124:127], a[184:187]
  v_mfma_f32_16x16x32_bf16 a[216:219], v[232:235], v[128:131], a[216:219]
  s_add_u32 m0, s75, 23552
  v_mfma_f32_16x16x32_bf16 a[248:251], v[232:235], v[132:135], a[248:251]
  buffer_load_dwordx4 v21, s[16:19], s42 offen lds
  v_mfma_f32_16x16x32_bf16 v[224:227], v[232:235], v[136:139], v[224:227]
  ds_read_b64_tr_b16 v[232:233], v25 offset:24576
  v_mfma_f32_16x16x32_bf16 a[28:31], v[236:239], v[104:107], a[28:31]
  ds_read_b64_tr_b16 v[234:235], v25 offset:25600
  v_mfma_f32_16x16x32_bf16 a[60:63], v[236:239], v[108:111], a[60:63]
  v_mfma_f32_16x16x32_bf16 a[92:95], v[236:239], v[112:115], a[92:95]
  v_mfma_f32_16x16x32_bf16 a[124:127], v[236:239], v[116:119], a[124:127]
  s_add_u32 s37, s37, 65536
  v_mfma_f32_16x16x32_bf16 a[156:159], v[236:239], v[120:123], a[156:159]
  v_mfma_f32_16x16x32_bf16 a[188:191], v[236:239], v[124:127], a[188:191]
  v_mfma_f32_16x16x32_bf16 a[220:223], v[236:239], v[128:131], a[220:223]
  v_mfma_f32_16x16x32_bf16 a[252:255], v[236:239], v[132:135], a[252:255]
  v_mfma_f32_16x16x32_bf16 v[228:231], v[236:239], v[136:139], v[228:231]
  ds_read_b64_tr_b16 v[236:237], v25 offset:24584
  s_waitcnt lgkmcnt(7)
  ds_read_b64_tr_b16 v[238:239], v25 offset:25608
  s_waitcnt vmcnt(34)
  v_mfma_f32_16x16x32_bf16 a[0:3], v[176:179], v[140:143], a[0:3]
  s_cmp_lt_u32 s36, s38
  s_cselect_b32 s41, s36, 1179648
  buffer_load_dwordx4 v[104:107], v10, s[12:15], s41 offen offset:0
  v_mfma_f32_16x16x32_bf16 a[32:35], v[176:179], v[144:147], a[32:35]
  v_mfma_f32_16x16x32_bf16 a[64:67], v[176:179], v[148:151], a[64:67]
  v_mfma_f32_16x16x32_bf16 a[96:99], v[176:179], v[152:155], a[96:99]
  buffer_load_dwordx4 v[108:111], v10, s[12:15], s41 offen offset:1024
  v_mfma_f32_16x16x32_bf16 a[128:131], v[176:179], v[156:159], a[128:131]
  v_mfma_f32_16x16x32_bf16 a[160:163], v[176:179], v[160:163], a[160:163]
  v_mfma_f32_16x16x32_bf16 a[192:195], v[176:179], v[164:167], a[192:195]
  s_waitcnt lgkmcnt(0)
  v_mfma_f32_16x16x32_bf16 a[224:227], v[176:179], v[168:171], a[224:227]
  buffer_load_dwordx4 v[112:115], v10, s[12:15], s41 offen offset:2048
  v_mfma_f32_16x16x32_bf16 v[200:203], v[176:179], v[172:175], v[200:203]
  ds_read_b64_tr_b16 v[176:177], v22 offset:0
  v_mfma_f32_16x16x32_bf16 a[4:7], v[180:183], v[140:143], a[4:7]
  ds_read_b64_tr_b16 v[178:179], v22 offset:1024
  v_mfma_f32_16x16x32_bf16 a[36:39], v[180:183], v[144:147], a[36:39]
  v_mfma_f32_16x16x32_bf16 a[68:71], v[180:183], v[148:151], a[68:71]
  v_mfma_f32_16x16x32_bf16 a[100:103], v[180:183], v[152:155], a[100:103]
  buffer_load_dwordx4 v[116:119], v10, s[12:15], s41 offen offset:3072
  v_mfma_f32_16x16x32_bf16 a[132:135], v[180:183], v[156:159], a[132:135]
  v_mfma_f32_16x16x32_bf16 a[164:167], v[180:183], v[160:163], a[164:167]
  v_mfma_f32_16x16x32_bf16 a[196:199], v[180:183], v[164:167], a[196:199]
  buffer_load_dwordx4 v[120:123], v11, s[12:15], s41 offen offset:0
  v_mfma_f32_16x16x32_bf16 a[228:231], v[180:183], v[168:171], a[228:231]
  v_mfma_f32_16x16x32_bf16 v[204:207], v[180:183], v[172:175], v[204:207]
  ds_read_b64_tr_b16 v[180:181], v22 offset:8
  v_mfma_f32_16x16x32_bf16 a[8:11], v[184:187], v[140:143], a[8:11]
  ds_read_b64_tr_b16 v[182:183], v22 offset:1032
  v_mfma_f32_16x16x32_bf16 a[40:43], v[184:187], v[144:147], a[40:43]
  v_mfma_f32_16x16x32_bf16 a[72:75], v[184:187], v[148:151], a[72:75]
  buffer_load_dwordx4 v[124:127], v11, s[12:15], s41 offen offset:1024
  v_mfma_f32_16x16x32_bf16 a[104:107], v[184:187], v[152:155], a[104:107]
  v_mfma_f32_16x16x32_bf16 a[136:139], v[184:187], v[156:159], a[136:139]
  v_mfma_f32_16x16x32_bf16 a[168:171], v[184:187], v[160:163], a[168:171]
  buffer_load_dwordx4 v[128:131], v11, s[12:15], s41 offen offset:2048
  v_mfma_f32_16x16x32_bf16 a[200:203], v[184:187], v[164:167], a[200:203]
  v_mfma_f32_16x16x32_bf16 a[232:235], v[184:187], v[168:171], a[232:235]
  v_mfma_f32_16x16x32_bf16 v[208:211], v[184:187], v[172:175], v[208:211]
  ds_read_b64_tr_b16 v[184:185], v23 offset:0
  v_mfma_f32_16x16x32_bf16 a[12:15], v[188:191], v[140:143], a[12:15]
  ds_read_b64_tr_b16 v[186:187], v23 offset:1024
  v_mfma_f32_16x16x32_bf16 a[44:47], v[188:191], v[144:147], a[44:47]
  buffer_load_dwordx4 v[132:135], v11, s[12:15], s41 offen offset:3072
  v_mfma_f32_16x16x32_bf16 a[76:79], v[188:191], v[148:151], a[76:79]
  v_mfma_f32_16x16x32_bf16 a[108:111], v[188:191], v[152:155], a[108:111]
  v_mfma_f32_16x16x32_bf16 a[140:143], v[188:191], v[156:159], a[140:143]
  buffer_load_dwordx4 v[136:139], v12, s[12:15], s41 offen offset:0
  v_mfma_f32_16x16x32_bf16 a[172:175], v[188:191], v[160:163], a[172:175]
  v_mfma_f32_16x16x32_bf16 a[204:207], v[188:191], v[164:167], a[204:207]
  s_add_u32 m0, s75, 24576
  v_mfma_f32_16x16x32_bf16 a[236:239], v[188:191], v[168:171], a[236:239]
  s_add_u32 s36, s36, 9216
  s_cmp_lt_u32 s37, s39
  s_cselect_b32 s42, s37, 8388608
  buffer_load_dwordx4 v14, s[16:19], s42 offen lds
  v_mfma_f32_16x16x32_bf16 v[212:215], v[188:191], v[172:175], v[212:215]
  ds_read_b64_tr_b16 v[188:189], v23 offset:8
  v_mfma_f32_16x16x32_bf16 a[16:19], v[192:195], v[140:143], a[16:19]
  ds_read_b64_tr_b16 v[190:191], v23 offset:1032
  v_mfma_f32_16x16x32_bf16 a[48:51], v[192:195], v[144:147], a[48:51]
  v_mfma_f32_16x16x32_bf16 a[80:83], v[192:195], v[148:151], a[80:83]
  s_add_u32 m0, s75, 25600
  v_mfma_f32_16x16x32_bf16 a[112:115], v[192:195], v[152:155], a[112:115]
  buffer_load_dwordx4 v15, s[16:19], s42 offen lds
  v_mfma_f32_16x16x32_bf16 a[144:147], v[192:195], v[156:159], a[144:147]
  v_mfma_f32_16x16x32_bf16 a[176:179], v[192:195], v[160:163], a[176:179]
  s_add_u32 m0, s75, 26624
  v_mfma_f32_16x16x32_bf16 a[208:211], v[192:195], v[164:167], a[208:211]
  buffer_load_dwordx4 v16, s[16:19], s42 offen lds
  v_mfma_f32_16x16x32_bf16 a[240:243], v[192:195], v[168:171], a[240:243]
  v_mfma_f32_16x16x32_bf16 v[216:219], v[192:195], v[172:175], v[216:219]
  ds_read_b64_tr_b16 v[192:193], v24 offset:0
  v_mfma_f32_16x16x32_bf16 a[20:23], v[196:199], v[140:143], a[20:23]
  ds_read_b64_tr_b16 v[194:195], v24 offset:1024
  v_mfma_f32_16x16x32_bf16 a[52:55], v[196:199], v[144:147], a[52:55]
  s_add_u32 m0, s75, 27648
  v_mfma_f32_16x16x32_bf16 a[84:87], v[196:199], v[148:151], a[84:87]
  buffer_load_dwordx4 v17, s[16:19], s42 offen lds
  v_mfma_f32_16x16x32_bf16 a[116:119], v[196:199], v[152:155], a[116:119]
  v_mfma_f32_16x16x32_bf16 a[148:151], v[196:199], v[156:159], a[148:151]
  s_add_u32 m0, s75, 28672
  v_mfma_f32_16x16x32_bf16 a[180:183], v[196:199], v[160:163], a[180:183]
  buffer_load_dwordx4 v18, s[16:19], s42 offen lds
  v_mfma_f32_16x16x32_bf16 a[212:215], v[196:199], v[164:167], a[212:215]
  v_mfma_f32_16x16x32_bf16 a[244:247], v[196:199], v[168:171], a[244:247]
  v_mfma_f32_16x16x32_bf16 v[220:223], v[196:199], v[172:175], v[220:223]
  ds_read_b64_tr_b16 v[196:197], v24 offset:8
  v_mfma_f32_16x16x32_bf16 a[24:27], v[232:235], v[140:143], a[24:27]
  ds_read_b64_tr_b16 v[198:199], v24 offset:1032
  s_add_u32 m0, s75, 29696
  v_mfma_f32_16x16x32_bf16 a[56:59], v[232:235], v[144:147], a[56:59]
  buffer_load_dwordx4 v19, s[16:19], s42 offen lds
  v_mfma_f32_16x16x32_bf16 a[88:91], v[232:235], v[148:151], a[88:91]
  v_mfma_f32_16x16x32_bf16 a[120:123], v[232:235], v[152:155], a[120:123]
  s_add_u32 m0, s75, 30720
  v_mfma_f32_16x16x32_bf16 a[152:155], v[232:235], v[156:159], a[152:155]
  buffer_load_dwordx4 v20, s[16:19], s42 offen lds
  v_mfma_f32_16x16x32_bf16 a[184:187], v[232:235], v[160:163], a[184:187]
  v_mfma_f32_16x16x32_bf16 a[216:219], v[232:235], v[164:167], a[216:219]
  s_add_u32 m0, s75, 31744
  v_mfma_f32_16x16x32_bf16 a[248:251], v[232:235], v[168:171], a[248:251]
  buffer_load_dwordx4 v21, s[16:19], s42 offen lds
  v_mfma_f32_16x16x32_bf16 v[224:227], v[232:235], v[172:175], v[224:227]
  ds_read_b64_tr_b16 v[232:233], v25 offset:0
  v_mfma_f32_16x16x32_bf16 a[28:31], v[236:239], v[140:143], a[28:31]
  ds_read_b64_tr_b16 v[234:235], v25 offset:1024
  v_mfma_f32_16x16x32_bf16 a[60:63], v[236:239], v[144:147], a[60:63]
  v_mfma_f32_16x16x32_bf16 a[92:95], v[236:239], v[148:151], a[92:95]
  v_mfma_f32_16x16x32_bf16 a[124:127], v[236:239], v[152:155], a[124:127]
  s_add_u32 s37, s37, 65536
  v_mfma_f32_16x16x32_bf16 a[156:159], v[236:239], v[156:159], a[156:159]
  v_mfma_f32_16x16x32_bf16 a[188:191], v[236:239], v[160:163], a[188:191]
  v_mfma_f32_16x16x32_bf16 a[220:223], v[236:239], v[164:167], a[220:223]
  v_mfma_f32_16x16x32_bf16 a[252:255], v[236:239], v[168:171], a[252:255]
  v_mfma_f32_16x16x32_bf16 v[228:231], v[236:239], v[172:175], v[228:231]
  ds_read_b64_tr_b16 v[236:237], v25 offset:8
  s_waitcnt lgkmcnt(7)
  ds_read_b64_tr_b16 v[238:239], v25 offset:1032
  s_sub_u32 s31, s31, 1
  s_cmp_lg_u32 s31, 0
  s_cbranch_scc1 oproj_kernel_loop
  s_waitcnt vmcnt(0) lgkmcnt(0)
  s_nop 7
  s_barrier
  v_lshlrev_b32 v3, 4, v2
  s_xor_b32 s32, s24, 1
  s_mul_i32 s32, s32, 30720
  s_add_u32 s32, s32, 0
  v_add_u32 v4, s32, v3
  s_xor_b32 s32, s24, 2
  s_mul_i32 s32, s32, 30720
  s_add_u32 s32, s32, 10240
  v_add_u32 v5, s32, v3
  s_xor_b32 s32, s24, 3
  s_mul_i32 s32, s32, 30720
  s_add_u32 s32, s32, 20480
  v_add_u32 v6, s32, v3
  ds_write_b128 v4, a[8:11] offset:0
  ds_write_b128 v4, a[12:15] offset:1024
  ds_write_b128 v4, a[40:43] offset:2048
  ds_write_b128 v4, a[44:47] offset:3072
  ds_write_b128 v4, a[72:75] offset:4096
  ds_write_b128 v4, a[76:79] offset:5120
  ds_write_b128 v4, a[104:107] offset:6144
  ds_write_b128 v4, a[108:111] offset:7168
  ds_write_b128 v4, a[136:139] offset:8192
  ds_write_b128 v4, a[140:143] offset:9216
  ds_write_b128 v5, a[16:19] offset:0
  ds_write_b128 v5, a[20:23] offset:1024
  ds_write_b128 v5, a[48:51] offset:2048
  ds_write_b128 v5, a[52:55] offset:3072
  ds_write_b128 v5, a[80:83] offset:4096
  s_waitcnt lgkmcnt(14)
  ds_write_b128 v5, a[84:87] offset:5120
  s_waitcnt lgkmcnt(14)
  ds_write_b128 v5, a[112:115] offset:6144
  s_waitcnt lgkmcnt(14)
  ds_write_b128 v5, a[116:119] offset:7168
  s_waitcnt lgkmcnt(14)
  ds_write_b128 v5, a[144:147] offset:8192
  s_waitcnt lgkmcnt(14)
  ds_write_b128 v5, a[148:151] offset:9216
  s_waitcnt lgkmcnt(14)
  ds_write_b128 v6, a[24:27] offset:0
  s_waitcnt lgkmcnt(14)
  ds_write_b128 v6, a[28:31] offset:1024
  s_waitcnt lgkmcnt(14)
  ds_write_b128 v6, a[56:59] offset:2048
  s_waitcnt lgkmcnt(14)
  ds_write_b128 v6, a[60:63] offset:3072
  s_waitcnt lgkmcnt(14)
  ds_write_b128 v6, a[88:91] offset:4096
  s_waitcnt lgkmcnt(14)
  ds_write_b128 v6, a[92:95] offset:5120
  s_waitcnt lgkmcnt(14)
  ds_write_b128 v6, a[120:123] offset:6144
  s_waitcnt lgkmcnt(14)
  ds_write_b128 v6, a[124:127] offset:7168
  s_waitcnt lgkmcnt(14)
  ds_write_b128 v6, a[152:155] offset:8192
  s_waitcnt lgkmcnt(14)
  ds_write_b128 v6, a[156:159] offset:9216
  v_accvgpr_read_b32 v32, a0
  v_accvgpr_read_b32 v33, a1
  v_accvgpr_read_b32 v34, a2
  v_accvgpr_read_b32 v35, a3
  v_accvgpr_read_b32 v36, a4
  v_accvgpr_read_b32 v37, a5
  v_accvgpr_read_b32 v38, a6
  v_accvgpr_read_b32 v39, a7
  v_accvgpr_read_b32 v40, a32
  v_accvgpr_read_b32 v41, a33
  v_accvgpr_read_b32 v42, a34
  v_accvgpr_read_b32 v43, a35
  v_accvgpr_read_b32 v44, a36
  v_accvgpr_read_b32 v45, a37
  v_accvgpr_read_b32 v46, a38
  v_accvgpr_read_b32 v47, a39
  v_accvgpr_read_b32 v48, a64
  v_accvgpr_read_b32 v49, a65
  v_accvgpr_read_b32 v50, a66
  v_accvgpr_read_b32 v51, a67
  v_accvgpr_read_b32 v52, a68
  v_accvgpr_read_b32 v53, a69
  v_accvgpr_read_b32 v54, a70
  v_accvgpr_read_b32 v55, a71
  v_accvgpr_read_b32 v56, a96
  v_accvgpr_read_b32 v57, a97
  v_accvgpr_read_b32 v58, a98
  v_accvgpr_read_b32 v59, a99
  v_accvgpr_read_b32 v60, a100
  v_accvgpr_read_b32 v61, a101
  v_accvgpr_read_b32 v62, a102
  v_accvgpr_read_b32 v63, a103
  v_accvgpr_read_b32 v64, a128
  v_accvgpr_read_b32 v65, a129
  v_accvgpr_read_b32 v66, a130
  v_accvgpr_read_b32 v67, a131
  v_accvgpr_read_b32 v68, a132
  v_accvgpr_read_b32 v69, a133
  v_accvgpr_read_b32 v70, a134
  v_accvgpr_read_b32 v71, a135
  v_accvgpr_read_b32 v72, a160
  v_accvgpr_read_b32 v73, a161
  v_accvgpr_read_b32 v74, a162
  v_accvgpr_read_b32 v75, a163
  v_accvgpr_read_b32 v76, a164
  v_accvgpr_read_b32 v77, a165
  v_accvgpr_read_b32 v78, a166
  v_accvgpr_read_b32 v79, a167
  v_accvgpr_read_b32 v80, a192
  v_accvgpr_read_b32 v81, a193
  v_accvgpr_read_b32 v82, a194
  v_accvgpr_read_b32 v83, a195
  v_accvgpr_read_b32 v84, a196
  v_accvgpr_read_b32 v85, a197
  v_accvgpr_read_b32 v86, a198
  v_accvgpr_read_b32 v87, a199
  v_accvgpr_read_b32 v88, a224
  v_accvgpr_read_b32 v89, a225
  v_accvgpr_read_b32 v90, a226
  v_accvgpr_read_b32 v91, a227
  v_accvgpr_read_b32 v92, a228
  v_accvgpr_read_b32 v93, a229
  v_accvgpr_read_b32 v94, a230
  v_accvgpr_read_b32 v95, a231
  v_mov_b32 v96, v200
  v_mov_b32 v97, v201
  v_mov_b32 v98, v202
  v_mov_b32 v99, v203
  v_mov_b32 v100, v204
  v_mov_b32 v101, v205
  v_mov_b32 v102, v206
  v_mov_b32 v103, v207
  s_mul_i32 s32, s24, 30720
  v_add_u32 v7, s32, v3
  s_waitcnt lgkmcnt(0)
  s_barrier
  ds_read_b128 v[104:107], v7 offset:0
  ds_read_b128 v[108:111], v7 offset:1024
  ds_read_b128 v[112:115], v7 offset:10240
  ds_read_b128 v[116:119], v7 offset:11264
  ds_read_b128 v[120:123], v7 offset:20480
  ds_read_b128 v[124:127], v7 offset:21504
  s_waitcnt lgkmcnt(5)
  v_add_f32 v32, v32, v104
  v_add_f32 v33, v33, v105
  v_add_f32 v34, v34, v106
  v_add_f32 v35, v35, v107
  s_waitcnt lgkmcnt(4)
  v_add_f32 v36, v36, v108
  v_add_f32 v37, v37, v109
  v_add_f32 v38, v38, v110
  v_add_f32 v39, v39, v111
  s_waitcnt lgkmcnt(3)
  v_add_f32 v32, v32, v112
  v_add_f32 v33, v33, v113
  v_add_f32 v34, v34, v114
  v_add_f32 v35, v35, v115
  s_waitcnt lgkmcnt(2)
  v_add_f32 v36, v36, v116
  v_add_f32 v37, v37, v117
  v_add_f32 v38, v38, v118
  v_add_f32 v39, v39, v119
  s_waitcnt lgkmcnt(1)
  v_add_f32 v32, v32, v120
  v_add_f32 v33, v33, v121
  v_add_f32 v34, v34, v122
  v_add_f32 v35, v35, v123
  s_waitcnt lgkmcnt(0)
  v_add_f32 v36, v36, v124
  v_add_f32 v37, v37, v125
  v_add_f32 v38, v38, v126
  v_add_f32 v39, v39, v127
  ds_read_b128 v[128:131], v7 offset:2048
  ds_read_b128 v[132:135], v7 offset:3072
  ds_read_b128 v[136:139], v7 offset:12288
  ds_read_b128 v[140:143], v7 offset:13312
  ds_read_b128 v[144:147], v7 offset:22528
  ds_read_b128 v[148:151], v7 offset:23552
  s_waitcnt lgkmcnt(5)
  v_add_f32 v40, v40, v128
  v_add_f32 v41, v41, v129
  v_add_f32 v42, v42, v130
  v_add_f32 v43, v43, v131
  s_waitcnt lgkmcnt(4)
  v_add_f32 v44, v44, v132
  v_add_f32 v45, v45, v133
  v_add_f32 v46, v46, v134
  v_add_f32 v47, v47, v135
  s_waitcnt lgkmcnt(3)
  v_add_f32 v40, v40, v136
  v_add_f32 v41, v41, v137
  v_add_f32 v42, v42, v138
  v_add_f32 v43, v43, v139
  s_waitcnt lgkmcnt(2)
  v_add_f32 v44, v44, v140
  v_add_f32 v45, v45, v141
  v_add_f32 v46, v46, v142
  v_add_f32 v47, v47, v143
  s_waitcnt lgkmcnt(1)
  v_add_f32 v40, v40, v144
  v_add_f32 v41, v41, v145
  v_add_f32 v42, v42, v146
  v_add_f32 v43, v43, v147
  s_waitcnt lgkmcnt(0)
  v_add_f32 v44, v44, v148
  v_add_f32 v45, v45, v149
  v_add_f32 v46, v46, v150
  v_add_f32 v47, v47, v151
  ds_read_b128 v[152:155], v7 offset:4096
  ds_read_b128 v[156:159], v7 offset:5120
  ds_read_b128 v[160:163], v7 offset:14336
  ds_read_b128 v[164:167], v7 offset:15360
  ds_read_b128 v[168:171], v7 offset:24576
  ds_read_b128 v[172:175], v7 offset:25600
  s_waitcnt lgkmcnt(5)
  v_add_f32 v48, v48, v152
  v_add_f32 v49, v49, v153
  v_add_f32 v50, v50, v154
  v_add_f32 v51, v51, v155
  s_waitcnt lgkmcnt(4)
  v_add_f32 v52, v52, v156
  v_add_f32 v53, v53, v157
  v_add_f32 v54, v54, v158
  v_add_f32 v55, v55, v159
  s_waitcnt lgkmcnt(3)
  v_add_f32 v48, v48, v160
  v_add_f32 v49, v49, v161
  v_add_f32 v50, v50, v162
  v_add_f32 v51, v51, v163
  s_waitcnt lgkmcnt(2)
  v_add_f32 v52, v52, v164
  v_add_f32 v53, v53, v165
  v_add_f32 v54, v54, v166
  v_add_f32 v55, v55, v167
  s_waitcnt lgkmcnt(1)
  v_add_f32 v48, v48, v168
  v_add_f32 v49, v49, v169
  v_add_f32 v50, v50, v170
  v_add_f32 v51, v51, v171
  s_waitcnt lgkmcnt(0)
  v_add_f32 v52, v52, v172
  v_add_f32 v53, v53, v173
  v_add_f32 v54, v54, v174
  v_add_f32 v55, v55, v175
  ds_read_b128 v[104:107], v7 offset:6144
  ds_read_b128 v[108:111], v7 offset:7168
  ds_read_b128 v[112:115], v7 offset:16384
  ds_read_b128 v[116:119], v7 offset:17408
  ds_read_b128 v[120:123], v7 offset:26624
  ds_read_b128 v[124:127], v7 offset:27648
  s_waitcnt lgkmcnt(5)
  v_add_f32 v56, v56, v104
  v_add_f32 v57, v57, v105
  v_add_f32 v58, v58, v106
  v_add_f32 v59, v59, v107
  s_waitcnt lgkmcnt(4)
  v_add_f32 v60, v60, v108
  v_add_f32 v61, v61, v109
  v_add_f32 v62, v62, v110
  v_add_f32 v63, v63, v111
  s_waitcnt lgkmcnt(3)
  v_add_f32 v56, v56, v112
  v_add_f32 v57, v57, v113
  v_add_f32 v58, v58, v114
  v_add_f32 v59, v59, v115
  s_waitcnt lgkmcnt(2)
  v_add_f32 v60, v60, v116
  v_add_f32 v61, v61, v117
  v_add_f32 v62, v62, v118
  v_add_f32 v63, v63, v119
  s_waitcnt lgkmcnt(1)
  v_add_f32 v56, v56, v120
  v_add_f32 v57, v57, v121
  v_add_f32 v58, v58, v122
  v_add_f32 v59, v59, v123
  s_waitcnt lgkmcnt(0)
  v_add_f32 v60, v60, v124
  v_add_f32 v61, v61, v125
  v_add_f32 v62, v62, v126
  v_add_f32 v63, v63, v127
  ds_read_b128 v[128:131], v7 offset:8192
  ds_read_b128 v[132:135], v7 offset:9216
  ds_read_b128 v[136:139], v7 offset:18432
  ds_read_b128 v[140:143], v7 offset:19456
  ds_read_b128 v[144:147], v7 offset:28672
  ds_read_b128 v[148:151], v7 offset:29696
  s_waitcnt lgkmcnt(5)
  v_add_f32 v64, v64, v128
  v_add_f32 v65, v65, v129
  v_add_f32 v66, v66, v130
  v_add_f32 v67, v67, v131
  s_waitcnt lgkmcnt(4)
  v_add_f32 v68, v68, v132
  v_add_f32 v69, v69, v133
  v_add_f32 v70, v70, v134
  v_add_f32 v71, v71, v135
  s_waitcnt lgkmcnt(3)
  v_add_f32 v64, v64, v136
  v_add_f32 v65, v65, v137
  v_add_f32 v66, v66, v138
  v_add_f32 v67, v67, v139
  s_waitcnt lgkmcnt(2)
  v_add_f32 v68, v68, v140
  v_add_f32 v69, v69, v141
  v_add_f32 v70, v70, v142
  v_add_f32 v71, v71, v143
  s_waitcnt lgkmcnt(1)
  v_add_f32 v64, v64, v144
  v_add_f32 v65, v65, v145
  v_add_f32 v66, v66, v146
  v_add_f32 v67, v67, v147
  s_waitcnt lgkmcnt(0)
  v_add_f32 v68, v68, v148
  v_add_f32 v69, v69, v149
  v_add_f32 v70, v70, v150
  v_add_f32 v71, v71, v151
  s_waitcnt lgkmcnt(0)
  s_barrier
  s_xor_b32 s32, s24, 1
  s_mul_i32 s32, s32, 24576
  s_add_u32 s32, s32, 0
  v_add_u32 v4, s32, v3
  s_xor_b32 s32, s24, 2
  s_mul_i32 s32, s32, 24576
  s_add_u32 s32, s32, 8192
  v_add_u32 v5, s32, v3
  s_xor_b32 s32, s24, 3
  s_mul_i32 s32, s32, 24576
  s_add_u32 s32, s32, 16384
  v_add_u32 v6, s32, v3
  ds_write_b128 v4, a[168:171] offset:0
  ds_write_b128 v4, a[172:175] offset:1024
  ds_write_b128 v4, a[200:203] offset:2048
  ds_write_b128 v4, a[204:207] offset:3072
  ds_write_b128 v4, a[232:235] offset:4096
  ds_write_b128 v4, a[236:239] offset:5120
  ds_write_b128 v4, v[208:211] offset:6144
  ds_write_b128 v4, v[212:215] offset:7168
  ds_write_b128 v5, a[176:179] offset:0
  ds_write_b128 v5, a[180:183] offset:1024
  ds_write_b128 v5, a[208:211] offset:2048
  ds_write_b128 v5, a[212:215] offset:3072
  ds_write_b128 v5, a[240:243] offset:4096
  ds_write_b128 v5, a[244:247] offset:5120
  ds_write_b128 v5, v[216:219] offset:6144
  s_waitcnt lgkmcnt(14)
  ds_write_b128 v5, v[220:223] offset:7168
  s_waitcnt lgkmcnt(14)
  ds_write_b128 v6, a[184:187] offset:0
  s_waitcnt lgkmcnt(14)
  ds_write_b128 v6, a[188:191] offset:1024
  s_waitcnt lgkmcnt(14)
  ds_write_b128 v6, a[216:219] offset:2048
  s_waitcnt lgkmcnt(14)
  ds_write_b128 v6, a[220:223] offset:3072
  s_waitcnt lgkmcnt(14)
  ds_write_b128 v6, a[248:251] offset:4096
  s_waitcnt lgkmcnt(14)
  ds_write_b128 v6, a[252:255] offset:5120
  s_waitcnt lgkmcnt(14)
  ds_write_b128 v6, v[224:227] offset:6144
  s_waitcnt lgkmcnt(14)
  ds_write_b128 v6, v[228:231] offset:7168
  s_mul_i32 s32, s24, 24576
  v_add_u32 v7, s32, v3
  s_waitcnt lgkmcnt(0)
  s_barrier
  ds_read_b128 v[104:107], v7 offset:0
  ds_read_b128 v[108:111], v7 offset:1024
  ds_read_b128 v[112:115], v7 offset:8192
  ds_read_b128 v[116:119], v7 offset:9216
  ds_read_b128 v[120:123], v7 offset:16384
  ds_read_b128 v[124:127], v7 offset:17408
  s_waitcnt lgkmcnt(5)
  v_add_f32 v72, v72, v104
  v_add_f32 v73, v73, v105
  v_add_f32 v74, v74, v106
  v_add_f32 v75, v75, v107
  s_waitcnt lgkmcnt(4)
  v_add_f32 v76, v76, v108
  v_add_f32 v77, v77, v109
  v_add_f32 v78, v78, v110
  v_add_f32 v79, v79, v111
  s_waitcnt lgkmcnt(3)
  v_add_f32 v72, v72, v112
  v_add_f32 v73, v73, v113
  v_add_f32 v74, v74, v114
  v_add_f32 v75, v75, v115
  s_waitcnt lgkmcnt(2)
  v_add_f32 v76, v76, v116
  v_add_f32 v77, v77, v117
  v_add_f32 v78, v78, v118
  v_add_f32 v79, v79, v119
  s_waitcnt lgkmcnt(1)
  v_add_f32 v72, v72, v120
  v_add_f32 v73, v73, v121
  v_add_f32 v74, v74, v122
  v_add_f32 v75, v75, v123
  s_waitcnt lgkmcnt(0)
  v_add_f32 v76, v76, v124
  v_add_f32 v77, v77, v125
  v_add_f32 v78, v78, v126
  v_add_f32 v79, v79, v127
  ds_read_b128 v[128:131], v7 offset:2048
  ds_read_b128 v[132:135], v7 offset:3072
  ds_read_b128 v[136:139], v7 offset:10240
  ds_read_b128 v[140:143], v7 offset:11264
  ds_read_b128 v[144:147], v7 offset:18432
  ds_read_b128 v[148:151], v7 offset:19456
  s_waitcnt lgkmcnt(5)
  v_add_f32 v80, v80, v128
  v_add_f32 v81, v81, v129
  v_add_f32 v82, v82, v130
  v_add_f32 v83, v83, v131
  s_waitcnt lgkmcnt(4)
  v_add_f32 v84, v84, v132
  v_add_f32 v85, v85, v133
  v_add_f32 v86, v86, v134
  v_add_f32 v87, v87, v135
  s_waitcnt lgkmcnt(3)
  v_add_f32 v80, v80, v136
  v_add_f32 v81, v81, v137
  v_add_f32 v82, v82, v138
  v_add_f32 v83, v83, v139
  s_waitcnt lgkmcnt(2)
  v_add_f32 v84, v84, v140
  v_add_f32 v85, v85, v141
  v_add_f32 v86, v86, v142
  v_add_f32 v87, v87, v143
  s_waitcnt lgkmcnt(1)
  v_add_f32 v80, v80, v144
  v_add_f32 v81, v81, v145
  v_add_f32 v82, v82, v146
  v_add_f32 v83, v83, v147
  s_waitcnt lgkmcnt(0)
  v_add_f32 v84, v84, v148
  v_add_f32 v85, v85, v149
  v_add_f32 v86, v86, v150
  v_add_f32 v87, v87, v151
  ds_read_b128 v[152:155], v7 offset:4096
  ds_read_b128 v[156:159], v7 offset:5120
  ds_read_b128 v[160:163], v7 offset:12288
  ds_read_b128 v[164:167], v7 offset:13312
  ds_read_b128 v[168:171], v7 offset:20480
  ds_read_b128 v[172:175], v7 offset:21504
  s_waitcnt lgkmcnt(5)
  v_add_f32 v88, v88, v152
  v_add_f32 v89, v89, v153
  v_add_f32 v90, v90, v154
  v_add_f32 v91, v91, v155
  s_waitcnt lgkmcnt(4)
  v_add_f32 v92, v92, v156
  v_add_f32 v93, v93, v157
  v_add_f32 v94, v94, v158
  v_add_f32 v95, v95, v159
  s_waitcnt lgkmcnt(3)
  v_add_f32 v88, v88, v160
  v_add_f32 v89, v89, v161
  v_add_f32 v90, v90, v162
  v_add_f32 v91, v91, v163
  s_waitcnt lgkmcnt(2)
  v_add_f32 v92, v92, v164
  v_add_f32 v93, v93, v165
  v_add_f32 v94, v94, v166
  v_add_f32 v95, v95, v167
  s_waitcnt lgkmcnt(1)
  v_add_f32 v88, v88, v168
  v_add_f32 v89, v89, v169
  v_add_f32 v90, v90, v170
  v_add_f32 v91, v91, v171
  s_waitcnt lgkmcnt(0)
  v_add_f32 v92, v92, v172
  v_add_f32 v93, v93, v173
  v_add_f32 v94, v94, v174
  v_add_f32 v95, v95, v175
  ds_read_b128 v[104:107], v7 offset:6144
  ds_read_b128 v[108:111], v7 offset:7168
  ds_read_b128 v[112:115], v7 offset:14336
  ds_read_b128 v[116:119], v7 offset:15360
  ds_read_b128 v[120:123], v7 offset:22528
  ds_read_b128 v[124:127], v7 offset:23552
  s_waitcnt lgkmcnt(5)
  v_add_f32 v96, v96, v104
  v_add_f32 v97, v97, v105
  v_add_f32 v98, v98, v106
  v_add_f32 v99, v99, v107
  s_waitcnt lgkmcnt(4)
  v_add_f32 v100, v100, v108
  v_add_f32 v101, v101, v109
  v_add_f32 v102, v102, v110
  v_add_f32 v103, v103, v111
  s_waitcnt lgkmcnt(3)
  v_add_f32 v96, v96, v112
  v_add_f32 v97, v97, v113
  v_add_f32 v98, v98, v114
  v_add_f32 v99, v99, v115
  s_waitcnt lgkmcnt(2)
  v_add_f32 v100, v100, v116
  v_add_f32 v101, v101, v117
  v_add_f32 v102, v102, v118
  v_add_f32 v103, v103, v119
  s_waitcnt lgkmcnt(1)
  v_add_f32 v96, v96, v120
  v_add_f32 v97, v97, v121
  v_add_f32 v98, v98, v122
  v_add_f32 v99, v99, v123
  s_waitcnt lgkmcnt(0)
  v_add_f32 v100, v100, v124
  v_add_f32 v101, v101, v125
  v_add_f32 v102, v102, v126
  v_add_f32 v103, v103, v127
  v_lshlrev_b32 v3, 4, v2
  s_lshl_b32 s32, s2, 1
  s_add_u32 s32, s32, s29
  s_mul_i32 s32, s32, 18432
  s_add_u32 s44, s4, s32
  s_addc_u32 s45, s5, 0
  s_add_u32 s44, s44, 33554432
  s_addc_u32 s45, s45, 0
  s_and_b32 s45, s45, 0xffff
  s_mov_b32 s46, 18432
  s_mov_b32 s47, 0x20000
  s_xor_b32 s33, s2, 8
  s_lshl_b32 s32, s33, 1
  s_add_u32 s32, s32, s29
  s_mul_i32 s32, s32, 18432
  s_add_u32 s56, s4, s32
  s_addc_u32 s57, s5, 0
  s_add_u32 s56, s56, 33554432
  s_addc_u32 s57, s57, 0
  s_and_b32 s57, s57, 0xffff
  s_mov_b32 s58, 18432
  s_mov_b32 s59, 0x20000
  s_cmp_eq_u32 s30, s28
  s_cbranch_scc1 oproj_kernel_keep
  s_mov_b32 s76, 0
  buffer_store_dwordx4 v[32:35], v3, s[44:47], s76 offen sc1
  s_mov_b32 s76, 1024
  buffer_store_dwordx4 v[36:39], v3, s[44:47], s76 offen sc1
  s_mov_b32 s76, 2048
  buffer_store_dwordx4 v[40:43], v3, s[44:47], s76 offen sc1
  s_mov_b32 s76, 3072
  buffer_store_dwordx4 v[44:47], v3, s[44:47], s76 offen sc1
  s_mov_b32 s76, 4096
  buffer_store_dwordx4 v[48:51], v3, s[44:47], s76 offen sc1
  s_mov_b32 s76, 5120
  buffer_store_dwordx4 v[52:55], v3, s[44:47], s76 offen sc1
  s_mov_b32 s76, 6144
  buffer_store_dwordx4 v[56:59], v3, s[44:47], s76 offen sc1
  s_mov_b32 s76, 7168
  buffer_store_dwordx4 v[60:63], v3, s[44:47], s76 offen sc1
  s_mov_b32 s76, 8192
  buffer_store_dwordx4 v[64:67], v3, s[44:47], s76 offen sc1
  s_mov_b32 s76, 9216
  buffer_store_dwordx4 v[68:71], v3, s[44:47], s76 offen sc1
  s_mov_b32 s76, 10240
  buffer_store_dwordx4 v[72:75], v3, s[44:47], s76 offen sc1
  s_mov_b32 s76, 11264
  buffer_store_dwordx4 v[76:79], v3, s[44:47], s76 offen sc1
  s_mov_b32 s76, 12288
  buffer_store_dwordx4 v[80:83], v3, s[44:47], s76 offen sc1
  s_mov_b32 s76, 13312
  buffer_store_dwordx4 v[84:87], v3, s[44:47], s76 offen sc1
  s_mov_b32 s76, 14336
  buffer_store_dwordx4 v[88:91], v3, s[44:47], s76 offen sc1
  s_mov_b32 s76, 15360
  buffer_store_dwordx4 v[92:95], v3, s[44:47], s76 offen sc1
  s_mov_b32 s76, 16384
  buffer_store_dwordx4 v[96:99], v3, s[44:47], s76 offen sc1
  s_mov_b32 s76, 17408
  buffer_store_dwordx4 v[100:103], v3, s[44:47], s76 offen sc1
  s_waitcnt vmcnt(0)
  s_xor_b32 s33, s2, 8
  s_lshl_b32 s33, s33, 7
  s_lshl_b32 s34, s29, 2
  s_add_u32 s33, s33, s34
  v_mov_b32 v6, s33
  v_mov_b32 v7, 1
  s_mov_b64 exec, 1
  global_store_dword v6, v7, s[52:53] sc1
  s_mov_b64 exec, -1
  s_branch oproj_kernel_sync
oproj_kernel_keep:
  s_lshl_b32 s33, s2, 7
  s_lshl_b32 s34, s29, 2
  s_add_u32 s33, s33, s34
  v_mov_b32 v6, s33
  s_mov_b32 s35, 0x100000
oproj_kernel_poll:
  global_load_dword v7, v6, s[52:53] sc1
  s_waitcnt vmcnt(0)
  v_readfirstlane_b32 s33, v7
  s_sub_u32 s35, s35, 1
  s_cmp_eq_u32 s33, 1
  s_cbranch_scc1 oproj_kernel_sync
  s_sleep 1
  s_cmp_lg_u32 s35, 0
  s_cbranch_scc1 oproj_kernel_poll
oproj_kernel_sync:
  s_barrier
  s_cmp_lg_u32 s30, s28
  s_cbranch_scc1 oproj_kernel_fin
  s_mov_b32 s76, 0
  buffer_load_dwordx4 v[104:107], v3, s[56:59], s76 offen sc1
  s_mov_b32 s76, 1024
  buffer_load_dwordx4 v[108:111], v3, s[56:59], s76 offen sc1
  s_mov_b32 s76, 2048
  buffer_load_dwordx4 v[112:115], v3, s[56:59], s76 offen sc1
  s_mov_b32 s76, 3072
  buffer_load_dwordx4 v[116:119], v3, s[56:59], s76 offen sc1
  s_mov_b32 s76, 4096
  buffer_load_dwordx4 v[120:123], v3, s[56:59], s76 offen sc1
  s_mov_b32 s76, 5120
  buffer_load_dwordx4 v[124:127], v3, s[56:59], s76 offen sc1
  s_mov_b32 s76, 6144
  buffer_load_dwordx4 v[128:131], v3, s[56:59], s76 offen sc1
  s_mov_b32 s76, 7168
  buffer_load_dwordx4 v[132:135], v3, s[56:59], s76 offen sc1
  s_mov_b32 s76, 8192
  buffer_load_dwordx4 v[136:139], v3, s[56:59], s76 offen sc1
  s_mov_b32 s76, 9216
  buffer_load_dwordx4 v[140:143], v3, s[56:59], s76 offen sc1
  s_mov_b32 s76, 10240
  buffer_load_dwordx4 v[144:147], v3, s[56:59], s76 offen sc1
  s_mov_b32 s76, 11264
  buffer_load_dwordx4 v[148:151], v3, s[56:59], s76 offen sc1
  s_mov_b32 s76, 12288
  buffer_load_dwordx4 v[152:155], v3, s[56:59], s76 offen sc1
  s_mov_b32 s76, 13312
  buffer_load_dwordx4 v[156:159], v3, s[56:59], s76 offen sc1
  s_mov_b32 s76, 14336
  buffer_load_dwordx4 v[160:163], v3, s[56:59], s76 offen sc1
  s_mov_b32 s76, 15360
  buffer_load_dwordx4 v[164:167], v3, s[56:59], s76 offen sc1
  s_mov_b32 s76, 16384
  buffer_load_dwordx4 v[168:171], v3, s[56:59], s76 offen sc1
  s_mov_b32 s76, 17408
  buffer_load_dwordx4 v[172:175], v3, s[56:59], s76 offen sc1
  s_mul_i32 s32, s26, 589824
  s_lshl_b32 s33, s25, 11
  s_add_u32 s32, s32, s33
  s_lshl_b32 s33, s27, 8
  s_add_u32 s32, s32, s33
  s_lshl_b32 s33, s24, 6
  s_add_u32 s32, s32, s33
  s_add_u32 s20, s6, s32
  s_addc_u32 s21, s7, 0
  s_and_b32 s21, s21, 0xffff
  s_sub_u32 s22, 4718592, s32
  s_mov_b32 s23, 0x20000
  v_and_b32 v9, 15, v2
  v_lshlrev_b32 v9, 12, v9
  v_lshrrev_b32 v21, 4, v2
  v_lshlrev_b32 v21, 4, v21
  v_add_u32 v9, v9, v21
  s_waitcnt vmcnt(16)
  v_add_f32 v32, v32, v104
  v_add_f32 v33, v33, v105
  v_add_f32 v34, v34, v106
  v_add_f32 v35, v35, v107
  v_add_f32 v36, v36, v108
  v_add_f32 v37, v37, v109
  v_add_f32 v38, v38, v110
  v_add_f32 v39, v39, v111
  v_cvt_pk_bf16_f32 v208, v32, v33
  v_cvt_pk_bf16_f32 v209, v34, v35
  v_cvt_pk_bf16_f32 v210, v36, v37
  v_cvt_pk_bf16_f32 v211, v38, v39
  s_mov_b32 s33, 0
  buffer_store_dwordx4 v[208:211], v9, s[20:23], s33 offen sc1
  s_waitcnt vmcnt(15)
  v_add_f32 v40, v40, v112
  v_add_f32 v41, v41, v113
  v_add_f32 v42, v42, v114
  v_add_f32 v43, v43, v115
  v_add_f32 v44, v44, v116
  v_add_f32 v45, v45, v117
  v_add_f32 v46, v46, v118
  v_add_f32 v47, v47, v119
  v_cvt_pk_bf16_f32 v212, v40, v41
  v_cvt_pk_bf16_f32 v213, v42, v43
  v_cvt_pk_bf16_f32 v214, v44, v45
  v_cvt_pk_bf16_f32 v215, v46, v47
  s_mov_b32 s33, 65536
  buffer_store_dwordx4 v[212:215], v9, s[20:23], s33 offen sc1
  s_waitcnt vmcnt(14)
  v_add_f32 v48, v48, v120
  v_add_f32 v49, v49, v121
  v_add_f32 v50, v50, v122
  v_add_f32 v51, v51, v123
  v_add_f32 v52, v52, v124
  v_add_f32 v53, v53, v125
  v_add_f32 v54, v54, v126
  v_add_f32 v55, v55, v127
  v_cvt_pk_bf16_f32 v216, v48, v49
  v_cvt_pk_bf16_f32 v217, v50, v51
  v_cvt_pk_bf16_f32 v218, v52, v53
  v_cvt_pk_bf16_f32 v219, v54, v55
  s_mov_b32 s33, 131072
  buffer_store_dwordx4 v[216:219], v9, s[20:23], s33 offen sc1
  s_waitcnt vmcnt(13)
  v_add_f32 v56, v56, v128
  v_add_f32 v57, v57, v129
  v_add_f32 v58, v58, v130
  v_add_f32 v59, v59, v131
  v_add_f32 v60, v60, v132
  v_add_f32 v61, v61, v133
  v_add_f32 v62, v62, v134
  v_add_f32 v63, v63, v135
  v_cvt_pk_bf16_f32 v208, v56, v57
  v_cvt_pk_bf16_f32 v209, v58, v59
  v_cvt_pk_bf16_f32 v210, v60, v61
  v_cvt_pk_bf16_f32 v211, v62, v63
  s_mov_b32 s33, 196608
  buffer_store_dwordx4 v[208:211], v9, s[20:23], s33 offen sc1
  s_waitcnt vmcnt(12)
  v_add_f32 v64, v64, v136
  v_add_f32 v65, v65, v137
  v_add_f32 v66, v66, v138
  v_add_f32 v67, v67, v139
  v_add_f32 v68, v68, v140
  v_add_f32 v69, v69, v141
  v_add_f32 v70, v70, v142
  v_add_f32 v71, v71, v143
  v_cvt_pk_bf16_f32 v212, v64, v65
  v_cvt_pk_bf16_f32 v213, v66, v67
  v_cvt_pk_bf16_f32 v214, v68, v69
  v_cvt_pk_bf16_f32 v215, v70, v71
  s_mov_b32 s33, 262144
  buffer_store_dwordx4 v[212:215], v9, s[20:23], s33 offen sc1
  s_waitcnt vmcnt(11)
  v_add_f32 v72, v72, v144
  v_add_f32 v73, v73, v145
  v_add_f32 v74, v74, v146
  v_add_f32 v75, v75, v147
  v_add_f32 v76, v76, v148
  v_add_f32 v77, v77, v149
  v_add_f32 v78, v78, v150
  v_add_f32 v79, v79, v151
  v_cvt_pk_bf16_f32 v216, v72, v73
  v_cvt_pk_bf16_f32 v217, v74, v75
  v_cvt_pk_bf16_f32 v218, v76, v77
  v_cvt_pk_bf16_f32 v219, v78, v79
  s_mov_b32 s33, 327680
  buffer_store_dwordx4 v[216:219], v9, s[20:23], s33 offen sc1
  s_waitcnt vmcnt(10)
  v_add_f32 v80, v80, v152
  v_add_f32 v81, v81, v153
  v_add_f32 v82, v82, v154
  v_add_f32 v83, v83, v155
  v_add_f32 v84, v84, v156
  v_add_f32 v85, v85, v157
  v_add_f32 v86, v86, v158
  v_add_f32 v87, v87, v159
  v_cvt_pk_bf16_f32 v208, v80, v81
  v_cvt_pk_bf16_f32 v209, v82, v83
  v_cvt_pk_bf16_f32 v210, v84, v85
  v_cvt_pk_bf16_f32 v211, v86, v87
  s_mov_b32 s33, 393216
  buffer_store_dwordx4 v[208:211], v9, s[20:23], s33 offen sc1
  s_waitcnt vmcnt(9)
  v_add_f32 v88, v88, v160
  v_add_f32 v89, v89, v161
  v_add_f32 v90, v90, v162
  v_add_f32 v91, v91, v163
  v_add_f32 v92, v92, v164
  v_add_f32 v93, v93, v165
  v_add_f32 v94, v94, v166
  v_add_f32 v95, v95, v167
  v_cvt_pk_bf16_f32 v212, v88, v89
  v_cvt_pk_bf16_f32 v213, v90, v91
  v_cvt_pk_bf16_f32 v214, v92, v93
  v_cvt_pk_bf16_f32 v215, v94, v95
  s_mov_b32 s33, 458752
  buffer_store_dwordx4 v[212:215], v9, s[20:23], s33 offen sc1
  s_waitcnt vmcnt(8)
  v_add_f32 v96, v96, v168
  v_add_f32 v97, v97, v169
  v_add_f32 v98, v98, v170
  v_add_f32 v99, v99, v171
  v_add_f32 v100, v100, v172
  v_add_f32 v101, v101, v173
  v_add_f32 v102, v102, v174
  v_add_f32 v103, v103, v175
  v_cvt_pk_bf16_f32 v216, v96, v97
  v_cvt_pk_bf16_f32 v217, v98, v99
  v_cvt_pk_bf16_f32 v218, v100, v101
  v_cvt_pk_bf16_f32 v219, v102, v103
  s_mov_b32 s33, 524288
  buffer_store_dwordx4 v[216:219], v9, s[20:23], s33 offen sc1
oproj_kernel_fin:
oproj_kernel_done:
  s_endpgm
.section .rodata,"a"
.p2align 6
.amdhsa_kernel oproj_kernel
  .amdhsa_next_free_vgpr 512
  .amdhsa_next_free_sgpr 96
  .amdhsa_accum_offset 256
  .amdhsa_group_segment_fixed_size 0
  .amdhsa_kernarg_size 104
  .amdhsa_user_sgpr_count 2
  .amdhsa_user_sgpr_kernarg_segment_ptr 1
  .amdhsa_system_sgpr_workgroup_id_x 1
.end_amdhsa_kernel
.text
```
